```python
import torch

def _softmax(x, axis=-1):
    return torch.softmax(x, dim=axis)
def _gelu(x):
    return torch.nn.functional.gelu(x, approximate="tanh")
def _silu(x):
    return torch.nn.functional.silu(x)
def _sigmoid(x):
    return torch.sigmoid(x)
def _layernorm(x, axis=-1, eps=1e-5):
    m = x.mean(dim=axis, keepdim=True)
    v = x.var(dim=axis, keepdim=True, unbiased=False)
    return (x - m) / torch.sqrt(v + eps)
def _scatter_add(tgt, idx, src, axis=0):
    return tgt.clone().index_add_(axis, idx, src)
def _segment_sum(src, seg, n):
    out = torch.zeros((n,) + src.shape[1:], dtype=src.dtype)
    return out.index_add_(0, seg, src)
def _pad(x, pw):
    flat = tuple(v for pair in reversed(pw) for v in pair)
    return torch.nn.functional.pad(x, flat)

kernel_name = 'recurrent_scan__gqa_block_cached__glu_gated_geglu__prompt'

def setup_inputs():

    _w = (lambda a: (lambda t: t.to(torch.bfloat16) if t.is_floating_point() else t)(torch.as_tensor(a)))
    def _A_setup():
        B, Sq, D = 1, 2048, 576
        Hq, Hkv, Sk, Dh = 32, 16, 2048, 128
        assert Hq % Hkv == 0, (Hq, Hkv)
        return {
            "x": _w((lambda *s: torch.randn(*s, dtype=torch.bfloat16) * 0.05)(B, Sq, D)),
            "k_cache": _w((lambda *s: torch.randn(*s, dtype=torch.bfloat16) * 3.2)(B, Hkv, Sk, Dh)),
            "v_cache": _w((lambda *s: torch.randn(*s, dtype=torch.bfloat16) * 3.2)(B, Hkv, Sk, Dh)),
            "wq": _w((lambda *s: torch.randn(*s, dtype=torch.bfloat16) * 3.2)(D, Hq * Dh) * (D ** -0.5)),
            "wo": _w((lambda *s: torch.randn(*s, dtype=torch.bfloat16) * 3.2)(Hq * Dh, D) * ((Hq * Dh) ** -0.5)),
        }
    _A_in = _A_setup()

    def _B_setup():
        B, S, Dm, Df = 1, 2048, 576, 4608
        return {
            "x": _w((lambda *s: torch.randn(*s, dtype=torch.bfloat16) * 0.05)(B, S, Dm)),
            "w_gate": _w((lambda *s: torch.randn(*s, dtype=torch.bfloat16) * 0.4)(Dm, Df) * (Dm ** -0.5)),
            "w_up": _w((lambda *s: torch.randn(*s, dtype=torch.bfloat16) * 0.4)(Dm, Df) * (Dm ** -0.5)),
            "w_down": _w((lambda *s: torch.randn(*s, dtype=torch.bfloat16) * 0.4)(Df, Dm) * (Df ** -0.5)),
        }
    _B_in = _B_setup()

    return {
        "A_x": _A_in["x"],
        "A_k_cache": _A_in["k_cache"],
        "A_v_cache": _A_in["v_cache"],
        "A_wq": _A_in["wq"],
        "A_wo": _A_in["wo"],
        "B_x": _B_in["x"],
        "B_w_gate": _B_in["w_gate"],
        "B_w_up": _B_in["w_up"],
        "B_w_down": _B_in["w_down"],
    }

def reference(A_x, A_k_cache, A_v_cache, A_wq, A_wo, B_x, B_w_gate, B_w_up, B_w_down):
    def _A_ref(x, k_cache, v_cache, wq, wo):
        B, Sq, D = x.shape
        Hq, Dh = 32, 128
        Hkv = k_cache.shape[1]
        rep = Hq // Hkv
        q = (lambda x, *d: x.permute(*d))((x @ wq).reshape(B, Sq, Hq, Dh), 0, 2, 1, 3)
        k = (lambda x, n, axis: torch.repeat_interleave(x, n, dim=axis))(k_cache, rep, axis=1)
        v = (lambda x, n, axis: torch.repeat_interleave(x, n, dim=axis))(v_cache, rep, axis=1)
        scores = torch.einsum("bhqd,bhkd->bhqk", q, k) * (Dh ** -0.5)
        p = _softmax(scores, axis=-1)
        o = torch.einsum("bhqk,bhkd->bhqd", p, v)
        return (lambda x, *d: x.permute(*d))(o, 0, 2, 1, 3).reshape(B, Sq, Hq * Dh) @ wo

    def _B_ref(x, w_gate, w_up, w_down):
        g = torch.einsum("bsd,df->bsf", x, w_gate)
        u = torch.einsum("bsd,df->bsf", x, w_up)
        h = _gelu(g) * u
        return torch.einsum("bsf,fd->bsd", h, w_down)

    x = A_x
    xn = _layernorm(x, axis=-1)
    s = _A_ref(xn, A_k_cache, A_v_cache, A_wq, A_wo)
    g = _silu(_B_ref(xn, B_w_gate, B_w_up, B_w_down))
    return x + s * g
```

```asm
; @launch grid=(256,1,1) block=(256,1,1) lds=163840
.amdgcn_target "amdgcn-amd-amdhsa--gfx950"
.text
.globl recurrent_scan__gqa_block_cached__glu_gated_geglu__prompt_kernel
.p2align 8
.type recurrent_scan__gqa_block_cached__glu_gated_geglu__prompt_kernel,@function
recurrent_scan__gqa_block_cached__glu_gated_geglu__prompt_kernel:
    s_cmp_ge_u32 s2, 256
    s_cbranch_scc1 done_k1_1
    s_load_dwordx2 s[58:59], s[0:1], 0
    s_getpc_b64 s[4:5]
pc_k1_2:
    s_lshr_b32 s3, s2, 3
    s_lshl_b32 s3, s3, 9
    v_and_b32 v29, 7, v0
    v_min_u32 v29, 5, v29
    v_and_b32 v28, 0xc0, v0
    v_lshlrev_b32 v29, 14, v29
    v_lshl_add_u32 v29, v28, 1, v29
    v_add_u32 v29, s3, v29
    v_mov_b32 v227, s5
    v_add_co_u32 v226, vcc, s4, v29
    s_nop 1
    v_addc_co_u32 v227, vcc, 0, v227, vcc
    global_load_dword v224, v[226:227], off
    s_load_dwordx4 s[60:63], s[0:1], 8
    s_load_dwordx4 s[64:67], s[0:1], 24
    s_load_dwordx4 s[68:71], s[0:1], 48
    s_load_dwordx2 s[72:73], s[0:1], 64
    s_load_dwordx2 s[6:7], s[0:1], 88
    s_load_dwordx2 s[94:95], s[0:1], 80
    v_lshrrev_b32 v28, 6, v0
    v_and_b32 v0, 63, v0
    v_readfirstlane_b32 s32, v28
    v_lshlrev_b32 v1, 4, v0
    v_lshrrev_b32 v28, 3, v0
    s_and_b32 s37, s2, 3
    s_lshl_b32 s37, s37, 3
    s_bfe_u32 s38, s2, 0x30003
    s_add_u32 s53, s37, s38
    s_lshr_b32 s3, s2, 6
    s_and_b32 s37, s2, 4
    s_add_u32 s3, s3, s37
    s_lshl_b32 s3, s3, 4
    s_lshl_b32 s37, s32, 2
    s_add_u32 s3, s3, s37
    s_and_b32 s38, s53, 1
    s_lshl_b32 s38, s38, 1
    s_mul_i32 s33, s32, 40960
    s_mov_b32 s39, 3641
    s_bfe_u32 s52, s53, 0x10001
    s_or_b32 s52, s52, s38
    s_xor_b32 s40, s52, 0
    s_add_u32 s37, s40, s3
    s_mul_i32 s44, s37, 18432
    s_xor_b32 s41, s52, 1
    s_add_u32 s37, s41, s3
    s_mul_i32 s45, s37, 18432
    s_xor_b32 s42, s52, 2
    s_add_u32 s37, s42, s3
    s_mul_i32 s46, s37, 18432
    s_xor_b32 s43, s52, 3
    s_add_u32 s37, s43, s3
    s_mul_i32 s47, s37, 18432
    s_waitcnt lgkmcnt(0)
    s_mov_b32 s24, s58
    s_and_b32 s25, s59, 0xffff
    s_mov_b32 s26, 0x240000
    s_mov_b32 s27, 0x00020000
    v_add_u32 v29, 0, v28
    v_mul_u32_u24 v29, s39, v29
    v_bfe_u32 v29, v29, 16, 3
    v_lshlrev_b32 v29, 4, v29
    v_xor_b32 v8, v29, v1
    s_add_u32 m0, s33, 18432
    s_nop 0
    buffer_load_dwordx4 v8, s[24:27], s44 offen offset:0 lds
    v_add_u32 v29, 8, v28
    v_mul_u32_u24 v29, s39, v29
    v_bfe_u32 v29, v29, 16, 3
    v_lshlrev_b32 v29, 4, v29
    v_xor_b32 v9, v29, v1
    buffer_load_dwordx4 v9, s[24:27], s44 offen offset:1024 lds
    v_add_u32 v29, 16, v28
    v_mul_u32_u24 v29, s39, v29
    v_bfe_u32 v29, v29, 16, 3
    v_lshlrev_b32 v29, 4, v29
    v_xor_b32 v10, v29, v1
    buffer_load_dwordx4 v10, s[24:27], s44 offen offset:2048 lds
    v_add_u32 v29, 24, v28
    v_mul_u32_u24 v29, s39, v29
    v_bfe_u32 v29, v29, 16, 3
    v_lshlrev_b32 v29, 4, v29
    v_xor_b32 v11, v29, v1
    buffer_load_dwordx4 v11, s[24:27], s44 offen offset:3072 lds
    v_add_u32 v29, 32, v28
    v_mul_u32_u24 v29, s39, v29
    v_bfe_u32 v29, v29, 16, 3
    v_lshlrev_b32 v29, 4, v29
    v_xor_b32 v12, v29, v1
    s_add_u32 m0, s33, 22528
    s_add_u32 s44, s44, 4096
    buffer_load_dwordx4 v12, s[24:27], s44 offen offset:0 lds
    v_add_u32 v29, 40, v28
    v_mul_u32_u24 v29, s39, v29
    v_bfe_u32 v29, v29, 16, 3
    v_lshlrev_b32 v29, 4, v29
    v_xor_b32 v13, v29, v1
    buffer_load_dwordx4 v13, s[24:27], s44 offen offset:1024 lds
    v_add_u32 v29, 48, v28
    v_mul_u32_u24 v29, s39, v29
    v_bfe_u32 v29, v29, 16, 3
    v_lshlrev_b32 v29, 4, v29
    v_xor_b32 v14, v29, v1
    buffer_load_dwordx4 v14, s[24:27], s44 offen offset:2048 lds
    v_add_u32 v29, 56, v28
    v_mul_u32_u24 v29, s39, v29
    v_bfe_u32 v29, v29, 16, 3
    v_lshlrev_b32 v29, 4, v29
    v_xor_b32 v15, v29, v1
    buffer_load_dwordx4 v15, s[24:27], s44 offen offset:3072 lds
    v_add_u32 v29, 64, v28
    v_mul_u32_u24 v29, s39, v29
    v_bfe_u32 v29, v29, 16, 3
    v_lshlrev_b32 v29, 4, v29
    v_xor_b32 v16, v29, v1
    v_add_u32 v29, 72, v28
    v_mul_u32_u24 v29, s39, v29
    v_bfe_u32 v29, v29, 16, 3
    v_lshlrev_b32 v29, 4, v29
    v_xor_b32 v17, v29, v1
    v_add_u32 v29, 80, v28
    v_mul_u32_u24 v29, s39, v29
    v_bfe_u32 v29, v29, 16, 3
    v_lshlrev_b32 v29, 4, v29
    v_xor_b32 v18, v29, v1
    v_add_u32 v29, 88, v28
    v_mul_u32_u24 v29, s39, v29
    v_bfe_u32 v29, v29, 16, 3
    v_lshlrev_b32 v29, 4, v29
    v_xor_b32 v19, v29, v1
    v_add_u32 v29, 96, v28
    v_mul_u32_u24 v29, s39, v29
    v_bfe_u32 v29, v29, 16, 3
    v_lshlrev_b32 v29, 4, v29
    v_xor_b32 v20, v29, v1
    v_add_u32 v29, 104, v28
    v_mul_u32_u24 v29, s39, v29
    v_bfe_u32 v29, v29, 16, 3
    v_lshlrev_b32 v29, 4, v29
    v_xor_b32 v21, v29, v1
    v_add_u32 v29, 112, v28
    v_mul_u32_u24 v29, s39, v29
    v_bfe_u32 v29, v29, 16, 3
    v_lshlrev_b32 v29, 4, v29
    v_xor_b32 v22, v29, v1
    v_add_u32 v29, 120, v28
    v_mul_u32_u24 v29, s39, v29
    v_bfe_u32 v29, v29, 16, 3
    v_lshlrev_b32 v29, 4, v29
    v_xor_b32 v23, v29, v1
    v_add_u32 v29, 128, v28
    v_mul_u32_u24 v29, s39, v29
    v_bfe_u32 v29, v29, 16, 3
    v_lshlrev_b32 v29, 4, v29
    v_xor_b32 v24, v29, v1
    v_add_u32 v29, 136, v28
    v_mul_u32_u24 v29, s39, v29
    v_bfe_u32 v29, v29, 16, 3
    v_lshlrev_b32 v29, 4, v29
    v_xor_b32 v25, v29, v1
    s_mul_i32 s52, s3, 278528
    s_lshl_b32 s40, s40, 10
    s_add_u32 s40, s40, s52
    s_lshl_b32 s41, s41, 10
    s_add_u32 s41, s41, s52
    s_lshl_b32 s42, s42, 10
    s_add_u32 s42, s42, s52
    s_lshl_b32 s43, s43, 10
    s_add_u32 s43, s43, s52
    s_lshr_b32 s37, s53, 1
    s_mul_i32 s34, s37, 576
    s_and_b32 s37, s37, 1
    s_xor_b32 s35, s37, 1
    s_lshl_b32 s35, s35, 9
    s_add_u32 s35, s35, s34
    s_lshl_b32 s37, s37, 6
    s_add_u32 s34, s34, s37
    s_lshl_b32 s38, s38, 7
    s_add_u32 s34, s34, s38
    s_lshl_b32 s36, s53, 8
    s_bitcmp1_b32 s32, 0
    s_cselect_b32 s68, s70, s68
    s_cselect_b32 s69, s71, s69
    s_mov_b32 s8, s68
    s_and_b32 s9, s69, 0xffff
    s_mov_b32 s10, 0x510000
    s_mov_b32 s11, 0x00020000
    s_mov_b32 s12, s64
    s_and_b32 s13, s65, 0xffff
    s_mov_b32 s14, 0x480000
    s_mov_b32 s15, 0x00020000
    v_lshrrev_b32 v28, 4, v0
    v_bfe_u32 v29, v0, 2, 2
    v_and_b32 v30, 3, v0
    v_lshl_add_u32 v31, v28, 3, v29
    s_lshr_b32 s37, s32, 1
    s_lshl_b32 s37, s37, 2
    v_add_u32 v31, s37, v31
    v_mul_u32_u24 v2, 9216, v31
    v_and_b32 v31, 1, v28
    v_lshlrev_b32 v31, 5, v31
    v_lshlrev_b32 v35, 4, v30
    v_xor_b32 v35, v35, v31
    v_add_u32 v2, v2, v35
    v_lshrrev_b32 v35, 2, v0
    v_lshl_add_u32 v31, v35, 6, v31
    v_lshl_add_u32 v4, v30, 3, v31
    v_xor_b32 v5, 32, v4
    v_lshrrev_b32 v31, 3, v0
    s_lshl_b32 s37, s32, 3
    v_add_u32 v31, s37, v31
    v_lshlrev_b32 v31, 13, v31
    v_and_b32 v35, 1, v28
    v_lshlrev_b32 v35, 6, v35
    v_and_b32 v3, 0x70, v1
    v_xor_b32 v3, v3, v35
    v_add_u32 v3, v3, v31
    v_mul_u32_u24 v31, 40960, v28
    v_lshl_add_u32 v31, v29, 7, v31
    v_lshl_add_u32 v31, v30, 4, v31
    v_lshrrev_b32 v35, 1, v29
    v_lshl_add_u32 v6, v35, 6, v31
    v_xor_b32 v7, 64, v6
    s_lshl_b32 s37, s32, 2
    v_add_u32 v31, s37, v28
    v_and_b32 v35, 15, v0
    v_xor_b32 v36, v31, v35
    v_lshlrev_b32 v36, 4, v36
    v_lshl_add_u32 v36, v31, 8, v36
    v_and_b32 v37, 7, v31
    v_lshlrev_b32 v37, 1, v37
    v_xor_b32 v37, v37, v35
    v_lshlrev_b32 v37, 4, v37
    v_lshl_add_u32 v37, v31, 8, v37
    v_mul_u32_u24 v31, 1152, v35
    v_add_u32 v31, s33, v31
    v_lshrrev_b32 v35, 1, v35
    v_xor_b32 v35, v35, v28
    v_lshl_add_u32 v26, v35, 4, v31
    v_xor_b32 v35, 4, v35
    v_lshl_add_u32 v27, v35, 4, v31
    v_cmp_eq_u32 s[84:85], 1, v30
    v_cmp_eq_u32 s[86:87], 2, v30
    v_cmp_eq_u32 s[88:89], 3, v30
    v_cmp_eq_u32 s[90:91], v28, v29
    s_add_u32 s28, s6, 0x400000
    s_addc_u32 s29, s7, 0
    s_and_b32 s29, s29, 0xffff
    s_mov_b32 s30, 0x6500000
    s_mov_b32 s31, 0x00020000
    s_lshr_b32 s37, s53, 1
    s_lshl_b32 s37, s37, 19
    s_add_u32 s16, s60, s37
    s_addc_u32 s17, s61, 0
    s_and_b32 s17, s17, 0xffff
    s_mov_b32 s18, 0x80000
    s_mov_b32 s19, 0x00020000
    s_sub_u32 s62, s62, 2048
    s_subb_u32 s63, s63, 0
    s_add_u32 s20, s62, s37
    s_addc_u32 s21, s63, 0
    s_and_b32 s21, s21, 0xffff
    s_mov_b32 s22, 0x80800
    s_mov_b32 s23, 0x00020000
    s_cmp_lt_u32 s2, 128
    s_cselect_b32 s66, s66, s72
    s_cselect_b32 s67, s67, s73
    s_cselect_b32 s37, 0, 589824
    s_mov_b32 s76, s66
    s_and_b32 s77, s67, 0xffff
    s_mov_b32 s78, 0x0
    s_mov_b32 s79, 0x00020000
    s_add_u32 s78, s37, 4718592
    s_add_u32 s80, s6, 0x4000000
    s_addc_u32 s81, s7, 0
    s_and_b32 s81, s81, 0xffff
    s_mov_b32 s82, 0x990000
    s_mov_b32 s83, 0x00020000
    v_mov_b32 v220, 0x3f803f80
    v_mov_b32 v221, 0x3f803f80
    v_mov_b32 v222, 0x3f803f80
    v_mov_b32 v223, 0x3f803f80
    v_and_b32 v39, 1, v0
    v_lshlrev_b32 v39, 4, v39
    v_mov_b32 v38, 0x3f80
    v_lshlrev_b32 v39, v39, v38
    v_cndmask_b32 v39, 0, v39, s[90:91]
    v_and_b32 v38, 2, v0
    v_cmp_eq_u32 vcc, 0, v38
    v_mov_b32 v30, 0
    v_mov_b32 v31, 0
    v_mov_b32 v32, 0
    v_mov_b32 v33, 0
    v_cndmask_b32 v28, 0, v39, vcc
    v_cndmask_b32 v29, v39, 0, vcc
    v_mov_b32 v34, v28
    v_mov_b32 v35, v29
    v_mov_b32 v38, v4
    v_lshrrev_b32 v39, 5, v0
    v_bfe_u32 v5, v0, 3, 2
    v_lshl_add_u32 v39, v39, 3, v5
    s_lshr_b32 s37, s32, 1
    s_lshl_b32 s37, s37, 2
    v_add_u32 v39, s37, v39
    v_mul_u32_u24 v39, 9216, v39
    v_and_b32 v4, 3, v0
    v_lshlrev_b32 v4, 3, v4
    v_lshl_add_u32 v4, v5, 5, v4
    v_lshrrev_b32 v5, 2, v0
    v_lshl_add_u32 v4, v5, 7, v4
    v_and_b32 v5, 0x30, v0
    v_lshlrev_b32 v5, 1, v5
    v_xor_b32 v5, v5, v1
    v_and_b32 v5, 0x70, v5
    v_add_u32 v39, v39, v5
    v_xor_b32 v5, 32, v4
    s_add_u32 m0, s33, 26624
    s_add_u32 s44, s44, 4096
    buffer_load_dwordx4 v16, s[24:27], s44 offen offset:0 lds
    buffer_load_dwordx4 v17, s[24:27], s44 offen offset:1024 lds
    buffer_load_dwordx4 v18, s[24:27], s44 offen offset:2048 lds
    buffer_load_dwordx4 v19, s[24:27], s44 offen offset:3072 lds
    s_add_u32 m0, s33, 30720
    s_add_u32 s44, s44, 4096
    buffer_load_dwordx4 v20, s[24:27], s44 offen offset:0 lds
    buffer_load_dwordx4 v21, s[24:27], s44 offen offset:1024 lds
    buffer_load_dwordx4 v22, s[24:27], s44 offen offset:2048 lds
    buffer_load_dwordx4 v23, s[24:27], s44 offen offset:3072 lds
    s_add_u32 m0, s33, 34816
    s_add_u32 s44, s44, 4096
    buffer_load_dwordx4 v24, s[24:27], s44 offen offset:0 lds
    buffer_load_dwordx4 v25, s[24:27], s44 offen offset:1024 lds
    s_add_u32 m0, s33, 0
    s_nop 0
    buffer_load_dwordx4 v8, s[24:27], s45 offen offset:0 lds
    buffer_load_dwordx4 v9, s[24:27], s45 offen offset:1024 lds
    buffer_load_dwordx4 v10, s[24:27], s45 offen offset:2048 lds
    buffer_load_dwordx4 v11, s[24:27], s45 offen offset:3072 lds
    s_add_u32 m0, s33, 4096
    s_add_u32 s45, s45, 4096
    buffer_load_dwordx4 v12, s[24:27], s45 offen offset:0 lds
    buffer_load_dwordx4 v13, s[24:27], s45 offen offset:1024 lds
    buffer_load_dwordx4 v14, s[24:27], s45 offen offset:2048 lds
    buffer_load_dwordx4 v15, s[24:27], s45 offen offset:3072 lds
    s_waitcnt vmcnt(8)
    ds_read_b128 v[40:43], v26 offset:18432
    ds_read_b128 v[44:47], v27 offset:18432
    ds_read_b128 v[48:51], v26 offset:18560
    ds_read_b128 v[52:55], v27 offset:18560
    ds_read_b128 v[56:59], v26 offset:18688
    ds_read_b128 v[60:63], v27 offset:18688
    ds_read_b128 v[64:67], v26 offset:18816
    ds_read_b128 v[68:71], v27 offset:18816
    ds_read_b128 v[72:75], v26 offset:18944
    ds_read_b128 v[76:79], v27 offset:18944
    ds_read_b128 v[80:83], v26 offset:19072
    ds_read_b128 v[84:87], v27 offset:19072
    ds_read_b128 v[88:91], v26 offset:19200
    ds_read_b128 v[92:95], v27 offset:19200
    ds_read_b128 v[96:99], v26 offset:19328
    ds_read_b128 v[100:103], v27 offset:19328
    ds_read_b128 v[104:107], v26 offset:19456
    ds_read_b128 v[108:111], v27 offset:19456
    s_add_u32 m0, s33, 8192
    s_waitcnt lgkmcnt(15)
    v_mfma_f32_16x16x32_bf16 v[184:187], v[220:223], v[40:43], 0
    s_add_u32 s45, s45, 4096
    v_mfma_f32_16x16x32_bf16 v[184:187], v[220:223], v[44:47], v[184:187]
    buffer_load_dwordx4 v16, s[24:27], s45 offen offset:0 lds
    v_mfma_f32_16x16x32_bf16 v[184:187], v[220:223], v[48:51], v[184:187]
    buffer_load_dwordx4 v17, s[24:27], s45 offen offset:1024 lds
    s_waitcnt lgkmcnt(14)
    v_mfma_f32_16x16x32_bf16 v[184:187], v[220:223], v[52:55], v[184:187]
    buffer_load_dwordx4 v18, s[24:27], s45 offen offset:2048 lds
    s_waitcnt lgkmcnt(13)
    v_mfma_f32_16x16x32_bf16 v[184:187], v[220:223], v[56:59], v[184:187]
    buffer_load_dwordx4 v19, s[24:27], s45 offen offset:3072 lds
    s_waitcnt lgkmcnt(12)
    v_mfma_f32_16x16x32_bf16 v[184:187], v[220:223], v[60:63], v[184:187]
    s_add_u32 m0, s33, 12288
    s_waitcnt lgkmcnt(11)
    v_mfma_f32_16x16x32_bf16 v[184:187], v[220:223], v[64:67], v[184:187]
    s_add_u32 s45, s45, 4096
    s_waitcnt lgkmcnt(10)
    v_mfma_f32_16x16x32_bf16 v[184:187], v[220:223], v[68:71], v[184:187]
    buffer_load_dwordx4 v20, s[24:27], s45 offen offset:0 lds
    s_waitcnt lgkmcnt(9)
    v_mfma_f32_16x16x32_bf16 v[184:187], v[220:223], v[72:75], v[184:187]
    buffer_load_dwordx4 v21, s[24:27], s45 offen offset:1024 lds
    s_waitcnt lgkmcnt(8)
    v_mfma_f32_16x16x32_bf16 v[184:187], v[220:223], v[76:79], v[184:187]
    buffer_load_dwordx4 v22, s[24:27], s45 offen offset:2048 lds
    s_waitcnt lgkmcnt(7)
    v_mfma_f32_16x16x32_bf16 v[184:187], v[220:223], v[80:83], v[184:187]
    buffer_load_dwordx4 v23, s[24:27], s45 offen offset:3072 lds
    s_waitcnt lgkmcnt(6)
    v_mfma_f32_16x16x32_bf16 v[184:187], v[220:223], v[84:87], v[184:187]
    s_add_u32 m0, s33, 16384
    s_waitcnt lgkmcnt(5)
    v_mfma_f32_16x16x32_bf16 v[184:187], v[220:223], v[88:91], v[184:187]
    s_add_u32 s45, s45, 4096
    s_waitcnt lgkmcnt(4)
    v_mfma_f32_16x16x32_bf16 v[184:187], v[220:223], v[92:95], v[184:187]
    buffer_load_dwordx4 v24, s[24:27], s45 offen offset:0 lds
    s_waitcnt lgkmcnt(3)
    v_mfma_f32_16x16x32_bf16 v[184:187], v[220:223], v[96:99], v[184:187]
    buffer_load_dwordx4 v25, s[24:27], s45 offen offset:1024 lds
    s_waitcnt lgkmcnt(2)
    v_mfma_f32_16x16x32_bf16 v[184:187], v[220:223], v[100:103], v[184:187]
    s_waitcnt lgkmcnt(0)
    v_mfma_f32_16x16x32_bf16 v[184:187], v[220:223], v[104:107], v[184:187]
    s_add_u32 m0, s33, 18432
    v_mfma_f32_16x16x32_bf16 v[184:187], v[220:223], v[108:111], v[184:187]
    s_nop 7
    v_mul_f32 v184, 0xbae38e39, v184
    v_mul_f32 v185, 0xbae38e39, v185
    v_mul_f32 v186, 0xbae38e39, v186
    v_mul_f32 v187, 0xbae38e39, v187
    s_nop 1
    v_mfma_f32_16x16x32_bf16 v[204:207], v[28:31], v[40:43], v[184:187]
    buffer_load_dwordx4 v8, s[24:27], s46 offen offset:0 lds
    v_mfma_f32_16x16x32_bf16 v[208:211], v[32:35], v[40:43], v[184:187]
    buffer_load_dwordx4 v9, s[24:27], s46 offen offset:1024 lds
    v_mfma_f32_16x16x32_bf16 v[212:215], v[28:31], v[44:47], v[184:187]
    buffer_load_dwordx4 v10, s[24:27], s46 offen offset:2048 lds
    v_mfma_f32_16x16x32_bf16 v[216:219], v[32:35], v[44:47], v[184:187]
    buffer_load_dwordx4 v11, s[24:27], s46 offen offset:3072 lds
    s_nop 0
    v_cvt_pk_bf16_f32 v40, v204, v205
    v_cvt_pk_bf16_f32 v41, v206, v207
    v_mfma_f32_16x16x32_bf16 v[204:207], v[28:31], v[48:51], v[184:187]
    s_add_u32 m0, s33, 22528
    v_cvt_pk_bf16_f32 v42, v208, v209
    v_cvt_pk_bf16_f32 v43, v210, v211
    v_mfma_f32_16x16x32_bf16 v[208:211], v[32:35], v[48:51], v[184:187]
    s_add_u32 s46, s46, 4096
    v_cvt_pk_bf16_f32 v44, v212, v213
    v_cvt_pk_bf16_f32 v45, v214, v215
    v_mfma_f32_16x16x32_bf16 v[212:215], v[28:31], v[52:55], v[184:187]
    v_cvt_pk_bf16_f32 v46, v216, v217
    v_cvt_pk_bf16_f32 v47, v218, v219
    v_mfma_f32_16x16x32_bf16 v[216:219], v[32:35], v[52:55], v[184:187]
    buffer_load_dwordx4 v12, s[24:27], s46 offen offset:0 lds
    v_cvt_pk_bf16_f32 v48, v204, v205
    v_cvt_pk_bf16_f32 v49, v206, v207
    v_mfma_f32_16x16x32_bf16 v[204:207], v[28:31], v[56:59], v[184:187]
    buffer_load_dwordx4 v13, s[24:27], s46 offen offset:1024 lds
    v_cvt_pk_bf16_f32 v50, v208, v209
    v_cvt_pk_bf16_f32 v51, v210, v211
    v_mfma_f32_16x16x32_bf16 v[208:211], v[32:35], v[56:59], v[184:187]
    buffer_load_dwordx4 v14, s[24:27], s46 offen offset:2048 lds
    v_cvt_pk_bf16_f32 v52, v212, v213
    v_cvt_pk_bf16_f32 v53, v214, v215
    v_mfma_f32_16x16x32_bf16 v[212:215], v[28:31], v[60:63], v[184:187]
    buffer_load_dwordx4 v15, s[24:27], s46 offen offset:3072 lds
    v_cvt_pk_bf16_f32 v54, v216, v217
    v_cvt_pk_bf16_f32 v55, v218, v219
    v_mfma_f32_16x16x32_bf16 v[216:219], v[32:35], v[60:63], v[184:187]
    s_add_u32 m0, s33, 26624
    v_accvgpr_write_b32 a0, v40
    v_accvgpr_write_b32 a1, v41
    v_cvt_pk_bf16_f32 v56, v204, v205
    v_cvt_pk_bf16_f32 v57, v206, v207
    v_mfma_f32_16x16x32_bf16 v[204:207], v[28:31], v[64:67], v[184:187]
    s_add_u32 s46, s46, 4096
    v_accvgpr_write_b32 a2, v42
    v_accvgpr_write_b32 a3, v43
    v_cvt_pk_bf16_f32 v58, v208, v209
    v_cvt_pk_bf16_f32 v59, v210, v211
    v_mfma_f32_16x16x32_bf16 v[208:211], v[32:35], v[64:67], v[184:187]
    buffer_load_dwordx4 v16, s[24:27], s46 offen offset:0 lds
    v_cvt_pk_bf16_f32 v60, v212, v213
    v_cvt_pk_bf16_f32 v61, v214, v215
    v_mfma_f32_16x16x32_bf16 v[212:215], v[28:31], v[68:71], v[184:187]
    v_accvgpr_write_b32 a16, v44
    v_accvgpr_write_b32 a17, v45
    v_cvt_pk_bf16_f32 v62, v216, v217
    v_cvt_pk_bf16_f32 v63, v218, v219
    v_mfma_f32_16x16x32_bf16 v[216:219], v[32:35], v[68:71], v[184:187]
    buffer_load_dwordx4 v17, s[24:27], s46 offen offset:1024 lds
    v_cvt_pk_bf16_f32 v64, v204, v205
    v_cvt_pk_bf16_f32 v65, v206, v207
    v_mfma_f32_16x16x32_bf16 v[204:207], v[28:31], v[72:75], v[184:187]
    buffer_load_dwordx4 v18, s[24:27], s46 offen offset:2048 lds
    v_cvt_pk_bf16_f32 v66, v208, v209
    v_cvt_pk_bf16_f32 v67, v210, v211
    v_mfma_f32_16x16x32_bf16 v[208:211], v[32:35], v[72:75], v[184:187]
    buffer_load_dwordx4 v19, s[24:27], s46 offen offset:3072 lds
    v_cvt_pk_bf16_f32 v68, v212, v213
    v_cvt_pk_bf16_f32 v69, v214, v215
    v_mfma_f32_16x16x32_bf16 v[212:215], v[28:31], v[76:79], v[184:187]
    s_add_u32 m0, s33, 30720
    v_accvgpr_write_b32 a18, v46
    v_accvgpr_write_b32 a19, v47
    v_cvt_pk_bf16_f32 v70, v216, v217
    v_cvt_pk_bf16_f32 v71, v218, v219
    v_mfma_f32_16x16x32_bf16 v[216:219], v[32:35], v[76:79], v[184:187]
    s_add_u32 s46, s46, 4096
    v_accvgpr_write_b32 a32, v48
    v_accvgpr_write_b32 a33, v49
    v_cvt_pk_bf16_f32 v72, v204, v205
    v_cvt_pk_bf16_f32 v73, v206, v207
    v_mfma_f32_16x16x32_bf16 v[204:207], v[28:31], v[80:83], v[184:187]
    buffer_load_dwordx4 v20, s[24:27], s46 offen offset:0 lds
    v_cvt_pk_bf16_f32 v74, v208, v209
    v_cvt_pk_bf16_f32 v75, v210, v211
    v_mfma_f32_16x16x32_bf16 v[208:211], v[32:35], v[80:83], v[184:187]
    buffer_load_dwordx4 v21, s[24:27], s46 offen offset:1024 lds
    v_cvt_pk_bf16_f32 v76, v212, v213
    v_cvt_pk_bf16_f32 v77, v214, v215
    v_mfma_f32_16x16x32_bf16 v[212:215], v[28:31], v[84:87], v[184:187]
    v_accvgpr_write_b32 a34, v50
    v_accvgpr_write_b32 a35, v51
    v_cvt_pk_bf16_f32 v78, v216, v217
    v_cvt_pk_bf16_f32 v79, v218, v219
    v_mfma_f32_16x16x32_bf16 v[216:219], v[32:35], v[84:87], v[184:187]
    buffer_load_dwordx4 v22, s[24:27], s46 offen offset:2048 lds
    v_cvt_pk_bf16_f32 v80, v204, v205
    v_cvt_pk_bf16_f32 v81, v206, v207
    v_mfma_f32_16x16x32_bf16 v[204:207], v[28:31], v[88:91], v[184:187]
    buffer_load_dwordx4 v23, s[24:27], s46 offen offset:3072 lds
    v_cvt_pk_bf16_f32 v82, v208, v209
    v_cvt_pk_bf16_f32 v83, v210, v211
    v_mfma_f32_16x16x32_bf16 v[208:211], v[32:35], v[88:91], v[184:187]
    s_add_u32 m0, s33, 34816
    v_accvgpr_write_b32 a48, v52
    v_accvgpr_write_b32 a49, v53
    v_cvt_pk_bf16_f32 v84, v212, v213
    v_cvt_pk_bf16_f32 v85, v214, v215
    v_mfma_f32_16x16x32_bf16 v[212:215], v[28:31], v[92:95], v[184:187]
    s_add_u32 s46, s46, 4096
    v_accvgpr_write_b32 a50, v54
    v_accvgpr_write_b32 a51, v55
    v_cvt_pk_bf16_f32 v86, v216, v217
    v_cvt_pk_bf16_f32 v87, v218, v219
    v_mfma_f32_16x16x32_bf16 v[216:219], v[32:35], v[92:95], v[184:187]
    buffer_load_dwordx4 v24, s[24:27], s46 offen offset:0 lds
    v_cvt_pk_bf16_f32 v88, v204, v205
    v_cvt_pk_bf16_f32 v89, v206, v207
    v_mfma_f32_16x16x32_bf16 v[204:207], v[28:31], v[96:99], v[184:187]
    buffer_load_dwordx4 v25, s[24:27], s46 offen offset:1024 lds
    v_cvt_pk_bf16_f32 v90, v208, v209
    v_cvt_pk_bf16_f32 v91, v210, v211
    v_mfma_f32_16x16x32_bf16 v[208:211], v[32:35], v[96:99], v[184:187]
    s_waitcnt vmcnt(18)
    ds_read_b128 v[112:115], v26 offset:0
    ds_read_b128 v[116:119], v27 offset:0
    v_cvt_pk_bf16_f32 v92, v212, v213
    v_cvt_pk_bf16_f32 v93, v214, v215
    v_mfma_f32_16x16x32_bf16 v[212:215], v[28:31], v[100:103], v[184:187]
    ds_read_b128 v[120:123], v26 offset:128
    ds_read_b128 v[124:127], v27 offset:128
    v_cvt_pk_bf16_f32 v94, v216, v217
    v_cvt_pk_bf16_f32 v95, v218, v219
    v_mfma_f32_16x16x32_bf16 v[216:219], v[32:35], v[100:103], v[184:187]
    ds_read_b128 v[128:131], v26 offset:256
    ds_read_b128 v[132:135], v27 offset:256
    v_cvt_pk_bf16_f32 v96, v204, v205
    v_cvt_pk_bf16_f32 v97, v206, v207
    v_mfma_f32_16x16x32_bf16 v[204:207], v[28:31], v[104:107], v[184:187]
    ds_read_b128 v[136:139], v26 offset:384
    ds_read_b128 v[140:143], v27 offset:384
    v_cvt_pk_bf16_f32 v98, v208, v209
    v_cvt_pk_bf16_f32 v99, v210, v211
    v_mfma_f32_16x16x32_bf16 v[208:211], v[32:35], v[104:107], v[184:187]
    ds_read_b128 v[144:147], v26 offset:512
    ds_read_b128 v[148:151], v27 offset:512
    v_cvt_pk_bf16_f32 v100, v212, v213
    v_cvt_pk_bf16_f32 v101, v214, v215
    v_mfma_f32_16x16x32_bf16 v[212:215], v[28:31], v[108:111], v[184:187]
    ds_read_b128 v[152:155], v26 offset:640
    ds_read_b128 v[156:159], v27 offset:640
    v_cvt_pk_bf16_f32 v102, v216, v217
    v_cvt_pk_bf16_f32 v103, v218, v219
    v_mfma_f32_16x16x32_bf16 v[216:219], v[32:35], v[108:111], v[184:187]
    ds_read_b128 v[160:163], v26 offset:768
    ds_read_b128 v[164:167], v27 offset:768
    s_waitcnt lgkmcnt(13)
    v_mfma_f32_16x16x32_bf16 v[184:187], v[220:223], v[112:115], 0
    ds_read_b128 v[168:171], v26 offset:896
    ds_read_b128 v[172:175], v27 offset:896
    s_waitcnt lgkmcnt(14)
    v_mfma_f32_16x16x32_bf16 v[184:187], v[220:223], v[116:119], v[184:187]
    ds_read_b128 v[176:179], v26 offset:1024
    ds_read_b128 v[180:183], v27 offset:1024
    s_waitcnt lgkmcnt(15)
    v_mfma_f32_16x16x32_bf16 v[184:187], v[220:223], v[120:123], v[184:187]
    v_accvgpr_write_b32 a64, v56
    v_accvgpr_write_b32 a65, v57
    s_waitcnt lgkmcnt(14)
    v_mfma_f32_16x16x32_bf16 v[184:187], v[220:223], v[124:127], v[184:187]
    v_accvgpr_write_b32 a66, v58
    v_accvgpr_write_b32 a67, v59
    s_waitcnt lgkmcnt(13)
    v_mfma_f32_16x16x32_bf16 v[184:187], v[220:223], v[128:131], v[184:187]
    v_accvgpr_write_b32 a80, v60
    v_accvgpr_write_b32 a81, v61
    s_waitcnt lgkmcnt(12)
    v_mfma_f32_16x16x32_bf16 v[184:187], v[220:223], v[132:135], v[184:187]
    v_accvgpr_write_b32 a82, v62
    v_accvgpr_write_b32 a83, v63
    s_waitcnt lgkmcnt(11)
    v_mfma_f32_16x16x32_bf16 v[184:187], v[220:223], v[136:139], v[184:187]
    v_accvgpr_write_b32 a96, v64
    v_accvgpr_write_b32 a97, v65
    s_waitcnt lgkmcnt(10)
    v_mfma_f32_16x16x32_bf16 v[184:187], v[220:223], v[140:143], v[184:187]
    v_accvgpr_write_b32 a98, v66
    v_accvgpr_write_b32 a99, v67
    s_waitcnt lgkmcnt(9)
    v_mfma_f32_16x16x32_bf16 v[184:187], v[220:223], v[144:147], v[184:187]
    v_accvgpr_write_b32 a112, v68
    v_accvgpr_write_b32 a113, v69
    s_waitcnt lgkmcnt(8)
    v_mfma_f32_16x16x32_bf16 v[184:187], v[220:223], v[148:151], v[184:187]
    v_accvgpr_write_b32 a114, v70
    v_accvgpr_write_b32 a115, v71
    s_waitcnt lgkmcnt(7)
    v_mfma_f32_16x16x32_bf16 v[184:187], v[220:223], v[152:155], v[184:187]
    v_accvgpr_write_b32 a128, v72
    v_accvgpr_write_b32 a129, v73
    s_waitcnt lgkmcnt(6)
    v_mfma_f32_16x16x32_bf16 v[184:187], v[220:223], v[156:159], v[184:187]
    v_accvgpr_write_b32 a130, v74
    v_accvgpr_write_b32 a131, v75
    s_waitcnt lgkmcnt(5)
    v_mfma_f32_16x16x32_bf16 v[184:187], v[220:223], v[160:163], v[184:187]
    v_cvt_pk_bf16_f32 v224, v204, v205
    v_cvt_pk_bf16_f32 v225, v206, v207
    s_waitcnt lgkmcnt(4)
    v_mfma_f32_16x16x32_bf16 v[184:187], v[220:223], v[164:167], v[184:187]
    v_cvt_pk_bf16_f32 v226, v208, v209
    v_cvt_pk_bf16_f32 v227, v210, v211
    s_waitcnt lgkmcnt(3)
    v_mfma_f32_16x16x32_bf16 v[184:187], v[220:223], v[168:171], v[184:187]
    v_accvgpr_write_b32 a144, v76
    v_accvgpr_write_b32 a145, v77
    s_waitcnt lgkmcnt(2)
    v_mfma_f32_16x16x32_bf16 v[184:187], v[220:223], v[172:175], v[184:187]
    s_waitcnt lgkmcnt(0)
    v_accvgpr_write_b32 a146, v78
    v_accvgpr_write_b32 a147, v79
    v_mfma_f32_16x16x32_bf16 v[184:187], v[220:223], v[176:179], v[184:187]
    s_add_u32 m0, s33, 0
    v_cvt_pk_bf16_f32 v240, v212, v213
    v_cvt_pk_bf16_f32 v241, v214, v215
    v_mfma_f32_16x16x32_bf16 v[184:187], v[220:223], v[180:183], v[184:187]
    v_cvt_pk_bf16_f32 v242, v216, v217
    v_cvt_pk_bf16_f32 v243, v218, v219
    v_mfma_f32_16x16x32_bf16 v[188:191], a[0:3], a[0:3], 0
    buffer_load_dwordx4 v8, s[24:27], s47 offen offset:0 lds
    v_mfma_f32_16x16x32_bf16 v[188:191], a[16:19], a[16:19], v[188:191]
    buffer_load_dwordx4 v9, s[24:27], s47 offen offset:1024 lds
    v_mfma_f32_16x16x32_bf16 v[188:191], a[32:35], a[32:35], v[188:191]
    buffer_load_dwordx4 v10, s[24:27], s47 offen offset:2048 lds
    v_mfma_f32_16x16x32_bf16 v[188:191], a[48:51], a[48:51], v[188:191]
    buffer_load_dwordx4 v11, s[24:27], s47 offen offset:3072 lds
    v_mfma_f32_16x16x32_bf16 v[188:191], a[64:67], a[64:67], v[188:191]
    s_add_u32 m0, s33, 4096
    v_accvgpr_write_b32 a160, v80
    v_accvgpr_write_b32 a161, v81
    v_mfma_f32_16x16x32_bf16 v[188:191], a[80:83], a[80:83], v[188:191]
    s_add_u32 s47, s47, 4096
    v_accvgpr_write_b32 a162, v82
    v_accvgpr_write_b32 a163, v83
    v_mfma_f32_16x16x32_bf16 v[188:191], a[96:99], a[96:99], v[188:191]
    v_accvgpr_write_b32 a176, v84
    v_accvgpr_write_b32 a177, v85
    v_mfma_f32_16x16x32_bf16 v[188:191], a[112:115], a[112:115], v[188:191]
    buffer_load_dwordx4 v12, s[24:27], s47 offen offset:0 lds
    v_mfma_f32_16x16x32_bf16 v[188:191], a[128:131], a[128:131], v[188:191]
    buffer_load_dwordx4 v13, s[24:27], s47 offen offset:1024 lds
    v_mfma_f32_16x16x32_bf16 v[188:191], a[144:147], a[144:147], v[188:191]
    buffer_load_dwordx4 v14, s[24:27], s47 offen offset:2048 lds
    v_mfma_f32_16x16x32_bf16 v[188:191], a[160:163], a[160:163], v[188:191]
    buffer_load_dwordx4 v15, s[24:27], s47 offen offset:3072 lds
    v_accvgpr_write_b32 a178, v86
    v_accvgpr_write_b32 a179, v87
    v_accvgpr_write_b32 a192, v88
    v_accvgpr_write_b32 a193, v89
    v_mfma_f32_16x16x32_bf16 v[188:191], a[176:179], a[176:179], v[188:191]
    s_add_u32 m0, s33, 8192
    v_accvgpr_write_b32 a194, v90
    v_accvgpr_write_b32 a195, v91
    v_accvgpr_write_b32 a208, v92
    v_accvgpr_write_b32 a209, v93
    v_mfma_f32_16x16x32_bf16 v[188:191], a[192:195], a[192:195], v[188:191]
    s_add_u32 s47, s47, 4096
    v_accvgpr_write_b32 a210, v94
    v_accvgpr_write_b32 a211, v95
    v_accvgpr_write_b32 a224, v96
    v_accvgpr_write_b32 a225, v97
    v_mfma_f32_16x16x32_bf16 v[188:191], a[208:211], a[208:211], v[188:191]
    buffer_load_dwordx4 v16, s[24:27], s47 offen offset:0 lds
    v_accvgpr_write_b32 a226, v98
    v_accvgpr_write_b32 a227, v99
    v_accvgpr_write_b32 a240, v100
    v_accvgpr_write_b32 a241, v101
    v_mfma_f32_16x16x32_bf16 v[188:191], a[224:227], a[224:227], v[188:191]
    v_accvgpr_write_b32 a242, v102
    v_accvgpr_write_b32 a243, v103
    v_mul_f32 v184, 0xbae38e39, v184
    v_mul_f32 v185, 0xbae38e39, v185
    v_mfma_f32_16x16x32_bf16 v[188:191], a[240:243], a[240:243], v[188:191]
    buffer_load_dwordx4 v17, s[24:27], s47 offen offset:1024 lds
    v_mfma_f32_16x16x32_bf16 v[188:191], v[224:227], v[224:227], v[188:191]
    buffer_load_dwordx4 v18, s[24:27], s47 offen offset:2048 lds
    v_mfma_f32_16x16x32_bf16 v[188:191], v[240:243], v[240:243], v[188:191]
    buffer_load_dwordx4 v19, s[24:27], s47 offen offset:3072 lds
    v_mul_f32 v186, 0xbae38e39, v186
    v_mul_f32 v187, 0xbae38e39, v187
    s_nop 1
    v_mfma_f32_16x16x32_bf16 v[204:207], v[28:31], v[112:115], v[184:187]
    s_add_u32 m0, s33, 12288
    v_mfma_f32_16x16x32_bf16 v[208:211], v[32:35], v[112:115], v[184:187]
    s_add_u32 s47, s47, 4096
    v_mfma_f32_16x16x32_bf16 v[212:215], v[28:31], v[116:119], v[184:187]
    buffer_load_dwordx4 v20, s[24:27], s47 offen offset:0 lds
    v_mfma_f32_16x16x32_bf16 v[216:219], v[32:35], v[116:119], v[184:187]
    buffer_load_dwordx4 v21, s[24:27], s47 offen offset:1024 lds
    s_nop 0
    v_cvt_pk_bf16_f32 v112, v204, v205
    v_cvt_pk_bf16_f32 v113, v206, v207
    v_mfma_f32_16x16x32_bf16 v[204:207], v[28:31], v[120:123], v[184:187]
    v_cvt_pk_bf16_f32 v114, v208, v209
    v_cvt_pk_bf16_f32 v115, v210, v211
    v_mfma_f32_16x16x32_bf16 v[208:211], v[32:35], v[120:123], v[184:187]
    buffer_load_dwordx4 v22, s[24:27], s47 offen offset:2048 lds
    v_cvt_pk_bf16_f32 v116, v212, v213
    v_cvt_pk_bf16_f32 v117, v214, v215
    v_mfma_f32_16x16x32_bf16 v[212:215], v[28:31], v[124:127], v[184:187]
    buffer_load_dwordx4 v23, s[24:27], s47 offen offset:3072 lds
    v_cvt_pk_bf16_f32 v118, v216, v217
    v_cvt_pk_bf16_f32 v119, v218, v219
    v_mfma_f32_16x16x32_bf16 v[216:219], v[32:35], v[124:127], v[184:187]
    s_add_u32 m0, s33, 16384
    v_cvt_pk_bf16_f32 v120, v204, v205
    v_cvt_pk_bf16_f32 v121, v206, v207
    v_mfma_f32_16x16x32_bf16 v[204:207], v[28:31], v[128:131], v[184:187]
    s_add_u32 s47, s47, 4096
    v_cvt_pk_bf16_f32 v122, v208, v209
    v_cvt_pk_bf16_f32 v123, v210, v211
    v_mfma_f32_16x16x32_bf16 v[208:211], v[32:35], v[128:131], v[184:187]
    buffer_load_dwordx4 v24, s[24:27], s47 offen offset:0 lds
    v_cvt_pk_bf16_f32 v124, v212, v213
    v_cvt_pk_bf16_f32 v125, v214, v215
    v_mfma_f32_16x16x32_bf16 v[212:215], v[28:31], v[132:135], v[184:187]
    buffer_load_dwordx4 v25, s[24:27], s47 offen offset:1024 lds
    v_cvt_pk_bf16_f32 v126, v216, v217
    v_cvt_pk_bf16_f32 v127, v218, v219
    v_mfma_f32_16x16x32_bf16 v[216:219], v[32:35], v[132:135], v[184:187]
    v_accvgpr_write_b32 a4, v112
    v_accvgpr_write_b32 a5, v113
    v_cvt_pk_bf16_f32 v128, v204, v205
    v_cvt_pk_bf16_f32 v129, v206, v207
    v_mfma_f32_16x16x32_bf16 v[204:207], v[28:31], v[136:139], v[184:187]
    v_accvgpr_write_b32 a6, v114
    v_accvgpr_write_b32 a7, v115
    v_cvt_pk_bf16_f32 v130, v208, v209
    v_cvt_pk_bf16_f32 v131, v210, v211
    v_mfma_f32_16x16x32_bf16 v[208:211], v[32:35], v[136:139], v[184:187]
    v_accvgpr_write_b32 a20, v116
    v_accvgpr_write_b32 a21, v117
    v_cvt_pk_bf16_f32 v132, v212, v213
    v_cvt_pk_bf16_f32 v133, v214, v215
    v_mfma_f32_16x16x32_bf16 v[212:215], v[28:31], v[140:143], v[184:187]
    v_accvgpr_write_b32 a22, v118
    v_accvgpr_write_b32 a23, v119
    v_cvt_pk_bf16_f32 v134, v216, v217
    v_cvt_pk_bf16_f32 v135, v218, v219
    v_mfma_f32_16x16x32_bf16 v[216:219], v[32:35], v[140:143], v[184:187]
    s_waitcnt vmcnt(18)
    ds_read_b128 v[40:43], v26 offset:18432
    v_cvt_pk_bf16_f32 v136, v204, v205
    v_cvt_pk_bf16_f32 v137, v206, v207
    v_mfma_f32_16x16x32_bf16 v[204:207], v[28:31], v[144:147], v[184:187]
    ds_read_b128 v[44:47], v27 offset:18432
    v_cvt_pk_bf16_f32 v138, v208, v209
    v_cvt_pk_bf16_f32 v139, v210, v211
    v_mfma_f32_16x16x32_bf16 v[208:211], v[32:35], v[144:147], v[184:187]
    ds_read_b128 v[48:51], v26 offset:18560
    v_accvgpr_write_b32 a36, v120
    v_cvt_pk_bf16_f32 v140, v212, v213
    v_cvt_pk_bf16_f32 v141, v214, v215
    v_mfma_f32_16x16x32_bf16 v[212:215], v[28:31], v[148:151], v[184:187]
    ds_read_b128 v[52:55], v27 offset:18560
    v_accvgpr_write_b32 a37, v121
    v_cvt_pk_bf16_f32 v142, v216, v217
    v_cvt_pk_bf16_f32 v143, v218, v219
    v_mfma_f32_16x16x32_bf16 v[216:219], v[32:35], v[148:151], v[184:187]
    ds_read_b128 v[56:59], v26 offset:18688
    v_accvgpr_write_b32 a38, v122
    v_cvt_pk_bf16_f32 v144, v204, v205
    v_cvt_pk_bf16_f32 v145, v206, v207
    v_mfma_f32_16x16x32_bf16 v[204:207], v[28:31], v[152:155], v[184:187]
    ds_read_b128 v[60:63], v27 offset:18688
    v_accvgpr_write_b32 a39, v123
    v_cvt_pk_bf16_f32 v146, v208, v209
    v_cvt_pk_bf16_f32 v147, v210, v211
    v_mfma_f32_16x16x32_bf16 v[208:211], v[32:35], v[152:155], v[184:187]
    ds_read_b128 v[64:67], v26 offset:18816
    v_accvgpr_write_b32 a52, v124
    v_cvt_pk_bf16_f32 v148, v212, v213
    v_cvt_pk_bf16_f32 v149, v214, v215
    v_mfma_f32_16x16x32_bf16 v[212:215], v[28:31], v[156:159], v[184:187]
    ds_read_b128 v[68:71], v27 offset:18816
    v_accvgpr_write_b32 a53, v125
    v_cvt_pk_bf16_f32 v150, v216, v217
    v_cvt_pk_bf16_f32 v151, v218, v219
    v_mfma_f32_16x16x32_bf16 v[216:219], v[32:35], v[156:159], v[184:187]
    ds_read_b128 v[72:75], v26 offset:18944
    v_accvgpr_write_b32 a54, v126
    v_cvt_pk_bf16_f32 v152, v204, v205
    v_cvt_pk_bf16_f32 v153, v206, v207
    v_mfma_f32_16x16x32_bf16 v[204:207], v[28:31], v[160:163], v[184:187]
    ds_read_b128 v[76:79], v27 offset:18944
    v_accvgpr_write_b32 a55, v127
    v_cvt_pk_bf16_f32 v154, v208, v209
    v_cvt_pk_bf16_f32 v155, v210, v211
    v_mfma_f32_16x16x32_bf16 v[208:211], v[32:35], v[160:163], v[184:187]
    ds_read_b128 v[80:83], v26 offset:19072
    v_accvgpr_write_b32 a68, v128
    v_cvt_pk_bf16_f32 v156, v212, v213
    v_cvt_pk_bf16_f32 v157, v214, v215
    v_mfma_f32_16x16x32_bf16 v[212:215], v[28:31], v[164:167], v[184:187]
    ds_read_b128 v[84:87], v27 offset:19072
    v_accvgpr_write_b32 a69, v129
    v_cvt_pk_bf16_f32 v158, v216, v217
    v_cvt_pk_bf16_f32 v159, v218, v219
    v_mfma_f32_16x16x32_bf16 v[216:219], v[32:35], v[164:167], v[184:187]
    ds_read_b128 v[88:91], v26 offset:19200
    v_accvgpr_write_b32 a70, v130
    v_cvt_pk_bf16_f32 v160, v204, v205
    v_cvt_pk_bf16_f32 v161, v206, v207
    v_mfma_f32_16x16x32_bf16 v[204:207], v[28:31], v[168:171], v[184:187]
    ds_read_b128 v[92:95], v27 offset:19200
    v_accvgpr_write_b32 a71, v131
    v_cvt_pk_bf16_f32 v162, v208, v209
    v_cvt_pk_bf16_f32 v163, v210, v211
    v_mfma_f32_16x16x32_bf16 v[208:211], v[32:35], v[168:171], v[184:187]
    ds_read_b128 v[96:99], v26 offset:19328
    v_accvgpr_write_b32 a84, v132
    v_cvt_pk_bf16_f32 v164, v212, v213
    v_cvt_pk_bf16_f32 v165, v214, v215
    v_mfma_f32_16x16x32_bf16 v[212:215], v[28:31], v[172:175], v[184:187]
    ds_read_b128 v[100:103], v27 offset:19328
    v_accvgpr_write_b32 a85, v133
    v_cvt_pk_bf16_f32 v166, v216, v217
    v_cvt_pk_bf16_f32 v167, v218, v219
    v_mfma_f32_16x16x32_bf16 v[216:219], v[32:35], v[172:175], v[184:187]
    ds_read_b128 v[104:107], v26 offset:19456
    v_accvgpr_write_b32 a86, v134
    v_cvt_pk_bf16_f32 v168, v204, v205
    v_cvt_pk_bf16_f32 v169, v206, v207
    v_mfma_f32_16x16x32_bf16 v[204:207], v[28:31], v[176:179], v[184:187]
    ds_read_b128 v[108:111], v27 offset:19456
    v_accvgpr_write_b32 a87, v135
    v_cvt_pk_bf16_f32 v170, v208, v209
    v_cvt_pk_bf16_f32 v171, v210, v211
    v_mfma_f32_16x16x32_bf16 v[208:211], v[32:35], v[176:179], v[184:187]
    v_accvgpr_write_b32 a100, v136
    v_accvgpr_write_b32 a101, v137
    v_cvt_pk_bf16_f32 v172, v212, v213
    v_cvt_pk_bf16_f32 v173, v214, v215
    v_mfma_f32_16x16x32_bf16 v[212:215], v[28:31], v[180:183], v[184:187]
    v_accvgpr_write_b32 a102, v138
    v_accvgpr_write_b32 a103, v139
    v_cvt_pk_bf16_f32 v174, v216, v217
    v_cvt_pk_bf16_f32 v175, v218, v219
    v_mfma_f32_16x16x32_bf16 v[216:219], v[32:35], v[180:183], v[184:187]
    v_accvgpr_write_b32 a116, v140
    v_accvgpr_write_b32 a117, v141
    s_waitcnt lgkmcnt(15)
    v_mfma_f32_16x16x32_bf16 v[184:187], v[220:223], v[40:43], 0
    v_accvgpr_write_b32 a118, v142
    v_accvgpr_write_b32 a119, v143
    v_mfma_f32_16x16x32_bf16 v[184:187], v[220:223], v[44:47], v[184:187]
    v_accvgpr_write_b32 a132, v144
    v_accvgpr_write_b32 a133, v145
    v_mfma_f32_16x16x32_bf16 v[184:187], v[220:223], v[48:51], v[184:187]
    v_accvgpr_write_b32 a134, v146
    v_accvgpr_write_b32 a135, v147
    s_waitcnt lgkmcnt(14)
    v_mfma_f32_16x16x32_bf16 v[184:187], v[220:223], v[52:55], v[184:187]
    v_cvt_pk_bf16_f32 v228, v204, v205
    v_cvt_pk_bf16_f32 v229, v206, v207
    s_waitcnt lgkmcnt(13)
    v_mfma_f32_16x16x32_bf16 v[184:187], v[220:223], v[56:59], v[184:187]
    v_cvt_pk_bf16_f32 v230, v208, v209
    v_cvt_pk_bf16_f32 v231, v210, v211
    s_waitcnt lgkmcnt(12)
    v_mfma_f32_16x16x32_bf16 v[184:187], v[220:223], v[60:63], v[184:187]
    v_accvgpr_write_b32 a148, v148
    v_accvgpr_write_b32 a149, v149
    s_waitcnt lgkmcnt(11)
    v_mfma_f32_16x16x32_bf16 v[184:187], v[220:223], v[64:67], v[184:187]
    v_accvgpr_write_b32 a150, v150
    v_accvgpr_write_b32 a151, v151
    s_waitcnt lgkmcnt(10)
    v_mfma_f32_16x16x32_bf16 v[184:187], v[220:223], v[68:71], v[184:187]
    v_cvt_pk_bf16_f32 v244, v212, v213
    v_cvt_pk_bf16_f32 v245, v214, v215
    s_waitcnt lgkmcnt(9)
    v_mfma_f32_16x16x32_bf16 v[184:187], v[220:223], v[72:75], v[184:187]
    v_cvt_pk_bf16_f32 v246, v216, v217
    v_cvt_pk_bf16_f32 v247, v218, v219
    s_waitcnt lgkmcnt(8)
    v_mfma_f32_16x16x32_bf16 v[184:187], v[220:223], v[76:79], v[184:187]
    v_accvgpr_write_b32 a164, v152
    v_accvgpr_write_b32 a165, v153
    s_waitcnt lgkmcnt(7)
    v_mfma_f32_16x16x32_bf16 v[184:187], v[220:223], v[80:83], v[184:187]
    v_accvgpr_write_b32 a166, v154
    v_accvgpr_write_b32 a167, v155
    s_waitcnt lgkmcnt(6)
    v_mfma_f32_16x16x32_bf16 v[184:187], v[220:223], v[84:87], v[184:187]
    v_accvgpr_write_b32 a180, v156
    v_accvgpr_write_b32 a181, v157
    s_waitcnt lgkmcnt(5)
    v_mfma_f32_16x16x32_bf16 v[184:187], v[220:223], v[88:91], v[184:187]
    v_accvgpr_write_b32 a182, v158
    v_accvgpr_write_b32 a183, v159
    s_waitcnt lgkmcnt(4)
    v_mfma_f32_16x16x32_bf16 v[184:187], v[220:223], v[92:95], v[184:187]
    v_accvgpr_write_b32 a196, v160
    v_accvgpr_write_b32 a197, v161
    s_waitcnt lgkmcnt(3)
    v_mfma_f32_16x16x32_bf16 v[184:187], v[220:223], v[96:99], v[184:187]
    v_accvgpr_write_b32 a198, v162
    v_accvgpr_write_b32 a199, v163
    s_waitcnt lgkmcnt(2)
    v_mfma_f32_16x16x32_bf16 v[184:187], v[220:223], v[100:103], v[184:187]
    s_waitcnt lgkmcnt(0)
    v_accvgpr_write_b32 a212, v164
    v_accvgpr_write_b32 a213, v165
    v_mfma_f32_16x16x32_bf16 v[184:187], v[220:223], v[104:107], v[184:187]
    s_add_u32 m0, s33, 0x4800
    v_accvgpr_write_b32 a214, v166
    v_accvgpr_write_b32 a215, v167
    v_mfma_f32_16x16x32_bf16 v[184:187], v[220:223], v[108:111], v[184:187]
    s_add_u32 s37, s34, 0x0
    v_accvgpr_write_b32 a228, v168
    v_accvgpr_write_b32 a229, v169
    v_mfma_f32_16x16x32_bf16 v[192:195], a[4:7], a[4:7], 0
    buffer_load_dwordx4 v39, s[8:11], s37 offen lds
    v_mfma_f32_16x16x32_bf16 v[192:195], a[20:23], a[20:23], v[192:195]
    s_add_u32 m0, s33, 0x4c00
    v_accvgpr_write_b32 a230, v170
    v_accvgpr_write_b32 a231, v171
    v_mfma_f32_16x16x32_bf16 v[192:195], a[36:39], a[36:39], v[192:195]
    s_add_u32 s37, s34, 0x24000
    v_accvgpr_write_b32 a244, v172
    v_accvgpr_write_b32 a245, v173
    v_mfma_f32_16x16x32_bf16 v[192:195], a[52:55], a[52:55], v[192:195]
    buffer_load_dwordx4 v39, s[8:11], s37 offen lds
    v_mfma_f32_16x16x32_bf16 v[192:195], a[68:71], a[68:71], v[192:195]
    s_add_u32 m0, s33, 0x5000
    v_accvgpr_write_b32 a246, v174
    v_accvgpr_write_b32 a247, v175
    v_mfma_f32_16x16x32_bf16 v[192:195], a[84:87], a[84:87], v[192:195]
    s_add_u32 s37, s34, 0x48000
    v_mul_f32 v184, 0xbae38e39, v184
    v_mul_f32 v185, 0xbae38e39, v185
    v_mfma_f32_16x16x32_bf16 v[192:195], a[100:103], a[100:103], v[192:195]
    buffer_load_dwordx4 v39, s[8:11], s37 offen lds
    v_mfma_f32_16x16x32_bf16 v[192:195], a[116:119], a[116:119], v[192:195]
    s_add_u32 m0, s33, 0x5400
    s_add_u32 s37, s34, 0x6c000
    v_mul_f32 v186, 0xbae38e39, v186
    v_mfma_f32_16x16x32_bf16 v[192:195], a[132:135], a[132:135], v[192:195]
    buffer_load_dwordx4 v39, s[8:11], s37 offen lds
    v_mfma_f32_16x16x32_bf16 v[192:195], a[148:151], a[148:151], v[192:195]
    s_add_u32 m0, s33, 0x5800
    v_mul_f32 v187, 0xbae38e39, v187
    v_mfma_f32_16x16x32_bf16 v[192:195], a[164:167], a[164:167], v[192:195]
    s_add_u32 s37, s34, 0x90000
    v_mfma_f32_16x16x32_bf16 v[192:195], a[180:183], a[180:183], v[192:195]
    buffer_load_dwordx4 v39, s[8:11], s37 offen lds
    v_mfma_f32_16x16x32_bf16 v[192:195], a[196:199], a[196:199], v[192:195]
    s_add_u32 m0, s33, 0x5c00
    s_add_u32 s37, s34, 0xb4000
    v_mfma_f32_16x16x32_bf16 v[192:195], a[212:215], a[212:215], v[192:195]
    buffer_load_dwordx4 v39, s[8:11], s37 offen lds
    v_mfma_f32_16x16x32_bf16 v[192:195], a[228:231], a[228:231], v[192:195]
    s_add_u32 m0, s33, 0x6000
    v_mfma_f32_16x16x32_bf16 v[192:195], a[244:247], a[244:247], v[192:195]
    s_add_u32 s37, s34, 0xd8000
    v_mfma_f32_16x16x32_bf16 v[192:195], v[228:231], v[228:231], v[192:195]
    buffer_load_dwordx4 v39, s[8:11], s37 offen lds
    v_mfma_f32_16x16x32_bf16 v[192:195], v[244:247], v[244:247], v[192:195]
    s_add_u32 m0, s33, 0x6400
    s_add_u32 s37, s34, 0xfc000
    v_mfma_f32_16x16x32_bf16 v[204:207], v[28:31], v[40:43], v[184:187]
    buffer_load_dwordx4 v39, s[8:11], s37 offen lds
    v_mfma_f32_16x16x32_bf16 v[208:211], v[32:35], v[40:43], v[184:187]
    s_add_u32 m0, s33, 0x6800
    v_mfma_f32_16x16x32_bf16 v[212:215], v[28:31], v[44:47], v[184:187]
    s_add_u32 s37, s34, 0x120000
    v_mfma_f32_16x16x32_bf16 v[216:219], v[32:35], v[44:47], v[184:187]
    buffer_load_dwordx4 v39, s[8:11], s37 offen lds
    s_nop 0
    v_cvt_pk_bf16_f32 v40, v204, v205
    v_cvt_pk_bf16_f32 v41, v206, v207
    v_mfma_f32_16x16x32_bf16 v[204:207], v[28:31], v[48:51], v[184:187]
    s_add_u32 m0, s33, 0x6c00
    v_cvt_pk_bf16_f32 v42, v208, v209
    v_cvt_pk_bf16_f32 v43, v210, v211
    v_mfma_f32_16x16x32_bf16 v[208:211], v[32:35], v[48:51], v[184:187]
    s_add_u32 s37, s34, 0x144000
    v_cvt_pk_bf16_f32 v44, v212, v213
    v_cvt_pk_bf16_f32 v45, v214, v215
    v_mfma_f32_16x16x32_bf16 v[212:215], v[28:31], v[52:55], v[184:187]
    buffer_load_dwordx4 v39, s[8:11], s37 offen lds
    v_cvt_pk_bf16_f32 v46, v216, v217
    v_cvt_pk_bf16_f32 v47, v218, v219
    v_mfma_f32_16x16x32_bf16 v[216:219], v[32:35], v[52:55], v[184:187]
    s_add_u32 m0, s33, 0x7000
    s_add_u32 s37, s34, 0x168000
    v_cvt_pk_bf16_f32 v48, v204, v205
    v_cvt_pk_bf16_f32 v49, v206, v207
    v_mfma_f32_16x16x32_bf16 v[204:207], v[28:31], v[56:59], v[184:187]
    buffer_load_dwordx4 v39, s[8:11], s37 offen lds
    v_cvt_pk_bf16_f32 v50, v208, v209
    v_cvt_pk_bf16_f32 v51, v210, v211
    v_mfma_f32_16x16x32_bf16 v[208:211], v[32:35], v[56:59], v[184:187]
    s_add_u32 m0, s33, 0x7400
    v_cvt_pk_bf16_f32 v52, v212, v213
    v_cvt_pk_bf16_f32 v53, v214, v215
    v_mfma_f32_16x16x32_bf16 v[212:215], v[28:31], v[60:63], v[184:187]
    s_add_u32 s37, s34, 0x18c000
    v_cvt_pk_bf16_f32 v54, v216, v217
    v_cvt_pk_bf16_f32 v55, v218, v219
    v_mfma_f32_16x16x32_bf16 v[216:219], v[32:35], v[60:63], v[184:187]
    buffer_load_dwordx4 v39, s[8:11], s37 offen lds
    v_cvt_pk_bf16_f32 v56, v204, v205
    v_cvt_pk_bf16_f32 v57, v206, v207
    v_mfma_f32_16x16x32_bf16 v[204:207], v[28:31], v[64:67], v[184:187]
    v_accvgpr_write_b32 a8, v40
    v_accvgpr_write_b32 a9, v41
    v_cvt_pk_bf16_f32 v58, v208, v209
    v_cvt_pk_bf16_f32 v59, v210, v211
    v_mfma_f32_16x16x32_bf16 v[208:211], v[32:35], v[64:67], v[184:187]
    v_accvgpr_write_b32 a10, v42
    v_accvgpr_write_b32 a11, v43
    v_cvt_pk_bf16_f32 v60, v212, v213
    v_cvt_pk_bf16_f32 v61, v214, v215
    v_mfma_f32_16x16x32_bf16 v[212:215], v[28:31], v[68:71], v[184:187]
    v_accvgpr_write_b32 a24, v44
    v_accvgpr_write_b32 a25, v45
    v_cvt_pk_bf16_f32 v62, v216, v217
    v_cvt_pk_bf16_f32 v63, v218, v219
    v_mfma_f32_16x16x32_bf16 v[216:219], v[32:35], v[68:71], v[184:187]
    s_waitcnt vmcnt(12)
    ds_read_b128 v[112:115], v26 offset:0
    v_accvgpr_write_b32 a26, v46
    v_cvt_pk_bf16_f32 v64, v204, v205
    v_cvt_pk_bf16_f32 v65, v206, v207
    v_mfma_f32_16x16x32_bf16 v[204:207], v[28:31], v[72:75], v[184:187]
    ds_read_b128 v[116:119], v27 offset:0
    v_accvgpr_write_b32 a27, v47
    v_cvt_pk_bf16_f32 v66, v208, v209
    v_cvt_pk_bf16_f32 v67, v210, v211
    v_mfma_f32_16x16x32_bf16 v[208:211], v[32:35], v[72:75], v[184:187]
    ds_read_b128 v[120:123], v26 offset:128
    v_accvgpr_write_b32 a40, v48
    v_cvt_pk_bf16_f32 v68, v212, v213
    v_cvt_pk_bf16_f32 v69, v214, v215
    v_mfma_f32_16x16x32_bf16 v[212:215], v[28:31], v[76:79], v[184:187]
    ds_read_b128 v[124:127], v27 offset:128
    v_accvgpr_write_b32 a41, v49
    v_cvt_pk_bf16_f32 v70, v216, v217
    v_cvt_pk_bf16_f32 v71, v218, v219
    v_mfma_f32_16x16x32_bf16 v[216:219], v[32:35], v[76:79], v[184:187]
    ds_read_b128 v[128:131], v26 offset:256
    v_accvgpr_write_b32 a42, v50
    v_cvt_pk_bf16_f32 v72, v204, v205
    v_cvt_pk_bf16_f32 v73, v206, v207
    v_mfma_f32_16x16x32_bf16 v[204:207], v[28:31], v[80:83], v[184:187]
    ds_read_b128 v[132:135], v27 offset:256
    v_accvgpr_write_b32 a43, v51
    v_cvt_pk_bf16_f32 v74, v208, v209
    v_cvt_pk_bf16_f32 v75, v210, v211
    v_mfma_f32_16x16x32_bf16 v[208:211], v[32:35], v[80:83], v[184:187]
    ds_read_b128 v[136:139], v26 offset:384
    v_accvgpr_write_b32 a56, v52
    v_cvt_pk_bf16_f32 v76, v212, v213
    v_cvt_pk_bf16_f32 v77, v214, v215
    v_mfma_f32_16x16x32_bf16 v[212:215], v[28:31], v[84:87], v[184:187]
    ds_read_b128 v[140:143], v27 offset:384
    v_accvgpr_write_b32 a57, v53
    v_cvt_pk_bf16_f32 v78, v216, v217
    v_cvt_pk_bf16_f32 v79, v218, v219
    v_mfma_f32_16x16x32_bf16 v[216:219], v[32:35], v[84:87], v[184:187]
    ds_read_b128 v[144:147], v26 offset:512
    v_accvgpr_write_b32 a58, v54
    v_cvt_pk_bf16_f32 v80, v204, v205
    v_cvt_pk_bf16_f32 v81, v206, v207
    v_mfma_f32_16x16x32_bf16 v[204:207], v[28:31], v[88:91], v[184:187]
    ds_read_b128 v[148:151], v27 offset:512
    v_accvgpr_write_b32 a59, v55
    v_cvt_pk_bf16_f32 v82, v208, v209
    v_cvt_pk_bf16_f32 v83, v210, v211
    v_mfma_f32_16x16x32_bf16 v[208:211], v[32:35], v[88:91], v[184:187]
    ds_read_b128 v[152:155], v26 offset:640
    v_accvgpr_write_b32 a72, v56
    v_cvt_pk_bf16_f32 v84, v212, v213
    v_cvt_pk_bf16_f32 v85, v214, v215
    v_mfma_f32_16x16x32_bf16 v[212:215], v[28:31], v[92:95], v[184:187]
    ds_read_b128 v[156:159], v27 offset:640
    v_accvgpr_write_b32 a73, v57
    v_cvt_pk_bf16_f32 v86, v216, v217
    v_cvt_pk_bf16_f32 v87, v218, v219
    v_mfma_f32_16x16x32_bf16 v[216:219], v[32:35], v[92:95], v[184:187]
    ds_read_b128 v[160:163], v26 offset:768
    v_accvgpr_write_b32 a74, v58
    v_cvt_pk_bf16_f32 v88, v204, v205
    v_cvt_pk_bf16_f32 v89, v206, v207
    v_mfma_f32_16x16x32_bf16 v[204:207], v[28:31], v[96:99], v[184:187]
    ds_read_b128 v[164:167], v27 offset:768
    v_accvgpr_write_b32 a75, v59
    v_cvt_pk_bf16_f32 v90, v208, v209
    v_cvt_pk_bf16_f32 v91, v210, v211
    v_mfma_f32_16x16x32_bf16 v[208:211], v[32:35], v[96:99], v[184:187]
    ds_read_b128 v[168:171], v26 offset:896
    v_accvgpr_write_b32 a88, v60
    v_cvt_pk_bf16_f32 v92, v212, v213
    v_cvt_pk_bf16_f32 v93, v214, v215
    v_mfma_f32_16x16x32_bf16 v[212:215], v[28:31], v[100:103], v[184:187]
    ds_read_b128 v[172:175], v27 offset:896
    v_accvgpr_write_b32 a89, v61
    v_cvt_pk_bf16_f32 v94, v216, v217
    v_cvt_pk_bf16_f32 v95, v218, v219
    v_mfma_f32_16x16x32_bf16 v[216:219], v[32:35], v[100:103], v[184:187]
    ds_read_b128 v[176:179], v26 offset:1024
    v_accvgpr_write_b32 a90, v62
    v_cvt_pk_bf16_f32 v96, v204, v205
    v_cvt_pk_bf16_f32 v97, v206, v207
    v_mfma_f32_16x16x32_bf16 v[204:207], v[28:31], v[104:107], v[184:187]
    ds_read_b128 v[180:183], v27 offset:1024
    v_accvgpr_write_b32 a91, v63
    v_cvt_pk_bf16_f32 v98, v208, v209
    v_cvt_pk_bf16_f32 v99, v210, v211
    v_mfma_f32_16x16x32_bf16 v[208:211], v[32:35], v[104:107], v[184:187]
    v_accvgpr_write_b32 a104, v64
    v_accvgpr_write_b32 a105, v65
    v_cvt_pk_bf16_f32 v100, v212, v213
    v_cvt_pk_bf16_f32 v101, v214, v215
    v_mfma_f32_16x16x32_bf16 v[212:215], v[28:31], v[108:111], v[184:187]
    v_accvgpr_write_b32 a106, v66
    v_accvgpr_write_b32 a107, v67
    v_cvt_pk_bf16_f32 v102, v216, v217
    v_cvt_pk_bf16_f32 v103, v218, v219
    v_mfma_f32_16x16x32_bf16 v[216:219], v[32:35], v[108:111], v[184:187]
    v_accvgpr_write_b32 a120, v68
    v_accvgpr_write_b32 a121, v69
    s_waitcnt lgkmcnt(15)
    v_mfma_f32_16x16x32_bf16 v[184:187], v[220:223], v[112:115], 0
    v_accvgpr_write_b32 a122, v70
    v_accvgpr_write_b32 a123, v71
    v_mfma_f32_16x16x32_bf16 v[184:187], v[220:223], v[116:119], v[184:187]
    v_accvgpr_write_b32 a136, v72
    v_accvgpr_write_b32 a137, v73
    v_mfma_f32_16x16x32_bf16 v[184:187], v[220:223], v[120:123], v[184:187]
    v_accvgpr_write_b32 a138, v74
    v_accvgpr_write_b32 a139, v75
    s_waitcnt lgkmcnt(14)
    v_mfma_f32_16x16x32_bf16 v[184:187], v[220:223], v[124:127], v[184:187]
    v_cvt_pk_bf16_f32 v232, v204, v205
    v_cvt_pk_bf16_f32 v233, v206, v207
    s_waitcnt lgkmcnt(13)
    v_mfma_f32_16x16x32_bf16 v[184:187], v[220:223], v[128:131], v[184:187]
    v_cvt_pk_bf16_f32 v234, v208, v209
    v_cvt_pk_bf16_f32 v235, v210, v211
    s_waitcnt lgkmcnt(12)
    v_mfma_f32_16x16x32_bf16 v[184:187], v[220:223], v[132:135], v[184:187]
    v_accvgpr_write_b32 a152, v76
    v_accvgpr_write_b32 a153, v77
    s_waitcnt lgkmcnt(11)
    v_mfma_f32_16x16x32_bf16 v[184:187], v[220:223], v[136:139], v[184:187]
    v_accvgpr_write_b32 a154, v78
    v_accvgpr_write_b32 a155, v79
    s_waitcnt lgkmcnt(10)
    v_mfma_f32_16x16x32_bf16 v[184:187], v[220:223], v[140:143], v[184:187]
    v_cvt_pk_bf16_f32 v248, v212, v213
    v_cvt_pk_bf16_f32 v249, v214, v215
    s_waitcnt lgkmcnt(9)
    v_mfma_f32_16x16x32_bf16 v[184:187], v[220:223], v[144:147], v[184:187]
    v_cvt_pk_bf16_f32 v250, v216, v217
    v_cvt_pk_bf16_f32 v251, v218, v219
    s_waitcnt lgkmcnt(8)
    v_mfma_f32_16x16x32_bf16 v[184:187], v[220:223], v[148:151], v[184:187]
    v_accvgpr_write_b32 a168, v80
    v_accvgpr_write_b32 a169, v81
    s_waitcnt lgkmcnt(7)
    v_mfma_f32_16x16x32_bf16 v[184:187], v[220:223], v[152:155], v[184:187]
    v_accvgpr_write_b32 a170, v82
    v_accvgpr_write_b32 a171, v83
    s_waitcnt lgkmcnt(6)
    v_mfma_f32_16x16x32_bf16 v[184:187], v[220:223], v[156:159], v[184:187]
    v_accvgpr_write_b32 a184, v84
    v_accvgpr_write_b32 a185, v85
    s_waitcnt lgkmcnt(5)
    v_mfma_f32_16x16x32_bf16 v[184:187], v[220:223], v[160:163], v[184:187]
    v_accvgpr_write_b32 a186, v86
    v_accvgpr_write_b32 a187, v87
    s_waitcnt lgkmcnt(4)
    v_mfma_f32_16x16x32_bf16 v[184:187], v[220:223], v[164:167], v[184:187]
    v_accvgpr_write_b32 a200, v88
    v_accvgpr_write_b32 a201, v89
    s_waitcnt lgkmcnt(3)
    v_mfma_f32_16x16x32_bf16 v[184:187], v[220:223], v[168:171], v[184:187]
    v_accvgpr_write_b32 a202, v90
    v_accvgpr_write_b32 a203, v91
    s_waitcnt lgkmcnt(2)
    v_mfma_f32_16x16x32_bf16 v[184:187], v[220:223], v[172:175], v[184:187]
    s_waitcnt lgkmcnt(0)
    v_accvgpr_write_b32 a216, v92
    v_accvgpr_write_b32 a217, v93
    v_mfma_f32_16x16x32_bf16 v[184:187], v[220:223], v[176:179], v[184:187]
    s_add_u32 m0, s33, 0x7800
    v_accvgpr_write_b32 a218, v94
    v_accvgpr_write_b32 a219, v95
    v_mfma_f32_16x16x32_bf16 v[184:187], v[220:223], v[180:183], v[184:187]
    s_add_u32 s37, s34, 0x1b0000
    v_accvgpr_write_b32 a232, v96
    v_accvgpr_write_b32 a233, v97
    v_mfma_f32_16x16x32_bf16 v[196:199], a[8:11], a[8:11], 0
    buffer_load_dwordx4 v39, s[8:11], s37 offen lds
    v_mfma_f32_16x16x32_bf16 v[196:199], a[24:27], a[24:27], v[196:199]
    s_add_u32 m0, s33, 0x7c00
    v_accvgpr_write_b32 a234, v98
    v_accvgpr_write_b32 a235, v99
    v_mfma_f32_16x16x32_bf16 v[196:199], a[40:43], a[40:43], v[196:199]
    s_add_u32 s37, s34, 0x1d4000
    v_accvgpr_write_b32 a248, v100
    v_accvgpr_write_b32 a249, v101
    v_mfma_f32_16x16x32_bf16 v[196:199], a[56:59], a[56:59], v[196:199]
    buffer_load_dwordx4 v39, s[8:11], s37 offen lds
    v_mfma_f32_16x16x32_bf16 v[196:199], a[72:75], a[72:75], v[196:199]
    s_add_u32 m0, s33, 0x8000
    v_accvgpr_write_b32 a250, v102
    v_accvgpr_write_b32 a251, v103
    v_mfma_f32_16x16x32_bf16 v[196:199], a[88:91], a[88:91], v[196:199]
    s_add_u32 s37, s34, 0x1f8000
    v_mul_f32 v184, 0xbae38e39, v184
    v_mul_f32 v185, 0xbae38e39, v185
    v_mfma_f32_16x16x32_bf16 v[196:199], a[104:107], a[104:107], v[196:199]
    buffer_load_dwordx4 v39, s[8:11], s37 offen lds
    v_mfma_f32_16x16x32_bf16 v[196:199], a[120:123], a[120:123], v[196:199]
    s_add_u32 m0, s33, 0x8400
    v_mul_f32 v186, 0xbae38e39, v186
    v_mul_f32 v187, 0xbae38e39, v187
    v_mfma_f32_16x16x32_bf16 v[196:199], a[136:139], a[136:139], v[196:199]
    s_add_u32 s37, s34, 0x21c000
    v_mfma_f32_16x16x32_bf16 v[196:199], a[152:155], a[152:155], v[196:199]
    buffer_load_dwordx4 v39, s[8:11], s37 offen lds
    v_mfma_f32_16x16x32_bf16 v[196:199], a[168:171], a[168:171], v[196:199]
    s_add_u32 m0, s33, 0x8800
    s_add_u32 s37, s34, 0x240000
    v_mfma_f32_16x16x32_bf16 v[196:199], a[184:187], a[184:187], v[196:199]
    buffer_load_dwordx4 v39, s[8:11], s37 offen lds
    v_mfma_f32_16x16x32_bf16 v[196:199], a[200:203], a[200:203], v[196:199]
    s_add_u32 m0, s33, 0x8c00
    v_mfma_f32_16x16x32_bf16 v[196:199], a[216:219], a[216:219], v[196:199]
    s_add_u32 s37, s34, 0x264000
    v_mfma_f32_16x16x32_bf16 v[196:199], a[232:235], a[232:235], v[196:199]
    buffer_load_dwordx4 v39, s[8:11], s37 offen lds
    v_mfma_f32_16x16x32_bf16 v[196:199], a[248:251], a[248:251], v[196:199]
    s_add_u32 m0, s33, 0x0
    v_add_u32 v92, 0x10000, v4
    v_add_u32 v93, 0x10000, v5
    v_mfma_f32_16x16x32_bf16 v[196:199], v[232:235], v[232:235], v[196:199]
    s_add_u32 s37, s34, 0x288000
    v_add_u32 v94, 0x20000, v4
    v_add_u32 v95, 0x20000, v5
    v_mfma_f32_16x16x32_bf16 v[196:199], v[248:251], v[248:251], v[196:199]
    buffer_load_dwordx4 v39, s[8:11], s37 offen lds
    v_mfma_f32_16x16x32_bf16 v[204:207], v[28:31], v[112:115], v[184:187]
    s_add_u32 m0, s33, 0x400
    v_mfma_f32_16x16x32_bf16 v[208:211], v[32:35], v[112:115], v[184:187]
    s_add_u32 s37, s34, 0x2ac000
    v_mfma_f32_16x16x32_bf16 v[212:215], v[28:31], v[116:119], v[184:187]
    buffer_load_dwordx4 v39, s[8:11], s37 offen lds
    v_mfma_f32_16x16x32_bf16 v[216:219], v[32:35], v[116:119], v[184:187]
    s_add_u32 m0, s33, 0x800
    s_add_u32 s37, s34, 0x2d0000
    v_cvt_pk_bf16_f32 v112, v204, v205
    v_cvt_pk_bf16_f32 v113, v206, v207
    v_mfma_f32_16x16x32_bf16 v[204:207], v[28:31], v[120:123], v[184:187]
    buffer_load_dwordx4 v39, s[8:11], s37 offen lds
    v_cvt_pk_bf16_f32 v114, v208, v209
    v_cvt_pk_bf16_f32 v115, v210, v211
    v_mfma_f32_16x16x32_bf16 v[208:211], v[32:35], v[120:123], v[184:187]
    s_add_u32 m0, s33, 0xc00
    v_cvt_pk_bf16_f32 v116, v212, v213
    v_cvt_pk_bf16_f32 v117, v214, v215
    v_mfma_f32_16x16x32_bf16 v[212:215], v[28:31], v[124:127], v[184:187]
    s_add_u32 s37, s34, 0x2f4000
    v_cvt_pk_bf16_f32 v118, v216, v217
    v_cvt_pk_bf16_f32 v119, v218, v219
    v_mfma_f32_16x16x32_bf16 v[216:219], v[32:35], v[124:127], v[184:187]
    buffer_load_dwordx4 v39, s[8:11], s37 offen lds
    v_cvt_pk_bf16_f32 v120, v204, v205
    v_cvt_pk_bf16_f32 v121, v206, v207
    v_mfma_f32_16x16x32_bf16 v[204:207], v[28:31], v[128:131], v[184:187]
    s_add_u32 m0, s33, 0x1000
    v_cvt_pk_bf16_f32 v122, v208, v209
    v_cvt_pk_bf16_f32 v123, v210, v211
    v_mfma_f32_16x16x32_bf16 v[208:211], v[32:35], v[128:131], v[184:187]
    s_add_u32 s37, s34, 0x318000
    v_cvt_pk_bf16_f32 v124, v212, v213
    v_cvt_pk_bf16_f32 v125, v214, v215
    v_mfma_f32_16x16x32_bf16 v[212:215], v[28:31], v[132:135], v[184:187]
    buffer_load_dwordx4 v39, s[8:11], s37 offen lds
    v_cvt_pk_bf16_f32 v126, v216, v217
    v_cvt_pk_bf16_f32 v127, v218, v219
    v_mfma_f32_16x16x32_bf16 v[216:219], v[32:35], v[132:135], v[184:187]
    s_add_u32 m0, s33, 0x1400
    v_accvgpr_write_b32 a12, v112
    v_accvgpr_write_b32 a13, v113
    v_cvt_pk_bf16_f32 v128, v204, v205
    v_cvt_pk_bf16_f32 v129, v206, v207
    v_mfma_f32_16x16x32_bf16 v[204:207], v[28:31], v[136:139], v[184:187]
    s_add_u32 s37, s34, 0x33c000
    v_accvgpr_write_b32 a14, v114
    v_accvgpr_write_b32 a15, v115
    v_cvt_pk_bf16_f32 v130, v208, v209
    v_cvt_pk_bf16_f32 v131, v210, v211
    v_mfma_f32_16x16x32_bf16 v[208:211], v[32:35], v[136:139], v[184:187]
    buffer_load_dwordx4 v39, s[8:11], s37 offen lds
    v_cvt_pk_bf16_f32 v132, v212, v213
    v_cvt_pk_bf16_f32 v133, v214, v215
    v_mfma_f32_16x16x32_bf16 v[212:215], v[28:31], v[140:143], v[184:187]
    v_accvgpr_write_b32 a28, v116
    v_accvgpr_write_b32 a29, v117
    v_cvt_pk_bf16_f32 v134, v216, v217
    v_cvt_pk_bf16_f32 v135, v218, v219
    v_mfma_f32_16x16x32_bf16 v[216:219], v[32:35], v[140:143], v[184:187]
    s_waitcnt vmcnt(12)
    s_barrier
    v_accvgpr_write_b32 a30, v118
    v_cvt_pk_bf16_f32 v136, v204, v205
    v_cvt_pk_bf16_f32 v137, v206, v207
    v_mfma_f32_16x16x32_bf16 v[204:207], v[28:31], v[144:147], v[184:187]
    ds_read_b64_tr_b16 v[40:41], v4 offset:18432
    v_accvgpr_write_b32 a31, v119
    v_cvt_pk_bf16_f32 v138, v208, v209
    v_cvt_pk_bf16_f32 v139, v210, v211
    v_mfma_f32_16x16x32_bf16 v[208:211], v[32:35], v[144:147], v[184:187]
    ds_read_b64_tr_b16 v[42:43], v92 offset:34816
    v_accvgpr_write_b32 a44, v120
    v_cvt_pk_bf16_f32 v140, v212, v213
    v_cvt_pk_bf16_f32 v141, v214, v215
    v_mfma_f32_16x16x32_bf16 v[212:215], v[28:31], v[148:151], v[184:187]
    ds_read_b64_tr_b16 v[44:45], v4 offset:20480
    v_accvgpr_write_b32 a45, v121
    v_cvt_pk_bf16_f32 v142, v216, v217
    v_cvt_pk_bf16_f32 v143, v218, v219
    v_mfma_f32_16x16x32_bf16 v[216:219], v[32:35], v[148:151], v[184:187]
    ds_read_b64_tr_b16 v[46:47], v92 offset:36864
    v_accvgpr_write_b32 a46, v122
    v_cvt_pk_bf16_f32 v144, v204, v205
    v_cvt_pk_bf16_f32 v145, v206, v207
    v_mfma_f32_16x16x32_bf16 v[204:207], v[28:31], v[152:155], v[184:187]
    ds_read_b64_tr_b16 v[48:49], v4 offset:22528
    v_accvgpr_write_b32 a47, v123
    v_cvt_pk_bf16_f32 v146, v208, v209
    v_cvt_pk_bf16_f32 v147, v210, v211
    v_mfma_f32_16x16x32_bf16 v[208:211], v[32:35], v[152:155], v[184:187]
    ds_read_b64_tr_b16 v[50:51], v92 offset:38912
    v_accvgpr_write_b32 a60, v124
    v_cvt_pk_bf16_f32 v148, v212, v213
    v_cvt_pk_bf16_f32 v149, v214, v215
    v_mfma_f32_16x16x32_bf16 v[212:215], v[28:31], v[156:159], v[184:187]
    ds_read_b64_tr_b16 v[52:53], v4 offset:24576
    v_accvgpr_write_b32 a61, v125
    v_cvt_pk_bf16_f32 v150, v216, v217
    v_cvt_pk_bf16_f32 v151, v218, v219
    v_mfma_f32_16x16x32_bf16 v[216:219], v[32:35], v[156:159], v[184:187]
    ds_read_b64_tr_b16 v[54:55], v92 offset:40960
    v_accvgpr_write_b32 a62, v126
    v_cvt_pk_bf16_f32 v152, v204, v205
    v_cvt_pk_bf16_f32 v153, v206, v207
    v_mfma_f32_16x16x32_bf16 v[204:207], v[28:31], v[160:163], v[184:187]
    ds_read_b64_tr_b16 v[56:57], v4 offset:26624
    v_accvgpr_write_b32 a63, v127
    v_cvt_pk_bf16_f32 v154, v208, v209
    v_cvt_pk_bf16_f32 v155, v210, v211
    v_mfma_f32_16x16x32_bf16 v[208:211], v[32:35], v[160:163], v[184:187]
    ds_read_b64_tr_b16 v[58:59], v92 offset:43008
    v_accvgpr_write_b32 a76, v128
    v_cvt_pk_bf16_f32 v156, v212, v213
    v_cvt_pk_bf16_f32 v157, v214, v215
    v_mfma_f32_16x16x32_bf16 v[212:215], v[28:31], v[164:167], v[184:187]
    ds_read_b64_tr_b16 v[60:61], v4 offset:28672
    v_accvgpr_write_b32 a77, v129
    v_cvt_pk_bf16_f32 v158, v216, v217
    v_cvt_pk_bf16_f32 v159, v218, v219
    v_mfma_f32_16x16x32_bf16 v[216:219], v[32:35], v[164:167], v[184:187]
    ds_read_b64_tr_b16 v[62:63], v92 offset:45056
    v_accvgpr_write_b32 a78, v130
    v_cvt_pk_bf16_f32 v160, v204, v205
    v_cvt_pk_bf16_f32 v161, v206, v207
    v_mfma_f32_16x16x32_bf16 v[204:207], v[28:31], v[168:171], v[184:187]
    v_accvgpr_write_b32 a79, v131
    v_accvgpr_write_b32 a92, v132
    v_cvt_pk_bf16_f32 v162, v208, v209
    v_cvt_pk_bf16_f32 v163, v210, v211
    v_mfma_f32_16x16x32_bf16 v[208:211], v[32:35], v[168:171], v[184:187]
    v_accvgpr_write_b32 a93, v133
    v_accvgpr_write_b32 a94, v134
    v_cvt_pk_bf16_f32 v164, v212, v213
    v_cvt_pk_bf16_f32 v165, v214, v215
    v_mfma_f32_16x16x32_bf16 v[212:215], v[28:31], v[172:175], v[184:187]
    v_accvgpr_write_b32 a95, v135
    v_accvgpr_write_b32 a108, v136
    v_cvt_pk_bf16_f32 v166, v216, v217
    v_cvt_pk_bf16_f32 v167, v218, v219
    v_mfma_f32_16x16x32_bf16 v[216:219], v[32:35], v[172:175], v[184:187]
    s_add_u32 m0, s33, 0x1800
    v_accvgpr_write_b32 a109, v137
    v_accvgpr_write_b32 a110, v138
    v_cvt_pk_bf16_f32 v168, v204, v205
    v_cvt_pk_bf16_f32 v169, v206, v207
    v_mfma_f32_16x16x32_bf16 v[204:207], v[28:31], v[176:179], v[184:187]
    v_accvgpr_write_b32 a111, v139
    v_accvgpr_write_b32 a124, v140
    v_cvt_pk_bf16_f32 v170, v208, v209
    v_cvt_pk_bf16_f32 v171, v210, v211
    v_mfma_f32_16x16x32_bf16 v[208:211], v[32:35], v[176:179], v[184:187]
    s_add_u32 s37, s34, 0x360000
    v_accvgpr_write_b32 a125, v141
    v_accvgpr_write_b32 a126, v142
    v_cvt_pk_bf16_f32 v172, v212, v213
    v_cvt_pk_bf16_f32 v173, v214, v215
    v_mfma_f32_16x16x32_bf16 v[212:215], v[28:31], v[180:183], v[184:187]
    v_accvgpr_write_b32 a127, v143
    v_cvt_pk_bf16_f32 v174, v216, v217
    v_cvt_pk_bf16_f32 v175, v218, v219
    v_mfma_f32_16x16x32_bf16 v[216:219], v[32:35], v[180:183], v[184:187]
    s_waitcnt lgkmcnt(0)
    ds_read_b64_tr_b16 v[64:65], v5 offset:18432
    v_accvgpr_write_b32 a140, v144
    v_mfma_f32_16x16x32_bf16 v[96:99], v[40:43], a[0:3], 0
    buffer_load_dwordx4 v39, s[8:11], s37 offen lds
    v_mfma_f32_16x16x32_bf16 v[96:99], v[44:47], a[16:19], v[96:99]
    s_add_u32 m0, s33, 0x1c00
    ds_read_b64_tr_b16 v[66:67], v93 offset:34816
    v_accvgpr_write_b32 a141, v145
    v_mfma_f32_16x16x32_bf16 v[96:99], v[48:51], a[32:35], v[96:99]
    ds_read_b64_tr_b16 v[68:69], v5 offset:20480
    v_accvgpr_write_b32 a142, v146
    v_mfma_f32_16x16x32_bf16 v[96:99], v[52:55], a[48:51], v[96:99]
    s_add_u32 s37, s34, 0x384000
    ds_read_b64_tr_b16 v[70:71], v93 offset:36864
    v_accvgpr_write_b32 a143, v147
    v_mfma_f32_16x16x32_bf16 v[96:99], v[56:59], a[64:67], v[96:99]
    ds_read_b64_tr_b16 v[72:73], v5 offset:22528
    v_cvt_pk_bf16_f32 v236, v204, v205
    v_mfma_f32_16x16x32_bf16 v[96:99], v[60:63], a[80:83], v[96:99]
    buffer_load_dwordx4 v39, s[8:11], s37 offen lds
    v_mfma_f32_16x16x32_bf16 v[100:103], v[60:63], a[84:87], 0
    ds_read_b64_tr_b16 v[74:75], v93 offset:38912
    v_cvt_pk_bf16_f32 v237, v206, v207
    v_mfma_f32_16x16x32_bf16 v[100:103], v[56:59], a[68:71], v[100:103]
    s_add_u32 m0, s33, 0x2000
    ds_read_b64_tr_b16 v[76:77], v5 offset:24576
    v_cvt_pk_bf16_f32 v238, v208, v209
    v_mfma_f32_16x16x32_bf16 v[100:103], v[52:55], a[52:55], v[100:103]
    ds_read_b64_tr_b16 v[78:79], v93 offset:40960
    v_cvt_pk_bf16_f32 v239, v210, v211
    v_mfma_f32_16x16x32_bf16 v[100:103], v[48:51], a[36:39], v[100:103]
    s_add_u32 s37, s34, 0x3a8000
    ds_read_b64_tr_b16 v[80:81], v5 offset:26624
    v_accvgpr_write_b32 a156, v148
    v_mfma_f32_16x16x32_bf16 v[100:103], v[44:47], a[20:23], v[100:103]
    ds_read_b64_tr_b16 v[82:83], v93 offset:43008
    v_accvgpr_write_b32 a157, v149
    v_mfma_f32_16x16x32_bf16 v[100:103], v[40:43], a[4:7], v[100:103]
    buffer_load_dwordx4 v39, s[8:11], s37 offen lds
    v_mfma_f32_16x16x32_bf16 v[128:131], v[40:43], a[8:11], 0
    ds_read_b64_tr_b16 v[84:85], v5 offset:28672
    v_accvgpr_write_b32 a158, v150
    v_mfma_f32_16x16x32_bf16 v[128:131], v[44:47], a[24:27], v[128:131]
    s_add_u32 m0, s33, 0x2400
    ds_read_b64_tr_b16 v[86:87], v93 offset:45056
    v_accvgpr_write_b32 a159, v151
    v_mfma_f32_16x16x32_bf16 v[128:131], v[48:51], a[40:43], v[128:131]
    v_cvt_pk_bf16_f32 v252, v212, v213
    v_cvt_pk_bf16_f32 v253, v214, v215
    v_mfma_f32_16x16x32_bf16 v[128:131], v[52:55], a[56:59], v[128:131]
    s_add_u32 s37, s34, 0x3cc000
    v_cvt_pk_bf16_f32 v254, v216, v217
    v_cvt_pk_bf16_f32 v255, v218, v219
    v_mfma_f32_16x16x32_bf16 v[128:131], v[56:59], a[72:75], v[128:131]
    v_accvgpr_write_b32 a172, v152
    v_accvgpr_write_b32 a173, v153
    v_mfma_f32_16x16x32_bf16 v[128:131], v[60:63], a[88:91], v[128:131]
    buffer_load_dwordx4 v39, s[8:11], s37 offen lds
    v_mfma_f32_16x16x32_bf16 v[132:135], v[60:63], a[92:95], 0
    v_accvgpr_write_b32 a174, v154
    v_accvgpr_write_b32 a175, v155
    v_mfma_f32_16x16x32_bf16 v[132:135], v[56:59], a[76:79], v[132:135]
    s_add_u32 m0, s33, 0x2800
    v_accvgpr_write_b32 a188, v156
    v_accvgpr_write_b32 a189, v157
    v_mfma_f32_16x16x32_bf16 v[132:135], v[52:55], a[60:63], v[132:135]
    v_accvgpr_write_b32 a190, v158
    v_accvgpr_write_b32 a191, v159
    v_mfma_f32_16x16x32_bf16 v[132:135], v[48:51], a[44:47], v[132:135]
    s_add_u32 s37, s34, 0x3f0000
    v_accvgpr_write_b32 a204, v160
    v_accvgpr_write_b32 a205, v161
    v_mfma_f32_16x16x32_bf16 v[132:135], v[44:47], a[28:31], v[132:135]
    v_accvgpr_write_b32 a206, v162
    v_accvgpr_write_b32 a207, v163
    v_mfma_f32_16x16x32_bf16 v[132:135], v[40:43], a[12:15], v[132:135]
    buffer_load_dwordx4 v39, s[8:11], s37 offen lds
    s_waitcnt lgkmcnt(0)
    v_mfma_f32_16x16x32_bf16 v[104:107], v[64:67], a[0:3], 0
    ds_read_b64_tr_b16 v[40:41], v4 offset:59392
    v_accvgpr_write_b32 a220, v164
    v_mfma_f32_16x16x32_bf16 v[104:107], v[68:71], a[16:19], v[104:107]
    s_add_u32 m0, s33, 0x2c00
    ds_read_b64_tr_b16 v[42:43], v94 offset:10240
    v_accvgpr_write_b32 a221, v165
    v_mfma_f32_16x16x32_bf16 v[104:107], v[72:75], a[32:35], v[104:107]
    ds_read_b64_tr_b16 v[44:45], v4 offset:61440
    v_accvgpr_write_b32 a222, v166
    v_mfma_f32_16x16x32_bf16 v[104:107], v[76:79], a[48:51], v[104:107]
    s_add_u32 s37, s34, 0x414000
    ds_read_b64_tr_b16 v[46:47], v94 offset:12288
    v_accvgpr_write_b32 a223, v167
    v_mfma_f32_16x16x32_bf16 v[104:107], v[80:83], a[64:67], v[104:107]
    ds_read_b64_tr_b16 v[48:49], v4 offset:63488
    v_accvgpr_write_b32 a236, v168
    v_mfma_f32_16x16x32_bf16 v[104:107], v[84:87], a[80:83], v[104:107]
    buffer_load_dwordx4 v39, s[8:11], s37 offen lds
    v_mfma_f32_16x16x32_bf16 v[108:111], v[84:87], a[84:87], 0
    s_add_u32 m0, s33, 0x3000
    ds_read_b64_tr_b16 v[50:51], v94 offset:14336
    v_accvgpr_write_b32 a237, v169
    v_mfma_f32_16x16x32_bf16 v[108:111], v[80:83], a[68:71], v[108:111]
    ds_read_b64_tr_b16 v[52:53], v92 offset:0
    v_accvgpr_write_b32 a238, v170
    v_mfma_f32_16x16x32_bf16 v[108:111], v[76:79], a[52:55], v[108:111]
    s_add_u32 s37, s34, 0x438000
    ds_read_b64_tr_b16 v[54:55], v94 offset:16384
    v_accvgpr_write_b32 a239, v171
    v_mfma_f32_16x16x32_bf16 v[108:111], v[72:75], a[36:39], v[108:111]
    ds_read_b64_tr_b16 v[56:57], v92 offset:2048
    v_accvgpr_write_b32 a252, v172
    v_mfma_f32_16x16x32_bf16 v[108:111], v[68:71], a[20:23], v[108:111]
    buffer_load_dwordx4 v39, s[8:11], s37 offen lds
    v_mfma_f32_16x16x32_bf16 v[108:111], v[64:67], a[4:7], v[108:111]
    ds_read_b64_tr_b16 v[58:59], v94 offset:18432
    v_accvgpr_write_b32 a253, v173
    v_mfma_f32_16x16x32_bf16 v[136:139], v[64:67], a[8:11], 0
    s_add_u32 m0, s33, 0x3400
    ds_read_b64_tr_b16 v[60:61], v92 offset:4096
    v_accvgpr_write_b32 a254, v174
    v_mfma_f32_16x16x32_bf16 v[136:139], v[68:71], a[24:27], v[136:139]
    ds_read_b64_tr_b16 v[62:63], v94 offset:20480
    v_accvgpr_write_b32 a255, v175
    v_mfma_f32_16x16x32_bf16 v[136:139], v[72:75], a[40:43], v[136:139]
    s_add_u32 s37, s34, 0x45c000
    v_mfma_f32_16x16x32_bf16 v[136:139], v[76:79], a[56:59], v[136:139]
    v_mfma_f32_16x16x32_bf16 v[136:139], v[80:83], a[72:75], v[136:139]
    buffer_load_dwordx4 v39, s[8:11], s37 offen lds
    v_mfma_f32_16x16x32_bf16 v[136:139], v[84:87], a[88:91], v[136:139]
    v_mfma_f32_16x16x32_bf16 v[140:143], v[84:87], a[92:95], 0
    s_add_u32 m0, s33, 0x3800
    v_mfma_f32_16x16x32_bf16 v[140:143], v[80:83], a[76:79], v[140:143]
    v_mfma_f32_16x16x32_bf16 v[140:143], v[76:79], a[60:63], v[140:143]
    s_add_u32 s37, s34, 0x480000
    v_mfma_f32_16x16x32_bf16 v[140:143], v[72:75], a[44:47], v[140:143]
    v_mfma_f32_16x16x32_bf16 v[140:143], v[68:71], a[28:31], v[140:143]
    buffer_load_dwordx4 v39, s[8:11], s37 offen lds
    v_mfma_f32_16x16x32_bf16 v[140:143], v[64:67], a[12:15], v[140:143]
    v_mfma_f32_16x16x32_bf16 v[200:203], a[12:15], a[12:15], 0
    s_add_u32 m0, s33, 0x3c00
    v_mfma_f32_16x16x32_bf16 v[200:203], a[28:31], a[28:31], v[200:203]
    v_mfma_f32_16x16x32_bf16 v[200:203], a[44:47], a[44:47], v[200:203]
    s_add_u32 s37, s34, 0x4a4000
    v_mfma_f32_16x16x32_bf16 v[200:203], a[60:63], a[60:63], v[200:203]
    v_mfma_f32_16x16x32_bf16 v[200:203], a[76:79], a[76:79], v[200:203]
    buffer_load_dwordx4 v39, s[8:11], s37 offen lds
    v_mfma_f32_16x16x32_bf16 v[200:203], a[92:95], a[92:95], v[200:203]
    v_mfma_f32_16x16x32_bf16 v[200:203], a[108:111], a[108:111], v[200:203]
    s_add_u32 m0, s33, 0x4000
    v_mfma_f32_16x16x32_bf16 v[200:203], a[124:127], a[124:127], v[200:203]
    v_mfma_f32_16x16x32_bf16 v[200:203], a[140:143], a[140:143], v[200:203]
    s_add_u32 s37, s34, 0x4c8000
    v_mfma_f32_16x16x32_bf16 v[200:203], a[156:159], a[156:159], v[200:203]
    v_cndmask_b32 v188, v188, v189, s[84:85]
    v_mfma_f32_16x16x32_bf16 v[200:203], a[172:175], a[172:175], v[200:203]
    buffer_load_dwordx4 v39, s[8:11], s37 offen lds
    v_mfma_f32_16x16x32_bf16 v[200:203], a[188:191], a[188:191], v[200:203]
    v_cndmask_b32 v188, v188, v190, s[86:87]
    v_mfma_f32_16x16x32_bf16 v[200:203], a[204:207], a[204:207], v[200:203]
    s_add_u32 m0, s33, 0x4400
    v_cndmask_b32 v188, v188, v191, s[88:89]
    v_mfma_f32_16x16x32_bf16 v[200:203], a[220:223], a[220:223], v[200:203]
    v_mfma_f32_16x16x32_bf16 v[200:203], a[236:239], a[236:239], v[200:203]
    s_add_u32 s37, s34, 0x4ec000
    v_cndmask_b32 v188, 0, v188, s[90:91]
    v_mfma_f32_16x16x32_bf16 v[200:203], a[252:255], a[252:255], v[200:203]
    v_mov_b32 v189, v188
    v_mfma_f32_16x16x32_bf16 v[200:203], v[236:239], v[236:239], v[200:203]
    buffer_load_dwordx4 v39, s[8:11], s37 offen lds
    v_mfma_f32_16x16x32_bf16 v[200:203], v[252:255], v[252:255], v[200:203]
    s_waitcnt lgkmcnt(0)
    ds_read_b64_tr_b16 v[64:65], v5 offset:59392
    ds_read_b64_tr_b16 v[66:67], v95 offset:10240
    v_mfma_f32_16x16x32_bf16 v[112:115], v[40:43], a[0:3], 0
    ds_read_b64_tr_b16 v[68:69], v5 offset:61440
    ds_read_b64_tr_b16 v[70:71], v95 offset:12288
    v_mfma_f32_16x16x32_bf16 v[112:115], v[44:47], a[16:19], v[112:115]
    ds_read_b64_tr_b16 v[72:73], v5 offset:63488
    v_permlane16_swap_b32 v188, v189
    v_mfma_f32_16x16x32_bf16 v[112:115], v[48:51], a[32:35], v[112:115]
    ds_read_b64_tr_b16 v[74:75], v95 offset:14336
    v_add_f32 v188, v188, v189
    v_mfma_f32_16x16x32_bf16 v[112:115], v[52:55], a[48:51], v[112:115]
    ds_read_b64_tr_b16 v[76:77], v93 offset:0
    v_mov_b32 v189, v188
    v_mfma_f32_16x16x32_bf16 v[112:115], v[56:59], a[64:67], v[112:115]
    ds_read_b64_tr_b16 v[78:79], v95 offset:16384
    v_permlane32_swap_b32 v188, v189
    v_mfma_f32_16x16x32_bf16 v[112:115], v[60:63], a[80:83], v[112:115]
    ds_read_b64_tr_b16 v[80:81], v93 offset:2048
    v_add_f32 v188, v188, v189
    v_mfma_f32_16x16x32_bf16 v[116:119], v[60:63], a[84:87], 0
    ds_read_b64_tr_b16 v[82:83], v95 offset:18432
    v_mov_b32 v16, 0x3727c5ac
    v_mfma_f32_16x16x32_bf16 v[116:119], v[56:59], a[68:71], v[116:119]
    ds_read_b64_tr_b16 v[84:85], v93 offset:4096
    v_fmac_f32 v16, 0x3ae38e39, v188
    v_mfma_f32_16x16x32_bf16 v[116:119], v[52:55], a[52:55], v[116:119]
    v_rsq_f32 v188, v16
    v_mfma_f32_16x16x32_bf16 v[116:119], v[48:51], a[36:39], v[116:119]
    ds_read_b64_tr_b16 v[86:87], v95 offset:20480
    v_mfma_f32_16x16x32_bf16 v[116:119], v[44:47], a[20:23], v[116:119]
    v_mfma_f32_16x16x32_bf16 v[116:119], v[40:43], a[4:7], v[116:119]
    v_mul_f32 v8, 0xc0135761, v188
    v_mfma_f32_16x16x32_bf16 v[144:147], v[40:43], a[8:11], 0
    v_mul_f32 v188, v188, v188
    v_mfma_f32_16x16x32_bf16 v[144:147], v[44:47], a[24:27], v[144:147]
    v_mfma_f32_16x16x32_bf16 v[144:147], v[48:51], a[40:43], v[144:147]
    v_mul_f32 v188, 0x3d372713, v188
    v_mfma_f32_16x16x32_bf16 v[144:147], v[52:55], a[56:59], v[144:147]
    v_mul_f32 v12, v188, v8
    v_mfma_f32_16x16x32_bf16 v[144:147], v[56:59], a[72:75], v[144:147]
    v_cndmask_b32 v192, v192, v193, s[84:85]
    v_mfma_f32_16x16x32_bf16 v[144:147], v[60:63], a[88:91], v[144:147]
    v_mfma_f32_16x16x32_bf16 v[148:151], v[60:63], a[92:95], 0
    v_cndmask_b32 v192, v192, v194, s[86:87]
    v_mfma_f32_16x16x32_bf16 v[148:151], v[56:59], a[76:79], v[148:151]
    v_cndmask_b32 v192, v192, v195, s[88:89]
    v_mfma_f32_16x16x32_bf16 v[148:151], v[52:55], a[60:63], v[148:151]
    v_mfma_f32_16x16x32_bf16 v[148:151], v[48:51], a[44:47], v[148:151]
    v_cndmask_b32 v192, 0, v192, s[90:91]
    v_mfma_f32_16x16x32_bf16 v[148:151], v[44:47], a[28:31], v[148:151]
    v_mov_b32 v193, v192
    v_mfma_f32_16x16x32_bf16 v[148:151], v[40:43], a[12:15], v[148:151]
    s_waitcnt lgkmcnt(0)
    s_waitcnt vmcnt(12)
    s_barrier
    v_mfma_f32_16x16x32_bf16 v[120:123], v[64:67], a[0:3], 0
    ds_read_b64_tr_b16 v[40:41], v4 offset:30720
    ds_read_b64_tr_b16 v[42:43], v92 offset:47104
    v_mfma_f32_16x16x32_bf16 v[120:123], v[68:71], a[16:19], v[120:123]
    ds_read_b64_tr_b16 v[44:45], v4 offset:32768
    ds_read_b64_tr_b16 v[46:47], v92 offset:49152
    v_mfma_f32_16x16x32_bf16 v[120:123], v[72:75], a[32:35], v[120:123]
    ds_read_b64_tr_b16 v[48:49], v4 offset:34816
    ds_read_b64_tr_b16 v[50:51], v92 offset:51200
    v_mfma_f32_16x16x32_bf16 v[120:123], v[76:79], a[48:51], v[120:123]
    ds_read_b64_tr_b16 v[52:53], v4 offset:0
    v_permlane16_swap_b32 v192, v193
    v_mfma_f32_16x16x32_bf16 v[120:123], v[80:83], a[64:67], v[120:123]
    ds_read_b64_tr_b16 v[54:55], v92 offset:16384
    v_add_f32 v192, v192, v193
    v_mfma_f32_16x16x32_bf16 v[120:123], v[84:87], a[80:83], v[120:123]
    ds_read_b64_tr_b16 v[56:57], v4 offset:2048
    v_mov_b32 v193, v192
    v_mfma_f32_16x16x32_bf16 v[124:127], v[84:87], a[84:87], 0
    ds_read_b64_tr_b16 v[58:59], v92 offset:18432
    v_permlane32_swap_b32 v192, v193
    v_mfma_f32_16x16x32_bf16 v[124:127], v[80:83], a[68:71], v[124:127]
    ds_read_b64_tr_b16 v[60:61], v4 offset:4096
    v_add_f32 v192, v192, v193
    v_mfma_f32_16x16x32_bf16 v[124:127], v[76:79], a[52:55], v[124:127]
    ds_read_b64_tr_b16 v[62:63], v92 offset:20480
    v_mov_b32 v17, 0x3727c5ac
    v_mfma_f32_16x16x32_bf16 v[124:127], v[72:75], a[36:39], v[124:127]
    v_fmac_f32 v17, 0x3ae38e39, v192
    v_mfma_f32_16x16x32_bf16 v[124:127], v[68:71], a[20:23], v[124:127]
    v_rsq_f32 v192, v17
    v_mfma_f32_16x16x32_bf16 v[124:127], v[64:67], a[4:7], v[124:127]
    v_mfma_f32_16x16x32_bf16 v[152:155], v[64:67], a[8:11], 0
    v_mul_f32 v9, 0xc0135761, v192
    v_mfma_f32_16x16x32_bf16 v[152:155], v[68:71], a[24:27], v[152:155]
    v_mul_f32 v192, v192, v192
    v_mfma_f32_16x16x32_bf16 v[152:155], v[72:75], a[40:43], v[152:155]
    v_mfma_f32_16x16x32_bf16 v[152:155], v[76:79], a[56:59], v[152:155]
    v_mul_f32 v192, 0x3d372713, v192
    v_mfma_f32_16x16x32_bf16 v[152:155], v[80:83], a[72:75], v[152:155]
    v_mul_f32 v13, v192, v9
    v_mfma_f32_16x16x32_bf16 v[152:155], v[84:87], a[88:91], v[152:155]
    v_cndmask_b32 v196, v196, v197, s[84:85]
    v_mfma_f32_16x16x32_bf16 v[156:159], v[84:87], a[92:95], 0
    v_mfma_f32_16x16x32_bf16 v[156:159], v[80:83], a[76:79], v[156:159]
    v_cndmask_b32 v196, v196, v198, s[86:87]
    v_mfma_f32_16x16x32_bf16 v[156:159], v[76:79], a[60:63], v[156:159]
    v_cndmask_b32 v196, v196, v199, s[88:89]
    v_mfma_f32_16x16x32_bf16 v[156:159], v[72:75], a[44:47], v[156:159]
    v_mfma_f32_16x16x32_bf16 v[156:159], v[68:71], a[28:31], v[156:159]
    v_cndmask_b32 v196, 0, v196, s[90:91]
    v_mfma_f32_16x16x32_bf16 v[156:159], v[64:67], a[12:15], v[156:159]
    s_waitcnt lgkmcnt(0)
    ds_read_b64_tr_b16 v[64:65], v5 offset:30720
    ds_read_b64_tr_b16 v[66:67], v93 offset:47104
    v_mfma_f32_16x16x32_bf16 v[96:99], v[40:43], a[96:99], v[96:99]
    ds_read_b64_tr_b16 v[68:69], v5 offset:32768
    ds_read_b64_tr_b16 v[70:71], v93 offset:49152
    v_mfma_f32_16x16x32_bf16 v[96:99], v[44:47], a[112:115], v[96:99]
    ds_read_b64_tr_b16 v[72:73], v5 offset:34816
    ds_read_b64_tr_b16 v[74:75], v93 offset:51200
    v_mfma_f32_16x16x32_bf16 v[96:99], v[48:51], a[128:131], v[96:99]
    ds_read_b64_tr_b16 v[76:77], v5 offset:0
    v_mov_b32 v197, v196
    v_mfma_f32_16x16x32_bf16 v[96:99], v[52:55], a[144:147], v[96:99]
    ds_read_b64_tr_b16 v[78:79], v93 offset:16384
    v_permlane16_swap_b32 v196, v197
    v_mfma_f32_16x16x32_bf16 v[96:99], v[56:59], a[160:163], v[96:99]
    ds_read_b64_tr_b16 v[80:81], v5 offset:2048
    v_add_f32 v196, v196, v197
    v_mfma_f32_16x16x32_bf16 v[96:99], v[60:63], a[176:179], v[96:99]
    ds_read_b64_tr_b16 v[82:83], v93 offset:18432
    v_mov_b32 v197, v196
    v_mfma_f32_16x16x32_bf16 v[100:103], v[60:63], a[180:183], v[100:103]
    ds_read_b64_tr_b16 v[84:85], v5 offset:4096
    v_permlane32_swap_b32 v196, v197
    v_mfma_f32_16x16x32_bf16 v[100:103], v[56:59], a[164:167], v[100:103]
    ds_read_b64_tr_b16 v[86:87], v93 offset:20480
    v_add_f32 v196, v196, v197
    v_mfma_f32_16x16x32_bf16 v[100:103], v[52:55], a[148:151], v[100:103]
    v_mov_b32 v18, 0x3727c5ac
    v_mfma_f32_16x16x32_bf16 v[100:103], v[48:51], a[132:135], v[100:103]
    v_fmac_f32 v18, 0x3ae38e39, v196
    v_mfma_f32_16x16x32_bf16 v[100:103], v[44:47], a[116:119], v[100:103]
    v_rsq_f32 v196, v18
    v_mfma_f32_16x16x32_bf16 v[100:103], v[40:43], a[100:103], v[100:103]
    v_mfma_f32_16x16x32_bf16 v[128:131], v[40:43], a[104:107], v[128:131]
    v_mfma_f32_16x16x32_bf16 v[128:131], v[44:47], a[120:123], v[128:131]
    v_mul_f32 v10, 0xc0135761, v196
    v_mfma_f32_16x16x32_bf16 v[128:131], v[48:51], a[136:139], v[128:131]
    v_mul_f32 v196, v196, v196
    v_mfma_f32_16x16x32_bf16 v[128:131], v[52:55], a[152:155], v[128:131]
    v_mfma_f32_16x16x32_bf16 v[128:131], v[56:59], a[168:171], v[128:131]
    v_mul_f32 v196, 0x3d372713, v196
    v_mfma_f32_16x16x32_bf16 v[128:131], v[60:63], a[184:187], v[128:131]
    v_mul_f32 v14, v196, v10
    v_mfma_f32_16x16x32_bf16 v[132:135], v[60:63], a[188:191], v[132:135]
    v_cndmask_b32 v200, v200, v201, s[84:85]
    v_mfma_f32_16x16x32_bf16 v[132:135], v[56:59], a[172:175], v[132:135]
    v_mfma_f32_16x16x32_bf16 v[132:135], v[52:55], a[156:159], v[132:135]
    v_cndmask_b32 v200, v200, v202, s[86:87]
    v_mfma_f32_16x16x32_bf16 v[132:135], v[48:51], a[140:143], v[132:135]
    v_cndmask_b32 v200, v200, v203, s[88:89]
    v_mfma_f32_16x16x32_bf16 v[132:135], v[44:47], a[124:127], v[132:135]
    v_mfma_f32_16x16x32_bf16 v[132:135], v[40:43], a[108:111], v[132:135]
    s_waitcnt lgkmcnt(0)
    ds_read_b64_tr_b16 v[40:41], v92 offset:6144
    ds_read_b64_tr_b16 v[42:43], v94 offset:22528
    v_mfma_f32_16x16x32_bf16 v[140:143], v[64:67], a[108:111], v[140:143]
    ds_read_b64_tr_b16 v[44:45], v92 offset:8192
    ds_read_b64_tr_b16 v[46:47], v94 offset:24576
    v_mfma_f32_16x16x32_bf16 v[140:143], v[68:71], a[124:127], v[140:143]
    ds_read_b64_tr_b16 v[48:49], v92 offset:10240
    v_cndmask_b32 v200, 0, v200, s[90:91]
    v_mfma_f32_16x16x32_bf16 v[140:143], v[72:75], a[140:143], v[140:143]
    ds_read_b64_tr_b16 v[50:51], v94 offset:26624
    v_mov_b32 v201, v200
    v_mfma_f32_16x16x32_bf16 v[140:143], v[76:79], a[156:159], v[140:143]
    ds_read_b64_tr_b16 v[52:53], v4 offset:40960
    v_permlane16_swap_b32 v200, v201
    v_mfma_f32_16x16x32_bf16 v[140:143], v[80:83], a[172:175], v[140:143]
    ds_read_b64_tr_b16 v[54:55], v92 offset:57344
    v_add_f32 v200, v200, v201
    v_mfma_f32_16x16x32_bf16 v[140:143], v[84:87], a[188:191], v[140:143]
    ds_read_b64_tr_b16 v[56:57], v4 offset:43008
    v_mov_b32 v201, v200
    v_mfma_f32_16x16x32_bf16 v[136:139], v[84:87], a[184:187], v[136:139]
    ds_read_b64_tr_b16 v[58:59], v92 offset:59392
    ds_read_b64_tr_b16 v[60:61], v4 offset:45056
    v_mfma_f32_16x16x32_bf16 v[136:139], v[80:83], a[168:171], v[136:139]
    ds_read_b64_tr_b16 v[62:63], v92 offset:61440
    v_permlane32_swap_b32 v200, v201
    v_mfma_f32_16x16x32_bf16 v[136:139], v[76:79], a[152:155], v[136:139]
    v_add_f32 v200, v200, v201
    v_mov_b32 v88, -1
    v_mfma_f32_16x16x32_bf16 v[136:139], v[72:75], a[136:139], v[136:139]
    v_mov_b32 v19, 0x3727c5ac
    v_mfma_f32_16x16x32_bf16 v[136:139], v[68:71], a[120:123], v[136:139]
    v_fmac_f32 v19, 0x3ae38e39, v200
    v_mfma_f32_16x16x32_bf16 v[136:139], v[64:67], a[104:107], v[136:139]
    v_rsq_f32 v200, v19
    v_mfma_f32_16x16x32_bf16 v[108:111], v[64:67], a[100:103], v[108:111]
    v_mfma_f32_16x16x32_bf16 v[108:111], v[68:71], a[116:119], v[108:111]
    v_mfma_f32_16x16x32_bf16 v[108:111], v[72:75], a[132:135], v[108:111]
    v_mul_f32 v11, 0xc0135761, v200
    v_mfma_f32_16x16x32_bf16 v[108:111], v[76:79], a[148:151], v[108:111]
    v_mov_b32 v89, -1
    v_mul_f32 v200, v200, v200
    v_mfma_f32_16x16x32_bf16 v[108:111], v[80:83], a[164:167], v[108:111]
    v_mfma_f32_16x16x32_bf16 v[108:111], v[84:87], a[180:183], v[108:111]
    v_mul_f32 v200, 0x3d372713, v200
    v_mfma_f32_16x16x32_bf16 v[104:107], v[84:87], a[176:179], v[104:107]
    v_mul_f32 v15, v200, v11
    v_mfma_f32_16x16x32_bf16 v[104:107], v[80:83], a[160:163], v[104:107]
    v_mfma_f32_16x16x32_bf16 v[104:107], v[76:79], a[144:147], v[104:107]
    v_mfma_f32_16x16x32_bf16 v[104:107], v[72:75], a[128:131], v[104:107]
    v_mfma_f32_16x16x32_bf16 v[104:107], v[68:71], a[112:115], v[104:107]
    v_mfma_f32_16x16x32_bf16 v[104:107], v[64:67], a[96:99], v[104:107]
    s_waitcnt lgkmcnt(0)
    ds_read_b64_tr_b16 v[64:65], v93 offset:6144
    ds_read_b64_tr_b16 v[66:67], v95 offset:22528
    v_mfma_f32_16x16x32_bf16 v[112:115], v[40:43], a[96:99], v[112:115]
    ds_read_b64_tr_b16 v[68:69], v93 offset:8192
    ds_read_b64_tr_b16 v[70:71], v95 offset:24576
    v_mfma_f32_16x16x32_bf16 v[112:115], v[44:47], a[112:115], v[112:115]
    ds_read_b64_tr_b16 v[72:73], v93 offset:10240
    v_mov_b32 v90, -1
    v_mfma_f32_16x16x32_bf16 v[112:115], v[48:51], a[128:131], v[112:115]
    ds_read_b64_tr_b16 v[74:75], v95 offset:26624
    ds_read_b64_tr_b16 v[76:77], v5 offset:40960
    v_mfma_f32_16x16x32_bf16 v[112:115], v[52:55], a[144:147], v[112:115]
    ds_read_b64_tr_b16 v[78:79], v93 offset:57344
    ds_read_b64_tr_b16 v[80:81], v5 offset:43008
    v_mfma_f32_16x16x32_bf16 v[112:115], v[56:59], a[160:163], v[112:115]
    ds_read_b64_tr_b16 v[82:83], v93 offset:59392
    v_mfma_f32_16x16x32_bf16 v[112:115], v[60:63], a[176:179], v[112:115]
    v_mfma_f32_16x16x32_bf16 v[116:119], v[60:63], a[180:183], v[116:119]
    ds_read_b64_tr_b16 v[84:85], v5 offset:45056
    v_mov_b32 v91, -1
    v_mfma_f32_16x16x32_bf16 v[116:119], v[56:59], a[164:167], v[116:119]
    ds_read_b64_tr_b16 v[86:87], v93 offset:61440
    v_mfma_f32_16x16x32_bf16 v[116:119], v[52:55], a[148:151], v[116:119]
    v_mfma_f32_16x16x32_bf16 v[116:119], v[48:51], a[132:135], v[116:119]
    v_mfma_f32_16x16x32_bf16 v[116:119], v[44:47], a[116:119], v[116:119]
    v_mfma_f32_16x16x32_bf16 v[116:119], v[40:43], a[100:103], v[116:119]
    v_mfma_f32_16x16x32_bf16 v[144:147], v[40:43], a[104:107], v[144:147]
    v_mfma_f32_16x16x32_bf16 v[144:147], v[44:47], a[120:123], v[144:147]
    v_mfma_f32_16x16x32_bf16 v[144:147], v[48:51], a[136:139], v[144:147]
    v_mfma_f32_16x16x32_bf16 v[144:147], v[52:55], a[152:155], v[144:147]
    v_mfma_f32_16x16x32_bf16 v[144:147], v[56:59], a[168:171], v[144:147]
    v_mfma_f32_16x16x32_bf16 v[144:147], v[60:63], a[184:187], v[144:147]
    v_mfma_f32_16x16x32_bf16 v[148:151], v[60:63], a[188:191], v[148:151]
    v_mfma_f32_16x16x32_bf16 v[148:151], v[56:59], a[172:175], v[148:151]
    v_mfma_f32_16x16x32_bf16 v[148:151], v[52:55], a[156:159], v[148:151]
    v_mfma_f32_16x16x32_bf16 v[148:151], v[48:51], a[140:143], v[148:151]
    v_mfma_f32_16x16x32_bf16 v[148:151], v[44:47], a[124:127], v[148:151]
    s_lshl_b32 s38, s2, 2
    v_mfma_f32_16x16x32_bf16 v[148:151], v[40:43], a[108:111], v[148:151]
    s_waitcnt lgkmcnt(0)
    s_waitcnt vmcnt(0)
    s_barrier
    v_mfma_f32_16x16x32_bf16 v[156:159], v[64:67], a[108:111], v[156:159]
    ds_read_b64_tr_b16 v[40:41], v4 offset:6144
    ds_read_b64_tr_b16 v[42:43], v92 offset:22528
    v_mfma_f32_16x16x32_bf16 v[156:159], v[68:71], a[124:127], v[156:159]
    ds_read_b64_tr_b16 v[44:45], v4 offset:8192
    ds_read_b64_tr_b16 v[46:47], v92 offset:24576
    v_mfma_f32_16x16x32_bf16 v[156:159], v[72:75], a[140:143], v[156:159]
    ds_read_b64_tr_b16 v[48:49], v4 offset:10240
    ds_read_b64_tr_b16 v[50:51], v92 offset:26624
    v_mfma_f32_16x16x32_bf16 v[156:159], v[76:79], a[156:159], v[156:159]
    ds_read_b64_tr_b16 v[52:53], v4 offset:12288
    ds_read_b64_tr_b16 v[54:55], v92 offset:28672
    v_mfma_f32_16x16x32_bf16 v[156:159], v[80:83], a[172:175], v[156:159]
    ds_read_b64_tr_b16 v[56:57], v4 offset:14336
    ds_read_b64_tr_b16 v[58:59], v92 offset:30720
    v_mfma_f32_16x16x32_bf16 v[156:159], v[84:87], a[188:191], v[156:159]
    v_mfma_f32_16x16x32_bf16 v[152:155], v[84:87], a[184:187], v[152:155]
    s_add_u32 s38, s38, s32
    ds_read_b64_tr_b16 v[60:61], v4 offset:16384
    v_mfma_f32_16x16x32_bf16 v[152:155], v[80:83], a[168:171], v[152:155]
    ds_read_b64_tr_b16 v[62:63], v92 offset:32768
    v_mfma_f32_16x16x32_bf16 v[152:155], v[76:79], a[152:155], v[152:155]
    v_mfma_f32_16x16x32_bf16 v[152:155], v[72:75], a[136:139], v[152:155]
    v_mfma_f32_16x16x32_bf16 v[152:155], v[68:71], a[120:123], v[152:155]
    v_mfma_f32_16x16x32_bf16 v[152:155], v[64:67], a[104:107], v[152:155]
    v_mfma_f32_16x16x32_bf16 v[124:127], v[64:67], a[100:103], v[124:127]
    v_mfma_f32_16x16x32_bf16 v[124:127], v[68:71], a[116:119], v[124:127]
    s_mul_i32 s38, s38, 9216
    v_mfma_f32_16x16x32_bf16 v[124:127], v[72:75], a[132:135], v[124:127]
    v_mfma_f32_16x16x32_bf16 v[124:127], v[76:79], a[148:151], v[124:127]
    v_mfma_f32_16x16x32_bf16 v[124:127], v[80:83], a[164:167], v[124:127]
    v_mfma_f32_16x16x32_bf16 v[124:127], v[84:87], a[180:183], v[124:127]
    v_mfma_f32_16x16x32_bf16 v[120:123], v[84:87], a[176:179], v[120:123]
    v_mfma_f32_16x16x32_bf16 v[120:123], v[80:83], a[160:163], v[120:123]
    v_mfma_f32_16x16x32_bf16 v[120:123], v[76:79], a[144:147], v[120:123]
    v_mfma_f32_16x16x32_bf16 v[120:123], v[72:75], a[128:131], v[120:123]
    s_add_u32 s38, s38, 0x5c00000
    v_mfma_f32_16x16x32_bf16 v[120:123], v[68:71], a[112:115], v[120:123]
    v_mfma_f32_16x16x32_bf16 v[120:123], v[64:67], a[96:99], v[120:123]
    s_waitcnt lgkmcnt(0)
    ds_read_b64_tr_b16 v[64:65], v5 offset:6144
    ds_read_b64_tr_b16 v[66:67], v93 offset:22528
    v_mfma_f32_16x16x32_bf16 v[96:99], v[40:43], a[192:195], v[96:99]
    ds_read_b64_tr_b16 v[68:69], v5 offset:8192
    ds_read_b64_tr_b16 v[70:71], v93 offset:24576
    v_mfma_f32_16x16x32_bf16 v[96:99], v[44:47], a[208:211], v[96:99]
    ds_read_b64_tr_b16 v[72:73], v5 offset:10240
    ds_read_b64_tr_b16 v[74:75], v93 offset:26624
    v_mfma_f32_16x16x32_bf16 v[96:99], v[48:51], a[224:227], v[96:99]
    ds_read_b64_tr_b16 v[76:77], v5 offset:12288
    ds_read_b64_tr_b16 v[78:79], v93 offset:28672
    v_mfma_f32_16x16x32_bf16 v[96:99], v[52:55], a[240:243], v[96:99]
    ds_read_b64_tr_b16 v[80:81], v5 offset:14336
    v_mfma_f32_16x16x32_bf16 v[96:99], v[56:59], v[224:227], v[96:99]
    s_lshl_b32 s45, s2, 8
    ds_read_b64_tr_b16 v[82:83], v93 offset:30720
    v_mfma_f32_16x16x32_bf16 v[96:99], v[60:63], v[240:243], v[96:99]
    buffer_store_dwordx4 v[88:91], v1, s[28:31], s38 offen offset:0 sc1
    v_mfma_f32_16x16x32_bf16 v[100:103], v[60:63], v[244:247], v[100:103]
    s_add_u32 s45, s45, s32
    ds_read_b64_tr_b16 v[84:85], v5 offset:16384
    v_mfma_f32_16x16x32_bf16 v[100:103], v[56:59], v[228:231], v[100:103]
    ds_read_b64_tr_b16 v[86:87], v93 offset:32768
    v_mfma_f32_16x16x32_bf16 v[100:103], v[52:55], a[244:247], v[100:103]
    s_mov_b32 s26, 0x7f000000
    v_mfma_f32_16x16x32_bf16 v[100:103], v[48:51], a[228:231], v[100:103]
    v_mfma_f32_16x16x32_bf16 v[100:103], v[44:47], a[212:215], v[100:103]
    s_mov_b32 s27, 0x100000
    v_mfma_f32_16x16x32_bf16 v[100:103], v[40:43], a[196:199], v[100:103]
    v_mfma_f32_16x16x32_bf16 v[128:131], v[40:43], a[200:203], v[128:131]
    buffer_store_dwordx4 v[88:91], v1, s[28:31], s38 offen offset:1024 sc1
    v_mfma_f32_16x16x32_bf16 v[128:131], v[44:47], a[216:219], v[128:131]
    s_mov_b32 s49, 0x7f000000
    v_mfma_f32_16x16x32_bf16 v[128:131], v[48:51], a[232:235], v[128:131]
    v_mfma_f32_16x16x32_bf16 v[128:131], v[52:55], a[248:251], v[128:131]
    v_mfma_f32_16x16x32_bf16 v[128:131], v[56:59], v[232:235], v[128:131]
    v_mfma_f32_16x16x32_bf16 v[128:131], v[60:63], v[248:251], v[128:131]
    v_mfma_f32_16x16x32_bf16 v[132:135], v[60:63], v[252:255], v[132:135]
    v_mfma_f32_16x16x32_bf16 v[132:135], v[56:59], v[236:239], v[132:135]
    v_mfma_f32_16x16x32_bf16 v[132:135], v[52:55], a[252:255], v[132:135]
    buffer_store_dwordx4 v[88:91], v1, s[28:31], s38 offen offset:2048 sc1
    v_mfma_f32_16x16x32_bf16 v[132:135], v[48:51], a[236:239], v[132:135]
    v_mfma_f32_16x16x32_bf16 v[132:135], v[44:47], a[220:223], v[132:135]
    v_mfma_f32_16x16x32_bf16 v[132:135], v[40:43], a[204:207], v[132:135]
    s_waitcnt lgkmcnt(0)
    ds_read_b64_tr_b16 v[40:41], v4 offset:47104
    ds_read_b64_tr_b16 v[42:43], v92 offset:63488
    v_mfma_f32_16x16x32_bf16 v[140:143], v[64:67], a[204:207], v[140:143]
    ds_read_b64_tr_b16 v[44:45], v4 offset:49152
    ds_read_b64_tr_b16 v[46:47], v94 offset:0
    v_mfma_f32_16x16x32_bf16 v[140:143], v[68:71], a[220:223], v[140:143]
    ds_read_b64_tr_b16 v[48:49], v4 offset:51200
    ds_read_b64_tr_b16 v[50:51], v94 offset:2048
    v_mfma_f32_16x16x32_bf16 v[140:143], v[72:75], a[236:239], v[140:143]
    ds_read_b64_tr_b16 v[52:53], v4 offset:53248
    ds_read_b64_tr_b16 v[54:55], v94 offset:4096
    v_mfma_f32_16x16x32_bf16 v[140:143], v[76:79], a[252:255], v[140:143]
    buffer_store_dwordx4 v[88:91], v1, s[28:31], s38 offen offset:3072 sc1
    v_mfma_f32_16x16x32_bf16 v[140:143], v[80:83], v[236:239], v[140:143]
    ds_read_b64_tr_b16 v[56:57], v4 offset:55296
    ds_read_b64_tr_b16 v[58:59], v94 offset:6144
    v_mfma_f32_16x16x32_bf16 v[140:143], v[84:87], v[252:255], v[140:143]
    v_mfma_f32_16x16x32_bf16 v[136:139], v[84:87], v[248:251], v[136:139]
    ds_read_b64_tr_b16 v[60:61], v4 offset:57344
    v_mfma_f32_16x16x32_bf16 v[136:139], v[80:83], v[232:235], v[136:139]
    ds_read_b64_tr_b16 v[62:63], v94 offset:8192
    v_mfma_f32_16x16x32_bf16 v[136:139], v[76:79], a[248:251], v[136:139]
    v_mfma_f32_16x16x32_bf16 v[136:139], v[72:75], a[232:235], v[136:139]
    v_mfma_f32_16x16x32_bf16 v[136:139], v[68:71], a[216:219], v[136:139]
    v_mfma_f32_16x16x32_bf16 v[136:139], v[64:67], a[200:203], v[136:139]
    s_add_u32 s38, s38, 4096
    v_mfma_f32_16x16x32_bf16 v[108:111], v[64:67], a[196:199], v[108:111]
    v_mfma_f32_16x16x32_bf16 v[108:111], v[68:71], a[212:215], v[108:111]
    v_mfma_f32_16x16x32_bf16 v[108:111], v[72:75], a[228:231], v[108:111]
    v_mfma_f32_16x16x32_bf16 v[108:111], v[76:79], a[244:247], v[108:111]
    v_mfma_f32_16x16x32_bf16 v[108:111], v[80:83], v[228:231], v[108:111]
    v_mfma_f32_16x16x32_bf16 v[108:111], v[84:87], v[244:247], v[108:111]
    v_mfma_f32_16x16x32_bf16 v[104:107], v[84:87], v[240:243], v[104:107]
    v_mfma_f32_16x16x32_bf16 v[104:107], v[80:83], v[224:227], v[104:107]
    buffer_store_dwordx4 v[88:91], v1, s[28:31], s38 offen offset:0 sc1
    v_mfma_f32_16x16x32_bf16 v[104:107], v[76:79], a[240:243], v[104:107]
    v_mfma_f32_16x16x32_bf16 v[104:107], v[72:75], a[224:227], v[104:107]
    v_mfma_f32_16x16x32_bf16 v[104:107], v[68:71], a[208:211], v[104:107]
    v_mfma_f32_16x16x32_bf16 v[104:107], v[64:67], a[192:195], v[104:107]
    s_waitcnt lgkmcnt(0)
    ds_read_b64_tr_b16 v[64:65], v5 offset:47104
    ds_read_b64_tr_b16 v[66:67], v93 offset:63488
    v_mfma_f32_16x16x32_bf16 v[112:115], v[40:43], a[192:195], v[112:115]
    ds_read_b64_tr_b16 v[68:69], v5 offset:49152
    ds_read_b64_tr_b16 v[70:71], v95 offset:0
    v_mfma_f32_16x16x32_bf16 v[112:115], v[44:47], a[208:211], v[112:115]
    ds_read_b64_tr_b16 v[72:73], v5 offset:51200
    ds_read_b64_tr_b16 v[74:75], v95 offset:2048
    v_mfma_f32_16x16x32_bf16 v[112:115], v[48:51], a[224:227], v[112:115]
    buffer_store_dwordx4 v[88:91], v1, s[28:31], s38 offen offset:1024 sc1
    v_mfma_f32_16x16x32_bf16 v[112:115], v[52:55], a[240:243], v[112:115]
    ds_read_b64_tr_b16 v[76:77], v5 offset:53248
    ds_read_b64_tr_b16 v[78:79], v95 offset:4096
    v_mfma_f32_16x16x32_bf16 v[112:115], v[56:59], v[224:227], v[112:115]
    ds_read_b64_tr_b16 v[80:81], v5 offset:55296
    ds_read_b64_tr_b16 v[82:83], v95 offset:6144
    v_mfma_f32_16x16x32_bf16 v[112:115], v[60:63], v[240:243], v[112:115]
    v_mfma_f32_16x16x32_bf16 v[116:119], v[60:63], v[244:247], v[116:119]
    ds_read_b64_tr_b16 v[84:85], v5 offset:57344
    v_mfma_f32_16x16x32_bf16 v[116:119], v[56:59], v[228:231], v[116:119]
    ds_read_b64_tr_b16 v[86:87], v95 offset:8192
    v_mfma_f32_16x16x32_bf16 v[116:119], v[52:55], a[244:247], v[116:119]
    v_mfma_f32_16x16x32_bf16 v[116:119], v[48:51], a[228:231], v[116:119]
    v_mfma_f32_16x16x32_bf16 v[116:119], v[44:47], a[212:215], v[116:119]
    buffer_store_dwordx4 v[88:91], v1, s[28:31], s38 offen offset:2048 sc1
    v_mfma_f32_16x16x32_bf16 v[116:119], v[40:43], a[196:199], v[116:119]
    v_mfma_f32_16x16x32_bf16 v[144:147], v[40:43], a[200:203], v[144:147]
    v_mfma_f32_16x16x32_bf16 v[144:147], v[44:47], a[216:219], v[144:147]
    v_mfma_f32_16x16x32_bf16 v[144:147], v[48:51], a[232:235], v[144:147]
    v_mfma_f32_16x16x32_bf16 v[144:147], v[52:55], a[248:251], v[144:147]
    v_mfma_f32_16x16x32_bf16 v[144:147], v[56:59], v[232:235], v[144:147]
    v_xor_b32 v4, 64, v4
    v_mfma_f32_16x16x32_bf16 v[144:147], v[60:63], v[248:251], v[144:147]
    v_xor_b32 v92, 64, v92
    v_mfma_f32_16x16x32_bf16 v[148:151], v[60:63], v[252:255], v[148:151]
    buffer_store_dwordx4 v[88:91], v1, s[28:31], s38 offen offset:3072 sc1
    v_mfma_f32_16x16x32_bf16 v[148:151], v[56:59], v[236:239], v[148:151]
    v_xor_b32 v94, 64, v94
    v_xor_b32 v5, 64, v5
    v_mfma_f32_16x16x32_bf16 v[148:151], v[52:55], a[252:255], v[148:151]
    v_xor_b32 v93, 64, v93
    v_mfma_f32_16x16x32_bf16 v[148:151], v[48:51], a[236:239], v[148:151]
    v_xor_b32 v95, 64, v95
    v_mfma_f32_16x16x32_bf16 v[148:151], v[44:47], a[220:223], v[148:151]
    v_mfma_f32_16x16x32_bf16 v[148:151], v[40:43], a[204:207], v[148:151]
    s_waitcnt lgkmcnt(0)
    ds_read_b64_tr_b16 v[40:41], v4 offset:18432
    ds_read_b64_tr_b16 v[42:43], v92 offset:34816
    v_mfma_f32_16x16x32_bf16 v[156:159], v[64:67], a[204:207], v[156:159]
    ds_read_b64_tr_b16 v[44:45], v4 offset:20480
    ds_read_b64_tr_b16 v[46:47], v92 offset:36864
    v_mfma_f32_16x16x32_bf16 v[156:159], v[68:71], a[220:223], v[156:159]
    s_add_u32 s38, s38, 4096
    ds_read_b64_tr_b16 v[48:49], v4 offset:22528
    v_mfma_f32_16x16x32_bf16 v[156:159], v[72:75], a[236:239], v[156:159]
    ds_read_b64_tr_b16 v[50:51], v92 offset:38912
    v_mfma_f32_16x16x32_bf16 v[156:159], v[76:79], a[252:255], v[156:159]
    ds_read_b64_tr_b16 v[52:53], v4 offset:24576
    v_mfma_f32_16x16x32_bf16 v[156:159], v[80:83], v[236:239], v[156:159]
    ds_read_b64_tr_b16 v[54:55], v92 offset:40960
    v_mfma_f32_16x16x32_bf16 v[156:159], v[84:87], v[252:255], v[156:159]
    ds_read_b64_tr_b16 v[56:57], v4 offset:26624
    v_mfma_f32_16x16x32_bf16 v[152:155], v[84:87], v[248:251], v[152:155]
    ds_read_b64_tr_b16 v[58:59], v92 offset:43008
    ds_read_b64_tr_b16 v[60:61], v4 offset:28672
    v_mfma_f32_16x16x32_bf16 v[152:155], v[80:83], v[232:235], v[152:155]
    ds_read_b64_tr_b16 v[62:63], v92 offset:45056
    v_mfma_f32_16x16x32_bf16 v[152:155], v[76:79], a[248:251], v[152:155]
    v_mfma_f32_16x16x32_bf16 v[152:155], v[72:75], a[232:235], v[152:155]
    s_add_u32 s48, s33, 0x8000
    v_mfma_f32_16x16x32_bf16 v[152:155], v[68:71], a[216:219], v[152:155]
    buffer_store_dwordx4 v[88:91], v1, s[28:31], s38 offen offset:0 sc1
    v_mfma_f32_16x16x32_bf16 v[152:155], v[64:67], a[200:203], v[152:155]
    s_and_b32 s38, s2, 127
    s_mul_i32 s44, s38, 36864
    s_add_u32 s46, s38, 0
    v_mfma_f32_16x16x32_bf16 v[124:127], v[64:67], a[196:199], v[124:127]
    s_mul_i32 s47, s46, 7282
    s_lshr_b32 s47, s47, 16
    s_mul_i32 s3, s47, 220
    v_mfma_f32_16x16x32_bf16 v[124:127], v[68:71], a[212:215], v[124:127]
    s_lshl_b32 s39, s46, 2
    s_add_u32 s3, s3, s39
    s_lshl_b32 s46, s46, 7
    v_mfma_f32_16x16x32_bf16 v[124:127], v[72:75], a[228:231], v[124:127]
    s_mul_i32 s47, s47, 35712
    s_add_u32 s46, s46, s47
    s_add_u32 s46, s46, 4718592
    v_mfma_f32_16x16x32_bf16 v[124:127], v[76:79], a[244:247], v[124:127]
    s_add_u32 s3, s3, 65536
    s_add_u32 s47, s3, s32
    s_sub_u32 s3, s2, 128
    v_mfma_f32_16x16x32_bf16 v[124:127], v[80:83], v[228:231], v[124:127]
    s_cmp_ge_u32 s3, 128
    s_cselect_b64 s[46:47], s[26:27], s[46:47]
    s_add_u32 s24, s38, 128
    v_mfma_f32_16x16x32_bf16 v[124:127], v[84:87], v[244:247], v[124:127]
    s_mul_i32 s25, s24, 7282
    s_lshr_b32 s25, s25, 16
    s_mul_i32 s3, s25, 220
    v_mfma_f32_16x16x32_bf16 v[120:123], v[84:87], v[240:243], v[120:123]
    s_lshl_b32 s39, s24, 2
    s_add_u32 s3, s3, s39
    s_lshl_b32 s24, s24, 7
    v_mfma_f32_16x16x32_bf16 v[120:123], v[80:83], v[224:227], v[120:123]
    s_mul_i32 s25, s25, 35712
    s_add_u32 s24, s24, s25
    s_add_u32 s24, s24, 4718592
    v_mfma_f32_16x16x32_bf16 v[120:123], v[76:79], a[240:243], v[120:123]
    s_add_u32 s3, s3, 65536
    s_add_u32 s25, s3, s32
    s_sub_u32 s3, s2, 128
    v_mfma_f32_16x16x32_bf16 v[120:123], v[72:75], a[224:227], v[120:123]
    s_cmp_ge_u32 s3, 16
    s_cselect_b64 s[24:25], s[26:27], s[24:25]
    s_mov_b32 s50, 0xc000
    v_mfma_f32_16x16x32_bf16 v[120:123], v[68:71], a[208:211], v[120:123]
    s_mov_b32 s52, 14
    s_mov_b32 s51, 0x6000
    v_mul_f32 v20, v96, v96
    v_mfma_f32_16x16x32_bf16 v[120:123], v[64:67], a[192:195], v[120:123]
    s_waitcnt lgkmcnt(0)
    ds_read_b64_tr_b16 v[64:65], v5 offset:18432
    ds_read_b64_tr_b16 v[66:67], v93 offset:34816
    v_mfma_f32_16x16x32_bf16 v[160:163], v[40:43], a[0:3], 0
    ds_read_b64_tr_b16 v[68:69], v5 offset:20480
    v_mul_f32 v22, v97, v97
    v_mfma_f32_16x16x32_bf16 v[160:163], v[44:47], a[16:19], v[160:163]
    ds_read_b64_tr_b16 v[70:71], v93 offset:36864
    v_fma_f32 v20, v20, v12, v8
    v_mfma_f32_16x16x32_bf16 v[160:163], v[48:51], a[32:35], v[160:163]
    ds_read_b64_tr_b16 v[72:73], v5 offset:22528
    v_fma_f32 v22, v22, v12, v8
    v_mfma_f32_16x16x32_bf16 v[160:163], v[52:55], a[48:51], v[160:163]
    ds_read_b64_tr_b16 v[74:75], v93 offset:38912
    v_mul_f32 v20, v20, v96
    v_mfma_f32_16x16x32_bf16 v[160:163], v[56:59], a[64:67], v[160:163]
    ds_read_b64_tr_b16 v[76:77], v5 offset:24576
    v_mul_f32 v22, v22, v97
    v_mfma_f32_16x16x32_bf16 v[160:163], v[60:63], a[80:83], v[160:163]
    ds_read_b64_tr_b16 v[78:79], v93 offset:40960
    v_mul_f32 v21, v96, v112
    v_mfma_f32_16x16x32_bf16 v[164:167], v[60:63], a[84:87], 0
    ds_read_b64_tr_b16 v[80:81], v5 offset:26624
    v_mul_f32 v23, v97, v113
    v_mfma_f32_16x16x32_bf16 v[164:167], v[56:59], a[68:71], v[164:167]
    v_exp_f32 v20, v20
    v_mfma_f32_16x16x32_bf16 v[164:167], v[52:55], a[52:55], v[164:167]
    v_exp_f32 v22, v22
    v_mfma_f32_16x16x32_bf16 v[164:167], v[48:51], a[36:39], v[164:167]
    ds_read_b64_tr_b16 v[82:83], v93 offset:43008
    v_fma_f32 v20, v20, v16, v16
    v_mfma_f32_16x16x32_bf16 v[164:167], v[44:47], a[20:23], v[164:167]
    ds_read_b64_tr_b16 v[84:85], v5 offset:28672
    v_fma_f32 v22, v22, v16, v16
    v_mfma_f32_16x16x32_bf16 v[164:167], v[40:43], a[4:7], v[164:167]
    v_rcp_f32 v20, v20
    v_mfma_f32_16x16x32_bf16 v[192:195], v[40:43], a[8:11], 0
    ds_read_b64_tr_b16 v[86:87], v93 offset:45056
    v_mul_f32 v21, v21, v20
    v_mfma_f32_16x16x32_bf16 v[192:195], v[44:47], a[24:27], v[192:195]
    v_rcp_f32 v22, v22
    v_mfma_f32_16x16x32_bf16 v[192:195], v[48:51], a[40:43], v[192:195]
    v_mul_f32 v23, v23, v22
    v_cvt_pk_bf16_f32 v32, v21, v23
    v_mfma_f32_16x16x32_bf16 v[192:195], v[52:55], a[56:59], v[192:195]
    v_mul_f32 v24, v98, v98
    v_mul_f32 v26, v99, v99
    v_mfma_f32_16x16x32_bf16 v[192:195], v[56:59], a[72:75], v[192:195]
    v_fma_f32 v24, v24, v12, v8
    v_fma_f32 v26, v26, v12, v8
    v_mfma_f32_16x16x32_bf16 v[192:195], v[60:63], a[88:91], v[192:195]
    v_mul_f32 v24, v24, v98
    v_mul_f32 v26, v26, v99
    v_mfma_f32_16x16x32_bf16 v[196:199], v[60:63], a[92:95], 0
    v_mul_f32 v25, v98, v114
    v_mul_f32 v27, v99, v115
    v_mfma_f32_16x16x32_bf16 v[196:199], v[56:59], a[76:79], v[196:199]
    v_exp_f32 v24, v24
    v_mfma_f32_16x16x32_bf16 v[196:199], v[52:55], a[60:63], v[196:199]
    v_exp_f32 v26, v26
    v_mfma_f32_16x16x32_bf16 v[196:199], v[48:51], a[44:47], v[196:199]
    v_fma_f32 v24, v24, v16, v16
    v_fma_f32 v26, v26, v16, v16
    v_mfma_f32_16x16x32_bf16 v[196:199], v[44:47], a[28:31], v[196:199]
    v_rcp_f32 v24, v24
    v_mfma_f32_16x16x32_bf16 v[196:199], v[40:43], a[12:15], v[196:199]
    s_waitcnt lgkmcnt(0)
    ds_read_b64_tr_b16 v[40:41], v4 offset:59392
    ds_read_b64_tr_b16 v[42:43], v94 offset:10240
    v_mfma_f32_16x16x32_bf16 v[204:207], v[64:67], a[12:15], 0
    ds_read_b64_tr_b16 v[44:45], v4 offset:61440
    ds_read_b64_tr_b16 v[46:47], v94 offset:12288
    v_mfma_f32_16x16x32_bf16 v[204:207], v[68:71], a[28:31], v[204:207]
    ds_read_b64_tr_b16 v[48:49], v4 offset:63488
    ds_read_b64_tr_b16 v[50:51], v94 offset:14336
    v_mfma_f32_16x16x32_bf16 v[204:207], v[72:75], a[44:47], v[204:207]
    v_rcp_f32 v26, v26
    v_mfma_f32_16x16x32_bf16 v[204:207], v[76:79], a[60:63], v[204:207]
    ds_read_b64_tr_b16 v[52:53], v92 offset:0
    v_mul_f32 v25, v25, v24
    v_mfma_f32_16x16x32_bf16 v[204:207], v[80:83], a[76:79], v[204:207]
    ds_read_b64_tr_b16 v[54:55], v94 offset:16384
    v_mul_f32 v27, v27, v26
    v_mfma_f32_16x16x32_bf16 v[204:207], v[84:87], a[92:95], v[204:207]
    ds_read_b64_tr_b16 v[56:57], v92 offset:2048
    v_cvt_pk_bf16_f32 v33, v25, v27
    v_mfma_f32_16x16x32_bf16 v[200:203], v[84:87], a[88:91], 0
    ds_read_b64_tr_b16 v[58:59], v94 offset:18432
    v_mul_f32 v28, v104, v104
    v_mfma_f32_16x16x32_bf16 v[200:203], v[80:83], a[72:75], v[200:203]
    ds_read_b64_tr_b16 v[60:61], v92 offset:4096
    v_mul_f32 v30, v105, v105
    v_mfma_f32_16x16x32_bf16 v[200:203], v[76:79], a[56:59], v[200:203]
    ds_read_b64_tr_b16 v[62:63], v94 offset:20480
    v_fma_f32 v28, v28, v12, v8
    v_mfma_f32_16x16x32_bf16 v[200:203], v[72:75], a[40:43], v[200:203]
    v_fma_f32 v30, v30, v12, v8
    v_mul_f32 v28, v28, v104
    v_mfma_f32_16x16x32_bf16 v[200:203], v[68:71], a[24:27], v[200:203]
    v_mul_f32 v30, v30, v105
    v_mul_f32 v29, v104, v120
    v_mfma_f32_16x16x32_bf16 v[200:203], v[64:67], a[8:11], v[200:203]
    v_exp_f32 v28, v28
    v_mfma_f32_16x16x32_bf16 v[172:175], v[64:67], a[4:7], 0
    v_exp_f32 v30, v30
    v_mfma_f32_16x16x32_bf16 v[172:175], v[68:71], a[20:23], v[172:175]
    v_mul_f32 v31, v105, v121
    v_fma_f32 v28, v28, v16, v16
    v_mfma_f32_16x16x32_bf16 v[172:175], v[72:75], a[36:39], v[172:175]
    v_rcp_f32 v28, v28
    v_mfma_f32_16x16x32_bf16 v[172:175], v[76:79], a[52:55], v[172:175]
    v_fma_f32 v30, v30, v16, v16
    v_mfma_f32_16x16x32_bf16 v[172:175], v[80:83], a[68:71], v[172:175]
    v_rcp_f32 v30, v30
    v_mfma_f32_16x16x32_bf16 v[172:175], v[84:87], a[84:87], v[172:175]
    v_mul_f32 v29, v29, v28
    v_mfma_f32_16x16x32_bf16 v[168:171], v[84:87], a[80:83], 0
    v_mul_f32 v31, v31, v30
    v_mfma_f32_16x16x32_bf16 v[168:171], v[80:83], a[64:67], v[168:171]
    v_cvt_pk_bf16_f32 v34, v29, v31
    v_mfma_f32_16x16x32_bf16 v[168:171], v[76:79], a[48:51], v[168:171]
    v_mul_f32 v20, v106, v106
    v_mfma_f32_16x16x32_bf16 v[168:171], v[72:75], a[32:35], v[168:171]
    v_mul_f32 v22, v107, v107
    v_fma_f32 v20, v20, v12, v8
    v_mfma_f32_16x16x32_bf16 v[168:171], v[68:71], a[16:19], v[168:171]
    v_fma_f32 v22, v22, v12, v8
    v_mfma_f32_16x16x32_bf16 v[168:171], v[64:67], a[0:3], v[168:171]
    s_waitcnt lgkmcnt(0)
    ds_read_b64_tr_b16 v[64:65], v5 offset:59392
    ds_read_b64_tr_b16 v[66:67], v95 offset:10240
    v_mfma_f32_16x16x32_bf16 v[176:179], v[40:43], a[0:3], 0
    ds_read_b64_tr_b16 v[68:69], v5 offset:61440
    ds_read_b64_tr_b16 v[70:71], v95 offset:12288
    v_mfma_f32_16x16x32_bf16 v[176:179], v[44:47], a[16:19], v[176:179]
    ds_read_b64_tr_b16 v[72:73], v5 offset:63488
    ds_read_b64_tr_b16 v[74:75], v95 offset:14336
    v_mfma_f32_16x16x32_bf16 v[176:179], v[48:51], a[32:35], v[176:179]
    ds_read_b64_tr_b16 v[76:77], v93 offset:0
    v_mul_f32 v20, v20, v106
    v_mfma_f32_16x16x32_bf16 v[176:179], v[52:55], a[48:51], v[176:179]
    ds_read_b64_tr_b16 v[78:79], v95 offset:16384
    v_mul_f32 v22, v22, v107
    v_mfma_f32_16x16x32_bf16 v[176:179], v[56:59], a[64:67], v[176:179]
    ds_read_b64_tr_b16 v[80:81], v93 offset:2048
    v_mul_f32 v21, v106, v122
    v_mfma_f32_16x16x32_bf16 v[176:179], v[60:63], a[80:83], v[176:179]
    ds_read_b64_tr_b16 v[82:83], v95 offset:18432
    v_mul_f32 v23, v107, v123
    v_mfma_f32_16x16x32_bf16 v[180:183], v[60:63], a[84:87], 0
    v_exp_f32 v20, v20
    v_mfma_f32_16x16x32_bf16 v[180:183], v[56:59], a[68:71], v[180:183]
    v_exp_f32 v22, v22
    v_mfma_f32_16x16x32_bf16 v[180:183], v[52:55], a[52:55], v[180:183]
    ds_read_b64_tr_b16 v[84:85], v93 offset:4096
    v_fma_f32 v20, v20, v16, v16
    v_mfma_f32_16x16x32_bf16 v[180:183], v[48:51], a[36:39], v[180:183]
    ds_read_b64_tr_b16 v[86:87], v95 offset:20480
    v_fma_f32 v22, v22, v16, v16
    v_mfma_f32_16x16x32_bf16 v[180:183], v[44:47], a[20:23], v[180:183]
    v_rcp_f32 v20, v20
    v_mfma_f32_16x16x32_bf16 v[180:183], v[40:43], a[4:7], v[180:183]
    v_rcp_f32 v22, v22
    v_mfma_f32_16x16x32_bf16 v[208:211], v[40:43], a[8:11], 0
    v_mul_f32 v21, v21, v20
    v_mul_f32 v23, v23, v22
    v_mfma_f32_16x16x32_bf16 v[208:211], v[44:47], a[24:27], v[208:211]
    v_cvt_pk_bf16_f32 v35, v21, v23
    v_mfma_f32_16x16x32_bf16 v[208:211], v[48:51], a[40:43], v[208:211]
    v_mfma_f32_16x16x32_bf16 v[208:211], v[52:55], a[56:59], v[208:211]
    v_mul_f32 v24, v100, v100
    v_mfma_f32_16x16x32_bf16 v[208:211], v[56:59], a[72:75], v[208:211]
    v_mul_f32 v26, v101, v101
    v_mfma_f32_16x16x32_bf16 v[208:211], v[60:63], a[88:91], v[208:211]
    v_fma_f32 v24, v24, v13, v9
    v_mfma_f32_16x16x32_bf16 v[212:215], v[60:63], a[92:95], 0
    v_fma_f32 v26, v26, v13, v9
    v_mul_f32 v24, v24, v100
    v_mfma_f32_16x16x32_bf16 v[212:215], v[56:59], a[76:79], v[212:215]
    v_mul_f32 v26, v26, v101
    v_mfma_f32_16x16x32_bf16 v[212:215], v[52:55], a[60:63], v[212:215]
    s_lshl_b32 s38, s34, 6
    v_mul_f32 v25, v100, v116
    v_mfma_f32_16x16x32_bf16 v[212:215], v[48:51], a[44:47], v[212:215]
    s_add_u32 s38, s38, s40
    v_mul_f32 v27, v101, v117
    v_mfma_f32_16x16x32_bf16 v[212:215], v[44:47], a[28:31], v[212:215]
    s_add_u32 s38, s38, 0x80000
    v_exp_f32 v24, v24
    v_mfma_f32_16x16x32_bf16 v[212:215], v[40:43], a[12:15], v[212:215]
    s_waitcnt lgkmcnt(0)
    s_barrier
    ds_read_b64_tr_b16 v[40:41], v4 offset:30720
    v_mfma_f32_16x16x32_bf16 v[220:223], v[64:67], a[12:15], 0
    s_add_u32 m0, s33, 0x4800
    ds_read_b64_tr_b16 v[42:43], v92 offset:47104
    ds_read_b64_tr_b16 v[44:45], v4 offset:32768
    v_mfma_f32_16x16x32_bf16 v[220:223], v[68:71], a[28:31], v[220:223]
    buffer_store_dwordx4 v[32:35], v1, s[28:31], s38 offen sc1
    v_mfma_f32_16x16x32_bf16 v[220:223], v[72:75], a[44:47], v[220:223]
    ds_read_b64_tr_b16 v[46:47], v92 offset:49152
    ds_read_b64_tr_b16 v[48:49], v4 offset:34816
    v_mfma_f32_16x16x32_bf16 v[220:223], v[76:79], a[60:63], v[220:223]
    s_add_u32 s37, s34, 0x80
    ds_read_b64_tr_b16 v[50:51], v92 offset:51200
    ds_read_b64_tr_b16 v[52:53], v4 offset:0
    v_mfma_f32_16x16x32_bf16 v[220:223], v[80:83], a[76:79], v[220:223]
    v_exp_f32 v26, v26
    v_mfma_f32_16x16x32_bf16 v[220:223], v[84:87], a[92:95], v[220:223]
    buffer_load_dwordx4 v39, s[8:11], s37 offen lds
    v_mfma_f32_16x16x32_bf16 v[216:219], v[84:87], a[88:91], 0
    ds_read_b64_tr_b16 v[54:55], v92 offset:16384
    v_fma_f32 v24, v24, v17, v17
    v_mfma_f32_16x16x32_bf16 v[216:219], v[80:83], a[72:75], v[216:219]
    ds_read_b64_tr_b16 v[56:57], v4 offset:2048
    v_fma_f32 v26, v26, v17, v17
    v_mfma_f32_16x16x32_bf16 v[216:219], v[76:79], a[56:59], v[216:219]
    s_add_u32 m0, s33, 0x4c00
    v_rcp_f32 v24, v24
    v_mfma_f32_16x16x32_bf16 v[216:219], v[72:75], a[40:43], v[216:219]
    v_rcp_f32 v26, v26
    v_mfma_f32_16x16x32_bf16 v[216:219], v[68:71], a[24:27], v[216:219]
    s_add_u32 s37, s34, 0x24080
    ds_read_b64_tr_b16 v[58:59], v92 offset:18432
    v_mul_f32 v25, v25, v24
    v_mfma_f32_16x16x32_bf16 v[216:219], v[64:67], a[8:11], v[216:219]
    ds_read_b64_tr_b16 v[60:61], v4 offset:4096
    v_mul_f32 v27, v27, v26
    v_mfma_f32_16x16x32_bf16 v[188:191], v[64:67], a[4:7], 0
    ds_read_b64_tr_b16 v[62:63], v92 offset:20480
    v_cvt_pk_bf16_f32 v88, v25, v27
    v_mfma_f32_16x16x32_bf16 v[188:191], v[68:71], a[20:23], v[188:191]
    buffer_load_dwordx4 v39, s[8:11], s37 offen lds
    v_mfma_f32_16x16x32_bf16 v[188:191], v[72:75], a[36:39], v[188:191]
    v_mul_f32 v28, v102, v102
    v_mul_f32 v30, v103, v103
    v_mfma_f32_16x16x32_bf16 v[188:191], v[76:79], a[52:55], v[188:191]
    s_add_u32 m0, s33, 0x5000
    v_fma_f32 v28, v28, v13, v9
    v_fma_f32 v30, v30, v13, v9
    v_mfma_f32_16x16x32_bf16 v[188:191], v[80:83], a[68:71], v[188:191]
    v_mul_f32 v28, v28, v102
    v_mul_f32 v30, v30, v103
    v_mfma_f32_16x16x32_bf16 v[188:191], v[84:87], a[84:87], v[188:191]
    s_add_u32 s37, s34, 0x48080
    v_mul_f32 v29, v102, v118
    v_mul_f32 v31, v103, v119
    v_mfma_f32_16x16x32_bf16 v[184:187], v[84:87], a[80:83], 0
    v_exp_f32 v28, v28
    v_mfma_f32_16x16x32_bf16 v[184:187], v[80:83], a[64:67], v[184:187]
    v_exp_f32 v30, v30
    v_mfma_f32_16x16x32_bf16 v[184:187], v[76:79], a[48:51], v[184:187]
    buffer_load_dwordx4 v39, s[8:11], s37 offen lds
    v_mfma_f32_16x16x32_bf16 v[184:187], v[72:75], a[32:35], v[184:187]
    v_fma_f32 v28, v28, v17, v17
    v_fma_f32 v30, v30, v17, v17
    v_mfma_f32_16x16x32_bf16 v[184:187], v[68:71], a[16:19], v[184:187]
    s_add_u32 m0, s33, 0x5400
    v_rcp_f32 v28, v28
    v_mfma_f32_16x16x32_bf16 v[184:187], v[64:67], a[0:3], v[184:187]
    s_waitcnt lgkmcnt(0)
    ds_read_b64_tr_b16 v[64:65], v5 offset:30720
    ds_read_b64_tr_b16 v[66:67], v93 offset:47104
    v_mfma_f32_16x16x32_bf16 v[160:163], v[40:43], a[96:99], v[160:163]
    ds_read_b64_tr_b16 v[68:69], v5 offset:32768
    ds_read_b64_tr_b16 v[70:71], v93 offset:49152
    v_mfma_f32_16x16x32_bf16 v[160:163], v[44:47], a[112:115], v[160:163]
    s_add_u32 s37, s34, 0x6c080
    v_rcp_f32 v30, v30
    v_mfma_f32_16x16x32_bf16 v[160:163], v[48:51], a[128:131], v[160:163]
    ds_read_b64_tr_b16 v[72:73], v5 offset:34816
    v_mul_f32 v29, v29, v28
    v_mfma_f32_16x16x32_bf16 v[160:163], v[52:55], a[144:147], v[160:163]
    buffer_load_dwordx4 v39, s[8:11], s37 offen lds
    v_mfma_f32_16x16x32_bf16 v[160:163], v[56:59], a[160:163], v[160:163]
    ds_read_b64_tr_b16 v[74:75], v93 offset:51200
    v_mul_f32 v31, v31, v30
    v_mfma_f32_16x16x32_bf16 v[160:163], v[60:63], a[176:179], v[160:163]
    s_add_u32 m0, s33, 0x5800
    ds_read_b64_tr_b16 v[76:77], v5 offset:0
    v_cvt_pk_bf16_f32 v89, v29, v31
    v_mfma_f32_16x16x32_bf16 v[164:167], v[60:63], a[180:183], v[164:167]
    ds_read_b64_tr_b16 v[78:79], v93 offset:16384
    v_mul_f32 v20, v108, v108
    v_mfma_f32_16x16x32_bf16 v[164:167], v[56:59], a[164:167], v[164:167]
    ds_read_b64_tr_b16 v[80:81], v5 offset:2048
    v_mul_f32 v22, v109, v109
    v_mfma_f32_16x16x32_bf16 v[164:167], v[52:55], a[148:151], v[164:167]
    s_add_u32 s37, s34, 0x90080
    ds_read_b64_tr_b16 v[82:83], v93 offset:18432
    v_fma_f32 v20, v20, v13, v9
    v_mfma_f32_16x16x32_bf16 v[164:167], v[48:51], a[132:135], v[164:167]
    ds_read_b64_tr_b16 v[84:85], v5 offset:4096
    v_fma_f32 v22, v22, v13, v9
    v_mfma_f32_16x16x32_bf16 v[164:167], v[44:47], a[116:119], v[164:167]
    buffer_load_dwordx4 v39, s[8:11], s37 offen lds
    v_mfma_f32_16x16x32_bf16 v[164:167], v[40:43], a[100:103], v[164:167]
    ds_read_b64_tr_b16 v[86:87], v93 offset:20480
    v_mul_f32 v20, v20, v108
    v_mfma_f32_16x16x32_bf16 v[192:195], v[40:43], a[104:107], v[192:195]
    v_mul_f32 v22, v22, v109
    v_mul_f32 v21, v108, v124
    v_mfma_f32_16x16x32_bf16 v[192:195], v[44:47], a[120:123], v[192:195]
    s_add_u32 m0, s33, 0x5c00
    v_exp_f32 v20, v20
    v_mfma_f32_16x16x32_bf16 v[192:195], v[48:51], a[136:139], v[192:195]
    v_mul_f32 v23, v109, v125
    v_fma_f32 v20, v20, v17, v17
    v_mfma_f32_16x16x32_bf16 v[192:195], v[52:55], a[152:155], v[192:195]
    s_add_u32 s37, s34, 0xb4080
    v_exp_f32 v22, v22
    v_mfma_f32_16x16x32_bf16 v[192:195], v[56:59], a[168:171], v[192:195]
    v_rcp_f32 v20, v20
    v_mfma_f32_16x16x32_bf16 v[192:195], v[60:63], a[184:187], v[192:195]
    v_fma_f32 v22, v22, v17, v17
    v_mul_f32 v21, v21, v20
    v_mfma_f32_16x16x32_bf16 v[196:199], v[60:63], a[188:191], v[196:199]
    buffer_load_dwordx4 v39, s[8:11], s37 offen lds
    v_mfma_f32_16x16x32_bf16 v[196:199], v[56:59], a[172:175], v[196:199]
    v_rcp_f32 v22, v22
    v_mfma_f32_16x16x32_bf16 v[196:199], v[52:55], a[156:159], v[196:199]
    s_add_u32 m0, s33, 0x6000
    v_mul_f32 v23, v23, v22
    v_cvt_pk_bf16_f32 v90, v21, v23
    v_mfma_f32_16x16x32_bf16 v[196:199], v[48:51], a[140:143], v[196:199]
    v_mul_f32 v24, v110, v110
    v_mul_f32 v26, v111, v111
    v_mfma_f32_16x16x32_bf16 v[196:199], v[44:47], a[124:127], v[196:199]
    s_add_u32 s37, s34, 0xd8080
    v_fma_f32 v24, v24, v13, v9
    v_fma_f32 v26, v26, v13, v9
    v_mfma_f32_16x16x32_bf16 v[196:199], v[40:43], a[108:111], v[196:199]
    s_waitcnt lgkmcnt(0)
    ds_read_b64_tr_b16 v[40:41], v92 offset:6144
    ds_read_b64_tr_b16 v[42:43], v94 offset:22528
    v_mfma_f32_16x16x32_bf16 v[204:207], v[64:67], a[108:111], v[204:207]
    ds_read_b64_tr_b16 v[44:45], v92 offset:8192
    v_mul_f32 v24, v24, v110
    v_mfma_f32_16x16x32_bf16 v[204:207], v[68:71], a[124:127], v[204:207]
    buffer_load_dwordx4 v39, s[8:11], s37 offen lds
    v_mfma_f32_16x16x32_bf16 v[204:207], v[72:75], a[140:143], v[204:207]
    ds_read_b64_tr_b16 v[46:47], v94 offset:24576
    v_mul_f32 v26, v26, v111
    v_mfma_f32_16x16x32_bf16 v[204:207], v[76:79], a[156:159], v[204:207]
    s_add_u32 m0, s33, 0x6400
    ds_read_b64_tr_b16 v[48:49], v92 offset:10240
    v_mul_f32 v25, v110, v126
    v_mfma_f32_16x16x32_bf16 v[204:207], v[80:83], a[172:175], v[204:207]
    ds_read_b64_tr_b16 v[50:51], v94 offset:26624
    v_mul_f32 v27, v111, v127
    v_mfma_f32_16x16x32_bf16 v[204:207], v[84:87], a[188:191], v[204:207]
    v_exp_f32 v24, v24
    v_mfma_f32_16x16x32_bf16 v[200:203], v[84:87], a[184:187], v[200:203]
    s_add_u32 s37, s34, 0xfc080
    ds_read_b64_tr_b16 v[52:53], v4 offset:40960
    ds_read_b64_tr_b16 v[54:55], v92 offset:57344
    v_mfma_f32_16x16x32_bf16 v[200:203], v[80:83], a[168:171], v[200:203]
    v_exp_f32 v26, v26
    v_mfma_f32_16x16x32_bf16 v[200:203], v[76:79], a[152:155], v[200:203]
    buffer_load_dwordx4 v39, s[8:11], s37 offen lds
    v_mfma_f32_16x16x32_bf16 v[200:203], v[72:75], a[136:139], v[200:203]
    ds_read_b64_tr_b16 v[56:57], v4 offset:43008
    v_fma_f32 v24, v24, v17, v17
    v_mfma_f32_16x16x32_bf16 v[200:203], v[68:71], a[120:123], v[200:203]
    s_add_u32 m0, s33, 0x6800
    ds_read_b64_tr_b16 v[58:59], v92 offset:59392
    v_fma_f32 v26, v26, v17, v17
    v_mfma_f32_16x16x32_bf16 v[200:203], v[64:67], a[104:107], v[200:203]
    v_rcp_f32 v24, v24
    v_mfma_f32_16x16x32_bf16 v[172:175], v[64:67], a[100:103], v[172:175]
    v_rcp_f32 v26, v26
    v_mfma_f32_16x16x32_bf16 v[172:175], v[68:71], a[116:119], v[172:175]
    s_add_u32 s37, s34, 0x120080
    ds_read_b64_tr_b16 v[60:61], v4 offset:45056
    v_mul_f32 v25, v25, v24
    v_mfma_f32_16x16x32_bf16 v[172:175], v[72:75], a[132:135], v[172:175]
    ds_read_b64_tr_b16 v[62:63], v92 offset:61440
    v_mul_f32 v27, v27, v26
    v_mfma_f32_16x16x32_bf16 v[172:175], v[76:79], a[148:151], v[172:175]
    buffer_load_dwordx4 v39, s[8:11], s37 offen lds
    v_mfma_f32_16x16x32_bf16 v[172:175], v[80:83], a[164:167], v[172:175]
    v_cvt_pk_bf16_f32 v91, v25, v27
    v_mul_f32 v28, v128, v128
    v_mfma_f32_16x16x32_bf16 v[172:175], v[84:87], a[180:183], v[172:175]
    s_lshl_b32 s38, s34, 6
    v_mul_f32 v30, v129, v129
    v_fma_f32 v28, v28, v14, v10
    v_mfma_f32_16x16x32_bf16 v[168:171], v[84:87], a[176:179], v[168:171]
    s_add_u32 m0, s33, 0x6c00
    s_add_u32 s38, s38, s41
    v_fma_f32 v30, v30, v14, v10
    v_mfma_f32_16x16x32_bf16 v[168:171], v[80:83], a[160:163], v[168:171]
    s_add_u32 s38, s38, 0x80000
    v_mul_f32 v28, v28, v128
    v_mul_f32 v30, v30, v129
    v_mfma_f32_16x16x32_bf16 v[168:171], v[76:79], a[144:147], v[168:171]
    s_add_u32 s37, s34, 0x144080
    v_mul_f32 v29, v128, v144
    v_mul_f32 v31, v129, v145
    v_mfma_f32_16x16x32_bf16 v[168:171], v[72:75], a[128:131], v[168:171]
    buffer_store_dwordx4 v[88:91], v1, s[28:31], s38 offen sc1
    v_mfma_f32_16x16x32_bf16 v[168:171], v[68:71], a[112:115], v[168:171]
    v_exp_f32 v28, v28
    v_mfma_f32_16x16x32_bf16 v[168:171], v[64:67], a[96:99], v[168:171]
    buffer_load_dwordx4 v39, s[8:11], s37 offen lds
    s_waitcnt lgkmcnt(0)
    v_mfma_f32_16x16x32_bf16 v[176:179], v[40:43], a[96:99], v[176:179]
    ds_read_b64_tr_b16 v[64:65], v93 offset:6144
    ds_read_b64_tr_b16 v[66:67], v95 offset:22528
    v_mfma_f32_16x16x32_bf16 v[176:179], v[44:47], a[112:115], v[176:179]
    s_add_u32 m0, s33, 0x7000
    ds_read_b64_tr_b16 v[68:69], v93 offset:8192
    ds_read_b64_tr_b16 v[70:71], v95 offset:24576
    v_mfma_f32_16x16x32_bf16 v[176:179], v[48:51], a[128:131], v[176:179]
    v_exp_f32 v30, v30
    v_mfma_f32_16x16x32_bf16 v[176:179], v[52:55], a[144:147], v[176:179]
    s_add_u32 s37, s34, 0x168080
    ds_read_b64_tr_b16 v[72:73], v93 offset:10240
    v_fma_f32 v28, v28, v18, v18
    v_mfma_f32_16x16x32_bf16 v[176:179], v[56:59], a[160:163], v[176:179]
    ds_read_b64_tr_b16 v[74:75], v95 offset:26624
    v_fma_f32 v30, v30, v18, v18
    v_mfma_f32_16x16x32_bf16 v[176:179], v[60:63], a[176:179], v[176:179]
    v_rcp_f32 v28, v28
    v_mfma_f32_16x16x32_bf16 v[180:183], v[60:63], a[180:183], v[180:183]
    buffer_load_dwordx4 v39, s[8:11], s37 offen lds
    v_mfma_f32_16x16x32_bf16 v[180:183], v[56:59], a[164:167], v[180:183]
    ds_read_b64_tr_b16 v[76:77], v5 offset:40960
    ds_read_b64_tr_b16 v[78:79], v93 offset:57344
    v_mfma_f32_16x16x32_bf16 v[180:183], v[52:55], a[148:151], v[180:183]
    s_add_u32 m0, s33, 0x7400
    v_rcp_f32 v30, v30
    v_mfma_f32_16x16x32_bf16 v[180:183], v[48:51], a[132:135], v[180:183]
    ds_read_b64_tr_b16 v[80:81], v5 offset:43008
    v_mul_f32 v29, v29, v28
    v_mfma_f32_16x16x32_bf16 v[180:183], v[44:47], a[116:119], v[180:183]
    ds_read_b64_tr_b16 v[82:83], v93 offset:59392
    v_mul_f32 v31, v31, v30
    v_mfma_f32_16x16x32_bf16 v[180:183], v[40:43], a[100:103], v[180:183]
    s_add_u32 s37, s34, 0x18c080
    ds_read_b64_tr_b16 v[84:85], v5 offset:45056
    v_cvt_pk_bf16_f32 v32, v29, v31
    v_mfma_f32_16x16x32_bf16 v[208:211], v[40:43], a[104:107], v[208:211]
    ds_read_b64_tr_b16 v[86:87], v93 offset:61440
    v_mul_f32 v20, v130, v130
    v_mfma_f32_16x16x32_bf16 v[208:211], v[44:47], a[120:123], v[208:211]
    buffer_load_dwordx4 v39, s[8:11], s37 offen lds
    v_mfma_f32_16x16x32_bf16 v[208:211], v[48:51], a[136:139], v[208:211]
    v_mul_f32 v22, v131, v131
    v_fma_f32 v20, v20, v14, v10
    v_mfma_f32_16x16x32_bf16 v[208:211], v[52:55], a[152:155], v[208:211]
    v_fma_f32 v22, v22, v14, v10
    v_mul_f32 v20, v20, v130
    v_mfma_f32_16x16x32_bf16 v[208:211], v[56:59], a[168:171], v[208:211]
    v_mul_f32 v22, v22, v131
    v_mul_f32 v21, v130, v146
    v_mfma_f32_16x16x32_bf16 v[208:211], v[60:63], a[184:187], v[208:211]
    v_exp_f32 v20, v20
    v_mfma_f32_16x16x32_bf16 v[212:215], v[60:63], a[188:191], v[212:215]
    v_mul_f32 v23, v131, v147
    v_fma_f32 v20, v20, v18, v18
    v_mfma_f32_16x16x32_bf16 v[212:215], v[56:59], a[172:175], v[212:215]
    v_exp_f32 v22, v22
    v_mfma_f32_16x16x32_bf16 v[212:215], v[52:55], a[156:159], v[212:215]
    v_rcp_f32 v20, v20
    v_mfma_f32_16x16x32_bf16 v[212:215], v[48:51], a[140:143], v[212:215]
    v_fma_f32 v22, v22, v18, v18
    v_mul_f32 v21, v21, v20
    v_mfma_f32_16x16x32_bf16 v[212:215], v[44:47], a[124:127], v[212:215]
    v_rcp_f32 v22, v22
    v_mfma_f32_16x16x32_bf16 v[212:215], v[40:43], a[108:111], v[212:215]
    s_waitcnt lgkmcnt(0)
    s_barrier
    ds_read_b64_tr_b16 v[40:41], v4 offset:6144
    v_mfma_f32_16x16x32_bf16 v[220:223], v[64:67], a[108:111], v[220:223]
    s_add_u32 m0, s33, 0x7800
    ds_read_b64_tr_b16 v[42:43], v92 offset:22528
    ds_read_b64_tr_b16 v[44:45], v4 offset:8192
    v_mfma_f32_16x16x32_bf16 v[220:223], v[68:71], a[124:127], v[220:223]
    ds_read_b64_tr_b16 v[46:47], v92 offset:24576
    v_mul_f32 v23, v23, v22
    v_mfma_f32_16x16x32_bf16 v[220:223], v[72:75], a[140:143], v[220:223]
    ds_read_b64_tr_b16 v[48:49], v4 offset:10240
    v_cvt_pk_bf16_f32 v33, v21, v23
    v_mfma_f32_16x16x32_bf16 v[220:223], v[76:79], a[156:159], v[220:223]
    s_add_u32 s37, s34, 0x1b0080
    ds_read_b64_tr_b16 v[50:51], v92 offset:26624
    v_mul_f32 v24, v136, v136
    v_mfma_f32_16x16x32_bf16 v[220:223], v[80:83], a[172:175], v[220:223]
    ds_read_b64_tr_b16 v[52:53], v4 offset:12288
    v_mul_f32 v26, v137, v137
    v_mfma_f32_16x16x32_bf16 v[220:223], v[84:87], a[188:191], v[220:223]
    buffer_load_dwordx4 v39, s[8:11], s37 offen lds
    v_mfma_f32_16x16x32_bf16 v[216:219], v[84:87], a[184:187], v[216:219]
    ds_read_b64_tr_b16 v[54:55], v92 offset:28672
    v_fma_f32 v24, v24, v14, v10
    v_mfma_f32_16x16x32_bf16 v[216:219], v[80:83], a[168:171], v[216:219]
    ds_read_b64_tr_b16 v[56:57], v4 offset:14336
    v_fma_f32 v26, v26, v14, v10
    v_mfma_f32_16x16x32_bf16 v[216:219], v[76:79], a[152:155], v[216:219]
    s_add_u32 m0, s33, 0x7c00
    ds_read_b64_tr_b16 v[58:59], v92 offset:30720
    v_mul_f32 v24, v24, v136
    v_mfma_f32_16x16x32_bf16 v[216:219], v[72:75], a[136:139], v[216:219]
    ds_read_b64_tr_b16 v[60:61], v4 offset:16384
    v_mul_f32 v26, v26, v137
    v_mfma_f32_16x16x32_bf16 v[216:219], v[68:71], a[120:123], v[216:219]
    s_add_u32 s37, s34, 0x1d4080
    ds_read_b64_tr_b16 v[62:63], v92 offset:32768
    v_mul_f32 v25, v136, v152
    v_mfma_f32_16x16x32_bf16 v[216:219], v[64:67], a[104:107], v[216:219]
    v_exp_f32 v24, v24
    v_mfma_f32_16x16x32_bf16 v[188:191], v[64:67], a[100:103], v[188:191]
    v_mul_f32 v27, v137, v153
    v_fma_f32 v24, v24, v18, v18
    v_mfma_f32_16x16x32_bf16 v[188:191], v[68:71], a[116:119], v[188:191]
    buffer_load_dwordx4 v39, s[8:11], s37 offen lds
    v_mfma_f32_16x16x32_bf16 v[188:191], v[72:75], a[132:135], v[188:191]
    v_exp_f32 v26, v26
    v_mfma_f32_16x16x32_bf16 v[188:191], v[76:79], a[148:151], v[188:191]
    s_add_u32 m0, s33, 0x8000
    v_fma_f32 v26, v26, v18, v18
    v_mul_f32 v28, v138, v138
    v_mfma_f32_16x16x32_bf16 v[188:191], v[80:83], a[164:167], v[188:191]
    v_rcp_f32 v24, v24
    v_mfma_f32_16x16x32_bf16 v[188:191], v[84:87], a[180:183], v[188:191]
    s_add_u32 s37, s34, 0x1f8080
    v_rcp_f32 v26, v26
    v_mfma_f32_16x16x32_bf16 v[184:187], v[84:87], a[176:179], v[184:187]
    v_mul_f32 v25, v25, v24
    v_mul_f32 v27, v27, v26
    v_mfma_f32_16x16x32_bf16 v[184:187], v[80:83], a[160:163], v[184:187]
    v_cvt_pk_bf16_f32 v34, v25, v27
    v_mul_f32 v30, v139, v139
    v_mfma_f32_16x16x32_bf16 v[184:187], v[76:79], a[144:147], v[184:187]
    buffer_load_dwordx4 v39, s[8:11], s37 offen lds
    v_mfma_f32_16x16x32_bf16 v[184:187], v[72:75], a[128:131], v[184:187]
    v_fma_f32 v28, v28, v14, v10
    v_fma_f32 v30, v30, v14, v10
    v_mfma_f32_16x16x32_bf16 v[184:187], v[68:71], a[112:115], v[184:187]
    s_add_u32 m0, s33, 0x8400
    v_mul_f32 v28, v28, v138
    v_mul_f32 v30, v30, v139
    v_mfma_f32_16x16x32_bf16 v[184:187], v[64:67], a[96:99], v[184:187]
    s_waitcnt lgkmcnt(0)
    ds_read_b64_tr_b16 v[64:65], v5 offset:6144
    ds_read_b64_tr_b16 v[66:67], v93 offset:22528
    v_mfma_f32_16x16x32_bf16 v[160:163], v[40:43], a[192:195], v[160:163]
    ds_read_b64_tr_b16 v[68:69], v5 offset:8192
    v_mul_f32 v29, v138, v154
    v_mfma_f32_16x16x32_bf16 v[160:163], v[44:47], a[208:211], v[160:163]
    s_add_u32 s37, s34, 0x21c080
    ds_read_b64_tr_b16 v[70:71], v93 offset:24576
    v_mul_f32 v31, v139, v155
    v_mfma_f32_16x16x32_bf16 v[160:163], v[48:51], a[224:227], v[160:163]
    v_exp_f32 v28, v28
    v_mfma_f32_16x16x32_bf16 v[160:163], v[52:55], a[240:243], v[160:163]
    buffer_load_dwordx4 v39, s[8:11], s37 offen lds
    v_mfma_f32_16x16x32_bf16 v[160:163], v[56:59], v[224:227], v[160:163]
    v_exp_f32 v30, v30
    v_mfma_f32_16x16x32_bf16 v[160:163], v[60:63], v[240:243], v[160:163]
    s_add_u32 m0, s33, 0x8800
    ds_read_b64_tr_b16 v[72:73], v5 offset:10240
    ds_read_b64_tr_b16 v[74:75], v93 offset:26624
    v_mfma_f32_16x16x32_bf16 v[164:167], v[60:63], v[244:247], v[164:167]
    ds_read_b64_tr_b16 v[76:77], v5 offset:12288
    v_fma_f32 v28, v28, v18, v18
    v_mfma_f32_16x16x32_bf16 v[164:167], v[56:59], v[228:231], v[164:167]
    ds_read_b64_tr_b16 v[78:79], v93 offset:28672
    v_fma_f32 v30, v30, v18, v18
    v_mfma_f32_16x16x32_bf16 v[164:167], v[52:55], a[244:247], v[164:167]
    s_add_u32 s37, s34, 0x240080
    v_rcp_f32 v28, v28
    v_mfma_f32_16x16x32_bf16 v[164:167], v[48:51], a[228:231], v[164:167]
    v_rcp_f32 v30, v30
    v_mfma_f32_16x16x32_bf16 v[164:167], v[44:47], a[212:215], v[164:167]
    buffer_load_dwordx4 v39, s[8:11], s37 offen lds
    v_mfma_f32_16x16x32_bf16 v[164:167], v[40:43], a[196:199], v[164:167]
    ds_read_b64_tr_b16 v[80:81], v5 offset:14336
    v_mul_f32 v29, v29, v28
    v_mfma_f32_16x16x32_bf16 v[192:195], v[40:43], a[200:203], v[192:195]
    ds_read_b64_tr_b16 v[82:83], v93 offset:30720
    v_mul_f32 v31, v31, v30
    v_mfma_f32_16x16x32_bf16 v[192:195], v[44:47], a[216:219], v[192:195]
    s_add_u32 m0, s33, 0x8c00
    ds_read_b64_tr_b16 v[84:85], v5 offset:16384
    v_cvt_pk_bf16_f32 v35, v29, v31
    v_mfma_f32_16x16x32_bf16 v[192:195], v[48:51], a[232:235], v[192:195]
    s_lshl_b32 s38, s34, 6
    ds_read_b64_tr_b16 v[86:87], v93 offset:32768
    v_mul_f32 v20, v132, v132
    v_mfma_f32_16x16x32_bf16 v[192:195], v[52:55], a[248:251], v[192:195]
    s_add_u32 s38, s38, s42
    s_add_u32 s37, s34, 0x264080
    s_add_u32 s38, s38, 0x80000
    v_mfma_f32_16x16x32_bf16 v[192:195], v[56:59], v[232:235], v[192:195]
    buffer_store_dwordx4 v[32:35], v1, s[28:31], s38 offen sc1
    v_mfma_f32_16x16x32_bf16 v[192:195], v[60:63], v[248:251], v[192:195]
    v_mul_f32 v22, v133, v133
    v_fma_f32 v20, v20, v15, v11
    v_mfma_f32_16x16x32_bf16 v[196:199], v[60:63], v[252:255], v[196:199]
    buffer_load_dwordx4 v39, s[8:11], s37 offen lds
    v_mfma_f32_16x16x32_bf16 v[196:199], v[56:59], v[236:239], v[196:199]
    v_fma_f32 v22, v22, v15, v11
    v_mul_f32 v20, v20, v132
    v_mfma_f32_16x16x32_bf16 v[196:199], v[52:55], a[252:255], v[196:199]
    s_add_u32 m0, s33, 0x0
    v_mul_f32 v22, v22, v133
    v_mul_f32 v21, v132, v148
    v_mfma_f32_16x16x32_bf16 v[196:199], v[48:51], a[236:239], v[196:199]
    v_exp_f32 v20, v20
    v_mfma_f32_16x16x32_bf16 v[196:199], v[44:47], a[220:223], v[196:199]
    s_add_u32 s37, s34, 0x288080
    v_mul_f32 v23, v133, v149
    v_fma_f32 v20, v20, v19, v19
    v_mfma_f32_16x16x32_bf16 v[196:199], v[40:43], a[204:207], v[196:199]
    s_waitcnt lgkmcnt(0)
    ds_read_b64_tr_b16 v[40:41], v4 offset:47104
    ds_read_b64_tr_b16 v[42:43], v92 offset:63488
    v_mfma_f32_16x16x32_bf16 v[204:207], v[64:67], a[204:207], v[204:207]
    v_exp_f32 v22, v22
    v_mfma_f32_16x16x32_bf16 v[204:207], v[68:71], a[220:223], v[204:207]
    buffer_load_dwordx4 v39, s[8:11], s37 offen lds
    v_mfma_f32_16x16x32_bf16 v[204:207], v[72:75], a[236:239], v[204:207]
    ds_read_b64_tr_b16 v[44:45], v4 offset:49152
    v_fma_f32 v22, v22, v19, v19
    v_mfma_f32_16x16x32_bf16 v[204:207], v[76:79], a[252:255], v[204:207]
    s_add_u32 m0, s33, 0x400
    v_rcp_f32 v20, v20
    v_mfma_f32_16x16x32_bf16 v[204:207], v[80:83], v[236:239], v[204:207]
    ds_read_b64_tr_b16 v[46:47], v94 offset:0
    ds_read_b64_tr_b16 v[48:49], v4 offset:51200
    v_mfma_f32_16x16x32_bf16 v[204:207], v[84:87], v[252:255], v[204:207]
    v_rcp_f32 v22, v22
    v_mfma_f32_16x16x32_bf16 v[200:203], v[84:87], v[248:251], v[200:203]
    s_add_u32 s37, s34, 0x2ac080
    ds_read_b64_tr_b16 v[50:51], v94 offset:2048
    v_mul_f32 v21, v21, v20
    v_mfma_f32_16x16x32_bf16 v[200:203], v[80:83], v[232:235], v[200:203]
    ds_read_b64_tr_b16 v[52:53], v4 offset:53248
    v_mul_f32 v23, v23, v22
    v_mfma_f32_16x16x32_bf16 v[200:203], v[76:79], a[248:251], v[200:203]
    buffer_load_dwordx4 v39, s[8:11], s37 offen lds
    v_mfma_f32_16x16x32_bf16 v[200:203], v[72:75], a[232:235], v[200:203]
    ds_read_b64_tr_b16 v[54:55], v94 offset:4096
    v_cvt_pk_bf16_f32 v88, v21, v23
    v_mfma_f32_16x16x32_bf16 v[200:203], v[68:71], a[216:219], v[200:203]
    s_add_u32 m0, s33, 0x800
    ds_read_b64_tr_b16 v[56:57], v4 offset:55296
    v_mul_f32 v24, v134, v134
    v_mfma_f32_16x16x32_bf16 v[200:203], v[64:67], a[200:203], v[200:203]
    ds_read_b64_tr_b16 v[58:59], v94 offset:6144
    v_mul_f32 v26, v135, v135
    v_mfma_f32_16x16x32_bf16 v[172:175], v[64:67], a[196:199], v[172:175]
    ds_read_b64_tr_b16 v[60:61], v4 offset:57344
    v_fma_f32 v24, v24, v15, v11
    v_mfma_f32_16x16x32_bf16 v[172:175], v[68:71], a[212:215], v[172:175]
    s_add_u32 s37, s34, 0x2d0080
    ds_read_b64_tr_b16 v[62:63], v94 offset:8192
    v_fma_f32 v26, v26, v15, v11
    v_mfma_f32_16x16x32_bf16 v[172:175], v[72:75], a[228:231], v[172:175]
    v_mul_f32 v24, v24, v134
    v_mul_f32 v26, v26, v135
    v_mfma_f32_16x16x32_bf16 v[172:175], v[76:79], a[244:247], v[172:175]
    buffer_load_dwordx4 v39, s[8:11], s37 offen lds
    v_mfma_f32_16x16x32_bf16 v[172:175], v[80:83], v[228:231], v[172:175]
    v_mul_f32 v25, v134, v150
    v_mul_f32 v27, v135, v151
    v_mfma_f32_16x16x32_bf16 v[172:175], v[84:87], v[244:247], v[172:175]
    v_exp_f32 v24, v24
    v_mfma_f32_16x16x32_bf16 v[168:171], v[84:87], v[240:243], v[168:171]
    s_add_u32 m0, s33, 0xc00
    v_exp_f32 v26, v26
    v_mfma_f32_16x16x32_bf16 v[168:171], v[80:83], v[224:227], v[168:171]
    v_fma_f32 v24, v24, v19, v19
    v_fma_f32 v26, v26, v19, v19
    v_mfma_f32_16x16x32_bf16 v[168:171], v[76:79], a[240:243], v[168:171]
    s_add_u32 s37, s34, 0x2f4080
    v_rcp_f32 v24, v24
    v_mfma_f32_16x16x32_bf16 v[168:171], v[72:75], a[224:227], v[168:171]
    v_rcp_f32 v26, v26
    v_mfma_f32_16x16x32_bf16 v[168:171], v[68:71], a[208:211], v[168:171]
    v_mul_f32 v25, v25, v24
    v_mul_f32 v27, v27, v26
    v_mfma_f32_16x16x32_bf16 v[168:171], v[64:67], a[192:195], v[168:171]
    buffer_load_dwordx4 v39, s[8:11], s37 offen lds
    s_waitcnt lgkmcnt(0)
    v_mfma_f32_16x16x32_bf16 v[176:179], v[40:43], a[192:195], v[176:179]
    ds_read_b64_tr_b16 v[64:65], v5 offset:47104
    v_cvt_pk_bf16_f32 v89, v25, v27
    v_mfma_f32_16x16x32_bf16 v[176:179], v[44:47], a[208:211], v[176:179]
    s_add_u32 m0, s33, 0x1000
    ds_read_b64_tr_b16 v[66:67], v93 offset:63488
    v_mul_f32 v28, v140, v140
    v_mfma_f32_16x16x32_bf16 v[176:179], v[48:51], a[224:227], v[176:179]
    ds_read_b64_tr_b16 v[68:69], v5 offset:49152
    v_mul_f32 v30, v141, v141
    v_mfma_f32_16x16x32_bf16 v[176:179], v[52:55], a[240:243], v[176:179]
    s_add_u32 s37, s34, 0x318080
    ds_read_b64_tr_b16 v[70:71], v95 offset:0
    v_fma_f32 v28, v28, v15, v11
    v_mfma_f32_16x16x32_bf16 v[176:179], v[56:59], v[224:227], v[176:179]
    ds_read_b64_tr_b16 v[72:73], v5 offset:51200
    v_fma_f32 v30, v30, v15, v11
    v_mfma_f32_16x16x32_bf16 v[176:179], v[60:63], v[240:243], v[176:179]
    ds_read_b64_tr_b16 v[74:75], v95 offset:2048
    v_mul_f32 v28, v28, v140
    v_mfma_f32_16x16x32_bf16 v[180:183], v[60:63], v[244:247], v[180:183]
    buffer_load_dwordx4 v39, s[8:11], s37 offen lds
    v_mfma_f32_16x16x32_bf16 v[180:183], v[56:59], v[228:231], v[180:183]
    ds_read_b64_tr_b16 v[76:77], v5 offset:53248
    v_mul_f32 v30, v30, v141
    v_mfma_f32_16x16x32_bf16 v[180:183], v[52:55], a[244:247], v[180:183]
    s_add_u32 m0, s33, 0x1400
    ds_read_b64_tr_b16 v[78:79], v95 offset:4096
    v_mul_f32 v29, v140, v156
    v_mfma_f32_16x16x32_bf16 v[180:183], v[48:51], a[228:231], v[180:183]
    ds_read_b64_tr_b16 v[80:81], v5 offset:55296
    v_mul_f32 v31, v141, v157
    v_mfma_f32_16x16x32_bf16 v[180:183], v[44:47], a[212:215], v[180:183]
    v_exp_f32 v28, v28
    v_mfma_f32_16x16x32_bf16 v[180:183], v[40:43], a[196:199], v[180:183]
    s_add_u32 s37, s34, 0x33c080
    v_exp_f32 v30, v30
    v_mfma_f32_16x16x32_bf16 v[208:211], v[40:43], a[200:203], v[208:211]
    ds_read_b64_tr_b16 v[82:83], v95 offset:6144
    v_fma_f32 v28, v28, v19, v19
    v_mfma_f32_16x16x32_bf16 v[208:211], v[44:47], a[216:219], v[208:211]
    buffer_load_dwordx4 v39, s[8:11], s37 offen lds
    v_mfma_f32_16x16x32_bf16 v[208:211], v[48:51], a[232:235], v[208:211]
    ds_read_b64_tr_b16 v[84:85], v5 offset:57344
    v_fma_f32 v30, v30, v19, v19
    v_mfma_f32_16x16x32_bf16 v[208:211], v[52:55], a[248:251], v[208:211]
    ds_read_b64_tr_b16 v[86:87], v95 offset:8192
    v_mul_f32 v20, v142, v142
    v_mfma_f32_16x16x32_bf16 v[208:211], v[56:59], v[232:235], v[208:211]
    v_rcp_f32 v28, v28
    v_mfma_f32_16x16x32_bf16 v[208:211], v[60:63], v[248:251], v[208:211]
    v_rcp_f32 v30, v30
    v_mfma_f32_16x16x32_bf16 v[212:215], v[60:63], v[252:255], v[212:215]
    v_mul_f32 v29, v29, v28
    v_mul_f32 v31, v31, v30
    v_mfma_f32_16x16x32_bf16 v[212:215], v[56:59], v[236:239], v[212:215]
    v_cvt_pk_bf16_f32 v90, v29, v31
    v_mul_f32 v22, v143, v143
    v_mfma_f32_16x16x32_bf16 v[212:215], v[52:55], a[252:255], v[212:215]
    v_fma_f32 v20, v20, v15, v11
    v_fma_f32 v22, v22, v15, v11
    v_mfma_f32_16x16x32_bf16 v[212:215], v[48:51], a[236:239], v[212:215]
    v_mul_f32 v20, v20, v142
    v_mul_f32 v22, v22, v143
    v_mfma_f32_16x16x32_bf16 v[212:215], v[44:47], a[220:223], v[212:215]
    v_mul_f32 v21, v142, v158
    v_mul_f32 v23, v143, v159
    v_mfma_f32_16x16x32_bf16 v[212:215], v[40:43], a[204:207], v[212:215]
    s_waitcnt lgkmcnt(0)
    s_waitcnt vmcnt(13)
    s_barrier
    v_mfma_f32_16x16x32_bf16 v[220:223], v[64:67], a[204:207], v[220:223]
    s_add_u32 m0, s33, 0x1800
    v_xor_b32 v4, 64, v4
    v_xor_b32 v92, 64, v92
    v_mfma_f32_16x16x32_bf16 v[220:223], v[68:71], a[220:223], v[220:223]
    v_exp_f32 v20, v20
    v_mfma_f32_16x16x32_bf16 v[220:223], v[72:75], a[236:239], v[220:223]
    ds_read_b64_tr_b16 v[40:41], v4 offset:18432
    v_xor_b32 v94, 64, v94
    v_mfma_f32_16x16x32_bf16 v[220:223], v[76:79], a[252:255], v[220:223]
    s_add_u32 s37, s34, 0x360080
    v_exp_f32 v22, v22
    v_mfma_f32_16x16x32_bf16 v[220:223], v[80:83], v[236:239], v[220:223]
    ds_read_b64_tr_b16 v[42:43], v92 offset:34816
    v_xor_b32 v5, 64, v5
    v_mfma_f32_16x16x32_bf16 v[220:223], v[84:87], v[252:255], v[220:223]
    buffer_load_dwordx4 v39, s[8:11], s37 offen lds
    v_mfma_f32_16x16x32_bf16 v[216:219], v[84:87], v[248:251], v[216:219]
    ds_read_b64_tr_b16 v[44:45], v4 offset:20480
    v_xor_b32 v93, 64, v93
    v_mfma_f32_16x16x32_bf16 v[216:219], v[80:83], v[232:235], v[216:219]
    ds_read_b64_tr_b16 v[46:47], v92 offset:36864
    v_fma_f32 v20, v20, v19, v19
    v_mfma_f32_16x16x32_bf16 v[216:219], v[76:79], a[248:251], v[216:219]
    s_add_u32 m0, s33, 0x1c00
    ds_read_b64_tr_b16 v[48:49], v4 offset:22528
    v_fma_f32 v22, v22, v19, v19
    v_mfma_f32_16x16x32_bf16 v[216:219], v[72:75], a[232:235], v[216:219]
    ds_read_b64_tr_b16 v[50:51], v92 offset:38912
    v_xor_b32 v95, 64, v95
    v_mfma_f32_16x16x32_bf16 v[216:219], v[68:71], a[216:219], v[216:219]
    s_add_u32 s37, s34, 0x384080
    v_rcp_f32 v20, v20
    v_mfma_f32_16x16x32_bf16 v[216:219], v[64:67], a[200:203], v[216:219]
    s_lshl_b32 s38, s34, 6
    ds_read_b64_tr_b16 v[52:53], v4 offset:24576
    v_mul_f32 v21, v21, v20
    v_mfma_f32_16x16x32_bf16 v[188:191], v[64:67], a[196:199], v[188:191]
    s_add_u32 s38, s38, s43
    ds_read_b64_tr_b16 v[54:55], v92 offset:40960
    s_add_u32 s38, s38, 0x80000
    v_mfma_f32_16x16x32_bf16 v[188:191], v[68:71], a[212:215], v[188:191]
    buffer_load_dwordx4 v39, s[8:11], s37 offen lds
    v_mfma_f32_16x16x32_bf16 v[188:191], v[72:75], a[228:231], v[188:191]
    ds_read_b64_tr_b16 v[56:57], v4 offset:26624
    ds_read_b64_tr_b16 v[58:59], v92 offset:43008
    v_mfma_f32_16x16x32_bf16 v[188:191], v[76:79], a[244:247], v[188:191]
    s_add_u32 m0, s33, 0x2000
    ds_read_b64_tr_b16 v[60:61], v4 offset:28672
    ds_read_b64_tr_b16 v[62:63], v92 offset:45056
    v_mfma_f32_16x16x32_bf16 v[188:191], v[80:83], v[228:231], v[188:191]
    v_rcp_f32 v22, v22
    v_mfma_f32_16x16x32_bf16 v[188:191], v[84:87], v[244:247], v[188:191]
    s_add_u32 s37, s34, 0x3a8080
    v_mul_f32 v23, v23, v22
    v_cvt_pk_bf16_f32 v91, v21, v23
    v_mfma_f32_16x16x32_bf16 v[184:187], v[84:87], v[240:243], v[184:187]
    buffer_store_dwordx4 v[88:91], v1, s[28:31], s38 offen sc1
    v_mfma_f32_16x16x32_bf16 v[184:187], v[80:83], v[224:227], v[184:187]
    v_mul_f32 v24, v160, v160
    v_mul_f32 v26, v161, v161
    v_mfma_f32_16x16x32_bf16 v[184:187], v[76:79], a[240:243], v[184:187]
    buffer_load_dwordx4 v39, s[8:11], s37 offen lds
    v_mfma_f32_16x16x32_bf16 v[184:187], v[72:75], a[224:227], v[184:187]
    v_fma_f32 v24, v24, v12, v8
    v_fma_f32 v26, v26, v12, v8
    v_mfma_f32_16x16x32_bf16 v[184:187], v[68:71], a[208:211], v[184:187]
    s_add_u32 m0, s33, 0x2400
    v_mul_f32 v24, v24, v160
    v_mul_f32 v26, v26, v161
    v_mfma_f32_16x16x32_bf16 v[184:187], v[64:67], a[192:195], v[184:187]
    s_waitcnt lgkmcnt(0)
    ds_read_b64_tr_b16 v[64:65], v5 offset:18432
    ds_read_b64_tr_b16 v[66:67], v93 offset:34816
    v_mfma_f32_16x16x32_bf16 v[96:99], v[40:43], a[0:3], 0
    ds_read_b64_tr_b16 v[68:69], v5 offset:20480
    ds_read_b64_tr_b16 v[70:71], v93 offset:36864
    v_mfma_f32_16x16x32_bf16 v[96:99], v[44:47], a[16:19], v[96:99]
    s_add_u32 s37, s34, 0x3cc080
    ds_read_b64_tr_b16 v[72:73], v5 offset:22528
    ds_read_b64_tr_b16 v[74:75], v93 offset:38912
    v_mfma_f32_16x16x32_bf16 v[96:99], v[48:51], a[32:35], v[96:99]
    ds_read_b64_tr_b16 v[76:77], v5 offset:24576
    v_mul_f32 v25, v160, v176
    v_mfma_f32_16x16x32_bf16 v[96:99], v[52:55], a[48:51], v[96:99]
    buffer_load_dwordx4 v39, s[8:11], s37 offen lds
    v_mfma_f32_16x16x32_bf16 v[96:99], v[56:59], a[64:67], v[96:99]
    ds_read_b64_tr_b16 v[78:79], v93 offset:40960
    v_mul_f32 v27, v161, v177
    v_mfma_f32_16x16x32_bf16 v[96:99], v[60:63], a[80:83], v[96:99]
    s_add_u32 m0, s33, 0x2800
    v_exp_f32 v24, v24
    v_mfma_f32_16x16x32_bf16 v[100:103], v[60:63], a[84:87], 0
    v_exp_f32 v26, v26
    v_mfma_f32_16x16x32_bf16 v[100:103], v[56:59], a[68:71], v[100:103]
    ds_read_b64_tr_b16 v[80:81], v5 offset:26624
    v_fma_f32 v24, v24, v16, v16
    v_mfma_f32_16x16x32_bf16 v[100:103], v[52:55], a[52:55], v[100:103]
    s_add_u32 s37, s34, 0x3f0080
    ds_read_b64_tr_b16 v[82:83], v93 offset:43008
    v_fma_f32 v26, v26, v16, v16
    v_mfma_f32_16x16x32_bf16 v[100:103], v[48:51], a[36:39], v[100:103]
    v_rcp_f32 v24, v24
    v_mfma_f32_16x16x32_bf16 v[100:103], v[44:47], a[20:23], v[100:103]
    buffer_load_dwordx4 v39, s[8:11], s37 offen lds
    v_mfma_f32_16x16x32_bf16 v[100:103], v[40:43], a[4:7], v[100:103]
    ds_read_b64_tr_b16 v[84:85], v5 offset:28672
    ds_read_b64_tr_b16 v[86:87], v93 offset:45056
    v_mfma_f32_16x16x32_bf16 v[128:131], v[40:43], a[8:11], 0
    v_rcp_f32 v26, v26
    v_mfma_f32_16x16x32_bf16 v[128:131], v[44:47], a[24:27], v[128:131]
    s_add_u32 m0, s33, 0x2c00
    v_mul_f32 v25, v25, v24
    v_mul_f32 v27, v27, v26
    v_mfma_f32_16x16x32_bf16 v[128:131], v[48:51], a[40:43], v[128:131]
    v_cvt_pk_bf16_f32 v32, v25, v27
    v_mul_f32 v28, v162, v162
    v_mfma_f32_16x16x32_bf16 v[128:131], v[52:55], a[56:59], v[128:131]
    s_add_u32 s37, s34, 0x414080
    v_mul_f32 v30, v163, v163
    v_fma_f32 v28, v28, v12, v8
    v_mfma_f32_16x16x32_bf16 v[128:131], v[56:59], a[72:75], v[128:131]
    v_fma_f32 v30, v30, v12, v8
    v_mul_f32 v28, v28, v162
    v_mfma_f32_16x16x32_bf16 v[128:131], v[60:63], a[88:91], v[128:131]
    v_mul_f32 v30, v30, v163
    v_mul_f32 v29, v162, v178
    v_mfma_f32_16x16x32_bf16 v[132:135], v[60:63], a[92:95], 0
    buffer_load_dwordx4 v39, s[8:11], s37 offen lds
    v_mfma_f32_16x16x32_bf16 v[132:135], v[56:59], a[76:79], v[132:135]
    v_exp_f32 v28, v28
    v_mfma_f32_16x16x32_bf16 v[132:135], v[52:55], a[60:63], v[132:135]
    s_add_u32 m0, s33, 0x3000
    v_mul_f32 v31, v163, v179
    v_fma_f32 v28, v28, v16, v16
    v_mfma_f32_16x16x32_bf16 v[132:135], v[48:51], a[44:47], v[132:135]
    v_exp_f32 v30, v30
    v_mfma_f32_16x16x32_bf16 v[132:135], v[44:47], a[28:31], v[132:135]
    s_add_u32 s37, s34, 0x438080
    v_rcp_f32 v28, v28
    v_mfma_f32_16x16x32_bf16 v[132:135], v[40:43], a[12:15], v[132:135]
    s_waitcnt lgkmcnt(0)
    ds_read_b64_tr_b16 v[40:41], v4 offset:59392
    ds_read_b64_tr_b16 v[42:43], v94 offset:10240
    v_mfma_f32_16x16x32_bf16 v[140:143], v[64:67], a[12:15], 0
    ds_read_b64_tr_b16 v[44:45], v4 offset:61440
    ds_read_b64_tr_b16 v[46:47], v94 offset:12288
    v_mfma_f32_16x16x32_bf16 v[140:143], v[68:71], a[28:31], v[140:143]
    buffer_load_dwordx4 v39, s[8:11], s37 offen lds
    v_mfma_f32_16x16x32_bf16 v[140:143], v[72:75], a[44:47], v[140:143]
    ds_read_b64_tr_b16 v[48:49], v4 offset:63488
    v_fma_f32 v30, v30, v16, v16
    v_mfma_f32_16x16x32_bf16 v[140:143], v[76:79], a[60:63], v[140:143]
    s_add_u32 m0, s33, 0x3400
    ds_read_b64_tr_b16 v[50:51], v94 offset:14336
    ds_read_b64_tr_b16 v[52:53], v92 offset:0
    v_mfma_f32_16x16x32_bf16 v[140:143], v[80:83], a[76:79], v[140:143]
    v_rcp_f32 v30, v30
    v_mfma_f32_16x16x32_bf16 v[140:143], v[84:87], a[92:95], v[140:143]
    ds_read_b64_tr_b16 v[54:55], v94 offset:16384
    v_mul_f32 v29, v29, v28
    v_mfma_f32_16x16x32_bf16 v[136:139], v[84:87], a[88:91], 0
    s_add_u32 s37, s34, 0x45c080
    ds_read_b64_tr_b16 v[56:57], v92 offset:2048
    v_mul_f32 v31, v31, v30
    v_mfma_f32_16x16x32_bf16 v[136:139], v[80:83], a[72:75], v[136:139]
    ds_read_b64_tr_b16 v[58:59], v94 offset:18432
    v_cvt_pk_bf16_f32 v33, v29, v31
    v_mfma_f32_16x16x32_bf16 v[136:139], v[76:79], a[56:59], v[136:139]
    buffer_load_dwordx4 v39, s[8:11], s37 offen lds
    v_mfma_f32_16x16x32_bf16 v[136:139], v[72:75], a[40:43], v[136:139]
    ds_read_b64_tr_b16 v[60:61], v92 offset:4096
    v_mul_f32 v20, v168, v168
    v_mfma_f32_16x16x32_bf16 v[136:139], v[68:71], a[24:27], v[136:139]
    s_add_u32 m0, s33, 0x3800
    ds_read_b64_tr_b16 v[62:63], v94 offset:20480
    v_mul_f32 v22, v169, v169
    v_mfma_f32_16x16x32_bf16 v[136:139], v[64:67], a[8:11], v[136:139]
    v_fma_f32 v20, v20, v12, v8
    v_fma_f32 v22, v22, v12, v8
    v_mfma_f32_16x16x32_bf16 v[108:111], v[64:67], a[4:7], 0
    v_mul_f32 v20, v20, v168
    v_mul_f32 v22, v22, v169
    v_mfma_f32_16x16x32_bf16 v[108:111], v[68:71], a[20:23], v[108:111]
    s_add_u32 s37, s34, 0x480080
    v_mul_f32 v21, v168, v184
    v_mul_f32 v23, v169, v185
    v_mfma_f32_16x16x32_bf16 v[108:111], v[72:75], a[36:39], v[108:111]
    v_exp_f32 v20, v20
    v_mfma_f32_16x16x32_bf16 v[108:111], v[76:79], a[52:55], v[108:111]
    buffer_load_dwordx4 v39, s[8:11], s37 offen lds
    v_mfma_f32_16x16x32_bf16 v[108:111], v[80:83], a[68:71], v[108:111]
    v_exp_f32 v22, v22
    v_mfma_f32_16x16x32_bf16 v[108:111], v[84:87], a[84:87], v[108:111]
    v_fma_f32 v20, v20, v16, v16
    v_fma_f32 v22, v22, v16, v16
    v_mfma_f32_16x16x32_bf16 v[104:107], v[84:87], a[80:83], 0
    s_add_u32 m0, s33, 0x3c00
    v_rcp_f32 v20, v20
    v_mfma_f32_16x16x32_bf16 v[104:107], v[80:83], a[64:67], v[104:107]
    v_rcp_f32 v22, v22
    v_mfma_f32_16x16x32_bf16 v[104:107], v[76:79], a[48:51], v[104:107]
    s_add_u32 s37, s34, 0x4a4080
    v_mul_f32 v21, v21, v20
    v_mul_f32 v23, v23, v22
    v_mfma_f32_16x16x32_bf16 v[104:107], v[72:75], a[32:35], v[104:107]
    v_cvt_pk_bf16_f32 v34, v21, v23
    v_mul_f32 v24, v170, v170
    v_mfma_f32_16x16x32_bf16 v[104:107], v[68:71], a[16:19], v[104:107]
    v_mul_f32 v26, v171, v171
    v_fma_f32 v24, v24, v12, v8
    v_mfma_f32_16x16x32_bf16 v[104:107], v[64:67], a[0:3], v[104:107]
    buffer_load_dwordx4 v39, s[8:11], s37 offen lds
    s_waitcnt lgkmcnt(0)
    v_mfma_f32_16x16x32_bf16 v[112:115], v[40:43], a[0:3], 0
    ds_read_b64_tr_b16 v[64:65], v5 offset:59392
    ds_read_b64_tr_b16 v[66:67], v95 offset:10240
    v_mfma_f32_16x16x32_bf16 v[112:115], v[44:47], a[16:19], v[112:115]
    s_add_u32 m0, s33, 0x4000
    ds_read_b64_tr_b16 v[68:69], v5 offset:61440
    ds_read_b64_tr_b16 v[70:71], v95 offset:12288
    v_mfma_f32_16x16x32_bf16 v[112:115], v[48:51], a[32:35], v[112:115]
    ds_read_b64_tr_b16 v[72:73], v5 offset:63488
    v_fma_f32 v26, v26, v12, v8
    v_mfma_f32_16x16x32_bf16 v[112:115], v[52:55], a[48:51], v[112:115]
    s_add_u32 s37, s34, 0x4c8080
    ds_read_b64_tr_b16 v[74:75], v95 offset:14336
    v_mul_f32 v24, v24, v170
    v_mfma_f32_16x16x32_bf16 v[112:115], v[56:59], a[64:67], v[112:115]
    ds_read_b64_tr_b16 v[76:77], v93 offset:0
    v_mul_f32 v26, v26, v171
    v_mfma_f32_16x16x32_bf16 v[112:115], v[60:63], a[80:83], v[112:115]
    ds_read_b64_tr_b16 v[78:79], v95 offset:16384
    v_mul_f32 v25, v170, v186
    v_mfma_f32_16x16x32_bf16 v[116:119], v[60:63], a[84:87], 0
    buffer_load_dwordx4 v39, s[8:11], s37 offen lds
    v_mfma_f32_16x16x32_bf16 v[116:119], v[56:59], a[68:71], v[116:119]
    ds_read_b64_tr_b16 v[80:81], v93 offset:2048
    v_mul_f32 v27, v171, v187
    v_mfma_f32_16x16x32_bf16 v[116:119], v[52:55], a[52:55], v[116:119]
    s_add_u32 m0, s33, 0x4400
    v_exp_f32 v24, v24
    v_mfma_f32_16x16x32_bf16 v[116:119], v[48:51], a[36:39], v[116:119]
    v_exp_f32 v26, v26
    v_mfma_f32_16x16x32_bf16 v[116:119], v[44:47], a[20:23], v[116:119]
    ds_read_b64_tr_b16 v[82:83], v95 offset:18432
    v_fma_f32 v24, v24, v16, v16
    v_mfma_f32_16x16x32_bf16 v[116:119], v[40:43], a[4:7], v[116:119]
    s_add_u32 s37, s34, 0x4ec080
    ds_read_b64_tr_b16 v[84:85], v93 offset:4096
    v_fma_f32 v26, v26, v16, v16
    v_mfma_f32_16x16x32_bf16 v[144:147], v[40:43], a[8:11], 0
    v_rcp_f32 v24, v24
    v_mfma_f32_16x16x32_bf16 v[144:147], v[44:47], a[24:27], v[144:147]
    buffer_load_dwordx4 v39, s[8:11], s37 offen lds
    v_mfma_f32_16x16x32_bf16 v[144:147], v[48:51], a[40:43], v[144:147]
    ds_read_b64_tr_b16 v[86:87], v95 offset:20480
    v_mul_f32 v25, v25, v24
    v_mfma_f32_16x16x32_bf16 v[144:147], v[52:55], a[56:59], v[144:147]
    v_rcp_f32 v26, v26
    v_mfma_f32_16x16x32_bf16 v[144:147], v[56:59], a[72:75], v[144:147]
    v_mul_f32 v27, v27, v26
    v_cvt_pk_bf16_f32 v35, v25, v27
    v_mfma_f32_16x16x32_bf16 v[144:147], v[60:63], a[88:91], v[144:147]
    v_mul_f32 v28, v164, v164
    v_mul_f32 v30, v165, v165
    v_mfma_f32_16x16x32_bf16 v[148:151], v[60:63], a[92:95], 0
    v_fma_f32 v28, v28, v13, v9
    v_fma_f32 v30, v30, v13, v9
    v_mfma_f32_16x16x32_bf16 v[148:151], v[56:59], a[76:79], v[148:151]
    v_mul_f32 v28, v28, v164
    v_mul_f32 v30, v30, v165
    v_mfma_f32_16x16x32_bf16 v[148:151], v[52:55], a[60:63], v[148:151]
    s_lshl_b32 s38, s34, 6
    v_mul_f32 v29, v164, v180
    v_mfma_f32_16x16x32_bf16 v[148:151], v[48:51], a[44:47], v[148:151]
    s_add_u32 s38, s38, s40
    v_mul_f32 v31, v165, v181
    v_mfma_f32_16x16x32_bf16 v[148:151], v[44:47], a[28:31], v[148:151]
    s_add_u32 s38, s38, 0x81000
    v_exp_f32 v28, v28
    v_mfma_f32_16x16x32_bf16 v[148:151], v[40:43], a[12:15], v[148:151]
    s_waitcnt lgkmcnt(0)
    s_waitcnt vmcnt(13)
    s_barrier
    v_mfma_f32_16x16x32_bf16 v[156:159], v[64:67], a[12:15], 0
    ds_read_b64_tr_b16 v[40:41], v4 offset:30720
    ds_read_b64_tr_b16 v[42:43], v92 offset:47104
    v_mfma_f32_16x16x32_bf16 v[156:159], v[68:71], a[28:31], v[156:159]
    buffer_store_dwordx4 v[32:35], v1, s[28:31], s38 offen sc1
    v_mfma_f32_16x16x32_bf16 v[156:159], v[72:75], a[44:47], v[156:159]
    ds_read_b64_tr_b16 v[44:45], v4 offset:32768
    ds_read_b64_tr_b16 v[46:47], v92 offset:49152
    v_mfma_f32_16x16x32_bf16 v[156:159], v[76:79], a[60:63], v[156:159]
    ds_read_b64_tr_b16 v[48:49], v4 offset:34816
    ds_read_b64_tr_b16 v[50:51], v92 offset:51200
    v_mfma_f32_16x16x32_bf16 v[156:159], v[80:83], a[76:79], v[156:159]
    v_exp_f32 v30, v30
    v_mfma_f32_16x16x32_bf16 v[156:159], v[84:87], a[92:95], v[156:159]
    ds_read_b64_tr_b16 v[52:53], v4 offset:0
    v_fma_f32 v28, v28, v17, v17
    v_mfma_f32_16x16x32_bf16 v[152:155], v[84:87], a[88:91], 0
    ds_read_b64_tr_b16 v[54:55], v92 offset:16384
    v_fma_f32 v30, v30, v17, v17
    v_mfma_f32_16x16x32_bf16 v[152:155], v[80:83], a[72:75], v[152:155]
    v_rcp_f32 v28, v28
    v_mfma_f32_16x16x32_bf16 v[152:155], v[76:79], a[56:59], v[152:155]
    ds_read_b64_tr_b16 v[56:57], v4 offset:2048
    ds_read_b64_tr_b16 v[58:59], v92 offset:18432
    v_mfma_f32_16x16x32_bf16 v[152:155], v[72:75], a[40:43], v[152:155]
    v_rcp_f32 v30, v30
    v_mfma_f32_16x16x32_bf16 v[152:155], v[68:71], a[24:27], v[152:155]
    ds_read_b64_tr_b16 v[60:61], v4 offset:4096
    v_mul_f32 v29, v29, v28
    v_mfma_f32_16x16x32_bf16 v[152:155], v[64:67], a[8:11], v[152:155]
    ds_read_b64_tr_b16 v[62:63], v92 offset:20480
    v_mul_f32 v31, v31, v30
    v_mfma_f32_16x16x32_bf16 v[124:127], v[64:67], a[4:7], 0
    v_cvt_pk_bf16_f32 v88, v29, v31
    v_mul_f32 v20, v166, v166
    v_mfma_f32_16x16x32_bf16 v[124:127], v[68:71], a[20:23], v[124:127]
    v_mul_f32 v22, v167, v167
    v_fma_f32 v20, v20, v13, v9
    v_mfma_f32_16x16x32_bf16 v[124:127], v[72:75], a[36:39], v[124:127]
    v_fma_f32 v22, v22, v13, v9
    v_mul_f32 v20, v20, v166
    v_mfma_f32_16x16x32_bf16 v[124:127], v[76:79], a[52:55], v[124:127]
    v_mul_f32 v22, v22, v167
    v_mul_f32 v21, v166, v182
    v_mfma_f32_16x16x32_bf16 v[124:127], v[80:83], a[68:71], v[124:127]
    v_exp_f32 v20, v20
    v_mfma_f32_16x16x32_bf16 v[124:127], v[84:87], a[84:87], v[124:127]
    v_mul_f32 v23, v167, v183
    v_fma_f32 v20, v20, v17, v17
    v_mfma_f32_16x16x32_bf16 v[120:123], v[84:87], a[80:83], 0
    v_exp_f32 v22, v22
    v_mfma_f32_16x16x32_bf16 v[120:123], v[80:83], a[64:67], v[120:123]
    v_rcp_f32 v20, v20
    v_mfma_f32_16x16x32_bf16 v[120:123], v[76:79], a[48:51], v[120:123]
    v_fma_f32 v22, v22, v17, v17
    v_mfma_f32_16x16x32_bf16 v[120:123], v[72:75], a[32:35], v[120:123]
    v_rcp_f32 v22, v22
    v_mfma_f32_16x16x32_bf16 v[120:123], v[68:71], a[16:19], v[120:123]
    v_mul_f32 v21, v21, v20
    v_mfma_f32_16x16x32_bf16 v[120:123], v[64:67], a[0:3], v[120:123]
    s_waitcnt lgkmcnt(0)
    ds_read_b64_tr_b16 v[64:65], v5 offset:30720
    ds_read_b64_tr_b16 v[66:67], v93 offset:47104
    v_mfma_f32_16x16x32_bf16 v[96:99], v[40:43], a[96:99], v[96:99]
    ds_read_b64_tr_b16 v[68:69], v5 offset:32768
    ds_read_b64_tr_b16 v[70:71], v93 offset:49152
    v_mfma_f32_16x16x32_bf16 v[96:99], v[44:47], a[112:115], v[96:99]
    ds_read_b64_tr_b16 v[72:73], v5 offset:34816
    v_mul_f32 v23, v23, v22
    v_mfma_f32_16x16x32_bf16 v[96:99], v[48:51], a[128:131], v[96:99]
    ds_read_b64_tr_b16 v[74:75], v93 offset:51200
    v_cvt_pk_bf16_f32 v89, v21, v23
    v_mfma_f32_16x16x32_bf16 v[96:99], v[52:55], a[144:147], v[96:99]
    ds_read_b64_tr_b16 v[76:77], v5 offset:0
    v_mul_f32 v24, v172, v172
    v_mfma_f32_16x16x32_bf16 v[96:99], v[56:59], a[160:163], v[96:99]
    ds_read_b64_tr_b16 v[78:79], v93 offset:16384
    v_mul_f32 v26, v173, v173
    v_mfma_f32_16x16x32_bf16 v[96:99], v[60:63], a[176:179], v[96:99]
    ds_read_b64_tr_b16 v[80:81], v5 offset:2048
    v_fma_f32 v24, v24, v13, v9
    v_mfma_f32_16x16x32_bf16 v[100:103], v[60:63], a[180:183], v[100:103]
    ds_read_b64_tr_b16 v[82:83], v93 offset:18432
    v_fma_f32 v26, v26, v13, v9
    v_mfma_f32_16x16x32_bf16 v[100:103], v[56:59], a[164:167], v[100:103]
    ds_read_b64_tr_b16 v[84:85], v5 offset:4096
    v_mul_f32 v24, v24, v172
    v_mfma_f32_16x16x32_bf16 v[100:103], v[52:55], a[148:151], v[100:103]
    ds_read_b64_tr_b16 v[86:87], v93 offset:20480
    v_mul_f32 v26, v26, v173
    v_mfma_f32_16x16x32_bf16 v[100:103], v[48:51], a[132:135], v[100:103]
    v_mul_f32 v25, v172, v188
    v_mul_f32 v27, v173, v189
    v_mfma_f32_16x16x32_bf16 v[100:103], v[44:47], a[116:119], v[100:103]
    v_exp_f32 v24, v24
    v_mfma_f32_16x16x32_bf16 v[100:103], v[40:43], a[100:103], v[100:103]
    v_exp_f32 v26, v26
    v_mfma_f32_16x16x32_bf16 v[128:131], v[40:43], a[104:107], v[128:131]
    v_fma_f32 v24, v24, v17, v17
    v_fma_f32 v26, v26, v17, v17
    v_mfma_f32_16x16x32_bf16 v[128:131], v[44:47], a[120:123], v[128:131]
    v_rcp_f32 v24, v24
    v_mfma_f32_16x16x32_bf16 v[128:131], v[48:51], a[136:139], v[128:131]
    v_rcp_f32 v26, v26
    v_mfma_f32_16x16x32_bf16 v[128:131], v[52:55], a[152:155], v[128:131]
    v_mul_f32 v25, v25, v24
    v_mul_f32 v27, v27, v26
    v_mfma_f32_16x16x32_bf16 v[128:131], v[56:59], a[168:171], v[128:131]
    v_cvt_pk_bf16_f32 v90, v25, v27
    v_mfma_f32_16x16x32_bf16 v[128:131], v[60:63], a[184:187], v[128:131]
    v_mul_f32 v28, v174, v174
    v_mul_f32 v30, v175, v175
    v_mfma_f32_16x16x32_bf16 v[132:135], v[60:63], a[188:191], v[132:135]
    v_fma_f32 v28, v28, v13, v9
    v_mfma_f32_16x16x32_bf16 v[132:135], v[56:59], a[172:175], v[132:135]
    v_fma_f32 v30, v30, v13, v9
    v_mfma_f32_16x16x32_bf16 v[132:135], v[52:55], a[156:159], v[132:135]
    v_mul_f32 v28, v28, v174
    v_mfma_f32_16x16x32_bf16 v[132:135], v[48:51], a[140:143], v[132:135]
    v_mul_f32 v30, v30, v175
    v_mul_f32 v29, v174, v190
    v_mfma_f32_16x16x32_bf16 v[132:135], v[44:47], a[124:127], v[132:135]
    v_mul_f32 v31, v175, v191
    v_mfma_f32_16x16x32_bf16 v[132:135], v[40:43], a[108:111], v[132:135]
    s_waitcnt lgkmcnt(0)
    ds_read_b64_tr_b16 v[40:41], v92 offset:6144
    ds_read_b64_tr_b16 v[42:43], v94 offset:22528
    v_mfma_f32_16x16x32_bf16 v[140:143], v[64:67], a[108:111], v[140:143]
    ds_read_b64_tr_b16 v[44:45], v92 offset:8192
    ds_read_b64_tr_b16 v[46:47], v94 offset:24576
    v_mfma_f32_16x16x32_bf16 v[140:143], v[68:71], a[124:127], v[140:143]
    ds_read_b64_tr_b16 v[48:49], v92 offset:10240
    ds_read_b64_tr_b16 v[50:51], v94 offset:26624
    v_mfma_f32_16x16x32_bf16 v[140:143], v[72:75], a[140:143], v[140:143]
    v_exp_f32 v28, v28
    v_mfma_f32_16x16x32_bf16 v[140:143], v[76:79], a[156:159], v[140:143]
    ds_read_b64_tr_b16 v[52:53], v4 offset:40960
    ds_read_b64_tr_b16 v[54:55], v92 offset:57344
    v_mfma_f32_16x16x32_bf16 v[140:143], v[80:83], a[172:175], v[140:143]
    v_exp_f32 v30, v30
    v_mfma_f32_16x16x32_bf16 v[140:143], v[84:87], a[188:191], v[140:143]
    ds_read_b64_tr_b16 v[56:57], v4 offset:43008
    v_fma_f32 v28, v28, v17, v17
    v_mfma_f32_16x16x32_bf16 v[136:139], v[84:87], a[184:187], v[136:139]
    ds_read_b64_tr_b16 v[58:59], v92 offset:59392
    v_fma_f32 v30, v30, v17, v17
    v_mfma_f32_16x16x32_bf16 v[136:139], v[80:83], a[168:171], v[136:139]
    v_rcp_f32 v28, v28
    v_mfma_f32_16x16x32_bf16 v[136:139], v[76:79], a[152:155], v[136:139]
    v_rcp_f32 v30, v30
    v_mfma_f32_16x16x32_bf16 v[136:139], v[72:75], a[136:139], v[136:139]
    ds_read_b64_tr_b16 v[60:61], v4 offset:45056
    v_mul_f32 v29, v29, v28
    v_mfma_f32_16x16x32_bf16 v[136:139], v[68:71], a[120:123], v[136:139]
    ds_read_b64_tr_b16 v[62:63], v92 offset:61440
    v_mul_f32 v31, v31, v30
    v_mfma_f32_16x16x32_bf16 v[136:139], v[64:67], a[104:107], v[136:139]
    v_cvt_pk_bf16_f32 v91, v29, v31
    v_mfma_f32_16x16x32_bf16 v[108:111], v[64:67], a[100:103], v[108:111]
    v_mul_f32 v20, v192, v192
    v_mfma_f32_16x16x32_bf16 v[108:111], v[68:71], a[116:119], v[108:111]
    v_mul_f32 v22, v193, v193
    v_mfma_f32_16x16x32_bf16 v[108:111], v[72:75], a[132:135], v[108:111]
    v_fma_f32 v20, v20, v14, v10
    v_mfma_f32_16x16x32_bf16 v[108:111], v[76:79], a[148:151], v[108:111]
    v_fma_f32 v22, v22, v14, v10
    v_mul_f32 v20, v20, v192
    v_mfma_f32_16x16x32_bf16 v[108:111], v[80:83], a[164:167], v[108:111]
    v_mul_f32 v22, v22, v193
    v_mfma_f32_16x16x32_bf16 v[108:111], v[84:87], a[180:183], v[108:111]
    s_lshl_b32 s38, s34, 6
    v_mul_f32 v21, v192, v208
    v_mfma_f32_16x16x32_bf16 v[104:107], v[84:87], a[176:179], v[104:107]
    s_add_u32 s38, s38, s41
    v_exp_f32 v20, v20
    v_mfma_f32_16x16x32_bf16 v[104:107], v[80:83], a[160:163], v[104:107]
    s_add_u32 s38, s38, 0x81000
    v_mul_f32 v23, v193, v209
    v_mfma_f32_16x16x32_bf16 v[104:107], v[76:79], a[144:147], v[104:107]
    buffer_store_dwordx4 v[88:91], v1, s[28:31], s38 offen sc1
    v_mfma_f32_16x16x32_bf16 v[104:107], v[72:75], a[128:131], v[104:107]
    v_exp_f32 v22, v22
    v_mfma_f32_16x16x32_bf16 v[104:107], v[68:71], a[112:115], v[104:107]
    v_fma_f32 v20, v20, v18, v18
    v_fma_f32 v22, v22, v18, v18
    v_mfma_f32_16x16x32_bf16 v[104:107], v[64:67], a[96:99], v[104:107]
    s_waitcnt lgkmcnt(0)
    ds_read_b64_tr_b16 v[64:65], v93 offset:6144
    ds_read_b64_tr_b16 v[66:67], v95 offset:22528
    v_mfma_f32_16x16x32_bf16 v[112:115], v[40:43], a[96:99], v[112:115]
    ds_read_b64_tr_b16 v[68:69], v93 offset:8192
    ds_read_b64_tr_b16 v[70:71], v95 offset:24576
    v_mfma_f32_16x16x32_bf16 v[112:115], v[44:47], a[112:115], v[112:115]
    ds_read_b64_tr_b16 v[72:73], v93 offset:10240
    ds_read_b64_tr_b16 v[74:75], v95 offset:26624
    v_mfma_f32_16x16x32_bf16 v[112:115], v[48:51], a[128:131], v[112:115]
    v_rcp_f32 v20, v20
    v_mfma_f32_16x16x32_bf16 v[112:115], v[52:55], a[144:147], v[112:115]
    ds_read_b64_tr_b16 v[76:77], v5 offset:40960
    ds_read_b64_tr_b16 v[78:79], v93 offset:57344
    v_mfma_f32_16x16x32_bf16 v[112:115], v[56:59], a[160:163], v[112:115]
    v_rcp_f32 v22, v22
    v_mfma_f32_16x16x32_bf16 v[112:115], v[60:63], a[176:179], v[112:115]
    ds_read_b64_tr_b16 v[80:81], v5 offset:43008
    v_mul_f32 v21, v21, v20
    v_mfma_f32_16x16x32_bf16 v[116:119], v[60:63], a[180:183], v[116:119]
    ds_read_b64_tr_b16 v[82:83], v93 offset:59392
    v_mul_f32 v23, v23, v22
    v_mfma_f32_16x16x32_bf16 v[116:119], v[56:59], a[164:167], v[116:119]
    ds_read_b64_tr_b16 v[84:85], v5 offset:45056
    v_cvt_pk_bf16_f32 v32, v21, v23
    v_mfma_f32_16x16x32_bf16 v[116:119], v[52:55], a[148:151], v[116:119]
    ds_read_b64_tr_b16 v[86:87], v93 offset:61440
    v_mul_f32 v24, v194, v194
    v_mfma_f32_16x16x32_bf16 v[116:119], v[48:51], a[132:135], v[116:119]
    v_mul_f32 v26, v195, v195
    v_fma_f32 v24, v24, v14, v10
    v_mfma_f32_16x16x32_bf16 v[116:119], v[44:47], a[116:119], v[116:119]
    v_fma_f32 v26, v26, v14, v10
    v_mul_f32 v24, v24, v194
    v_mfma_f32_16x16x32_bf16 v[116:119], v[40:43], a[100:103], v[116:119]
    v_mul_f32 v26, v26, v195
    v_mul_f32 v25, v194, v210
    v_mfma_f32_16x16x32_bf16 v[144:147], v[40:43], a[104:107], v[144:147]
    v_exp_f32 v24, v24
    v_mfma_f32_16x16x32_bf16 v[144:147], v[44:47], a[120:123], v[144:147]
    v_exp_f32 v26, v26
    v_mfma_f32_16x16x32_bf16 v[144:147], v[48:51], a[136:139], v[144:147]
    v_mul_f32 v27, v195, v211
    v_fma_f32 v24, v24, v18, v18
    v_mfma_f32_16x16x32_bf16 v[144:147], v[52:55], a[152:155], v[144:147]
    v_fma_f32 v26, v26, v18, v18
    v_mfma_f32_16x16x32_bf16 v[144:147], v[56:59], a[168:171], v[144:147]
    v_rcp_f32 v24, v24
    v_mfma_f32_16x16x32_bf16 v[144:147], v[60:63], a[184:187], v[144:147]
    v_rcp_f32 v26, v26
    v_mfma_f32_16x16x32_bf16 v[148:151], v[60:63], a[188:191], v[148:151]
    v_mfma_f32_16x16x32_bf16 v[148:151], v[56:59], a[172:175], v[148:151]
    v_mul_f32 v25, v25, v24
    v_mul_f32 v27, v27, v26
    v_mfma_f32_16x16x32_bf16 v[148:151], v[52:55], a[156:159], v[148:151]
    v_cvt_pk_bf16_f32 v33, v25, v27
    v_mfma_f32_16x16x32_bf16 v[148:151], v[48:51], a[140:143], v[148:151]
    v_mul_f32 v28, v200, v200
    v_mfma_f32_16x16x32_bf16 v[148:151], v[44:47], a[124:127], v[148:151]
    v_mul_f32 v30, v201, v201
    v_mfma_f32_16x16x32_bf16 v[148:151], v[40:43], a[108:111], v[148:151]
    s_waitcnt lgkmcnt(0)
    s_waitcnt vmcnt(2)
    s_barrier
    v_mfma_f32_16x16x32_bf16 v[156:159], v[64:67], a[108:111], v[156:159]
    ds_read_b64_tr_b16 v[40:41], v4 offset:6144
    ds_read_b64_tr_b16 v[42:43], v92 offset:22528
    v_mfma_f32_16x16x32_bf16 v[156:159], v[68:71], a[124:127], v[156:159]
    ds_read_b64_tr_b16 v[44:45], v4 offset:8192
    ds_read_b64_tr_b16 v[46:47], v92 offset:24576
    v_mfma_f32_16x16x32_bf16 v[156:159], v[72:75], a[140:143], v[156:159]
    ds_read_b64_tr_b16 v[48:49], v4 offset:10240
    v_fma_f32 v28, v28, v14, v10
    v_mfma_f32_16x16x32_bf16 v[156:159], v[76:79], a[156:159], v[156:159]
    ds_read_b64_tr_b16 v[50:51], v92 offset:26624
    v_fma_f32 v30, v30, v14, v10
    v_mfma_f32_16x16x32_bf16 v[156:159], v[80:83], a[172:175], v[156:159]
    ds_read_b64_tr_b16 v[52:53], v4 offset:12288
    v_mul_f32 v28, v28, v200
    v_mfma_f32_16x16x32_bf16 v[156:159], v[84:87], a[188:191], v[156:159]
    ds_read_b64_tr_b16 v[54:55], v92 offset:28672
    v_mul_f32 v30, v30, v201
    v_mfma_f32_16x16x32_bf16 v[152:155], v[84:87], a[184:187], v[152:155]
    ds_read_b64_tr_b16 v[56:57], v4 offset:14336
    v_mul_f32 v29, v200, v216
    v_mfma_f32_16x16x32_bf16 v[152:155], v[80:83], a[168:171], v[152:155]
    ds_read_b64_tr_b16 v[58:59], v92 offset:30720
    v_mul_f32 v31, v201, v217
    v_mfma_f32_16x16x32_bf16 v[152:155], v[76:79], a[152:155], v[152:155]
    v_exp_f32 v28, v28
    v_mfma_f32_16x16x32_bf16 v[152:155], v[72:75], a[136:139], v[152:155]
    v_exp_f32 v30, v30
    v_mfma_f32_16x16x32_bf16 v[152:155], v[68:71], a[120:123], v[152:155]
    ds_read_b64_tr_b16 v[60:61], v4 offset:16384
    v_fma_f32 v28, v28, v18, v18
    v_mfma_f32_16x16x32_bf16 v[152:155], v[64:67], a[104:107], v[152:155]
    ds_read_b64_tr_b16 v[62:63], v92 offset:32768
    v_fma_f32 v30, v30, v18, v18
    v_mfma_f32_16x16x32_bf16 v[124:127], v[64:67], a[100:103], v[124:127]
    v_rcp_f32 v28, v28
    v_mfma_f32_16x16x32_bf16 v[124:127], v[68:71], a[116:119], v[124:127]
    v_rcp_f32 v30, v30
    v_mfma_f32_16x16x32_bf16 v[124:127], v[72:75], a[132:135], v[124:127]
    v_mul_f32 v29, v29, v28
    v_mul_f32 v31, v31, v30
    v_mfma_f32_16x16x32_bf16 v[124:127], v[76:79], a[148:151], v[124:127]
    v_cvt_pk_bf16_f32 v34, v29, v31
    v_mul_f32 v20, v202, v202
    v_mfma_f32_16x16x32_bf16 v[124:127], v[80:83], a[164:167], v[124:127]
    v_mul_f32 v22, v203, v203
    v_fma_f32 v20, v20, v14, v10
    v_mfma_f32_16x16x32_bf16 v[124:127], v[84:87], a[180:183], v[124:127]
    v_fma_f32 v22, v22, v14, v10
    v_mul_f32 v20, v20, v202
    v_mfma_f32_16x16x32_bf16 v[120:123], v[84:87], a[176:179], v[120:123]
    v_mul_f32 v22, v22, v203
    v_mul_f32 v21, v202, v218
    v_mfma_f32_16x16x32_bf16 v[120:123], v[80:83], a[160:163], v[120:123]
    v_mul_f32 v23, v203, v219
    v_mfma_f32_16x16x32_bf16 v[120:123], v[76:79], a[144:147], v[120:123]
    v_exp_f32 v20, v20
    v_mfma_f32_16x16x32_bf16 v[120:123], v[72:75], a[128:131], v[120:123]
    v_exp_f32 v22, v22
    v_mfma_f32_16x16x32_bf16 v[120:123], v[68:71], a[112:115], v[120:123]
    v_mfma_f32_16x16x32_bf16 v[120:123], v[64:67], a[96:99], v[120:123]
    s_waitcnt lgkmcnt(0)
    ds_read_b64_tr_b16 v[64:65], v5 offset:6144
    ds_read_b64_tr_b16 v[66:67], v93 offset:22528
    v_mfma_f32_16x16x32_bf16 v[96:99], v[40:43], a[192:195], v[96:99]
    ds_read_b64_tr_b16 v[68:69], v5 offset:8192
    ds_read_b64_tr_b16 v[70:71], v93 offset:24576
    v_mfma_f32_16x16x32_bf16 v[96:99], v[44:47], a[208:211], v[96:99]
    ds_read_b64_tr_b16 v[72:73], v5 offset:10240
    ds_read_b64_tr_b16 v[74:75], v93 offset:26624
    v_mfma_f32_16x16x32_bf16 v[96:99], v[48:51], a[224:227], v[96:99]
    ds_read_b64_tr_b16 v[76:77], v5 offset:12288
    v_fma_f32 v20, v20, v18, v18
    v_mfma_f32_16x16x32_bf16 v[96:99], v[52:55], a[240:243], v[96:99]
    ds_read_b64_tr_b16 v[78:79], v93 offset:28672
    v_fma_f32 v22, v22, v18, v18
    v_mfma_f32_16x16x32_bf16 v[96:99], v[56:59], v[224:227], v[96:99]
    v_rcp_f32 v20, v20
    v_mfma_f32_16x16x32_bf16 v[96:99], v[60:63], v[240:243], v[96:99]
    v_rcp_f32 v22, v22
    v_mfma_f32_16x16x32_bf16 v[100:103], v[60:63], v[244:247], v[100:103]
    ds_read_b64_tr_b16 v[80:81], v5 offset:14336
    v_mul_f32 v21, v21, v20
    v_mfma_f32_16x16x32_bf16 v[100:103], v[56:59], v[228:231], v[100:103]
    ds_read_b64_tr_b16 v[82:83], v93 offset:30720
    v_mul_f32 v23, v23, v22
    v_mfma_f32_16x16x32_bf16 v[100:103], v[52:55], a[244:247], v[100:103]
    ds_read_b64_tr_b16 v[84:85], v5 offset:16384
    v_cvt_pk_bf16_f32 v35, v21, v23
    v_mfma_f32_16x16x32_bf16 v[100:103], v[48:51], a[228:231], v[100:103]
    ds_read_b64_tr_b16 v[86:87], v93 offset:32768
    v_mul_f32 v24, v196, v196
    v_mfma_f32_16x16x32_bf16 v[100:103], v[44:47], a[212:215], v[100:103]
    v_mul_f32 v26, v197, v197
    v_mfma_f32_16x16x32_bf16 v[100:103], v[40:43], a[196:199], v[100:103]
    v_fma_f32 v24, v24, v15, v11
    v_fma_f32 v26, v26, v15, v11
    v_mfma_f32_16x16x32_bf16 v[128:131], v[40:43], a[200:203], v[128:131]
    v_mul_f32 v24, v24, v196
    v_mfma_f32_16x16x32_bf16 v[128:131], v[44:47], a[216:219], v[128:131]
    v_mul_f32 v26, v26, v197
    v_mfma_f32_16x16x32_bf16 v[128:131], v[48:51], a[232:235], v[128:131]
    s_lshl_b32 s38, s34, 6
    v_mul_f32 v25, v196, v212
    v_mfma_f32_16x16x32_bf16 v[128:131], v[52:55], a[248:251], v[128:131]
    s_add_u32 s38, s38, s42
    s_add_u32 s38, s38, 0x81000
    v_mul_f32 v27, v197, v213
    v_mfma_f32_16x16x32_bf16 v[128:131], v[56:59], v[232:235], v[128:131]
    buffer_store_dwordx4 v[32:35], v1, s[28:31], s38 offen sc1
    v_mfma_f32_16x16x32_bf16 v[128:131], v[60:63], v[248:251], v[128:131]
    v_exp_f32 v24, v24
    v_mfma_f32_16x16x32_bf16 v[132:135], v[60:63], v[252:255], v[132:135]
    v_exp_f32 v26, v26
    v_mfma_f32_16x16x32_bf16 v[132:135], v[56:59], v[236:239], v[132:135]
    v_fma_f32 v24, v24, v19, v19
    v_fma_f32 v26, v26, v19, v19
    v_mfma_f32_16x16x32_bf16 v[132:135], v[52:55], a[252:255], v[132:135]
    v_rcp_f32 v24, v24
    v_mfma_f32_16x16x32_bf16 v[132:135], v[48:51], a[236:239], v[132:135]
    v_mfma_f32_16x16x32_bf16 v[132:135], v[44:47], a[220:223], v[132:135]
    v_rcp_f32 v26, v26
    v_mfma_f32_16x16x32_bf16 v[132:135], v[40:43], a[204:207], v[132:135]
    s_waitcnt lgkmcnt(0)
    ds_read_b64_tr_b16 v[40:41], v4 offset:47104
    ds_read_b64_tr_b16 v[42:43], v92 offset:63488
    v_mfma_f32_16x16x32_bf16 v[140:143], v[64:67], a[204:207], v[140:143]
    ds_read_b64_tr_b16 v[44:45], v4 offset:49152
    ds_read_b64_tr_b16 v[46:47], v94 offset:0
    v_mfma_f32_16x16x32_bf16 v[140:143], v[68:71], a[220:223], v[140:143]
    ds_read_b64_tr_b16 v[48:49], v4 offset:51200
    ds_read_b64_tr_b16 v[50:51], v94 offset:2048
    v_mfma_f32_16x16x32_bf16 v[140:143], v[72:75], a[236:239], v[140:143]
    ds_read_b64_tr_b16 v[52:53], v4 offset:53248
    v_mul_f32 v25, v25, v24
    v_mfma_f32_16x16x32_bf16 v[140:143], v[76:79], a[252:255], v[140:143]
    ds_read_b64_tr_b16 v[54:55], v94 offset:4096
    v_mul_f32 v27, v27, v26
    v_mfma_f32_16x16x32_bf16 v[140:143], v[80:83], v[236:239], v[140:143]
    ds_read_b64_tr_b16 v[56:57], v4 offset:55296
    v_cvt_pk_bf16_f32 v88, v25, v27
    v_mfma_f32_16x16x32_bf16 v[140:143], v[84:87], v[252:255], v[140:143]
    ds_read_b64_tr_b16 v[58:59], v94 offset:6144
    v_mul_f32 v28, v198, v198
    v_mfma_f32_16x16x32_bf16 v[136:139], v[84:87], v[248:251], v[136:139]
    ds_read_b64_tr_b16 v[60:61], v4 offset:57344
    v_mul_f32 v30, v199, v199
    v_mfma_f32_16x16x32_bf16 v[136:139], v[80:83], v[232:235], v[136:139]
    ds_read_b64_tr_b16 v[62:63], v94 offset:8192
    v_fma_f32 v28, v28, v15, v11
    v_mfma_f32_16x16x32_bf16 v[136:139], v[76:79], a[248:251], v[136:139]
    v_fma_f32 v30, v30, v15, v11
    v_mul_f32 v28, v28, v198
    v_mfma_f32_16x16x32_bf16 v[136:139], v[72:75], a[232:235], v[136:139]
    v_mul_f32 v30, v30, v199
    v_mul_f32 v29, v198, v214
    v_mfma_f32_16x16x32_bf16 v[136:139], v[68:71], a[216:219], v[136:139]
    v_exp_f32 v28, v28
    v_mfma_f32_16x16x32_bf16 v[136:139], v[64:67], a[200:203], v[136:139]
    v_mul_f32 v31, v199, v215
    v_fma_f32 v28, v28, v19, v19
    v_mfma_f32_16x16x32_bf16 v[108:111], v[64:67], a[196:199], v[108:111]
    v_exp_f32 v30, v30
    v_mfma_f32_16x16x32_bf16 v[108:111], v[68:71], a[212:215], v[108:111]
    v_rcp_f32 v28, v28
    v_mfma_f32_16x16x32_bf16 v[108:111], v[72:75], a[228:231], v[108:111]
    v_fma_f32 v30, v30, v19, v19
    v_mfma_f32_16x16x32_bf16 v[108:111], v[76:79], a[244:247], v[108:111]
    v_rcp_f32 v30, v30
    v_mfma_f32_16x16x32_bf16 v[108:111], v[80:83], v[228:231], v[108:111]
    v_mul_f32 v29, v29, v28
    v_mul_f32 v31, v31, v30
    v_mfma_f32_16x16x32_bf16 v[108:111], v[84:87], v[244:247], v[108:111]
    v_cvt_pk_bf16_f32 v89, v29, v31
    v_mfma_f32_16x16x32_bf16 v[104:107], v[84:87], v[240:243], v[104:107]
    v_mul_f32 v20, v204, v204
    v_mfma_f32_16x16x32_bf16 v[104:107], v[80:83], v[224:227], v[104:107]
    v_mul_f32 v22, v205, v205
    v_fma_f32 v20, v20, v15, v11
    v_mfma_f32_16x16x32_bf16 v[104:107], v[76:79], a[240:243], v[104:107]
    v_fma_f32 v22, v22, v15, v11
    v_mfma_f32_16x16x32_bf16 v[104:107], v[72:75], a[224:227], v[104:107]
    v_mul_f32 v20, v20, v204
    v_mfma_f32_16x16x32_bf16 v[104:107], v[68:71], a[208:211], v[104:107]
    v_mul_f32 v22, v22, v205
    v_mfma_f32_16x16x32_bf16 v[104:107], v[64:67], a[192:195], v[104:107]
    s_waitcnt lgkmcnt(0)
    ds_read_b64_tr_b16 v[64:65], v5 offset:47104
    ds_read_b64_tr_b16 v[66:67], v93 offset:63488
    v_mfma_f32_16x16x32_bf16 v[112:115], v[40:43], a[192:195], v[112:115]
    ds_read_b64_tr_b16 v[68:69], v5 offset:49152
    ds_read_b64_tr_b16 v[70:71], v95 offset:0
    v_mfma_f32_16x16x32_bf16 v[112:115], v[44:47], a[208:211], v[112:115]
    ds_read_b64_tr_b16 v[72:73], v5 offset:51200
    v_mul_f32 v21, v204, v220
    v_mfma_f32_16x16x32_bf16 v[112:115], v[48:51], a[224:227], v[112:115]
    ds_read_b64_tr_b16 v[74:75], v95 offset:2048
    v_mul_f32 v23, v205, v221
    v_mfma_f32_16x16x32_bf16 v[112:115], v[52:55], a[240:243], v[112:115]
    ds_read_b64_tr_b16 v[76:77], v5 offset:53248
    ds_read_b64_tr_b16 v[78:79], v95 offset:4096
    v_mfma_f32_16x16x32_bf16 v[112:115], v[56:59], v[224:227], v[112:115]
    v_exp_f32 v20, v20
    v_mfma_f32_16x16x32_bf16 v[112:115], v[60:63], v[240:243], v[112:115]
    v_exp_f32 v22, v22
    v_mfma_f32_16x16x32_bf16 v[116:119], v[60:63], v[244:247], v[116:119]
    ds_read_b64_tr_b16 v[80:81], v5 offset:55296
    v_fma_f32 v20, v20, v19, v19
    v_mfma_f32_16x16x32_bf16 v[116:119], v[56:59], v[228:231], v[116:119]
    ds_read_b64_tr_b16 v[82:83], v95 offset:6144
    v_fma_f32 v22, v22, v19, v19
    v_mfma_f32_16x16x32_bf16 v[116:119], v[52:55], a[244:247], v[116:119]
    v_rcp_f32 v20, v20
    v_mfma_f32_16x16x32_bf16 v[116:119], v[48:51], a[228:231], v[116:119]
    ds_read_b64_tr_b16 v[84:85], v5 offset:57344
    ds_read_b64_tr_b16 v[86:87], v95 offset:8192
    v_mfma_f32_16x16x32_bf16 v[116:119], v[44:47], a[212:215], v[116:119]
    v_rcp_f32 v22, v22
    v_mfma_f32_16x16x32_bf16 v[116:119], v[40:43], a[196:199], v[116:119]
    v_mul_f32 v21, v21, v20
    v_mul_f32 v23, v23, v22
    v_mfma_f32_16x16x32_bf16 v[144:147], v[40:43], a[200:203], v[144:147]
    v_cvt_pk_bf16_f32 v90, v21, v23
    v_mul_f32 v24, v206, v206
    v_mfma_f32_16x16x32_bf16 v[144:147], v[44:47], a[216:219], v[144:147]
    v_mul_f32 v26, v207, v207
    v_fma_f32 v24, v24, v15, v11
    v_mfma_f32_16x16x32_bf16 v[144:147], v[48:51], a[232:235], v[144:147]
    v_fma_f32 v26, v26, v15, v11
    v_mul_f32 v24, v24, v206
    v_mfma_f32_16x16x32_bf16 v[144:147], v[52:55], a[248:251], v[144:147]
    v_mul_f32 v26, v26, v207
    v_mul_f32 v25, v206, v222
    v_mfma_f32_16x16x32_bf16 v[144:147], v[56:59], v[232:235], v[144:147]
    v_mul_f32 v27, v207, v223
    v_xor_b32 v4, 64, v4
    v_mfma_f32_16x16x32_bf16 v[144:147], v[60:63], v[248:251], v[144:147]
    v_exp_f32 v24, v24
    v_mfma_f32_16x16x32_bf16 v[148:151], v[60:63], v[252:255], v[148:151]
    v_xor_b32 v92, 64, v92
    v_xor_b32 v94, 64, v94
    v_mfma_f32_16x16x32_bf16 v[148:151], v[56:59], v[236:239], v[148:151]
    v_exp_f32 v26, v26
    v_mfma_f32_16x16x32_bf16 v[148:151], v[52:55], a[252:255], v[148:151]
    v_xor_b32 v5, 64, v5
    v_xor_b32 v93, 64, v93
    v_mfma_f32_16x16x32_bf16 v[148:151], v[48:51], a[236:239], v[148:151]
    v_fma_f32 v24, v24, v19, v19
    v_fma_f32 v26, v26, v19, v19
    v_mfma_f32_16x16x32_bf16 v[148:151], v[44:47], a[220:223], v[148:151]
    v_rcp_f32 v24, v24
    v_mfma_f32_16x16x32_bf16 v[148:151], v[40:43], a[204:207], v[148:151]
    s_waitcnt lgkmcnt(0)
    ds_read_b64_tr_b16 v[40:41], v4 offset:18432
    v_xor_b32 v95, 64, v95
    v_mfma_f32_16x16x32_bf16 v[156:159], v[64:67], a[204:207], v[156:159]
    ds_read_b64_tr_b16 v[42:43], v92 offset:34816
    ds_read_b64_tr_b16 v[44:45], v4 offset:20480
    v_mfma_f32_16x16x32_bf16 v[156:159], v[68:71], a[220:223], v[156:159]
    v_rcp_f32 v26, v26
    v_mfma_f32_16x16x32_bf16 v[156:159], v[72:75], a[236:239], v[156:159]
    ds_read_b64_tr_b16 v[46:47], v92 offset:36864
    v_mul_f32 v25, v25, v24
    v_mfma_f32_16x16x32_bf16 v[156:159], v[76:79], a[252:255], v[156:159]
    ds_read_b64_tr_b16 v[48:49], v4 offset:22528
    v_mul_f32 v27, v27, v26
    v_mfma_f32_16x16x32_bf16 v[156:159], v[80:83], v[236:239], v[156:159]
    ds_read_b64_tr_b16 v[50:51], v92 offset:38912
    v_cvt_pk_bf16_f32 v91, v25, v27
    v_mfma_f32_16x16x32_bf16 v[156:159], v[84:87], v[252:255], v[156:159]
    ds_read_b64_tr_b16 v[52:53], v4 offset:24576
    ds_read_b64_tr_b16 v[54:55], v92 offset:40960
    v_mfma_f32_16x16x32_bf16 v[152:155], v[84:87], v[248:251], v[152:155]
    ds_read_b64_tr_b16 v[56:57], v4 offset:26624
    ds_read_b64_tr_b16 v[58:59], v92 offset:43008
    v_mfma_f32_16x16x32_bf16 v[152:155], v[80:83], v[232:235], v[152:155]
    ds_read_b64_tr_b16 v[60:61], v4 offset:28672
    ds_read_b64_tr_b16 v[62:63], v92 offset:45056
    v_mfma_f32_16x16x32_bf16 v[152:155], v[76:79], a[248:251], v[152:155]
    v_mfma_f32_16x16x32_bf16 v[152:155], v[72:75], a[232:235], v[152:155]
    v_mfma_f32_16x16x32_bf16 v[152:155], v[68:71], a[216:219], v[152:155]
    v_mfma_f32_16x16x32_bf16 v[152:155], v[64:67], a[200:203], v[152:155]
    s_lshl_b32 s38, s34, 6
    v_mfma_f32_16x16x32_bf16 v[124:127], v[64:67], a[196:199], v[124:127]
    s_add_u32 s38, s38, s43
    s_add_u32 s38, s38, 0x81000
    v_mfma_f32_16x16x32_bf16 v[124:127], v[68:71], a[212:215], v[124:127]
    buffer_store_dwordx4 v[88:91], v1, s[28:31], s38 offen sc1
    v_mfma_f32_16x16x32_bf16 v[124:127], v[72:75], a[228:231], v[124:127]
    v_mfma_f32_16x16x32_bf16 v[124:127], v[76:79], a[244:247], v[124:127]
    v_mfma_f32_16x16x32_bf16 v[124:127], v[80:83], v[228:231], v[124:127]
    v_mfma_f32_16x16x32_bf16 v[124:127], v[84:87], v[244:247], v[124:127]
    v_mfma_f32_16x16x32_bf16 v[120:123], v[84:87], v[240:243], v[120:123]
    v_mul_f32 v28, v96, v96
    v_mfma_f32_16x16x32_bf16 v[120:123], v[80:83], v[224:227], v[120:123]
    v_mul_f32 v30, v97, v97
    v_mfma_f32_16x16x32_bf16 v[120:123], v[76:79], a[240:243], v[120:123]
    v_fma_f32 v28, v28, v12, v8
    v_mfma_f32_16x16x32_bf16 v[120:123], v[72:75], a[224:227], v[120:123]
    v_fma_f32 v30, v30, v12, v8
    v_mfma_f32_16x16x32_bf16 v[120:123], v[68:71], a[208:211], v[120:123]
    v_mul_f32 v28, v28, v96
    v_mul_f32 v30, v30, v97
    v_mfma_f32_16x16x32_bf16 v[120:123], v[64:67], a[192:195], v[120:123]
    s_waitcnt lgkmcnt(0)
    ds_read_b64_tr_b16 v[64:65], v5 offset:18432
    ds_read_b64_tr_b16 v[66:67], v93 offset:34816
    v_mfma_f32_16x16x32_bf16 v[160:163], v[40:43], a[0:3], 0
    ds_read_b64_tr_b16 v[68:69], v5 offset:20480
    ds_read_b64_tr_b16 v[70:71], v93 offset:36864
    v_mfma_f32_16x16x32_bf16 v[160:163], v[44:47], a[16:19], v[160:163]
    ds_read_b64_tr_b16 v[72:73], v5 offset:22528
    ds_read_b64_tr_b16 v[74:75], v93 offset:38912
    v_mfma_f32_16x16x32_bf16 v[160:163], v[48:51], a[32:35], v[160:163]
    ds_read_b64_tr_b16 v[76:77], v5 offset:24576
    v_mul_f32 v29, v96, v112
    v_mfma_f32_16x16x32_bf16 v[160:163], v[52:55], a[48:51], v[160:163]
    ds_read_b64_tr_b16 v[78:79], v93 offset:40960
    v_mul_f32 v31, v97, v113
    v_mfma_f32_16x16x32_bf16 v[160:163], v[56:59], a[64:67], v[160:163]
    v_exp_f32 v28, v28
    v_mfma_f32_16x16x32_bf16 v[160:163], v[60:63], a[80:83], v[160:163]
    v_exp_f32 v30, v30
    v_mfma_f32_16x16x32_bf16 v[164:167], v[60:63], a[84:87], 0
    ds_read_b64_tr_b16 v[80:81], v5 offset:26624
    v_fma_f32 v28, v28, v16, v16
    v_mfma_f32_16x16x32_bf16 v[164:167], v[56:59], a[68:71], v[164:167]
    ds_read_b64_tr_b16 v[82:83], v93 offset:43008
    v_fma_f32 v30, v30, v16, v16
    v_mfma_f32_16x16x32_bf16 v[164:167], v[52:55], a[52:55], v[164:167]
    v_rcp_f32 v28, v28
    v_mfma_f32_16x16x32_bf16 v[164:167], v[48:51], a[36:39], v[164:167]
    ds_read_b64_tr_b16 v[84:85], v5 offset:28672
    ds_read_b64_tr_b16 v[86:87], v93 offset:45056
    v_mfma_f32_16x16x32_bf16 v[164:167], v[44:47], a[20:23], v[164:167]
    v_rcp_f32 v30, v30
    v_mfma_f32_16x16x32_bf16 v[164:167], v[40:43], a[4:7], v[164:167]
    v_mul_f32 v29, v29, v28
    v_mul_f32 v31, v31, v30
    v_mfma_f32_16x16x32_bf16 v[192:195], v[40:43], a[8:11], 0
    v_cvt_pk_bf16_f32 v32, v29, v31
    v_mul_f32 v20, v98, v98
    v_mfma_f32_16x16x32_bf16 v[192:195], v[44:47], a[24:27], v[192:195]
    v_mul_f32 v22, v99, v99
    v_fma_f32 v20, v20, v12, v8
    v_mfma_f32_16x16x32_bf16 v[192:195], v[48:51], a[40:43], v[192:195]
    v_fma_f32 v22, v22, v12, v8
    v_mul_f32 v20, v20, v98
    v_mfma_f32_16x16x32_bf16 v[192:195], v[52:55], a[56:59], v[192:195]
    v_mul_f32 v22, v22, v99
    v_mfma_f32_16x16x32_bf16 v[192:195], v[56:59], a[72:75], v[192:195]
    v_mul_f32 v21, v98, v114
    v_mul_f32 v23, v99, v115
    v_mfma_f32_16x16x32_bf16 v[192:195], v[60:63], a[88:91], v[192:195]
    v_exp_f32 v20, v20
    v_mfma_f32_16x16x32_bf16 v[196:199], v[60:63], a[92:95], 0
    v_mfma_f32_16x16x32_bf16 v[196:199], v[56:59], a[76:79], v[196:199]
    v_exp_f32 v22, v22
    v_mfma_f32_16x16x32_bf16 v[196:199], v[52:55], a[60:63], v[196:199]
    v_fma_f32 v20, v20, v16, v16
    v_mfma_f32_16x16x32_bf16 v[196:199], v[48:51], a[44:47], v[196:199]
    v_fma_f32 v22, v22, v16, v16
    v_mfma_f32_16x16x32_bf16 v[196:199], v[44:47], a[28:31], v[196:199]
    v_rcp_f32 v20, v20
    v_mfma_f32_16x16x32_bf16 v[196:199], v[40:43], a[12:15], v[196:199]
    s_waitcnt lgkmcnt(0)
    ds_read_b64_tr_b16 v[40:41], v4 offset:59392
    ds_read_b64_tr_b16 v[42:43], v94 offset:10240
    v_mfma_f32_16x16x32_bf16 v[204:207], v[64:67], a[12:15], 0
    ds_read_b64_tr_b16 v[44:45], v4 offset:61440
    ds_read_b64_tr_b16 v[46:47], v94 offset:12288
    v_mfma_f32_16x16x32_bf16 v[204:207], v[68:71], a[28:31], v[204:207]
    ds_read_b64_tr_b16 v[48:49], v4 offset:63488
    ds_read_b64_tr_b16 v[50:51], v94 offset:14336
    v_mfma_f32_16x16x32_bf16 v[204:207], v[72:75], a[44:47], v[204:207]
    v_rcp_f32 v22, v22
    v_mfma_f32_16x16x32_bf16 v[204:207], v[76:79], a[60:63], v[204:207]
    ds_read_b64_tr_b16 v[52:53], v92 offset:0
    v_mul_f32 v21, v21, v20
    v_mfma_f32_16x16x32_bf16 v[204:207], v[80:83], a[76:79], v[204:207]
    ds_read_b64_tr_b16 v[54:55], v94 offset:16384
    v_mul_f32 v23, v23, v22
    v_mfma_f32_16x16x32_bf16 v[204:207], v[84:87], a[92:95], v[204:207]
    ds_read_b64_tr_b16 v[56:57], v92 offset:2048
    v_cvt_pk_bf16_f32 v33, v21, v23
    v_mfma_f32_16x16x32_bf16 v[200:203], v[84:87], a[88:91], 0
    ds_read_b64_tr_b16 v[58:59], v94 offset:18432
    v_mul_f32 v24, v104, v104
    v_mfma_f32_16x16x32_bf16 v[200:203], v[80:83], a[72:75], v[200:203]
    ds_read_b64_tr_b16 v[60:61], v92 offset:4096
    v_mul_f32 v26, v105, v105
    v_mfma_f32_16x16x32_bf16 v[200:203], v[76:79], a[56:59], v[200:203]
    ds_read_b64_tr_b16 v[62:63], v94 offset:20480
    v_fma_f32 v24, v24, v12, v8
    v_mfma_f32_16x16x32_bf16 v[200:203], v[72:75], a[40:43], v[200:203]
    v_fma_f32 v26, v26, v12, v8
    v_mul_f32 v24, v24, v104
    v_mfma_f32_16x16x32_bf16 v[200:203], v[68:71], a[24:27], v[200:203]
    v_mul_f32 v26, v26, v105
    v_mul_f32 v25, v104, v120
    v_mfma_f32_16x16x32_bf16 v[200:203], v[64:67], a[8:11], v[200:203]
    v_exp_f32 v24, v24
    v_mfma_f32_16x16x32_bf16 v[172:175], v[64:67], a[4:7], 0
    v_exp_f32 v26, v26
    v_mfma_f32_16x16x32_bf16 v[172:175], v[68:71], a[20:23], v[172:175]
    v_mul_f32 v27, v105, v121
    v_fma_f32 v24, v24, v16, v16
    v_mfma_f32_16x16x32_bf16 v[172:175], v[72:75], a[36:39], v[172:175]
    v_rcp_f32 v24, v24
    v_mfma_f32_16x16x32_bf16 v[172:175], v[76:79], a[52:55], v[172:175]
    v_fma_f32 v26, v26, v16, v16
    v_mfma_f32_16x16x32_bf16 v[172:175], v[80:83], a[68:71], v[172:175]
    v_rcp_f32 v26, v26
    v_mfma_f32_16x16x32_bf16 v[172:175], v[84:87], a[84:87], v[172:175]
    v_mul_f32 v25, v25, v24
    v_mfma_f32_16x16x32_bf16 v[168:171], v[84:87], a[80:83], 0
    v_mul_f32 v27, v27, v26
    v_mfma_f32_16x16x32_bf16 v[168:171], v[80:83], a[64:67], v[168:171]
    v_cvt_pk_bf16_f32 v34, v25, v27
    v_mfma_f32_16x16x32_bf16 v[168:171], v[76:79], a[48:51], v[168:171]
    v_mul_f32 v28, v106, v106
    v_mfma_f32_16x16x32_bf16 v[168:171], v[72:75], a[32:35], v[168:171]
    v_mul_f32 v30, v107, v107
    v_fma_f32 v28, v28, v12, v8
    v_mfma_f32_16x16x32_bf16 v[168:171], v[68:71], a[16:19], v[168:171]
    v_fma_f32 v30, v30, v12, v8
    v_mfma_f32_16x16x32_bf16 v[168:171], v[64:67], a[0:3], v[168:171]
    s_waitcnt lgkmcnt(0)
    ds_read_b64_tr_b16 v[64:65], v5 offset:59392
    ds_read_b64_tr_b16 v[66:67], v95 offset:10240
    v_mfma_f32_16x16x32_bf16 v[176:179], v[40:43], a[0:3], 0
    ds_read_b64_tr_b16 v[68:69], v5 offset:61440
    ds_read_b64_tr_b16 v[70:71], v95 offset:12288
    v_mfma_f32_16x16x32_bf16 v[176:179], v[44:47], a[16:19], v[176:179]
    ds_read_b64_tr_b16 v[72:73], v5 offset:63488
    ds_read_b64_tr_b16 v[74:75], v95 offset:14336
    v_mfma_f32_16x16x32_bf16 v[176:179], v[48:51], a[32:35], v[176:179]
    ds_read_b64_tr_b16 v[76:77], v93 offset:0
    v_mul_f32 v28, v28, v106
    v_mfma_f32_16x16x32_bf16 v[176:179], v[52:55], a[48:51], v[176:179]
    ds_read_b64_tr_b16 v[78:79], v95 offset:16384
    v_mul_f32 v30, v30, v107
    v_mfma_f32_16x16x32_bf16 v[176:179], v[56:59], a[64:67], v[176:179]
    ds_read_b64_tr_b16 v[80:81], v93 offset:2048
    v_mul_f32 v29, v106, v122
    v_mfma_f32_16x16x32_bf16 v[176:179], v[60:63], a[80:83], v[176:179]
    ds_read_b64_tr_b16 v[82:83], v95 offset:18432
    v_mul_f32 v31, v107, v123
    v_mfma_f32_16x16x32_bf16 v[180:183], v[60:63], a[84:87], 0
    v_exp_f32 v28, v28
    v_mfma_f32_16x16x32_bf16 v[180:183], v[56:59], a[68:71], v[180:183]
    v_exp_f32 v30, v30
    v_mfma_f32_16x16x32_bf16 v[180:183], v[52:55], a[52:55], v[180:183]
    ds_read_b64_tr_b16 v[84:85], v93 offset:4096
    v_fma_f32 v28, v28, v16, v16
    v_mfma_f32_16x16x32_bf16 v[180:183], v[48:51], a[36:39], v[180:183]
    ds_read_b64_tr_b16 v[86:87], v95 offset:20480
    v_fma_f32 v30, v30, v16, v16
    v_mfma_f32_16x16x32_bf16 v[180:183], v[44:47], a[20:23], v[180:183]
    v_rcp_f32 v28, v28
    v_mfma_f32_16x16x32_bf16 v[180:183], v[40:43], a[4:7], v[180:183]
    v_rcp_f32 v30, v30
    v_mfma_f32_16x16x32_bf16 v[208:211], v[40:43], a[8:11], 0
    v_mul_f32 v29, v29, v28
    v_mul_f32 v31, v31, v30
    v_mfma_f32_16x16x32_bf16 v[208:211], v[44:47], a[24:27], v[208:211]
    v_cvt_pk_bf16_f32 v35, v29, v31
    v_mfma_f32_16x16x32_bf16 v[208:211], v[48:51], a[40:43], v[208:211]
    v_mfma_f32_16x16x32_bf16 v[208:211], v[52:55], a[56:59], v[208:211]
    v_mul_f32 v20, v100, v100
    v_mfma_f32_16x16x32_bf16 v[208:211], v[56:59], a[72:75], v[208:211]
    v_mul_f32 v22, v101, v101
    v_mfma_f32_16x16x32_bf16 v[208:211], v[60:63], a[88:91], v[208:211]
    v_fma_f32 v20, v20, v13, v9
    v_mfma_f32_16x16x32_bf16 v[212:215], v[60:63], a[92:95], 0
    v_fma_f32 v22, v22, v13, v9
    v_mul_f32 v20, v20, v100
    v_mfma_f32_16x16x32_bf16 v[212:215], v[56:59], a[76:79], v[212:215]
    v_mul_f32 v22, v22, v101
    v_mfma_f32_16x16x32_bf16 v[212:215], v[52:55], a[60:63], v[212:215]
    s_lshl_b32 s38, s34, 6
    v_mul_f32 v21, v100, v116
    v_mfma_f32_16x16x32_bf16 v[212:215], v[48:51], a[44:47], v[212:215]
    s_add_u32 s38, s38, s40
    v_mul_f32 v23, v101, v117
    v_mfma_f32_16x16x32_bf16 v[212:215], v[44:47], a[28:31], v[212:215]
    s_add_u32 s38, s38, 0x82000
    v_exp_f32 v20, v20
    v_mfma_f32_16x16x32_bf16 v[212:215], v[40:43], a[12:15], v[212:215]
    s_waitcnt lgkmcnt(0)
    s_barrier
    ds_read_b64_tr_b16 v[40:41], v4 offset:30720
    v_mfma_f32_16x16x32_bf16 v[220:223], v[64:67], a[12:15], 0
    s_add_u32 m0, s33, 0x4800
    ds_read_b64_tr_b16 v[42:43], v92 offset:47104
    ds_read_b64_tr_b16 v[44:45], v4 offset:32768
    v_mfma_f32_16x16x32_bf16 v[220:223], v[68:71], a[28:31], v[220:223]
    buffer_store_dwordx4 v[32:35], v1, s[28:31], s38 offen sc1
    v_mfma_f32_16x16x32_bf16 v[220:223], v[72:75], a[44:47], v[220:223]
    ds_read_b64_tr_b16 v[46:47], v92 offset:49152
    ds_read_b64_tr_b16 v[48:49], v4 offset:34816
    v_mfma_f32_16x16x32_bf16 v[220:223], v[76:79], a[60:63], v[220:223]
    s_add_u32 s37, s36, 0x0
    ds_read_b64_tr_b16 v[50:51], v92 offset:51200
    ds_read_b64_tr_b16 v[52:53], v4 offset:0
    v_mfma_f32_16x16x32_bf16 v[220:223], v[80:83], a[76:79], v[220:223]
    v_exp_f32 v22, v22
    v_mfma_f32_16x16x32_bf16 v[220:223], v[84:87], a[92:95], v[220:223]
    buffer_load_dwordx4 v3, s[12:15], s37 offen lds
    v_mfma_f32_16x16x32_bf16 v[216:219], v[84:87], a[88:91], 0
    ds_read_b64_tr_b16 v[54:55], v92 offset:16384
    v_fma_f32 v20, v20, v17, v17
    v_mfma_f32_16x16x32_bf16 v[216:219], v[80:83], a[72:75], v[216:219]
    ds_read_b64_tr_b16 v[56:57], v4 offset:2048
    v_fma_f32 v22, v22, v17, v17
    v_mfma_f32_16x16x32_bf16 v[216:219], v[76:79], a[56:59], v[216:219]
    s_add_u32 m0, s33, 0x4c00
    v_rcp_f32 v20, v20
    v_mfma_f32_16x16x32_bf16 v[216:219], v[72:75], a[40:43], v[216:219]
    v_rcp_f32 v22, v22
    v_mfma_f32_16x16x32_bf16 v[216:219], v[68:71], a[24:27], v[216:219]
    s_add_u32 s37, s36, 0x40000
    ds_read_b64_tr_b16 v[58:59], v92 offset:18432
    v_mul_f32 v21, v21, v20
    v_mfma_f32_16x16x32_bf16 v[216:219], v[64:67], a[8:11], v[216:219]
    ds_read_b64_tr_b16 v[60:61], v4 offset:4096
    v_mul_f32 v23, v23, v22
    v_mfma_f32_16x16x32_bf16 v[188:191], v[64:67], a[4:7], 0
    ds_read_b64_tr_b16 v[62:63], v92 offset:20480
    v_cvt_pk_bf16_f32 v88, v21, v23
    v_mfma_f32_16x16x32_bf16 v[188:191], v[68:71], a[20:23], v[188:191]
    buffer_load_dwordx4 v3, s[12:15], s37 offen lds
    v_mfma_f32_16x16x32_bf16 v[188:191], v[72:75], a[36:39], v[188:191]
    v_mul_f32 v24, v102, v102
    v_mul_f32 v26, v103, v103
    v_mfma_f32_16x16x32_bf16 v[188:191], v[76:79], a[52:55], v[188:191]
    s_add_u32 m0, s33, 0x5000
    v_fma_f32 v24, v24, v13, v9
    v_fma_f32 v26, v26, v13, v9
    v_mfma_f32_16x16x32_bf16 v[188:191], v[80:83], a[68:71], v[188:191]
    v_mul_f32 v24, v24, v102
    v_mul_f32 v26, v26, v103
    v_mfma_f32_16x16x32_bf16 v[188:191], v[84:87], a[84:87], v[188:191]
    s_add_u32 s37, s36, 0x80000
    v_mul_f32 v25, v102, v118
    v_mul_f32 v27, v103, v119
    v_mfma_f32_16x16x32_bf16 v[184:187], v[84:87], a[80:83], 0
    v_exp_f32 v24, v24
    v_mfma_f32_16x16x32_bf16 v[184:187], v[80:83], a[64:67], v[184:187]
    v_exp_f32 v26, v26
    v_mfma_f32_16x16x32_bf16 v[184:187], v[76:79], a[48:51], v[184:187]
    buffer_load_dwordx4 v3, s[12:15], s37 offen lds
    v_mfma_f32_16x16x32_bf16 v[184:187], v[72:75], a[32:35], v[184:187]
    v_fma_f32 v24, v24, v17, v17
    v_fma_f32 v26, v26, v17, v17
    v_mfma_f32_16x16x32_bf16 v[184:187], v[68:71], a[16:19], v[184:187]
    s_add_u32 m0, s33, 0x5400
    v_rcp_f32 v24, v24
    v_mfma_f32_16x16x32_bf16 v[184:187], v[64:67], a[0:3], v[184:187]
    s_waitcnt lgkmcnt(0)
    ds_read_b64_tr_b16 v[64:65], v5 offset:30720
    ds_read_b64_tr_b16 v[66:67], v93 offset:47104
    v_mfma_f32_16x16x32_bf16 v[160:163], v[40:43], a[96:99], v[160:163]
    ds_read_b64_tr_b16 v[68:69], v5 offset:32768
    ds_read_b64_tr_b16 v[70:71], v93 offset:49152
    v_mfma_f32_16x16x32_bf16 v[160:163], v[44:47], a[112:115], v[160:163]
    s_add_u32 s37, s36, 0xc0000
    v_rcp_f32 v26, v26
    v_mfma_f32_16x16x32_bf16 v[160:163], v[48:51], a[128:131], v[160:163]
    ds_read_b64_tr_b16 v[72:73], v5 offset:34816
    v_mul_f32 v25, v25, v24
    v_mfma_f32_16x16x32_bf16 v[160:163], v[52:55], a[144:147], v[160:163]
    buffer_load_dwordx4 v3, s[12:15], s37 offen lds
    v_mfma_f32_16x16x32_bf16 v[160:163], v[56:59], a[160:163], v[160:163]
    ds_read_b64_tr_b16 v[74:75], v93 offset:51200
    v_mul_f32 v27, v27, v26
    v_mfma_f32_16x16x32_bf16 v[160:163], v[60:63], a[176:179], v[160:163]
    s_add_u32 m0, s33, 0x5800
    ds_read_b64_tr_b16 v[76:77], v5 offset:0
    v_cvt_pk_bf16_f32 v89, v25, v27
    v_mfma_f32_16x16x32_bf16 v[164:167], v[60:63], a[180:183], v[164:167]
    ds_read_b64_tr_b16 v[78:79], v93 offset:16384
    v_mul_f32 v28, v108, v108
    v_mfma_f32_16x16x32_bf16 v[164:167], v[56:59], a[164:167], v[164:167]
    ds_read_b64_tr_b16 v[80:81], v5 offset:2048
    v_mul_f32 v30, v109, v109
    v_mfma_f32_16x16x32_bf16 v[164:167], v[52:55], a[148:151], v[164:167]
    s_add_u32 s37, s36, 0x100000
    ds_read_b64_tr_b16 v[82:83], v93 offset:18432
    v_fma_f32 v28, v28, v13, v9
    v_mfma_f32_16x16x32_bf16 v[164:167], v[48:51], a[132:135], v[164:167]
    ds_read_b64_tr_b16 v[84:85], v5 offset:4096
    v_fma_f32 v30, v30, v13, v9
    v_mfma_f32_16x16x32_bf16 v[164:167], v[44:47], a[116:119], v[164:167]
    buffer_load_dwordx4 v3, s[12:15], s37 offen lds
    v_mfma_f32_16x16x32_bf16 v[164:167], v[40:43], a[100:103], v[164:167]
    ds_read_b64_tr_b16 v[86:87], v93 offset:20480
    v_mul_f32 v28, v28, v108
    v_mfma_f32_16x16x32_bf16 v[192:195], v[40:43], a[104:107], v[192:195]
    v_mul_f32 v30, v30, v109
    v_mul_f32 v29, v108, v124
    v_mfma_f32_16x16x32_bf16 v[192:195], v[44:47], a[120:123], v[192:195]
    s_add_u32 m0, s33, 0x5c00
    v_exp_f32 v28, v28
    v_mfma_f32_16x16x32_bf16 v[192:195], v[48:51], a[136:139], v[192:195]
    v_mul_f32 v31, v109, v125
    v_fma_f32 v28, v28, v17, v17
    v_mfma_f32_16x16x32_bf16 v[192:195], v[52:55], a[152:155], v[192:195]
    s_add_u32 s37, s36, 0x140000
    v_exp_f32 v30, v30
    v_mfma_f32_16x16x32_bf16 v[192:195], v[56:59], a[168:171], v[192:195]
    v_rcp_f32 v28, v28
    v_mfma_f32_16x16x32_bf16 v[192:195], v[60:63], a[184:187], v[192:195]
    v_fma_f32 v30, v30, v17, v17
    v_mul_f32 v29, v29, v28
    v_mfma_f32_16x16x32_bf16 v[196:199], v[60:63], a[188:191], v[196:199]
    buffer_load_dwordx4 v3, s[12:15], s37 offen lds
    v_mfma_f32_16x16x32_bf16 v[196:199], v[56:59], a[172:175], v[196:199]
    v_rcp_f32 v30, v30
    v_mfma_f32_16x16x32_bf16 v[196:199], v[52:55], a[156:159], v[196:199]
    s_add_u32 m0, s33, 0x6000
    v_mul_f32 v31, v31, v30
    v_cvt_pk_bf16_f32 v90, v29, v31
    v_mfma_f32_16x16x32_bf16 v[196:199], v[48:51], a[140:143], v[196:199]
    v_mul_f32 v20, v110, v110
    v_mul_f32 v22, v111, v111
    v_mfma_f32_16x16x32_bf16 v[196:199], v[44:47], a[124:127], v[196:199]
    s_add_u32 s37, s36, 0x180000
    v_fma_f32 v20, v20, v13, v9
    v_fma_f32 v22, v22, v13, v9
    v_mfma_f32_16x16x32_bf16 v[196:199], v[40:43], a[108:111], v[196:199]
    s_waitcnt lgkmcnt(0)
    ds_read_b64_tr_b16 v[40:41], v92 offset:6144
    ds_read_b64_tr_b16 v[42:43], v94 offset:22528
    v_mfma_f32_16x16x32_bf16 v[204:207], v[64:67], a[108:111], v[204:207]
    ds_read_b64_tr_b16 v[44:45], v92 offset:8192
    v_mul_f32 v20, v20, v110
    v_mfma_f32_16x16x32_bf16 v[204:207], v[68:71], a[124:127], v[204:207]
    buffer_load_dwordx4 v3, s[12:15], s37 offen lds
    v_mfma_f32_16x16x32_bf16 v[204:207], v[72:75], a[140:143], v[204:207]
    ds_read_b64_tr_b16 v[46:47], v94 offset:24576
    v_mul_f32 v22, v22, v111
    v_mfma_f32_16x16x32_bf16 v[204:207], v[76:79], a[156:159], v[204:207]
    s_add_u32 m0, s33, 0x6400
    ds_read_b64_tr_b16 v[48:49], v92 offset:10240
    v_mul_f32 v21, v110, v126
    v_mfma_f32_16x16x32_bf16 v[204:207], v[80:83], a[172:175], v[204:207]
    ds_read_b64_tr_b16 v[50:51], v94 offset:26624
    v_mul_f32 v23, v111, v127
    v_mfma_f32_16x16x32_bf16 v[204:207], v[84:87], a[188:191], v[204:207]
    v_exp_f32 v20, v20
    v_mfma_f32_16x16x32_bf16 v[200:203], v[84:87], a[184:187], v[200:203]
    s_add_u32 s37, s36, 0x1c0000
    ds_read_b64_tr_b16 v[52:53], v4 offset:40960
    ds_read_b64_tr_b16 v[54:55], v92 offset:57344
    v_mfma_f32_16x16x32_bf16 v[200:203], v[80:83], a[168:171], v[200:203]
    v_exp_f32 v22, v22
    v_mfma_f32_16x16x32_bf16 v[200:203], v[76:79], a[152:155], v[200:203]
    buffer_load_dwordx4 v3, s[12:15], s37 offen lds
    v_mfma_f32_16x16x32_bf16 v[200:203], v[72:75], a[136:139], v[200:203]
    ds_read_b64_tr_b16 v[56:57], v4 offset:43008
    v_fma_f32 v20, v20, v17, v17
    v_mfma_f32_16x16x32_bf16 v[200:203], v[68:71], a[120:123], v[200:203]
    s_add_u32 m0, s33, 0x6800
    ds_read_b64_tr_b16 v[58:59], v92 offset:59392
    v_fma_f32 v22, v22, v17, v17
    v_mfma_f32_16x16x32_bf16 v[200:203], v[64:67], a[104:107], v[200:203]
    v_rcp_f32 v20, v20
    v_mfma_f32_16x16x32_bf16 v[172:175], v[64:67], a[100:103], v[172:175]
    v_rcp_f32 v22, v22
    v_mfma_f32_16x16x32_bf16 v[172:175], v[68:71], a[116:119], v[172:175]
    s_add_u32 s37, s36, 0x200000
    ds_read_b64_tr_b16 v[60:61], v4 offset:45056
    v_mul_f32 v21, v21, v20
    v_mfma_f32_16x16x32_bf16 v[172:175], v[72:75], a[132:135], v[172:175]
    ds_read_b64_tr_b16 v[62:63], v92 offset:61440
    v_mul_f32 v23, v23, v22
    v_mfma_f32_16x16x32_bf16 v[172:175], v[76:79], a[148:151], v[172:175]
    buffer_load_dwordx4 v3, s[12:15], s37 offen lds
    v_mfma_f32_16x16x32_bf16 v[172:175], v[80:83], a[164:167], v[172:175]
    v_cvt_pk_bf16_f32 v91, v21, v23
    v_mul_f32 v24, v128, v128
    v_mfma_f32_16x16x32_bf16 v[172:175], v[84:87], a[180:183], v[172:175]
    s_lshl_b32 s38, s34, 6
    v_mul_f32 v26, v129, v129
    v_fma_f32 v24, v24, v14, v10
    v_mfma_f32_16x16x32_bf16 v[168:171], v[84:87], a[176:179], v[168:171]
    s_add_u32 m0, s33, 0x6c00
    s_add_u32 s38, s38, s41
    v_fma_f32 v26, v26, v14, v10
    v_mfma_f32_16x16x32_bf16 v[168:171], v[80:83], a[160:163], v[168:171]
    s_add_u32 s38, s38, 0x82000
    v_mul_f32 v24, v24, v128
    v_mul_f32 v26, v26, v129
    v_mfma_f32_16x16x32_bf16 v[168:171], v[76:79], a[144:147], v[168:171]
    s_add_u32 s37, s36, 0x240000
    v_mul_f32 v25, v128, v144
    v_mul_f32 v27, v129, v145
    v_mfma_f32_16x16x32_bf16 v[168:171], v[72:75], a[128:131], v[168:171]
    buffer_store_dwordx4 v[88:91], v1, s[28:31], s38 offen sc1
    v_mfma_f32_16x16x32_bf16 v[168:171], v[68:71], a[112:115], v[168:171]
    v_exp_f32 v24, v24
    v_mfma_f32_16x16x32_bf16 v[168:171], v[64:67], a[96:99], v[168:171]
    buffer_load_dwordx4 v3, s[12:15], s37 offen lds
    s_waitcnt lgkmcnt(0)
    v_mfma_f32_16x16x32_bf16 v[176:179], v[40:43], a[96:99], v[176:179]
    ds_read_b64_tr_b16 v[64:65], v93 offset:6144
    ds_read_b64_tr_b16 v[66:67], v95 offset:22528
    v_mfma_f32_16x16x32_bf16 v[176:179], v[44:47], a[112:115], v[176:179]
    s_add_u32 m0, s33, 0x7000
    ds_read_b64_tr_b16 v[68:69], v93 offset:8192
    ds_read_b64_tr_b16 v[70:71], v95 offset:24576
    v_mfma_f32_16x16x32_bf16 v[176:179], v[48:51], a[128:131], v[176:179]
    v_exp_f32 v26, v26
    v_mfma_f32_16x16x32_bf16 v[176:179], v[52:55], a[144:147], v[176:179]
    s_add_u32 s37, s36, 0x280000
    ds_read_b64_tr_b16 v[72:73], v93 offset:10240
    v_fma_f32 v24, v24, v18, v18
    v_mfma_f32_16x16x32_bf16 v[176:179], v[56:59], a[160:163], v[176:179]
    ds_read_b64_tr_b16 v[74:75], v95 offset:26624
    v_fma_f32 v26, v26, v18, v18
    v_mfma_f32_16x16x32_bf16 v[176:179], v[60:63], a[176:179], v[176:179]
    v_rcp_f32 v24, v24
    v_mfma_f32_16x16x32_bf16 v[180:183], v[60:63], a[180:183], v[180:183]
    buffer_load_dwordx4 v3, s[12:15], s37 offen lds
    v_mfma_f32_16x16x32_bf16 v[180:183], v[56:59], a[164:167], v[180:183]
    ds_read_b64_tr_b16 v[76:77], v5 offset:40960
    ds_read_b64_tr_b16 v[78:79], v93 offset:57344
    v_mfma_f32_16x16x32_bf16 v[180:183], v[52:55], a[148:151], v[180:183]
    s_add_u32 m0, s33, 0x7400
    v_rcp_f32 v26, v26
    v_mfma_f32_16x16x32_bf16 v[180:183], v[48:51], a[132:135], v[180:183]
    ds_read_b64_tr_b16 v[80:81], v5 offset:43008
    v_mul_f32 v25, v25, v24
    v_mfma_f32_16x16x32_bf16 v[180:183], v[44:47], a[116:119], v[180:183]
    ds_read_b64_tr_b16 v[82:83], v93 offset:59392
    v_mul_f32 v27, v27, v26
    v_mfma_f32_16x16x32_bf16 v[180:183], v[40:43], a[100:103], v[180:183]
    s_add_u32 s37, s36, 0x2c0000
    ds_read_b64_tr_b16 v[84:85], v5 offset:45056
    v_cvt_pk_bf16_f32 v32, v25, v27
    v_mfma_f32_16x16x32_bf16 v[208:211], v[40:43], a[104:107], v[208:211]
    ds_read_b64_tr_b16 v[86:87], v93 offset:61440
    v_mul_f32 v28, v130, v130
    v_mfma_f32_16x16x32_bf16 v[208:211], v[44:47], a[120:123], v[208:211]
    buffer_load_dwordx4 v3, s[12:15], s37 offen lds
    v_mfma_f32_16x16x32_bf16 v[208:211], v[48:51], a[136:139], v[208:211]
    v_mul_f32 v30, v131, v131
    v_fma_f32 v28, v28, v14, v10
    v_mfma_f32_16x16x32_bf16 v[208:211], v[52:55], a[152:155], v[208:211]
    v_fma_f32 v30, v30, v14, v10
    v_mul_f32 v28, v28, v130
    v_mfma_f32_16x16x32_bf16 v[208:211], v[56:59], a[168:171], v[208:211]
    v_mul_f32 v30, v30, v131
    v_mul_f32 v29, v130, v146
    v_mfma_f32_16x16x32_bf16 v[208:211], v[60:63], a[184:187], v[208:211]
    v_exp_f32 v28, v28
    v_mfma_f32_16x16x32_bf16 v[212:215], v[60:63], a[188:191], v[212:215]
    v_mul_f32 v31, v131, v147
    v_fma_f32 v28, v28, v18, v18
    v_mfma_f32_16x16x32_bf16 v[212:215], v[56:59], a[172:175], v[212:215]
    v_exp_f32 v30, v30
    v_mfma_f32_16x16x32_bf16 v[212:215], v[52:55], a[156:159], v[212:215]
    v_rcp_f32 v28, v28
    v_mfma_f32_16x16x32_bf16 v[212:215], v[48:51], a[140:143], v[212:215]
    v_fma_f32 v30, v30, v18, v18
    v_mul_f32 v29, v29, v28
    v_mfma_f32_16x16x32_bf16 v[212:215], v[44:47], a[124:127], v[212:215]
    v_rcp_f32 v30, v30
    v_mfma_f32_16x16x32_bf16 v[212:215], v[40:43], a[108:111], v[212:215]
    s_waitcnt lgkmcnt(0)
    s_barrier
    ds_read_b64_tr_b16 v[40:41], v4 offset:6144
    v_mfma_f32_16x16x32_bf16 v[220:223], v[64:67], a[108:111], v[220:223]
    s_add_u32 m0, s33, 0x7800
    ds_read_b64_tr_b16 v[42:43], v92 offset:22528
    ds_read_b64_tr_b16 v[44:45], v4 offset:8192
    v_mfma_f32_16x16x32_bf16 v[220:223], v[68:71], a[124:127], v[220:223]
    ds_read_b64_tr_b16 v[46:47], v92 offset:24576
    v_mul_f32 v31, v31, v30
    v_mfma_f32_16x16x32_bf16 v[220:223], v[72:75], a[140:143], v[220:223]
    ds_read_b64_tr_b16 v[48:49], v4 offset:10240
    v_cvt_pk_bf16_f32 v33, v29, v31
    v_mfma_f32_16x16x32_bf16 v[220:223], v[76:79], a[156:159], v[220:223]
    s_add_u32 s37, s36, 0x300000
    ds_read_b64_tr_b16 v[50:51], v92 offset:26624
    v_mul_f32 v20, v136, v136
    v_mfma_f32_16x16x32_bf16 v[220:223], v[80:83], a[172:175], v[220:223]
    ds_read_b64_tr_b16 v[52:53], v4 offset:12288
    v_mul_f32 v22, v137, v137
    v_mfma_f32_16x16x32_bf16 v[220:223], v[84:87], a[188:191], v[220:223]
    buffer_load_dwordx4 v3, s[12:15], s37 offen lds
    v_mfma_f32_16x16x32_bf16 v[216:219], v[84:87], a[184:187], v[216:219]
    ds_read_b64_tr_b16 v[54:55], v92 offset:28672
    v_fma_f32 v20, v20, v14, v10
    v_mfma_f32_16x16x32_bf16 v[216:219], v[80:83], a[168:171], v[216:219]
    ds_read_b64_tr_b16 v[56:57], v4 offset:14336
    v_fma_f32 v22, v22, v14, v10
    v_mfma_f32_16x16x32_bf16 v[216:219], v[76:79], a[152:155], v[216:219]
    s_add_u32 m0, s33, 0x7c00
    ds_read_b64_tr_b16 v[58:59], v92 offset:30720
    v_mul_f32 v20, v20, v136
    v_mfma_f32_16x16x32_bf16 v[216:219], v[72:75], a[136:139], v[216:219]
    ds_read_b64_tr_b16 v[60:61], v4 offset:16384
    v_mul_f32 v22, v22, v137
    v_mfma_f32_16x16x32_bf16 v[216:219], v[68:71], a[120:123], v[216:219]
    s_add_u32 s37, s36, 0x340000
    ds_read_b64_tr_b16 v[62:63], v92 offset:32768
    v_mul_f32 v21, v136, v152
    v_mfma_f32_16x16x32_bf16 v[216:219], v[64:67], a[104:107], v[216:219]
    v_exp_f32 v20, v20
    v_mfma_f32_16x16x32_bf16 v[188:191], v[64:67], a[100:103], v[188:191]
    v_mul_f32 v23, v137, v153
    v_fma_f32 v20, v20, v18, v18
    v_mfma_f32_16x16x32_bf16 v[188:191], v[68:71], a[116:119], v[188:191]
    buffer_load_dwordx4 v3, s[12:15], s37 offen lds
    v_mfma_f32_16x16x32_bf16 v[188:191], v[72:75], a[132:135], v[188:191]
    v_exp_f32 v22, v22
    v_mfma_f32_16x16x32_bf16 v[188:191], v[76:79], a[148:151], v[188:191]
    s_add_u32 m0, s33, 0x8000
    v_fma_f32 v22, v22, v18, v18
    v_mul_f32 v24, v138, v138
    v_mfma_f32_16x16x32_bf16 v[188:191], v[80:83], a[164:167], v[188:191]
    v_rcp_f32 v20, v20
    v_mfma_f32_16x16x32_bf16 v[188:191], v[84:87], a[180:183], v[188:191]
    s_add_u32 s37, s36, 0x380000
    v_rcp_f32 v22, v22
    v_mfma_f32_16x16x32_bf16 v[184:187], v[84:87], a[176:179], v[184:187]
    v_mul_f32 v21, v21, v20
    v_mul_f32 v23, v23, v22
    v_mfma_f32_16x16x32_bf16 v[184:187], v[80:83], a[160:163], v[184:187]
    v_cvt_pk_bf16_f32 v34, v21, v23
    v_mul_f32 v26, v139, v139
    v_mfma_f32_16x16x32_bf16 v[184:187], v[76:79], a[144:147], v[184:187]
    buffer_load_dwordx4 v3, s[12:15], s37 offen lds
    v_mfma_f32_16x16x32_bf16 v[184:187], v[72:75], a[128:131], v[184:187]
    v_fma_f32 v24, v24, v14, v10
    v_fma_f32 v26, v26, v14, v10
    v_mfma_f32_16x16x32_bf16 v[184:187], v[68:71], a[112:115], v[184:187]
    s_add_u32 m0, s33, 0x8400
    v_mul_f32 v24, v24, v138
    v_mul_f32 v26, v26, v139
    v_mfma_f32_16x16x32_bf16 v[184:187], v[64:67], a[96:99], v[184:187]
    s_waitcnt lgkmcnt(0)
    ds_read_b64_tr_b16 v[64:65], v5 offset:6144
    ds_read_b64_tr_b16 v[66:67], v93 offset:22528
    v_mfma_f32_16x16x32_bf16 v[160:163], v[40:43], a[192:195], v[160:163]
    ds_read_b64_tr_b16 v[68:69], v5 offset:8192
    v_mul_f32 v25, v138, v154
    v_mfma_f32_16x16x32_bf16 v[160:163], v[44:47], a[208:211], v[160:163]
    s_add_u32 s37, s36, 0x3c0000
    ds_read_b64_tr_b16 v[70:71], v93 offset:24576
    v_mul_f32 v27, v139, v155
    v_mfma_f32_16x16x32_bf16 v[160:163], v[48:51], a[224:227], v[160:163]
    v_exp_f32 v24, v24
    v_mfma_f32_16x16x32_bf16 v[160:163], v[52:55], a[240:243], v[160:163]
    buffer_load_dwordx4 v3, s[12:15], s37 offen lds
    v_mfma_f32_16x16x32_bf16 v[160:163], v[56:59], v[224:227], v[160:163]
    v_exp_f32 v26, v26
    v_mfma_f32_16x16x32_bf16 v[160:163], v[60:63], v[240:243], v[160:163]
    s_add_u32 m0, s33, 0x8800
    ds_read_b64_tr_b16 v[72:73], v5 offset:10240
    ds_read_b64_tr_b16 v[74:75], v93 offset:26624
    v_mfma_f32_16x16x32_bf16 v[164:167], v[60:63], v[244:247], v[164:167]
    ds_read_b64_tr_b16 v[76:77], v5 offset:12288
    v_fma_f32 v24, v24, v18, v18
    v_mfma_f32_16x16x32_bf16 v[164:167], v[56:59], v[228:231], v[164:167]
    ds_read_b64_tr_b16 v[78:79], v93 offset:28672
    v_fma_f32 v26, v26, v18, v18
    v_mfma_f32_16x16x32_bf16 v[164:167], v[52:55], a[244:247], v[164:167]
    s_add_u32 s37, s36, 0x400000
    v_rcp_f32 v24, v24
    v_mfma_f32_16x16x32_bf16 v[164:167], v[48:51], a[228:231], v[164:167]
    v_rcp_f32 v26, v26
    v_mfma_f32_16x16x32_bf16 v[164:167], v[44:47], a[212:215], v[164:167]
    buffer_load_dwordx4 v3, s[12:15], s37 offen lds
    v_mfma_f32_16x16x32_bf16 v[164:167], v[40:43], a[196:199], v[164:167]
    ds_read_b64_tr_b16 v[80:81], v5 offset:14336
    v_mul_f32 v25, v25, v24
    v_mfma_f32_16x16x32_bf16 v[192:195], v[40:43], a[200:203], v[192:195]
    ds_read_b64_tr_b16 v[82:83], v93 offset:30720
    v_mul_f32 v27, v27, v26
    v_mfma_f32_16x16x32_bf16 v[192:195], v[44:47], a[216:219], v[192:195]
    s_add_u32 m0, s33, 0x8c00
    ds_read_b64_tr_b16 v[84:85], v5 offset:16384
    v_cvt_pk_bf16_f32 v35, v25, v27
    v_mfma_f32_16x16x32_bf16 v[192:195], v[48:51], a[232:235], v[192:195]
    s_lshl_b32 s38, s34, 6
    ds_read_b64_tr_b16 v[86:87], v93 offset:32768
    v_mul_f32 v28, v132, v132
    v_mfma_f32_16x16x32_bf16 v[192:195], v[52:55], a[248:251], v[192:195]
    s_add_u32 s38, s38, s42
    s_add_u32 s37, s36, 0x440000
    s_add_u32 s38, s38, 0x82000
    v_mfma_f32_16x16x32_bf16 v[192:195], v[56:59], v[232:235], v[192:195]
    buffer_store_dwordx4 v[32:35], v1, s[28:31], s38 offen sc1
    v_mfma_f32_16x16x32_bf16 v[192:195], v[60:63], v[248:251], v[192:195]
    v_mul_f32 v30, v133, v133
    v_fma_f32 v28, v28, v15, v11
    v_mfma_f32_16x16x32_bf16 v[196:199], v[60:63], v[252:255], v[196:199]
    buffer_load_dwordx4 v3, s[12:15], s37 offen lds
    v_mfma_f32_16x16x32_bf16 v[196:199], v[56:59], v[236:239], v[196:199]
    v_fma_f32 v30, v30, v15, v11
    v_mul_f32 v28, v28, v132
    v_mfma_f32_16x16x32_bf16 v[196:199], v[52:55], a[252:255], v[196:199]
    s_add_u32 m0, s33, 0x0
    v_mul_f32 v30, v30, v133
    v_mul_f32 v29, v132, v148
    v_mfma_f32_16x16x32_bf16 v[196:199], v[48:51], a[236:239], v[196:199]
    v_exp_f32 v28, v28
    v_mfma_f32_16x16x32_bf16 v[196:199], v[44:47], a[220:223], v[196:199]
    s_add_u32 s37, s35, 0x0
    v_mul_f32 v31, v133, v149
    v_fma_f32 v28, v28, v19, v19
    v_mfma_f32_16x16x32_bf16 v[196:199], v[40:43], a[204:207], v[196:199]
    s_waitcnt lgkmcnt(0)
    ds_read_b64_tr_b16 v[40:41], v4 offset:47104
    ds_read_b64_tr_b16 v[42:43], v92 offset:63488
    v_mfma_f32_16x16x32_bf16 v[204:207], v[64:67], a[204:207], v[204:207]
    v_exp_f32 v30, v30
    v_mfma_f32_16x16x32_bf16 v[204:207], v[68:71], a[220:223], v[204:207]
    buffer_load_dwordx4 v2, s[8:11], s37 offen lds
    v_mfma_f32_16x16x32_bf16 v[204:207], v[72:75], a[236:239], v[204:207]
    ds_read_b64_tr_b16 v[44:45], v4 offset:49152
    v_fma_f32 v30, v30, v19, v19
    v_mfma_f32_16x16x32_bf16 v[204:207], v[76:79], a[252:255], v[204:207]
    s_add_u32 m0, s33, 0x400
    v_rcp_f32 v28, v28
    v_mfma_f32_16x16x32_bf16 v[204:207], v[80:83], v[236:239], v[204:207]
    ds_read_b64_tr_b16 v[46:47], v94 offset:0
    ds_read_b64_tr_b16 v[48:49], v4 offset:51200
    v_mfma_f32_16x16x32_bf16 v[204:207], v[84:87], v[252:255], v[204:207]
    v_rcp_f32 v30, v30
    v_mfma_f32_16x16x32_bf16 v[200:203], v[84:87], v[248:251], v[200:203]
    s_add_u32 s37, s35, 0x48000
    ds_read_b64_tr_b16 v[50:51], v94 offset:2048
    v_mul_f32 v29, v29, v28
    v_mfma_f32_16x16x32_bf16 v[200:203], v[80:83], v[232:235], v[200:203]
    ds_read_b64_tr_b16 v[52:53], v4 offset:53248
    v_mul_f32 v31, v31, v30
    v_mfma_f32_16x16x32_bf16 v[200:203], v[76:79], a[248:251], v[200:203]
    buffer_load_dwordx4 v2, s[8:11], s37 offen lds
    v_mfma_f32_16x16x32_bf16 v[200:203], v[72:75], a[232:235], v[200:203]
    ds_read_b64_tr_b16 v[54:55], v94 offset:4096
    v_cvt_pk_bf16_f32 v88, v29, v31
    v_mfma_f32_16x16x32_bf16 v[200:203], v[68:71], a[216:219], v[200:203]
    s_add_u32 m0, s33, 0x800
    ds_read_b64_tr_b16 v[56:57], v4 offset:55296
    v_mul_f32 v20, v134, v134
    v_mfma_f32_16x16x32_bf16 v[200:203], v[64:67], a[200:203], v[200:203]
    ds_read_b64_tr_b16 v[58:59], v94 offset:6144
    v_mul_f32 v22, v135, v135
    v_mfma_f32_16x16x32_bf16 v[172:175], v[64:67], a[196:199], v[172:175]
    ds_read_b64_tr_b16 v[60:61], v4 offset:57344
    v_fma_f32 v20, v20, v15, v11
    v_mfma_f32_16x16x32_bf16 v[172:175], v[68:71], a[212:215], v[172:175]
    s_add_u32 s37, s35, 0x90000
    ds_read_b64_tr_b16 v[62:63], v94 offset:8192
    v_fma_f32 v22, v22, v15, v11
    v_mfma_f32_16x16x32_bf16 v[172:175], v[72:75], a[228:231], v[172:175]
    v_mul_f32 v20, v20, v134
    v_mul_f32 v22, v22, v135
    v_mfma_f32_16x16x32_bf16 v[172:175], v[76:79], a[244:247], v[172:175]
    buffer_load_dwordx4 v2, s[8:11], s37 offen lds
    v_mfma_f32_16x16x32_bf16 v[172:175], v[80:83], v[228:231], v[172:175]
    v_mul_f32 v21, v134, v150
    v_mul_f32 v23, v135, v151
    v_mfma_f32_16x16x32_bf16 v[172:175], v[84:87], v[244:247], v[172:175]
    v_exp_f32 v20, v20
    v_mfma_f32_16x16x32_bf16 v[168:171], v[84:87], v[240:243], v[168:171]
    s_add_u32 m0, s33, 0xc00
    v_exp_f32 v22, v22
    v_mfma_f32_16x16x32_bf16 v[168:171], v[80:83], v[224:227], v[168:171]
    v_fma_f32 v20, v20, v19, v19
    v_fma_f32 v22, v22, v19, v19
    v_mfma_f32_16x16x32_bf16 v[168:171], v[76:79], a[240:243], v[168:171]
    s_add_u32 s37, s35, 0xd8000
    v_rcp_f32 v20, v20
    v_mfma_f32_16x16x32_bf16 v[168:171], v[72:75], a[224:227], v[168:171]
    v_rcp_f32 v22, v22
    v_mfma_f32_16x16x32_bf16 v[168:171], v[68:71], a[208:211], v[168:171]
    v_mul_f32 v21, v21, v20
    v_mul_f32 v23, v23, v22
    v_mfma_f32_16x16x32_bf16 v[168:171], v[64:67], a[192:195], v[168:171]
    buffer_load_dwordx4 v2, s[8:11], s37 offen lds
    s_waitcnt lgkmcnt(0)
    v_mfma_f32_16x16x32_bf16 v[176:179], v[40:43], a[192:195], v[176:179]
    ds_read_b64_tr_b16 v[64:65], v5 offset:47104
    v_cvt_pk_bf16_f32 v89, v21, v23
    v_mfma_f32_16x16x32_bf16 v[176:179], v[44:47], a[208:211], v[176:179]
    s_add_u32 m0, s33, 0x1000
    ds_read_b64_tr_b16 v[66:67], v93 offset:63488
    v_mul_f32 v24, v140, v140
    v_mfma_f32_16x16x32_bf16 v[176:179], v[48:51], a[224:227], v[176:179]
    ds_read_b64_tr_b16 v[68:69], v5 offset:49152
    v_mul_f32 v26, v141, v141
    v_mfma_f32_16x16x32_bf16 v[176:179], v[52:55], a[240:243], v[176:179]
    s_add_u32 s37, s35, 0x120000
    ds_read_b64_tr_b16 v[70:71], v95 offset:0
    v_fma_f32 v24, v24, v15, v11
    v_mfma_f32_16x16x32_bf16 v[176:179], v[56:59], v[224:227], v[176:179]
    ds_read_b64_tr_b16 v[72:73], v5 offset:51200
    v_fma_f32 v26, v26, v15, v11
    v_mfma_f32_16x16x32_bf16 v[176:179], v[60:63], v[240:243], v[176:179]
    ds_read_b64_tr_b16 v[74:75], v95 offset:2048
    v_mul_f32 v24, v24, v140
    v_mfma_f32_16x16x32_bf16 v[180:183], v[60:63], v[244:247], v[180:183]
    buffer_load_dwordx4 v2, s[8:11], s37 offen lds
    v_mfma_f32_16x16x32_bf16 v[180:183], v[56:59], v[228:231], v[180:183]
    ds_read_b64_tr_b16 v[76:77], v5 offset:53248
    v_mul_f32 v26, v26, v141
    v_mfma_f32_16x16x32_bf16 v[180:183], v[52:55], a[244:247], v[180:183]
    s_add_u32 m0, s33, 0x1400
    ds_read_b64_tr_b16 v[78:79], v95 offset:4096
    v_mul_f32 v25, v140, v156
    v_mfma_f32_16x16x32_bf16 v[180:183], v[48:51], a[228:231], v[180:183]
    ds_read_b64_tr_b16 v[80:81], v5 offset:55296
    v_mul_f32 v27, v141, v157
    v_mfma_f32_16x16x32_bf16 v[180:183], v[44:47], a[212:215], v[180:183]
    v_exp_f32 v24, v24
    v_mfma_f32_16x16x32_bf16 v[180:183], v[40:43], a[196:199], v[180:183]
    s_add_u32 s37, s35, 0x168000
    v_exp_f32 v26, v26
    v_mfma_f32_16x16x32_bf16 v[208:211], v[40:43], a[200:203], v[208:211]
    ds_read_b64_tr_b16 v[82:83], v95 offset:6144
    v_fma_f32 v24, v24, v19, v19
    v_mfma_f32_16x16x32_bf16 v[208:211], v[44:47], a[216:219], v[208:211]
    buffer_load_dwordx4 v2, s[8:11], s37 offen lds
    v_mfma_f32_16x16x32_bf16 v[208:211], v[48:51], a[232:235], v[208:211]
    ds_read_b64_tr_b16 v[84:85], v5 offset:57344
    v_fma_f32 v26, v26, v19, v19
    v_mfma_f32_16x16x32_bf16 v[208:211], v[52:55], a[248:251], v[208:211]
    ds_read_b64_tr_b16 v[86:87], v95 offset:8192
    v_mul_f32 v28, v142, v142
    v_mfma_f32_16x16x32_bf16 v[208:211], v[56:59], v[232:235], v[208:211]
    v_rcp_f32 v24, v24
    v_mfma_f32_16x16x32_bf16 v[208:211], v[60:63], v[248:251], v[208:211]
    v_rcp_f32 v26, v26
    v_mfma_f32_16x16x32_bf16 v[212:215], v[60:63], v[252:255], v[212:215]
    v_mul_f32 v25, v25, v24
    v_mul_f32 v27, v27, v26
    v_mfma_f32_16x16x32_bf16 v[212:215], v[56:59], v[236:239], v[212:215]
    v_cvt_pk_bf16_f32 v90, v25, v27
    v_mul_f32 v30, v143, v143
    v_mfma_f32_16x16x32_bf16 v[212:215], v[52:55], a[252:255], v[212:215]
    v_fma_f32 v28, v28, v15, v11
    v_fma_f32 v30, v30, v15, v11
    v_mfma_f32_16x16x32_bf16 v[212:215], v[48:51], a[236:239], v[212:215]
    v_mul_f32 v28, v28, v142
    v_mul_f32 v30, v30, v143
    v_mfma_f32_16x16x32_bf16 v[212:215], v[44:47], a[220:223], v[212:215]
    v_mul_f32 v29, v142, v158
    v_mul_f32 v31, v143, v159
    v_mfma_f32_16x16x32_bf16 v[212:215], v[40:43], a[204:207], v[212:215]
    s_waitcnt lgkmcnt(0)
    s_waitcnt vmcnt(20)
    s_barrier
    v_mfma_f32_16x16x32_bf16 v[220:223], v[64:67], a[204:207], v[220:223]
    s_add_u32 m0, s33, 0x1800
    ds_read_b64_tr_b16 v[40:41], v6 offset:18432
    ds_read_b64_tr_b16 v[42:43], v6 offset:18944
    v_mfma_f32_16x16x32_bf16 v[220:223], v[68:71], a[220:223], v[220:223]
    v_exp_f32 v28, v28
    v_mfma_f32_16x16x32_bf16 v[220:223], v[72:75], a[236:239], v[220:223]
    v_exp_f32 v30, v30
    v_mfma_f32_16x16x32_bf16 v[220:223], v[76:79], a[252:255], v[220:223]
    ds_read_b64_tr_b16 v[44:45], v6 offset:19456
    v_fma_f32 v28, v28, v19, v19
    v_mfma_f32_16x16x32_bf16 v[220:223], v[80:83], v[236:239], v[220:223]
    ds_read_b64_tr_b16 v[46:47], v6 offset:19968
    v_fma_f32 v30, v30, v19, v19
    v_mfma_f32_16x16x32_bf16 v[220:223], v[84:87], v[252:255], v[220:223]
    s_add_u32 s37, s35, 0x1b0000
    ds_read_b64_tr_b16 v[48:49], v6 offset:20480
    ds_read_b64_tr_b16 v[50:51], v6 offset:20992
    v_mfma_f32_16x16x32_bf16 v[216:219], v[84:87], v[248:251], v[216:219]
    v_rcp_f32 v28, v28
    v_mfma_f32_16x16x32_bf16 v[216:219], v[80:83], v[232:235], v[216:219]
    v_rcp_f32 v30, v30
    v_mfma_f32_16x16x32_bf16 v[216:219], v[76:79], a[248:251], v[216:219]
    ds_read_b64_tr_b16 v[52:53], v6 offset:21504
    v_mul_f32 v29, v29, v28
    v_mfma_f32_16x16x32_bf16 v[216:219], v[72:75], a[232:235], v[216:219]
    ds_read_b64_tr_b16 v[54:55], v6 offset:22016
    v_mul_f32 v31, v31, v30
    v_mfma_f32_16x16x32_bf16 v[216:219], v[68:71], a[216:219], v[216:219]
    buffer_load_dwordx4 v2, s[8:11], s37 offen lds
    v_mfma_f32_16x16x32_bf16 v[216:219], v[64:67], a[200:203], v[216:219]
    s_lshl_b32 s38, s34, 6
    ds_read_b64_tr_b16 v[56:57], v6 offset:22528
    v_cvt_pk_bf16_f32 v91, v29, v31
    v_mfma_f32_16x16x32_bf16 v[188:191], v[64:67], a[196:199], v[188:191]
    s_add_u32 s38, s38, s43
    ds_read_b64_tr_b16 v[58:59], v6 offset:23040
    s_add_u32 s38, s38, 0x82000
    v_mfma_f32_16x16x32_bf16 v[188:191], v[68:71], a[212:215], v[188:191]
    buffer_store_dwordx4 v[88:91], v1, s[28:31], s38 offen sc1
    v_mfma_f32_16x16x32_bf16 v[188:191], v[72:75], a[228:231], v[188:191]
    ds_read_b64_tr_b16 v[60:61], v6 offset:23552
    ds_read_b64_tr_b16 v[62:63], v6 offset:24064
    v_mfma_f32_16x16x32_bf16 v[188:191], v[76:79], a[244:247], v[188:191]
    s_add_u32 m0, s33, 0x1c00
    v_mfma_f32_16x16x32_bf16 v[188:191], v[80:83], v[228:231], v[188:191]
    v_mfma_f32_16x16x32_bf16 v[188:191], v[84:87], v[244:247], v[188:191]
    v_mfma_f32_16x16x32_bf16 v[184:187], v[84:87], v[240:243], v[184:187]
    v_mul_f32 v20, v160, v160
    v_mfma_f32_16x16x32_bf16 v[184:187], v[80:83], v[224:227], v[184:187]
    v_mul_f32 v22, v161, v161
    v_mfma_f32_16x16x32_bf16 v[184:187], v[76:79], a[240:243], v[184:187]
    s_add_u32 s37, s35, 0x1f8000
    v_fma_f32 v20, v20, v12, v8
    v_mfma_f32_16x16x32_bf16 v[184:187], v[72:75], a[224:227], v[184:187]
    v_fma_f32 v22, v22, v12, v8
    v_mfma_f32_16x16x32_bf16 v[184:187], v[68:71], a[208:211], v[184:187]
    v_mul_f32 v20, v20, v160
    v_mul_f32 v22, v22, v161
    v_mfma_f32_16x16x32_bf16 v[184:187], v[64:67], a[192:195], v[184:187]
    s_waitcnt lgkmcnt(0)
    ds_read_b64_tr_b16 v[64:65], v6 offset:18440
    ds_read_b64_tr_b16 v[66:67], v6 offset:18952
    v_mfma_f32_16x16x32_bf16 v[96:99], v[40:43], a[0:3], 0
    ds_read_b64_tr_b16 v[68:69], v6 offset:19464
    ds_read_b64_tr_b16 v[70:71], v6 offset:19976
    v_mfma_f32_16x16x32_bf16 v[96:99], v[44:47], a[16:19], v[96:99]
    buffer_load_dwordx4 v2, s[8:11], s37 offen lds
    v_mfma_f32_16x16x32_bf16 v[96:99], v[48:51], a[32:35], v[96:99]
    ds_read_b64_tr_b16 v[72:73], v6 offset:20488
    ds_read_b64_tr_b16 v[74:75], v6 offset:21000
    v_mfma_f32_16x16x32_bf16 v[96:99], v[52:55], a[48:51], v[96:99]
    ds_read_b64_tr_b16 v[76:77], v6 offset:21512
    v_mul_f32 v21, v160, v176
    v_mfma_f32_16x16x32_bf16 v[96:99], v[56:59], a[64:67], v[96:99]
    ds_read_b64_tr_b16 v[78:79], v6 offset:22024
    v_mul_f32 v23, v161, v177
    v_mfma_f32_16x16x32_bf16 v[96:99], v[60:63], a[80:83], v[96:99]
    s_add_u32 m0, s33, 0x2000
    v_exp_f32 v20, v20
    v_mfma_f32_16x16x32_bf16 v[100:103], v[60:63], a[84:87], 0
    v_exp_f32 v22, v22
    v_mfma_f32_16x16x32_bf16 v[100:103], v[56:59], a[68:71], v[100:103]
    ds_read_b64_tr_b16 v[80:81], v6 offset:22536
    v_fma_f32 v20, v20, v16, v16
    v_mfma_f32_16x16x32_bf16 v[100:103], v[52:55], a[52:55], v[100:103]
    ds_read_b64_tr_b16 v[82:83], v6 offset:23048
    v_fma_f32 v22, v22, v16, v16
    v_mfma_f32_16x16x32_bf16 v[100:103], v[48:51], a[36:39], v[100:103]
    v_rcp_f32 v20, v20
    v_mfma_f32_16x16x32_bf16 v[100:103], v[44:47], a[20:23], v[100:103]
    s_add_u32 s37, s35, 0x240000
    ds_read_b64_tr_b16 v[84:85], v6 offset:23560
    ds_read_b64_tr_b16 v[86:87], v6 offset:24072
    v_mfma_f32_16x16x32_bf16 v[100:103], v[40:43], a[4:7], v[100:103]
    v_rcp_f32 v22, v22
    v_mfma_f32_16x16x32_bf16 v[128:131], v[40:43], a[8:11], 0
    v_mul_f32 v21, v21, v20
    v_mul_f32 v23, v23, v22
    v_mfma_f32_16x16x32_bf16 v[128:131], v[44:47], a[24:27], v[128:131]
    v_cvt_pk_bf16_f32 v32, v21, v23
    v_mul_f32 v24, v162, v162
    v_mfma_f32_16x16x32_bf16 v[128:131], v[48:51], a[40:43], v[128:131]
    v_mul_f32 v26, v163, v163
    v_fma_f32 v24, v24, v12, v8
    v_mfma_f32_16x16x32_bf16 v[128:131], v[52:55], a[56:59], v[128:131]
    buffer_load_dwordx4 v2, s[8:11], s37 offen lds
    v_mfma_f32_16x16x32_bf16 v[128:131], v[56:59], a[72:75], v[128:131]
    v_fma_f32 v26, v26, v12, v8
    v_mul_f32 v24, v24, v162
    v_mfma_f32_16x16x32_bf16 v[128:131], v[60:63], a[88:91], v[128:131]
    v_mul_f32 v26, v26, v163
    v_mul_f32 v25, v162, v178
    v_mfma_f32_16x16x32_bf16 v[132:135], v[60:63], a[92:95], 0
    v_exp_f32 v24, v24
    v_mfma_f32_16x16x32_bf16 v[132:135], v[56:59], a[76:79], v[132:135]
    v_exp_f32 v26, v26
    v_mfma_f32_16x16x32_bf16 v[132:135], v[52:55], a[60:63], v[132:135]
    s_add_u32 m0, s33, 0x2400
    v_mul_f32 v27, v163, v179
    v_fma_f32 v24, v24, v16, v16
    v_mfma_f32_16x16x32_bf16 v[132:135], v[48:51], a[44:47], v[132:135]
    v_fma_f32 v26, v26, v16, v16
    v_mfma_f32_16x16x32_bf16 v[132:135], v[44:47], a[28:31], v[132:135]
    v_rcp_f32 v24, v24
    v_mfma_f32_16x16x32_bf16 v[132:135], v[40:43], a[12:15], v[132:135]
    s_waitcnt lgkmcnt(0)
    ds_read_b64_tr_b16 v[40:41], v7 offset:18432
    ds_read_b64_tr_b16 v[42:43], v7 offset:18944
    v_mfma_f32_16x16x32_bf16 v[140:143], v[64:67], a[12:15], 0
    ds_read_b64_tr_b16 v[44:45], v7 offset:19456
    ds_read_b64_tr_b16 v[46:47], v7 offset:19968
    v_mfma_f32_16x16x32_bf16 v[140:143], v[68:71], a[28:31], v[140:143]
    s_add_u32 s37, s35, 0x288000
    ds_read_b64_tr_b16 v[48:49], v7 offset:20480
    ds_read_b64_tr_b16 v[50:51], v7 offset:20992
    v_mfma_f32_16x16x32_bf16 v[140:143], v[72:75], a[44:47], v[140:143]
    v_rcp_f32 v26, v26
    v_mfma_f32_16x16x32_bf16 v[140:143], v[76:79], a[60:63], v[140:143]
    ds_read_b64_tr_b16 v[52:53], v7 offset:21504
    v_mul_f32 v25, v25, v24
    v_mfma_f32_16x16x32_bf16 v[140:143], v[80:83], a[76:79], v[140:143]
    ds_read_b64_tr_b16 v[54:55], v7 offset:22016
    v_mul_f32 v27, v27, v26
    v_mfma_f32_16x16x32_bf16 v[140:143], v[84:87], a[92:95], v[140:143]
    ds_read_b64_tr_b16 v[56:57], v7 offset:22528
    v_cvt_pk_bf16_f32 v33, v25, v27
    v_mfma_f32_16x16x32_bf16 v[136:139], v[84:87], a[88:91], 0
    buffer_load_dwordx4 v2, s[8:11], s37 offen lds
    v_mfma_f32_16x16x32_bf16 v[136:139], v[80:83], a[72:75], v[136:139]
    ds_read_b64_tr_b16 v[58:59], v7 offset:23040
    v_mul_f32 v28, v168, v168
    v_mfma_f32_16x16x32_bf16 v[136:139], v[76:79], a[56:59], v[136:139]
    ds_read_b64_tr_b16 v[60:61], v7 offset:23552
    v_mul_f32 v30, v169, v169
    v_mfma_f32_16x16x32_bf16 v[136:139], v[72:75], a[40:43], v[136:139]
    ds_read_b64_tr_b16 v[62:63], v7 offset:24064
    v_fma_f32 v28, v28, v12, v8
    v_mfma_f32_16x16x32_bf16 v[136:139], v[68:71], a[24:27], v[136:139]
    s_add_u32 m0, s33, 0x2800
    v_fma_f32 v30, v30, v12, v8
    v_mul_f32 v28, v28, v168
    v_mfma_f32_16x16x32_bf16 v[136:139], v[64:67], a[8:11], v[136:139]
    v_mul_f32 v30, v30, v169
    v_mul_f32 v29, v168, v184
    v_mfma_f32_16x16x32_bf16 v[108:111], v[64:67], a[4:7], 0
    v_exp_f32 v28, v28
    v_mfma_f32_16x16x32_bf16 v[108:111], v[68:71], a[20:23], v[108:111]
    v_mul_f32 v31, v169, v185
    v_fma_f32 v28, v28, v16, v16
    v_mfma_f32_16x16x32_bf16 v[108:111], v[72:75], a[36:39], v[108:111]
    v_exp_f32 v30, v30
    v_mfma_f32_16x16x32_bf16 v[108:111], v[76:79], a[52:55], v[108:111]
    s_add_u32 s37, s35, 0x2d0000
    v_rcp_f32 v28, v28
    v_mfma_f32_16x16x32_bf16 v[108:111], v[80:83], a[68:71], v[108:111]
    v_fma_f32 v30, v30, v16, v16
    v_mfma_f32_16x16x32_bf16 v[108:111], v[84:87], a[84:87], v[108:111]
    v_rcp_f32 v30, v30
    v_mfma_f32_16x16x32_bf16 v[104:107], v[84:87], a[80:83], 0
    v_mul_f32 v29, v29, v28
    v_mul_f32 v31, v31, v30
    v_mfma_f32_16x16x32_bf16 v[104:107], v[80:83], a[64:67], v[104:107]
    v_cvt_pk_bf16_f32 v34, v29, v31
    v_mfma_f32_16x16x32_bf16 v[104:107], v[76:79], a[48:51], v[104:107]
    buffer_load_dwordx4 v2, s[8:11], s37 offen lds
    v_mfma_f32_16x16x32_bf16 v[104:107], v[72:75], a[32:35], v[104:107]
    v_mul_f32 v20, v170, v170
    v_mul_f32 v22, v171, v171
    v_mfma_f32_16x16x32_bf16 v[104:107], v[68:71], a[16:19], v[104:107]
    v_fma_f32 v20, v20, v12, v8
    v_fma_f32 v22, v22, v12, v8
    v_mfma_f32_16x16x32_bf16 v[104:107], v[64:67], a[0:3], v[104:107]
    s_waitcnt lgkmcnt(0)
    ds_read_b64_tr_b16 v[64:65], v7 offset:18440
    ds_read_b64_tr_b16 v[66:67], v7 offset:18952
    v_mfma_f32_16x16x32_bf16 v[112:115], v[40:43], a[0:3], 0
    ds_read_b64_tr_b16 v[68:69], v7 offset:19464
    ds_read_b64_tr_b16 v[70:71], v7 offset:19976
    v_mfma_f32_16x16x32_bf16 v[112:115], v[44:47], a[16:19], v[112:115]
    s_add_u32 m0, s33, 0x2c00
    ds_read_b64_tr_b16 v[72:73], v7 offset:20488
    ds_read_b64_tr_b16 v[74:75], v7 offset:21000
    v_mfma_f32_16x16x32_bf16 v[112:115], v[48:51], a[32:35], v[112:115]
    ds_read_b64_tr_b16 v[76:77], v7 offset:21512
    v_mul_f32 v20, v20, v170
    v_mfma_f32_16x16x32_bf16 v[112:115], v[52:55], a[48:51], v[112:115]
    ds_read_b64_tr_b16 v[78:79], v7 offset:22024
    v_mul_f32 v22, v22, v171
    v_mfma_f32_16x16x32_bf16 v[112:115], v[56:59], a[64:67], v[112:115]
    ds_read_b64_tr_b16 v[80:81], v7 offset:22536
    v_mul_f32 v21, v170, v186
    v_mfma_f32_16x16x32_bf16 v[112:115], v[60:63], a[80:83], v[112:115]
    ds_read_b64_tr_b16 v[82:83], v7 offset:23048
    v_mul_f32 v23, v171, v187
    v_mfma_f32_16x16x32_bf16 v[116:119], v[60:63], a[84:87], 0
    s_add_u32 s37, s35, 0x318000
    v_exp_f32 v20, v20
    v_mfma_f32_16x16x32_bf16 v[116:119], v[56:59], a[68:71], v[116:119]
    v_exp_f32 v22, v22
    v_mfma_f32_16x16x32_bf16 v[116:119], v[52:55], a[52:55], v[116:119]
    ds_read_b64_tr_b16 v[84:85], v7 offset:23560
    v_fma_f32 v20, v20, v16, v16
    v_mfma_f32_16x16x32_bf16 v[116:119], v[48:51], a[36:39], v[116:119]
    ds_read_b64_tr_b16 v[86:87], v7 offset:24072
    v_fma_f32 v22, v22, v16, v16
    v_mfma_f32_16x16x32_bf16 v[116:119], v[44:47], a[20:23], v[116:119]
    v_rcp_f32 v20, v20
    v_mfma_f32_16x16x32_bf16 v[116:119], v[40:43], a[4:7], v[116:119]
    buffer_load_dwordx4 v2, s[8:11], s37 offen lds
    v_mfma_f32_16x16x32_bf16 v[144:147], v[40:43], a[8:11], 0
    v_rcp_f32 v22, v22
    v_mfma_f32_16x16x32_bf16 v[144:147], v[44:47], a[24:27], v[144:147]
    v_mul_f32 v21, v21, v20
    v_mul_f32 v23, v23, v22
    v_mfma_f32_16x16x32_bf16 v[144:147], v[48:51], a[40:43], v[144:147]
    v_cvt_pk_bf16_f32 v35, v21, v23
    v_mfma_f32_16x16x32_bf16 v[144:147], v[52:55], a[56:59], v[144:147]
    v_mul_f32 v24, v164, v164
    v_mfma_f32_16x16x32_bf16 v[144:147], v[56:59], a[72:75], v[144:147]
    v_mul_f32 v26, v165, v165
    v_mfma_f32_16x16x32_bf16 v[144:147], v[60:63], a[88:91], v[144:147]
    v_fma_f32 v24, v24, v13, v9
    v_mfma_f32_16x16x32_bf16 v[148:151], v[60:63], a[92:95], 0
    v_fma_f32 v26, v26, v13, v9
    v_mul_f32 v24, v24, v164
    v_mfma_f32_16x16x32_bf16 v[148:151], v[56:59], a[76:79], v[148:151]
    v_mul_f32 v26, v26, v165
    v_mfma_f32_16x16x32_bf16 v[148:151], v[52:55], a[60:63], v[148:151]
    s_lshl_b32 s38, s34, 6
    v_mul_f32 v25, v164, v180
    v_mfma_f32_16x16x32_bf16 v[148:151], v[48:51], a[44:47], v[148:151]
    s_add_u32 s38, s38, s40
    v_mul_f32 v27, v165, v181
    v_mfma_f32_16x16x32_bf16 v[148:151], v[44:47], a[28:31], v[148:151]
    s_add_u32 s38, s38, 0x83000
    v_exp_f32 v24, v24
    v_mfma_f32_16x16x32_bf16 v[148:151], v[40:43], a[12:15], v[148:151]
    s_waitcnt lgkmcnt(0)
    s_waitcnt vmcnt(20)
    s_barrier
    v_mfma_f32_16x16x32_bf16 v[156:159], v[64:67], a[12:15], 0
    s_add_u32 m0, s33, 0x3000
    ds_read_b64_tr_b16 v[40:41], v6 offset:24576
    ds_read_b64_tr_b16 v[42:43], v6 offset:25088
    v_mfma_f32_16x16x32_bf16 v[156:159], v[68:71], a[28:31], v[156:159]
    buffer_store_dwordx4 v[32:35], v1, s[28:31], s38 offen sc1
    v_mfma_f32_16x16x32_bf16 v[156:159], v[72:75], a[44:47], v[156:159]
    ds_read_b64_tr_b16 v[44:45], v6 offset:25600
    ds_read_b64_tr_b16 v[46:47], v6 offset:26112
    v_mfma_f32_16x16x32_bf16 v[156:159], v[76:79], a[60:63], v[156:159]
    ds_read_b64_tr_b16 v[48:49], v6 offset:26624
    ds_read_b64_tr_b16 v[50:51], v6 offset:27136
    v_mfma_f32_16x16x32_bf16 v[156:159], v[80:83], a[76:79], v[156:159]
    v_exp_f32 v26, v26
    v_mfma_f32_16x16x32_bf16 v[156:159], v[84:87], a[92:95], v[156:159]
    s_add_u32 s37, s35, 0x360000
    ds_read_b64_tr_b16 v[52:53], v6 offset:27648
    v_fma_f32 v24, v24, v17, v17
    v_mfma_f32_16x16x32_bf16 v[152:155], v[84:87], a[88:91], 0
    ds_read_b64_tr_b16 v[54:55], v6 offset:28160
    v_fma_f32 v26, v26, v17, v17
    v_mfma_f32_16x16x32_bf16 v[152:155], v[80:83], a[72:75], v[152:155]
    v_rcp_f32 v24, v24
    v_mfma_f32_16x16x32_bf16 v[152:155], v[76:79], a[56:59], v[152:155]
    ds_read_b64_tr_b16 v[56:57], v6 offset:28672
    ds_read_b64_tr_b16 v[58:59], v6 offset:29184
    v_mfma_f32_16x16x32_bf16 v[152:155], v[72:75], a[40:43], v[152:155]
    v_rcp_f32 v26, v26
    v_mfma_f32_16x16x32_bf16 v[152:155], v[68:71], a[24:27], v[152:155]
    buffer_load_dwordx4 v2, s[8:11], s37 offen lds
    v_mfma_f32_16x16x32_bf16 v[152:155], v[64:67], a[8:11], v[152:155]
    ds_read_b64_tr_b16 v[60:61], v6 offset:29696
    v_mul_f32 v25, v25, v24
    v_mfma_f32_16x16x32_bf16 v[124:127], v[64:67], a[4:7], 0
    ds_read_b64_tr_b16 v[62:63], v6 offset:30208
    v_mul_f32 v27, v27, v26
    v_mfma_f32_16x16x32_bf16 v[124:127], v[68:71], a[20:23], v[124:127]
    v_cvt_pk_bf16_f32 v88, v25, v27
    v_mul_f32 v28, v166, v166
    v_mfma_f32_16x16x32_bf16 v[124:127], v[72:75], a[36:39], v[124:127]
    v_mul_f32 v30, v167, v167
    v_fma_f32 v28, v28, v13, v9
    v_mfma_f32_16x16x32_bf16 v[124:127], v[76:79], a[52:55], v[124:127]
    s_add_u32 m0, s33, 0x3400
    v_fma_f32 v30, v30, v13, v9
    v_mul_f32 v28, v28, v166
    v_mfma_f32_16x16x32_bf16 v[124:127], v[80:83], a[68:71], v[124:127]
    v_mul_f32 v30, v30, v167
    v_mul_f32 v29, v166, v182
    v_mfma_f32_16x16x32_bf16 v[124:127], v[84:87], a[84:87], v[124:127]
    v_exp_f32 v28, v28
    v_mfma_f32_16x16x32_bf16 v[120:123], v[84:87], a[80:83], 0
    v_mul_f32 v31, v167, v183
    v_fma_f32 v28, v28, v17, v17
    v_mfma_f32_16x16x32_bf16 v[120:123], v[80:83], a[64:67], v[120:123]
    v_exp_f32 v30, v30
    v_mfma_f32_16x16x32_bf16 v[120:123], v[76:79], a[48:51], v[120:123]
    s_add_u32 s37, s35, 0x3a8000
    v_rcp_f32 v28, v28
    v_mfma_f32_16x16x32_bf16 v[120:123], v[72:75], a[32:35], v[120:123]
    v_fma_f32 v30, v30, v17, v17
    v_mfma_f32_16x16x32_bf16 v[120:123], v[68:71], a[16:19], v[120:123]
    v_rcp_f32 v30, v30
    v_mfma_f32_16x16x32_bf16 v[120:123], v[64:67], a[0:3], v[120:123]
    s_waitcnt lgkmcnt(0)
    ds_read_b64_tr_b16 v[64:65], v6 offset:24584
    ds_read_b64_tr_b16 v[66:67], v6 offset:25096
    v_mfma_f32_16x16x32_bf16 v[96:99], v[40:43], a[96:99], v[96:99]
    ds_read_b64_tr_b16 v[68:69], v6 offset:25608
    ds_read_b64_tr_b16 v[70:71], v6 offset:26120
    v_mfma_f32_16x16x32_bf16 v[96:99], v[44:47], a[112:115], v[96:99]
    buffer_load_dwordx4 v2, s[8:11], s37 offen lds
    v_mfma_f32_16x16x32_bf16 v[96:99], v[48:51], a[128:131], v[96:99]
    ds_read_b64_tr_b16 v[72:73], v6 offset:26632
    v_mul_f32 v29, v29, v28
    v_mfma_f32_16x16x32_bf16 v[96:99], v[52:55], a[144:147], v[96:99]
    ds_read_b64_tr_b16 v[74:75], v6 offset:27144
    v_mul_f32 v31, v31, v30
    v_mfma_f32_16x16x32_bf16 v[96:99], v[56:59], a[160:163], v[96:99]
    ds_read_b64_tr_b16 v[76:77], v6 offset:27656
    v_cvt_pk_bf16_f32 v89, v29, v31
    v_mfma_f32_16x16x32_bf16 v[96:99], v[60:63], a[176:179], v[96:99]
    s_add_u32 m0, s33, 0x3800
    ds_read_b64_tr_b16 v[78:79], v6 offset:28168
    v_mul_f32 v20, v172, v172
    v_mfma_f32_16x16x32_bf16 v[100:103], v[60:63], a[180:183], v[100:103]
    ds_read_b64_tr_b16 v[80:81], v6 offset:28680
    v_mul_f32 v22, v173, v173
    v_mfma_f32_16x16x32_bf16 v[100:103], v[56:59], a[164:167], v[100:103]
    ds_read_b64_tr_b16 v[82:83], v6 offset:29192
    v_fma_f32 v20, v20, v13, v9
    v_mfma_f32_16x16x32_bf16 v[100:103], v[52:55], a[148:151], v[100:103]
    ds_read_b64_tr_b16 v[84:85], v6 offset:29704
    v_fma_f32 v22, v22, v13, v9
    v_mfma_f32_16x16x32_bf16 v[100:103], v[48:51], a[132:135], v[100:103]
    ds_read_b64_tr_b16 v[86:87], v6 offset:30216
    v_mul_f32 v20, v20, v172
    v_mfma_f32_16x16x32_bf16 v[100:103], v[44:47], a[116:119], v[100:103]
    s_add_u32 s37, s35, 0x3f0000
    v_mul_f32 v22, v22, v173
    v_mul_f32 v21, v172, v188
    v_mfma_f32_16x16x32_bf16 v[100:103], v[40:43], a[100:103], v[100:103]
    v_exp_f32 v20, v20
    v_mfma_f32_16x16x32_bf16 v[128:131], v[40:43], a[104:107], v[128:131]
    v_mul_f32 v23, v173, v189
    v_fma_f32 v20, v20, v17, v17
    v_mfma_f32_16x16x32_bf16 v[128:131], v[44:47], a[120:123], v[128:131]
    v_exp_f32 v22, v22
    v_mfma_f32_16x16x32_bf16 v[128:131], v[48:51], a[136:139], v[128:131]
    v_rcp_f32 v20, v20
    v_mfma_f32_16x16x32_bf16 v[128:131], v[52:55], a[152:155], v[128:131]
    buffer_load_dwordx4 v2, s[8:11], s37 offen lds
    v_mfma_f32_16x16x32_bf16 v[128:131], v[56:59], a[168:171], v[128:131]
    v_fma_f32 v22, v22, v17, v17
    v_mul_f32 v21, v21, v20
    v_mfma_f32_16x16x32_bf16 v[128:131], v[60:63], a[184:187], v[128:131]
    v_rcp_f32 v22, v22
    v_mfma_f32_16x16x32_bf16 v[132:135], v[60:63], a[188:191], v[132:135]
    v_mul_f32 v23, v23, v22
    v_cvt_pk_bf16_f32 v90, v21, v23
    v_mfma_f32_16x16x32_bf16 v[132:135], v[56:59], a[172:175], v[132:135]
    v_mul_f32 v24, v174, v174
    v_mul_f32 v26, v175, v175
    v_mfma_f32_16x16x32_bf16 v[132:135], v[52:55], a[156:159], v[132:135]
    s_add_u32 m0, s33, 0x3c00
    v_fma_f32 v24, v24, v13, v9
    v_fma_f32 v26, v26, v13, v9
    v_mfma_f32_16x16x32_bf16 v[132:135], v[48:51], a[140:143], v[132:135]
    v_mul_f32 v24, v24, v174
    v_mul_f32 v26, v26, v175
    v_mfma_f32_16x16x32_bf16 v[132:135], v[44:47], a[124:127], v[132:135]
    v_mul_f32 v25, v174, v190
    v_mul_f32 v27, v175, v191
    v_mfma_f32_16x16x32_bf16 v[132:135], v[40:43], a[108:111], v[132:135]
    s_waitcnt lgkmcnt(0)
    ds_read_b64_tr_b16 v[40:41], v7 offset:24576
    ds_read_b64_tr_b16 v[42:43], v7 offset:25088
    v_mfma_f32_16x16x32_bf16 v[140:143], v[64:67], a[108:111], v[140:143]
    ds_read_b64_tr_b16 v[44:45], v7 offset:25600
    ds_read_b64_tr_b16 v[46:47], v7 offset:26112
    v_mfma_f32_16x16x32_bf16 v[140:143], v[68:71], a[124:127], v[140:143]
    s_add_u32 s37, s35, 0x438000
    ds_read_b64_tr_b16 v[48:49], v7 offset:26624
    ds_read_b64_tr_b16 v[50:51], v7 offset:27136
    v_mfma_f32_16x16x32_bf16 v[140:143], v[72:75], a[140:143], v[140:143]
    v_exp_f32 v24, v24
    v_mfma_f32_16x16x32_bf16 v[140:143], v[76:79], a[156:159], v[140:143]
    ds_read_b64_tr_b16 v[52:53], v7 offset:27648
    ds_read_b64_tr_b16 v[54:55], v7 offset:28160
    v_mfma_f32_16x16x32_bf16 v[140:143], v[80:83], a[172:175], v[140:143]
    v_exp_f32 v26, v26
    v_mfma_f32_16x16x32_bf16 v[140:143], v[84:87], a[188:191], v[140:143]
    ds_read_b64_tr_b16 v[56:57], v7 offset:28672
    v_fma_f32 v24, v24, v17, v17
    v_mfma_f32_16x16x32_bf16 v[136:139], v[84:87], a[184:187], v[136:139]
    buffer_load_dwordx4 v2, s[8:11], s37 offen lds
    v_mfma_f32_16x16x32_bf16 v[136:139], v[80:83], a[168:171], v[136:139]
    ds_read_b64_tr_b16 v[58:59], v7 offset:29184
    v_fma_f32 v26, v26, v17, v17
    v_mfma_f32_16x16x32_bf16 v[136:139], v[76:79], a[152:155], v[136:139]
    v_rcp_f32 v24, v24
    v_mfma_f32_16x16x32_bf16 v[136:139], v[72:75], a[136:139], v[136:139]
    v_rcp_f32 v26, v26
    v_mfma_f32_16x16x32_bf16 v[136:139], v[68:71], a[120:123], v[136:139]
    s_add_u32 m0, s33, 0x4000
    ds_read_b64_tr_b16 v[60:61], v7 offset:29696
    v_mul_f32 v25, v25, v24
    v_mfma_f32_16x16x32_bf16 v[136:139], v[64:67], a[104:107], v[136:139]
    ds_read_b64_tr_b16 v[62:63], v7 offset:30208
    v_mul_f32 v27, v27, v26
    v_mfma_f32_16x16x32_bf16 v[108:111], v[64:67], a[100:103], v[108:111]
    v_cvt_pk_bf16_f32 v91, v25, v27
    v_mul_f32 v28, v192, v192
    v_mfma_f32_16x16x32_bf16 v[108:111], v[68:71], a[116:119], v[108:111]
    v_mul_f32 v30, v193, v193
    v_mfma_f32_16x16x32_bf16 v[108:111], v[72:75], a[132:135], v[108:111]
    v_fma_f32 v28, v28, v14, v10
    v_mfma_f32_16x16x32_bf16 v[108:111], v[76:79], a[148:151], v[108:111]
    s_add_u32 s37, s35, 0x480000
    v_fma_f32 v30, v30, v14, v10
    v_mul_f32 v28, v28, v192
    v_mfma_f32_16x16x32_bf16 v[108:111], v[80:83], a[164:167], v[108:111]
    v_mul_f32 v30, v30, v193
    v_mfma_f32_16x16x32_bf16 v[108:111], v[84:87], a[180:183], v[108:111]
    s_lshl_b32 s38, s34, 6
    v_mul_f32 v29, v192, v208
    v_mfma_f32_16x16x32_bf16 v[104:107], v[84:87], a[176:179], v[104:107]
    s_add_u32 s38, s38, s41
    v_exp_f32 v28, v28
    v_mfma_f32_16x16x32_bf16 v[104:107], v[80:83], a[160:163], v[104:107]
    s_add_u32 s38, s38, 0x83000
    v_mul_f32 v31, v193, v209
    v_mfma_f32_16x16x32_bf16 v[104:107], v[76:79], a[144:147], v[104:107]
    buffer_load_dwordx4 v2, s[8:11], s37 offen lds
    v_mfma_f32_16x16x32_bf16 v[104:107], v[72:75], a[128:131], v[104:107]
    buffer_store_dwordx4 v[88:91], v1, s[28:31], s38 offen sc1
    v_mfma_f32_16x16x32_bf16 v[104:107], v[68:71], a[112:115], v[104:107]
    v_exp_f32 v30, v30
    v_mfma_f32_16x16x32_bf16 v[104:107], v[64:67], a[96:99], v[104:107]
    s_waitcnt lgkmcnt(0)
    ds_read_b64_tr_b16 v[64:65], v7 offset:24584
    ds_read_b64_tr_b16 v[66:67], v7 offset:25096
    v_mfma_f32_16x16x32_bf16 v[112:115], v[40:43], a[96:99], v[112:115]
    ds_read_b64_tr_b16 v[68:69], v7 offset:25608
    ds_read_b64_tr_b16 v[70:71], v7 offset:26120
    v_mfma_f32_16x16x32_bf16 v[112:115], v[44:47], a[112:115], v[112:115]
    s_add_u32 m0, s33, 0x4400
    ds_read_b64_tr_b16 v[72:73], v7 offset:26632
    v_fma_f32 v28, v28, v18, v18
    v_mfma_f32_16x16x32_bf16 v[112:115], v[48:51], a[128:131], v[112:115]
    ds_read_b64_tr_b16 v[74:75], v7 offset:27144
    v_fma_f32 v30, v30, v18, v18
    v_mfma_f32_16x16x32_bf16 v[112:115], v[52:55], a[144:147], v[112:115]
    v_rcp_f32 v28, v28
    v_mfma_f32_16x16x32_bf16 v[112:115], v[56:59], a[160:163], v[112:115]
    ds_read_b64_tr_b16 v[76:77], v7 offset:27656
    ds_read_b64_tr_b16 v[78:79], v7 offset:28168
    v_mfma_f32_16x16x32_bf16 v[112:115], v[60:63], a[176:179], v[112:115]
    v_rcp_f32 v30, v30
    v_mfma_f32_16x16x32_bf16 v[116:119], v[60:63], a[180:183], v[116:119]
    s_add_u32 s37, s35, 0x4c8000
    ds_read_b64_tr_b16 v[80:81], v7 offset:28680
    v_mul_f32 v29, v29, v28
    v_mfma_f32_16x16x32_bf16 v[116:119], v[56:59], a[164:167], v[116:119]
    ds_read_b64_tr_b16 v[82:83], v7 offset:29192
    v_mul_f32 v31, v31, v30
    v_mfma_f32_16x16x32_bf16 v[116:119], v[52:55], a[148:151], v[116:119]
    ds_read_b64_tr_b16 v[84:85], v7 offset:29704
    v_cvt_pk_bf16_f32 v32, v29, v31
    v_mfma_f32_16x16x32_bf16 v[116:119], v[48:51], a[132:135], v[116:119]
    ds_read_b64_tr_b16 v[86:87], v7 offset:30216
    v_mul_f32 v20, v194, v194
    v_mfma_f32_16x16x32_bf16 v[116:119], v[44:47], a[116:119], v[116:119]
    v_mul_f32 v22, v195, v195
    v_fma_f32 v20, v20, v14, v10
    v_mfma_f32_16x16x32_bf16 v[116:119], v[40:43], a[100:103], v[116:119]
    buffer_load_dwordx4 v2, s[8:11], s37 offen lds
    v_mfma_f32_16x16x32_bf16 v[144:147], v[40:43], a[104:107], v[144:147]
    v_fma_f32 v22, v22, v14, v10
    v_mul_f32 v20, v20, v194
    v_mfma_f32_16x16x32_bf16 v[144:147], v[44:47], a[120:123], v[144:147]
    v_mul_f32 v22, v22, v195
    v_mul_f32 v21, v194, v210
    v_mfma_f32_16x16x32_bf16 v[144:147], v[48:51], a[136:139], v[144:147]
    v_exp_f32 v20, v20
    v_mfma_f32_16x16x32_bf16 v[144:147], v[52:55], a[152:155], v[144:147]
    v_mul_f32 v23, v195, v211
    v_fma_f32 v20, v20, v18, v18
    v_mfma_f32_16x16x32_bf16 v[144:147], v[56:59], a[168:171], v[144:147]
    v_exp_f32 v22, v22
    v_mfma_f32_16x16x32_bf16 v[144:147], v[60:63], a[184:187], v[144:147]
    v_fma_f32 v22, v22, v18, v18
    v_mov_b32 v4, v38
    v_mfma_f32_16x16x32_bf16 v[148:151], v[60:63], a[188:191], v[148:151]
    v_rcp_f32 v20, v20
    v_mfma_f32_16x16x32_bf16 v[148:151], v[56:59], a[172:175], v[148:151]
    v_xor_b32 v5, 32, v38
    v_add_u32 v92, 0x10000, v4
    v_mfma_f32_16x16x32_bf16 v[148:151], v[52:55], a[156:159], v[148:151]
    v_rcp_f32 v22, v22
    v_mfma_f32_16x16x32_bf16 v[148:151], v[48:51], a[140:143], v[148:151]
    v_mul_f32 v21, v21, v20
    v_add_u32 v93, 0x10000, v5
    v_mfma_f32_16x16x32_bf16 v[148:151], v[44:47], a[124:127], v[148:151]
    v_mul_f32 v23, v23, v22
    v_add_u32 v94, 0x20000, v4
    v_mfma_f32_16x16x32_bf16 v[148:151], v[40:43], a[108:111], v[148:151]
    s_waitcnt lgkmcnt(0)
    s_waitcnt vmcnt(21)
    s_barrier
    v_mfma_f32_16x16x32_bf16 v[156:159], v[64:67], a[108:111], v[156:159]
    s_add_u32 m0, s33, 0x4800
    ds_read_b64_tr_b16 v[40:41], v6 offset:30720
    v_cvt_pk_bf16_f32 v33, v21, v23
    v_mfma_f32_16x16x32_bf16 v[156:159], v[68:71], a[124:127], v[156:159]
    ds_read_b64_tr_b16 v[42:43], v6 offset:31232
    v_add_u32 v95, 0x20000, v5
    v_mfma_f32_16x16x32_bf16 v[156:159], v[72:75], a[140:143], v[156:159]
    ds_read_b64_tr_b16 v[44:45], v6 offset:31744
    v_mul_f32 v24, v200, v200
    v_mfma_f32_16x16x32_bf16 v[156:159], v[76:79], a[156:159], v[156:159]
    ds_read_b64_tr_b16 v[46:47], v6 offset:32256
    v_mul_f32 v26, v201, v201
    v_mfma_f32_16x16x32_bf16 v[156:159], v[80:83], a[172:175], v[156:159]
    ds_read_b64_tr_b16 v[48:49], v6 offset:32768
    v_fma_f32 v24, v24, v14, v10
    v_mfma_f32_16x16x32_bf16 v[156:159], v[84:87], a[188:191], v[156:159]
    s_add_u32 s37, s36, 0x80
    ds_read_b64_tr_b16 v[50:51], v6 offset:33280
    v_fma_f32 v26, v26, v14, v10
    v_mfma_f32_16x16x32_bf16 v[152:155], v[84:87], a[184:187], v[152:155]
    ds_read_b64_tr_b16 v[52:53], v6 offset:33792
    v_mul_f32 v24, v24, v200
    v_mfma_f32_16x16x32_bf16 v[152:155], v[80:83], a[168:171], v[152:155]
    ds_read_b64_tr_b16 v[54:55], v6 offset:34304
    v_mul_f32 v26, v26, v201
    v_mfma_f32_16x16x32_bf16 v[152:155], v[76:79], a[152:155], v[152:155]
    ds_read_b64_tr_b16 v[56:57], v6 offset:34816
    v_mul_f32 v25, v200, v216
    v_mfma_f32_16x16x32_bf16 v[152:155], v[72:75], a[136:139], v[152:155]
    ds_read_b64_tr_b16 v[58:59], v6 offset:35328
    v_mul_f32 v27, v201, v217
    v_mfma_f32_16x16x32_bf16 v[152:155], v[68:71], a[120:123], v[152:155]
    buffer_load_dwordx4 v3, s[12:15], s37 offen lds
    v_mfma_f32_16x16x32_bf16 v[152:155], v[64:67], a[104:107], v[152:155]
    v_exp_f32 v24, v24
    v_mfma_f32_16x16x32_bf16 v[124:127], v[64:67], a[100:103], v[124:127]
    v_exp_f32 v26, v26
    v_mfma_f32_16x16x32_bf16 v[124:127], v[68:71], a[116:119], v[124:127]
    ds_read_b64_tr_b16 v[60:61], v6 offset:35840
    v_fma_f32 v24, v24, v18, v18
    v_mfma_f32_16x16x32_bf16 v[124:127], v[72:75], a[132:135], v[124:127]
    ds_read_b64_tr_b16 v[62:63], v6 offset:36352
    v_fma_f32 v26, v26, v18, v18
    v_mfma_f32_16x16x32_bf16 v[124:127], v[76:79], a[148:151], v[124:127]
    s_add_u32 m0, s33, 0x4c00
    v_rcp_f32 v24, v24
    v_mfma_f32_16x16x32_bf16 v[124:127], v[80:83], a[164:167], v[124:127]
    v_rcp_f32 v26, v26
    v_mfma_f32_16x16x32_bf16 v[124:127], v[84:87], a[180:183], v[124:127]
    v_mul_f32 v25, v25, v24
    v_mul_f32 v27, v27, v26
    v_mfma_f32_16x16x32_bf16 v[120:123], v[84:87], a[176:179], v[120:123]
    v_cvt_pk_bf16_f32 v34, v25, v27
    v_mul_f32 v28, v202, v202
    v_mfma_f32_16x16x32_bf16 v[120:123], v[80:83], a[160:163], v[120:123]
    v_mul_f32 v30, v203, v203
    v_fma_f32 v28, v28, v14, v10
    v_mfma_f32_16x16x32_bf16 v[120:123], v[76:79], a[144:147], v[120:123]
    s_add_u32 s37, s36, 0x40080
    v_fma_f32 v30, v30, v14, v10
    v_mul_f32 v28, v28, v202
    v_mfma_f32_16x16x32_bf16 v[120:123], v[72:75], a[128:131], v[120:123]
    v_mul_f32 v30, v30, v203
    v_mul_f32 v29, v202, v218
    v_mfma_f32_16x16x32_bf16 v[120:123], v[68:71], a[112:115], v[120:123]
    v_exp_f32 v28, v28
    v_mfma_f32_16x16x32_bf16 v[120:123], v[64:67], a[96:99], v[120:123]
    s_waitcnt lgkmcnt(0)
    ds_read_b64_tr_b16 v[64:65], v6 offset:30728
    ds_read_b64_tr_b16 v[66:67], v6 offset:31240
    v_mfma_f32_16x16x32_bf16 v[96:99], v[40:43], a[192:195], v[96:99]
    ds_read_b64_tr_b16 v[68:69], v6 offset:31752
    v_mul_f32 v31, v203, v219
    v_mfma_f32_16x16x32_bf16 v[96:99], v[44:47], a[208:211], v[96:99]
    buffer_load_dwordx4 v3, s[12:15], s37 offen lds
    v_mfma_f32_16x16x32_bf16 v[96:99], v[48:51], a[224:227], v[96:99]
    ds_read_b64_tr_b16 v[70:71], v6 offset:32264
    ds_read_b64_tr_b16 v[72:73], v6 offset:32776
    v_mfma_f32_16x16x32_bf16 v[96:99], v[52:55], a[240:243], v[96:99]
    v_exp_f32 v30, v30
    v_mfma_f32_16x16x32_bf16 v[96:99], v[56:59], v[224:227], v[96:99]
    ds_read_b64_tr_b16 v[74:75], v6 offset:33288
    v_fma_f32 v28, v28, v18, v18
    v_mfma_f32_16x16x32_bf16 v[96:99], v[60:63], v[240:243], v[96:99]
    s_add_u32 m0, s33, 0x5000
    ds_read_b64_tr_b16 v[76:77], v6 offset:33800
    v_fma_f32 v30, v30, v18, v18
    v_mfma_f32_16x16x32_bf16 v[100:103], v[60:63], v[244:247], v[100:103]
    v_rcp_f32 v28, v28
    v_mfma_f32_16x16x32_bf16 v[100:103], v[56:59], v[228:231], v[100:103]
    ds_read_b64_tr_b16 v[78:79], v6 offset:34312
    ds_read_b64_tr_b16 v[80:81], v6 offset:34824
    v_mfma_f32_16x16x32_bf16 v[100:103], v[52:55], a[244:247], v[100:103]
    v_rcp_f32 v30, v30
    v_mfma_f32_16x16x32_bf16 v[100:103], v[48:51], a[228:231], v[100:103]
    ds_read_b64_tr_b16 v[82:83], v6 offset:35336
    v_mul_f32 v29, v29, v28
    v_mfma_f32_16x16x32_bf16 v[100:103], v[44:47], a[212:215], v[100:103]
    s_add_u32 s37, s36, 0x80080
    ds_read_b64_tr_b16 v[84:85], v6 offset:35848
    v_mul_f32 v31, v31, v30
    v_mfma_f32_16x16x32_bf16 v[100:103], v[40:43], a[196:199], v[100:103]
    ds_read_b64_tr_b16 v[86:87], v6 offset:36360
    v_cvt_pk_bf16_f32 v35, v29, v31
    v_mfma_f32_16x16x32_bf16 v[128:131], v[40:43], a[200:203], v[128:131]
    v_mul_f32 v20, v196, v196
    v_mul_f32 v22, v197, v197
    v_mfma_f32_16x16x32_bf16 v[128:131], v[44:47], a[216:219], v[128:131]
    v_fma_f32 v20, v20, v15, v11
    v_fma_f32 v22, v22, v15, v11
    v_mfma_f32_16x16x32_bf16 v[128:131], v[48:51], a[232:235], v[128:131]
    s_lshl_b32 s38, s34, 6
    v_mul_f32 v20, v20, v196
    v_mul_f32 v22, v22, v197
    v_mfma_f32_16x16x32_bf16 v[128:131], v[52:55], a[248:251], v[128:131]
    s_add_u32 s38, s38, s42
    s_add_u32 s38, s38, 0x83000
    v_mul_f32 v21, v196, v212
    v_mfma_f32_16x16x32_bf16 v[128:131], v[56:59], v[232:235], v[128:131]
    buffer_load_dwordx4 v3, s[12:15], s37 offen lds
    v_mfma_f32_16x16x32_bf16 v[128:131], v[60:63], v[248:251], v[128:131]
    buffer_store_dwordx4 v[32:35], v1, s[28:31], s38 offen sc1
    v_mfma_f32_16x16x32_bf16 v[132:135], v[60:63], v[252:255], v[132:135]
    v_exp_f32 v20, v20
    v_mfma_f32_16x16x32_bf16 v[132:135], v[56:59], v[236:239], v[132:135]
    v_mul_f32 v23, v197, v213
    v_fma_f32 v20, v20, v19, v19
    v_mfma_f32_16x16x32_bf16 v[132:135], v[52:55], a[252:255], v[132:135]
    s_add_u32 m0, s33, 0x5400
    v_exp_f32 v22, v22
    v_mfma_f32_16x16x32_bf16 v[132:135], v[48:51], a[236:239], v[132:135]
    v_rcp_f32 v20, v20
    v_mfma_f32_16x16x32_bf16 v[132:135], v[44:47], a[220:223], v[132:135]
    v_fma_f32 v22, v22, v19, v19
    v_mfma_f32_16x16x32_bf16 v[132:135], v[40:43], a[204:207], v[132:135]
    s_waitcnt lgkmcnt(0)
    ds_read_b64_tr_b16 v[40:41], v7 offset:30720
    ds_read_b64_tr_b16 v[42:43], v7 offset:31232
    v_mfma_f32_16x16x32_bf16 v[140:143], v[64:67], a[204:207], v[140:143]
    ds_read_b64_tr_b16 v[44:45], v7 offset:31744
    ds_read_b64_tr_b16 v[46:47], v7 offset:32256
    v_mfma_f32_16x16x32_bf16 v[140:143], v[68:71], a[220:223], v[140:143]
    s_add_u32 s37, s36, 0xc0080
    ds_read_b64_tr_b16 v[48:49], v7 offset:32768
    ds_read_b64_tr_b16 v[50:51], v7 offset:33280
    v_mfma_f32_16x16x32_bf16 v[140:143], v[72:75], a[236:239], v[140:143]
    v_rcp_f32 v22, v22
    v_mfma_f32_16x16x32_bf16 v[140:143], v[76:79], a[252:255], v[140:143]
    ds_read_b64_tr_b16 v[52:53], v7 offset:33792
    v_mul_f32 v21, v21, v20
    v_mfma_f32_16x16x32_bf16 v[140:143], v[80:83], v[236:239], v[140:143]
    ds_read_b64_tr_b16 v[54:55], v7 offset:34304
    v_mul_f32 v23, v23, v22
    v_mfma_f32_16x16x32_bf16 v[140:143], v[84:87], v[252:255], v[140:143]
    ds_read_b64_tr_b16 v[56:57], v7 offset:34816
    v_cvt_pk_bf16_f32 v88, v21, v23
    v_mfma_f32_16x16x32_bf16 v[136:139], v[84:87], v[248:251], v[136:139]
    buffer_load_dwordx4 v3, s[12:15], s37 offen lds
    v_mfma_f32_16x16x32_bf16 v[136:139], v[80:83], v[232:235], v[136:139]
    ds_read_b64_tr_b16 v[58:59], v7 offset:35328
    v_mul_f32 v24, v198, v198
    v_mfma_f32_16x16x32_bf16 v[136:139], v[76:79], a[248:251], v[136:139]
    ds_read_b64_tr_b16 v[60:61], v7 offset:35840
    v_mul_f32 v26, v199, v199
    v_mfma_f32_16x16x32_bf16 v[136:139], v[72:75], a[232:235], v[136:139]
    ds_read_b64_tr_b16 v[62:63], v7 offset:36352
    v_fma_f32 v24, v24, v15, v11
    v_mfma_f32_16x16x32_bf16 v[136:139], v[68:71], a[216:219], v[136:139]
    s_add_u32 m0, s33, 0x5800
    v_fma_f32 v26, v26, v15, v11
    v_mul_f32 v24, v24, v198
    v_mfma_f32_16x16x32_bf16 v[136:139], v[64:67], a[200:203], v[136:139]
    v_mul_f32 v26, v26, v199
    v_mul_f32 v25, v198, v214
    v_mfma_f32_16x16x32_bf16 v[108:111], v[64:67], a[196:199], v[108:111]
    v_exp_f32 v24, v24
    v_mfma_f32_16x16x32_bf16 v[108:111], v[68:71], a[212:215], v[108:111]
    v_mul_f32 v27, v199, v215
    v_fma_f32 v24, v24, v19, v19
    v_mfma_f32_16x16x32_bf16 v[108:111], v[72:75], a[228:231], v[108:111]
    v_exp_f32 v26, v26
    v_mfma_f32_16x16x32_bf16 v[108:111], v[76:79], a[244:247], v[108:111]
    s_add_u32 s37, s36, 0x100080
    v_rcp_f32 v24, v24
    v_mfma_f32_16x16x32_bf16 v[108:111], v[80:83], v[228:231], v[108:111]
    v_fma_f32 v26, v26, v19, v19
    v_mul_f32 v25, v25, v24
    v_mfma_f32_16x16x32_bf16 v[108:111], v[84:87], v[244:247], v[108:111]
    v_rcp_f32 v26, v26
    v_mfma_f32_16x16x32_bf16 v[104:107], v[84:87], v[240:243], v[104:107]
    v_mul_f32 v27, v27, v26
    v_cvt_pk_bf16_f32 v89, v25, v27
    v_mfma_f32_16x16x32_bf16 v[104:107], v[80:83], v[224:227], v[104:107]
    v_mul_f32 v28, v204, v204
    v_mul_f32 v30, v205, v205
    v_mfma_f32_16x16x32_bf16 v[104:107], v[76:79], a[240:243], v[104:107]
    buffer_load_dwordx4 v3, s[12:15], s37 offen lds
    v_mfma_f32_16x16x32_bf16 v[104:107], v[72:75], a[224:227], v[104:107]
    v_fma_f32 v28, v28, v15, v11
    v_fma_f32 v30, v30, v15, v11
    v_mfma_f32_16x16x32_bf16 v[104:107], v[68:71], a[208:211], v[104:107]
    v_mul_f32 v28, v28, v204
    v_mul_f32 v30, v30, v205
    v_mfma_f32_16x16x32_bf16 v[104:107], v[64:67], a[192:195], v[104:107]
    s_waitcnt lgkmcnt(0)
    ds_read_b64_tr_b16 v[64:65], v7 offset:30728
    ds_read_b64_tr_b16 v[66:67], v7 offset:31240
    v_mfma_f32_16x16x32_bf16 v[112:115], v[40:43], a[192:195], v[112:115]
    ds_read_b64_tr_b16 v[68:69], v7 offset:31752
    ds_read_b64_tr_b16 v[70:71], v7 offset:32264
    v_mfma_f32_16x16x32_bf16 v[112:115], v[44:47], a[208:211], v[112:115]
    s_add_u32 m0, s33, 0x5c00
    ds_read_b64_tr_b16 v[72:73], v7 offset:32776
    v_mul_f32 v29, v204, v220
    v_mfma_f32_16x16x32_bf16 v[112:115], v[48:51], a[224:227], v[112:115]
    ds_read_b64_tr_b16 v[74:75], v7 offset:33288
    v_mul_f32 v31, v205, v221
    v_mfma_f32_16x16x32_bf16 v[112:115], v[52:55], a[240:243], v[112:115]
    ds_read_b64_tr_b16 v[76:77], v7 offset:33800
    ds_read_b64_tr_b16 v[78:79], v7 offset:34312
    v_mfma_f32_16x16x32_bf16 v[112:115], v[56:59], v[224:227], v[112:115]
    v_exp_f32 v28, v28
    v_mfma_f32_16x16x32_bf16 v[112:115], v[60:63], v[240:243], v[112:115]
    v_exp_f32 v30, v30
    v_mfma_f32_16x16x32_bf16 v[116:119], v[60:63], v[244:247], v[116:119]
    s_add_u32 s37, s36, 0x140080
    ds_read_b64_tr_b16 v[80:81], v7 offset:34824
    v_fma_f32 v28, v28, v19, v19
    v_mfma_f32_16x16x32_bf16 v[116:119], v[56:59], v[228:231], v[116:119]
    ds_read_b64_tr_b16 v[82:83], v7 offset:35336
    v_fma_f32 v30, v30, v19, v19
    v_mfma_f32_16x16x32_bf16 v[116:119], v[52:55], a[244:247], v[116:119]
    v_rcp_f32 v28, v28
    v_mfma_f32_16x16x32_bf16 v[116:119], v[48:51], a[228:231], v[116:119]
    ds_read_b64_tr_b16 v[84:85], v7 offset:35848
    ds_read_b64_tr_b16 v[86:87], v7 offset:36360
    v_mfma_f32_16x16x32_bf16 v[116:119], v[44:47], a[212:215], v[116:119]
    v_rcp_f32 v30, v30
    v_mfma_f32_16x16x32_bf16 v[116:119], v[40:43], a[196:199], v[116:119]
    buffer_load_dwordx4 v3, s[12:15], s37 offen lds
    v_mfma_f32_16x16x32_bf16 v[144:147], v[40:43], a[200:203], v[144:147]
    v_mul_f32 v29, v29, v28
    v_mul_f32 v31, v31, v30
    v_mfma_f32_16x16x32_bf16 v[144:147], v[44:47], a[216:219], v[144:147]
    v_cvt_pk_bf16_f32 v90, v29, v31
    v_mul_f32 v20, v206, v206
    v_mfma_f32_16x16x32_bf16 v[144:147], v[48:51], a[232:235], v[144:147]
    v_mul_f32 v22, v207, v207
    v_fma_f32 v20, v20, v15, v11
    v_mfma_f32_16x16x32_bf16 v[144:147], v[52:55], a[248:251], v[144:147]
    v_fma_f32 v22, v22, v15, v11
    v_mul_f32 v20, v20, v206
    v_mfma_f32_16x16x32_bf16 v[144:147], v[56:59], v[232:235], v[144:147]
    v_mul_f32 v22, v22, v207
    v_mul_f32 v21, v206, v222
    v_mfma_f32_16x16x32_bf16 v[144:147], v[60:63], v[248:251], v[144:147]
    v_exp_f32 v20, v20
    v_mfma_f32_16x16x32_bf16 v[148:151], v[60:63], v[252:255], v[148:151]
    v_exp_f32 v22, v22
    v_mfma_f32_16x16x32_bf16 v[148:151], v[56:59], v[236:239], v[148:151]
    v_mul_f32 v23, v207, v223
    v_mfma_f32_16x16x32_bf16 v[148:151], v[52:55], a[252:255], v[148:151]
    v_fma_f32 v20, v20, v19, v19
    v_mfma_f32_16x16x32_bf16 v[148:151], v[48:51], a[236:239], v[148:151]
    v_rcp_f32 v20, v20
    v_mfma_f32_16x16x32_bf16 v[148:151], v[44:47], a[220:223], v[148:151]
    v_fma_f32 v22, v22, v19, v19
    v_mfma_f32_16x16x32_bf16 v[148:151], v[40:43], a[204:207], v[148:151]
    s_waitcnt lgkmcnt(0)
    s_waitcnt vmcnt(22)
    s_barrier
    v_mfma_f32_16x16x32_bf16 v[156:159], v[64:67], a[204:207], v[156:159]
    s_add_u32 m0, s33, 0x6000
    ds_read_b64_tr_b16 v[40:41], v4 offset:0
    ds_read_b64_tr_b16 v[42:43], v92 offset:16384
    v_mfma_f32_16x16x32_bf16 v[156:159], v[68:71], a[220:223], v[156:159]
    ds_read_b64_tr_b16 v[44:45], v4 offset:1024
    ds_read_b64_tr_b16 v[46:47], v92 offset:17408
    v_mfma_f32_16x16x32_bf16 v[156:159], v[72:75], a[236:239], v[156:159]
    s_add_u32 s37, s36, 0x180080
    ds_read_b64_tr_b16 v[48:49], v4 offset:2048
    ds_read_b64_tr_b16 v[50:51], v92 offset:18432
    v_mfma_f32_16x16x32_bf16 v[156:159], v[76:79], a[252:255], v[156:159]
    buffer_load_dwordx4 v3, s[12:15], s37 offen lds
    v_mfma_f32_16x16x32_bf16 v[156:159], v[80:83], v[236:239], v[156:159]
    v_rcp_f32 v22, v22
    v_mfma_f32_16x16x32_bf16 v[156:159], v[84:87], v[252:255], v[156:159]
    s_add_u32 m0, s33, 0x6400
    ds_read_b64_tr_b16 v[52:53], v4 offset:3072
    v_mul_f32 v21, v21, v20
    v_mfma_f32_16x16x32_bf16 v[152:155], v[84:87], v[248:251], v[152:155]
    s_add_u32 s37, s36, 0x1c0080
    ds_read_b64_tr_b16 v[54:55], v92 offset:19456
    v_mul_f32 v23, v23, v22
    v_mfma_f32_16x16x32_bf16 v[152:155], v[80:83], v[232:235], v[152:155]
    ds_read_b64_tr_b16 v[56:57], v4 offset:4096
    v_cvt_pk_bf16_f32 v91, v21, v23
    v_mfma_f32_16x16x32_bf16 v[152:155], v[76:79], a[248:251], v[152:155]
    buffer_load_dwordx4 v3, s[12:15], s37 offen lds
    v_mfma_f32_16x16x32_bf16 v[152:155], v[72:75], a[232:235], v[152:155]
    s_add_u32 m0, s33, 0x6800
    ds_read_b64_tr_b16 v[58:59], v92 offset:20480
    ds_read_b64_tr_b16 v[60:61], v4 offset:5120
    v_mfma_f32_16x16x32_bf16 v[152:155], v[68:71], a[216:219], v[152:155]
    s_add_u32 s37, s36, 0x200080
    ds_read_b64_tr_b16 v[62:63], v92 offset:21504
    v_mfma_f32_16x16x32_bf16 v[152:155], v[64:67], a[200:203], v[152:155]
    s_lshl_b32 s38, s34, 6
    v_mfma_f32_16x16x32_bf16 v[124:127], v[64:67], a[196:199], v[124:127]
    s_add_u32 s38, s38, s43
    s_add_u32 s38, s38, 0x83000
    v_mfma_f32_16x16x32_bf16 v[124:127], v[68:71], a[212:215], v[124:127]
    buffer_load_dwordx4 v3, s[12:15], s37 offen lds
    v_mfma_f32_16x16x32_bf16 v[124:127], v[72:75], a[228:231], v[124:127]
    s_add_u32 m0, s33, 0x6c00
    v_mfma_f32_16x16x32_bf16 v[124:127], v[76:79], a[244:247], v[124:127]
    s_add_u32 s37, s36, 0x240080
    v_mul_f32 v32, 0xbd62dfc5, v8
    v_mul_f32 v33, 0xbd62dfc5, v9
    v_mfma_f32_16x16x32_bf16 v[124:127], v[80:83], v[228:231], v[124:127]
    buffer_load_dwordx4 v3, s[12:15], s37 offen lds
    v_mfma_f32_16x16x32_bf16 v[124:127], v[84:87], v[244:247], v[124:127]
    s_add_u32 m0, s33, 0x7000
    v_mul_f32 v34, 0xbd62dfc5, v10
    v_mul_f32 v35, 0xbd62dfc5, v11
    v_mfma_f32_16x16x32_bf16 v[120:123], v[84:87], v[240:243], v[120:123]
    buffer_store_dwordx4 v[88:91], v1, s[28:31], s38 offen sc1
    v_mfma_f32_16x16x32_bf16 v[120:123], v[80:83], v[224:227], v[120:123]
    s_add_u32 s37, s36, 0x280080
    v_mul_f32 v96, v96, v32
    v_mfma_f32_16x16x32_bf16 v[120:123], v[76:79], a[240:243], v[120:123]
    buffer_load_dwordx4 v3, s[12:15], s37 offen lds
    v_mfma_f32_16x16x32_bf16 v[120:123], v[72:75], a[224:227], v[120:123]
    v_mul_f32 v97, v97, v32
    v_mul_f32 v98, v98, v32
    v_mfma_f32_16x16x32_bf16 v[120:123], v[68:71], a[208:211], v[120:123]
    s_add_u32 m0, s33, 0x7400
    v_mfma_f32_16x16x32_bf16 v[120:123], v[64:67], a[192:195], v[120:123]
    s_waitcnt lgkmcnt(0)
    s_add_u32 s37, s36, 0x2c0080
    ds_read_b64_tr_b16 v[64:65], v5 offset:0
    v_mfma_f32_16x16x32_bf16 v[160:163], v[40:43], a[0:3], 0
    ds_read_b64_tr_b16 v[66:67], v93 offset:16384
    ds_read_b64_tr_b16 v[68:69], v5 offset:1024
    v_mfma_f32_16x16x32_bf16 v[160:163], v[44:47], a[16:19], v[160:163]
    buffer_load_dwordx4 v3, s[12:15], s37 offen lds
    v_mfma_f32_16x16x32_bf16 v[160:163], v[48:51], a[32:35], v[160:163]
    s_add_u32 m0, s33, 0x7800
    ds_read_b64_tr_b16 v[70:71], v93 offset:17408
    ds_read_b64_tr_b16 v[72:73], v5 offset:2048
    v_mfma_f32_16x16x32_bf16 v[160:163], v[52:55], a[48:51], v[160:163]
    s_add_u32 s37, s36, 0x300080
    ds_read_b64_tr_b16 v[74:75], v93 offset:18432
    ds_read_b64_tr_b16 v[76:77], v5 offset:3072
    v_mfma_f32_16x16x32_bf16 v[160:163], v[56:59], a[64:67], v[160:163]
    ds_read_b64_tr_b16 v[78:79], v93 offset:19456
    ds_read_b64_tr_b16 v[80:81], v5 offset:4096
    v_mfma_f32_16x16x32_bf16 v[160:163], v[60:63], a[80:83], v[160:163]
    buffer_load_dwordx4 v3, s[12:15], s37 offen lds
    v_mfma_f32_16x16x32_bf16 v[164:167], v[60:63], a[84:87], 0
    s_add_u32 m0, s33, 0x7c00
    ds_read_b64_tr_b16 v[82:83], v93 offset:20480
    ds_read_b64_tr_b16 v[84:85], v5 offset:5120
    v_mfma_f32_16x16x32_bf16 v[164:167], v[56:59], a[68:71], v[164:167]
    ds_read_b64_tr_b16 v[86:87], v93 offset:21504
    v_mul_f32 v99, v99, v32
    v_mfma_f32_16x16x32_bf16 v[164:167], v[52:55], a[52:55], v[164:167]
    s_add_u32 s37, s36, 0x340080
    v_mul_f32 v104, v104, v32
    v_mul_f32 v105, v105, v32
    v_mfma_f32_16x16x32_bf16 v[164:167], v[48:51], a[36:39], v[164:167]
    buffer_load_dwordx4 v3, s[12:15], s37 offen lds
    v_mfma_f32_16x16x32_bf16 v[164:167], v[44:47], a[20:23], v[164:167]
    s_add_u32 m0, s33, 0x8000
    v_mul_f32 v106, v106, v32
    v_mul_f32 v107, v107, v32
    v_mfma_f32_16x16x32_bf16 v[164:167], v[40:43], a[4:7], v[164:167]
    s_waitcnt lgkmcnt(0)
    ds_read_b64_tr_b16 v[40:41], v4 offset:40960
    ds_read_b64_tr_b16 v[42:43], v92 offset:57344
    v_mfma_f32_16x16x32_bf16 v[172:175], v[64:67], a[4:7], 0
    s_add_u32 s37, s36, 0x380080
    ds_read_b64_tr_b16 v[44:45], v4 offset:41984
    v_cvt_pk_bf16_f32 v96, v96, v97
    v_mfma_f32_16x16x32_bf16 v[172:175], v[68:71], a[20:23], v[172:175]
    buffer_load_dwordx4 v3, s[12:15], s37 offen lds
    v_mfma_f32_16x16x32_bf16 v[172:175], v[72:75], a[36:39], v[172:175]
    ds_read_b64_tr_b16 v[46:47], v92 offset:58368
    ds_read_b64_tr_b16 v[48:49], v4 offset:43008
    v_mfma_f32_16x16x32_bf16 v[172:175], v[76:79], a[52:55], v[172:175]
    s_add_u32 m0, s33, 0x8400
    ds_read_b64_tr_b16 v[50:51], v92 offset:59392
    v_cvt_pk_bf16_f32 v97, v98, v99
    v_mfma_f32_16x16x32_bf16 v[172:175], v[80:83], a[68:71], v[172:175]
    s_add_u32 s37, s36, 0x3c0080
    ds_read_b64_tr_b16 v[52:53], v4 offset:44032
    ds_read_b64_tr_b16 v[54:55], v92 offset:60416
    v_mfma_f32_16x16x32_bf16 v[172:175], v[84:87], a[84:87], v[172:175]
    ds_read_b64_tr_b16 v[56:57], v4 offset:45056
    v_cvt_pk_bf16_f32 v98, v104, v105
    v_mfma_f32_16x16x32_bf16 v[168:171], v[84:87], a[80:83], 0
    buffer_load_dwordx4 v3, s[12:15], s37 offen lds
    v_mfma_f32_16x16x32_bf16 v[168:171], v[80:83], a[64:67], v[168:171]
    s_add_u32 m0, s33, 0x8800
    ds_read_b64_tr_b16 v[58:59], v92 offset:61440
    ds_read_b64_tr_b16 v[60:61], v4 offset:46080
    v_mfma_f32_16x16x32_bf16 v[168:171], v[76:79], a[48:51], v[168:171]
    s_add_u32 s37, s36, 0x400080
    ds_read_b64_tr_b16 v[62:63], v92 offset:62464
    v_cvt_pk_bf16_f32 v99, v106, v107
    v_mfma_f32_16x16x32_bf16 v[168:171], v[72:75], a[32:35], v[168:171]
    v_mul_f32 v100, v100, v33
    v_mul_f32 v101, v101, v33
    v_mfma_f32_16x16x32_bf16 v[168:171], v[68:71], a[16:19], v[168:171]
    buffer_load_dwordx4 v3, s[12:15], s37 offen lds
    v_mfma_f32_16x16x32_bf16 v[168:171], v[64:67], a[0:3], v[168:171]
    s_waitcnt lgkmcnt(0)
    s_add_u32 m0, s33, 0x8c00
    v_mul_f32 v102, v102, v33
    v_mfma_f32_16x16x32_bf16 v[176:179], v[40:43], a[0:3], 0
    ds_read_b64_tr_b16 v[64:65], v5 offset:40960
    v_mul_f32 v103, v103, v33
    v_mfma_f32_16x16x32_bf16 v[176:179], v[44:47], a[16:19], v[176:179]
    s_add_u32 s37, s36, 0x440080
    ds_read_b64_tr_b16 v[66:67], v93 offset:57344
    ds_read_b64_tr_b16 v[68:69], v5 offset:41984
    v_mfma_f32_16x16x32_bf16 v[176:179], v[48:51], a[32:35], v[176:179]
    ds_read_b64_tr_b16 v[70:71], v93 offset:58368
    v_mul_f32 v108, v108, v33
    v_mfma_f32_16x16x32_bf16 v[176:179], v[52:55], a[48:51], v[176:179]
    buffer_load_dwordx4 v3, s[12:15], s37 offen lds
    v_mfma_f32_16x16x32_bf16 v[176:179], v[56:59], a[64:67], v[176:179]
    ds_read_b64_tr_b16 v[72:73], v5 offset:43008
    ds_read_b64_tr_b16 v[74:75], v93 offset:59392
    v_mfma_f32_16x16x32_bf16 v[176:179], v[60:63], a[80:83], v[176:179]
    ds_read_b64_tr_b16 v[76:77], v5 offset:44032
    ds_read_b64_tr_b16 v[78:79], v93 offset:60416
    v_mfma_f32_16x16x32_bf16 v[180:183], v[60:63], a[84:87], 0
    ds_read_b64_tr_b16 v[80:81], v5 offset:45056
    ds_read_b64_tr_b16 v[82:83], v93 offset:61440
    v_mfma_f32_16x16x32_bf16 v[180:183], v[56:59], a[68:71], v[180:183]
    ds_read_b64_tr_b16 v[84:85], v5 offset:46080
    ds_read_b64_tr_b16 v[86:87], v93 offset:62464
    v_mfma_f32_16x16x32_bf16 v[180:183], v[52:55], a[52:55], v[180:183]
    v_mul_f32 v109, v109, v33
    v_mul_f32 v110, v110, v33
    v_mfma_f32_16x16x32_bf16 v[180:183], v[48:51], a[36:39], v[180:183]
    v_mul_f32 v111, v111, v33
    v_cvt_pk_bf16_f32 v100, v100, v101
    v_mfma_f32_16x16x32_bf16 v[180:183], v[44:47], a[20:23], v[180:183]
    v_cvt_pk_bf16_f32 v101, v102, v103
    v_cvt_pk_bf16_f32 v102, v108, v109
    v_mfma_f32_16x16x32_bf16 v[180:183], v[40:43], a[4:7], v[180:183]
    s_waitcnt lgkmcnt(0)
    s_waitcnt vmcnt(28)
    s_barrier
    v_mfma_f32_16x16x32_bf16 v[188:191], v[64:67], a[4:7], 0
    s_add_u32 m0, s33, 0x9000
    ds_read_b64_tr_b16 v[40:41], v4 offset:6144
    v_cvt_pk_bf16_f32 v103, v110, v111
    v_mfma_f32_16x16x32_bf16 v[188:191], v[68:71], a[20:23], v[188:191]
    ds_read_b64_tr_b16 v[42:43], v92 offset:22528
    ds_read_b64_tr_b16 v[44:45], v4 offset:7168
    v_mfma_f32_16x16x32_bf16 v[188:191], v[72:75], a[36:39], v[188:191]
    ds_read_b64_tr_b16 v[46:47], v92 offset:23552
    v_mul_f32 v128, v128, v34
    v_mfma_f32_16x16x32_bf16 v[188:191], v[76:79], a[52:55], v[188:191]
    ds_read_b64_tr_b16 v[48:49], v4 offset:8192
    ds_read_b64_tr_b16 v[50:51], v92 offset:24576
    v_mfma_f32_16x16x32_bf16 v[188:191], v[80:83], a[68:71], v[188:191]
    ds_read_b64_tr_b16 v[52:53], v4 offset:9216
    v_mul_f32 v129, v129, v34
    v_mfma_f32_16x16x32_bf16 v[188:191], v[84:87], a[84:87], v[188:191]
    s_mov_b32 s37, 0
    ds_read_b64_tr_b16 v[54:55], v92 offset:25600
    ds_read_b64_tr_b16 v[56:57], v4 offset:10240
    v_mfma_f32_16x16x32_bf16 v[184:187], v[84:87], a[80:83], 0
    ds_read_b64_tr_b16 v[58:59], v92 offset:26624
    v_mul_f32 v130, v130, v34
    v_mfma_f32_16x16x32_bf16 v[184:187], v[80:83], a[64:67], v[184:187]
    ds_read_b64_tr_b16 v[60:61], v4 offset:11264
    ds_read_b64_tr_b16 v[62:63], v92 offset:27648
    v_mfma_f32_16x16x32_bf16 v[184:187], v[76:79], a[48:51], v[184:187]
    v_mul_f32 v131, v131, v34
    v_mul_f32 v136, v136, v34
    v_mfma_f32_16x16x32_bf16 v[184:187], v[72:75], a[32:35], v[184:187]
    buffer_load_dwordx4 v36, s[16:19], s37 offen offset:0 lds
    v_mfma_f32_16x16x32_bf16 v[184:187], v[68:71], a[16:19], v[184:187]
    v_mul_f32 v137, v137, v34
    v_mul_f32 v138, v138, v34
    v_mfma_f32_16x16x32_bf16 v[184:187], v[64:67], a[0:3], v[184:187]
    s_waitcnt lgkmcnt(0)
    ds_read_b64_tr_b16 v[64:65], v5 offset:6144
    v_mul_f32 v139, v139, v34
    v_mfma_f32_16x16x32_bf16 v[160:163], v[40:43], a[96:99], v[160:163]
    ds_read_b64_tr_b16 v[66:67], v93 offset:22528
    v_cvt_pk_bf16_f32 v104, v128, v129
    v_mfma_f32_16x16x32_bf16 v[160:163], v[44:47], a[112:115], v[160:163]
    s_mov_b32 s37, 3072
    ds_read_b64_tr_b16 v[68:69], v5 offset:7168
    v_cvt_pk_bf16_f32 v105, v130, v131
    v_mfma_f32_16x16x32_bf16 v[160:163], v[48:51], a[128:131], v[160:163]
    ds_read_b64_tr_b16 v[70:71], v93 offset:23552
    ds_read_b64_tr_b16 v[72:73], v5 offset:8192
    v_mfma_f32_16x16x32_bf16 v[160:163], v[52:55], a[144:147], v[160:163]
    ds_read_b64_tr_b16 v[74:75], v93 offset:24576
    v_cvt_pk_bf16_f32 v106, v136, v137
    v_mfma_f32_16x16x32_bf16 v[160:163], v[56:59], a[160:163], v[160:163]
    ds_read_b64_tr_b16 v[76:77], v5 offset:9216
    v_cvt_pk_bf16_f32 v107, v138, v139
    v_mfma_f32_16x16x32_bf16 v[160:163], v[60:63], a[176:179], v[160:163]
    ds_read_b64_tr_b16 v[78:79], v93 offset:25600
    ds_read_b64_tr_b16 v[80:81], v5 offset:10240
    v_mfma_f32_16x16x32_bf16 v[164:167], v[60:63], a[180:183], v[164:167]
    buffer_load_dwordx4 v36, s[16:19], s37 offen offset:1024 lds
    v_mfma_f32_16x16x32_bf16 v[164:167], v[56:59], a[164:167], v[164:167]
    ds_read_b64_tr_b16 v[82:83], v93 offset:26624
    ds_read_b64_tr_b16 v[84:85], v5 offset:11264
    v_mfma_f32_16x16x32_bf16 v[164:167], v[52:55], a[148:151], v[164:167]
    ds_read_b64_tr_b16 v[86:87], v93 offset:27648
    v_mul_f32 v132, v132, v35
    v_mfma_f32_16x16x32_bf16 v[164:167], v[48:51], a[132:135], v[164:167]
    v_mul_f32 v133, v133, v35
    v_mul_f32 v134, v134, v35
    v_mfma_f32_16x16x32_bf16 v[164:167], v[44:47], a[116:119], v[164:167]
    s_mov_b32 s37, 6144
    v_mul_f32 v135, v135, v35
    v_mul_f32 v140, v140, v35
    v_mfma_f32_16x16x32_bf16 v[164:167], v[40:43], a[100:103], v[164:167]
    s_waitcnt lgkmcnt(0)
    ds_read_b64_tr_b16 v[40:41], v4 offset:47104
    ds_read_b64_tr_b16 v[42:43], v92 offset:63488
    v_mfma_f32_16x16x32_bf16 v[172:175], v[64:67], a[100:103], v[172:175]
    ds_read_b64_tr_b16 v[44:45], v4 offset:48128
    v_mul_f32 v141, v141, v35
    v_mfma_f32_16x16x32_bf16 v[172:175], v[68:71], a[116:119], v[172:175]
    ds_read_b64_tr_b16 v[46:47], v92 offset:64512
    v_mul_f32 v142, v142, v35
    v_mfma_f32_16x16x32_bf16 v[172:175], v[72:75], a[132:135], v[172:175]
    buffer_load_dwordx4 v36, s[16:19], s37 offen offset:2048 lds
    v_mfma_f32_16x16x32_bf16 v[172:175], v[76:79], a[148:151], v[172:175]
    ds_read_b64_tr_b16 v[48:49], v4 offset:49152
    ds_read_b64_tr_b16 v[50:51], v94 offset:0
    v_mfma_f32_16x16x32_bf16 v[172:175], v[80:83], a[164:167], v[172:175]
    ds_read_b64_tr_b16 v[52:53], v4 offset:50176
    v_mul_f32 v143, v143, v35
    v_mfma_f32_16x16x32_bf16 v[172:175], v[84:87], a[180:183], v[172:175]
    ds_read_b64_tr_b16 v[54:55], v94 offset:1024
    ds_read_b64_tr_b16 v[56:57], v4 offset:51200
    v_mfma_f32_16x16x32_bf16 v[168:171], v[84:87], a[176:179], v[168:171]
    ds_read_b64_tr_b16 v[58:59], v94 offset:2048
    v_cvt_pk_bf16_f32 v108, v132, v133
    v_mfma_f32_16x16x32_bf16 v[168:171], v[80:83], a[160:163], v[168:171]
    s_mov_b32 s37, 9216
    ds_read_b64_tr_b16 v[60:61], v4 offset:52224
    ds_read_b64_tr_b16 v[62:63], v94 offset:3072
    v_mfma_f32_16x16x32_bf16 v[168:171], v[76:79], a[144:147], v[168:171]
    v_cvt_pk_bf16_f32 v109, v134, v135
    v_cvt_pk_bf16_f32 v110, v140, v141
    v_mfma_f32_16x16x32_bf16 v[168:171], v[72:75], a[128:131], v[168:171]
    v_cvt_pk_bf16_f32 v111, v142, v143
    v_mul_f32 v112, v112, v32
    v_mfma_f32_16x16x32_bf16 v[168:171], v[68:71], a[112:115], v[168:171]
    v_mul_f32 v113, v113, v32
    v_mul_f32 v114, v114, v32
    v_mfma_f32_16x16x32_bf16 v[168:171], v[64:67], a[96:99], v[168:171]
    s_waitcnt lgkmcnt(0)
    ds_read_b64_tr_b16 v[64:65], v5 offset:47104
    ds_read_b64_tr_b16 v[66:67], v93 offset:63488
    v_mfma_f32_16x16x32_bf16 v[176:179], v[40:43], a[96:99], v[176:179]
    buffer_load_dwordx4 v36, s[16:19], s37 offen offset:3072 lds
    v_mfma_f32_16x16x32_bf16 v[176:179], v[44:47], a[112:115], v[176:179]
    ds_read_b64_tr_b16 v[68:69], v5 offset:48128
    ds_read_b64_tr_b16 v[70:71], v93 offset:64512
    v_mfma_f32_16x16x32_bf16 v[176:179], v[48:51], a[128:131], v[176:179]
    ds_read_b64_tr_b16 v[72:73], v5 offset:49152
    v_mul_f32 v115, v115, v32
    v_mfma_f32_16x16x32_bf16 v[176:179], v[52:55], a[144:147], v[176:179]
    ds_read_b64_tr_b16 v[74:75], v95 offset:0
    ds_read_b64_tr_b16 v[76:77], v5 offset:50176
    v_mfma_f32_16x16x32_bf16 v[176:179], v[56:59], a[160:163], v[176:179]
    ds_read_b64_tr_b16 v[78:79], v95 offset:1024
    v_mul_f32 v120, v120, v32
    v_mfma_f32_16x16x32_bf16 v[176:179], v[60:63], a[176:179], v[176:179]
    ds_read_b64_tr_b16 v[80:81], v5 offset:51200
    ds_read_b64_tr_b16 v[82:83], v95 offset:2048
    v_mfma_f32_16x16x32_bf16 v[180:183], v[60:63], a[180:183], v[180:183]
    ds_read_b64_tr_b16 v[84:85], v5 offset:52224
    v_mul_f32 v121, v121, v32
    v_mfma_f32_16x16x32_bf16 v[180:183], v[56:59], a[164:167], v[180:183]
    ds_read_b64_tr_b16 v[86:87], v95 offset:3072
    v_mul_f32 v122, v122, v32
    v_mfma_f32_16x16x32_bf16 v[180:183], v[52:55], a[148:151], v[180:183]
    v_mul_f32 v123, v123, v32
    v_cvt_pk_bf16_f32 v112, v112, v113
    v_mfma_f32_16x16x32_bf16 v[180:183], v[48:51], a[132:135], v[180:183]
    v_cvt_pk_bf16_f32 v113, v114, v115
    v_cvt_pk_bf16_f32 v114, v120, v121
    v_mfma_f32_16x16x32_bf16 v[180:183], v[44:47], a[116:119], v[180:183]
    v_cvt_pk_bf16_f32 v115, v122, v123
    v_mul_f32 v116, v116, v33
    v_mfma_f32_16x16x32_bf16 v[180:183], v[40:43], a[100:103], v[180:183]
    s_waitcnt lgkmcnt(0)
    s_waitcnt vmcnt(24)
    s_barrier
    v_mfma_f32_16x16x32_bf16 v[188:191], v[64:67], a[100:103], v[188:191]
    s_add_u32 m0, s33, 0x0
    ds_read_b64_tr_b16 v[40:41], v4 offset:12288
    ds_read_b64_tr_b16 v[42:43], v92 offset:28672
    v_mfma_f32_16x16x32_bf16 v[188:191], v[68:71], a[116:119], v[188:191]
    ds_read_b64_tr_b16 v[44:45], v4 offset:13312
    ds_read_b64_tr_b16 v[46:47], v92 offset:29696
    v_mfma_f32_16x16x32_bf16 v[188:191], v[72:75], a[132:135], v[188:191]
    ds_read_b64_tr_b16 v[48:49], v4 offset:14336
    ds_read_b64_tr_b16 v[50:51], v92 offset:30720
    v_mfma_f32_16x16x32_bf16 v[188:191], v[76:79], a[148:151], v[188:191]
    s_mov_b32 s37, 0x4000
    ds_read_b64_tr_b16 v[52:53], v4 offset:15360
    ds_read_b64_tr_b16 v[54:55], v92 offset:31744
    v_mfma_f32_16x16x32_bf16 v[188:191], v[80:83], a[164:167], v[188:191]
    ds_read_b64_tr_b16 v[56:57], v4 offset:16384
    v_mul_f32 v117, v117, v33
    v_mfma_f32_16x16x32_bf16 v[188:191], v[84:87], a[180:183], v[188:191]
    buffer_load_dwordx4 v36, s[16:19], s37 offen offset:0 lds
    v_mfma_f32_16x16x32_bf16 v[184:187], v[84:87], a[176:179], v[184:187]
    ds_read_b64_tr_b16 v[58:59], v92 offset:32768
    ds_read_b64_tr_b16 v[60:61], v4 offset:17408
    v_mfma_f32_16x16x32_bf16 v[184:187], v[80:83], a[160:163], v[184:187]
    s_mov_b32 s37, 0x4c00
    ds_read_b64_tr_b16 v[62:63], v92 offset:33792
    v_mul_f32 v118, v118, v33
    v_mfma_f32_16x16x32_bf16 v[184:187], v[76:79], a[144:147], v[184:187]
    v_mul_f32 v119, v119, v33
    v_mul_f32 v124, v124, v33
    v_mfma_f32_16x16x32_bf16 v[184:187], v[72:75], a[128:131], v[184:187]
    buffer_load_dwordx4 v36, s[16:19], s37 offen offset:1024 lds
    v_mfma_f32_16x16x32_bf16 v[184:187], v[68:71], a[112:115], v[184:187]
    v_mul_f32 v125, v125, v33
    v_mul_f32 v126, v126, v33
    v_mfma_f32_16x16x32_bf16 v[184:187], v[64:67], a[96:99], v[184:187]
    s_waitcnt lgkmcnt(0)
    s_mov_b32 s37, 0x0
    ds_read_b64_tr_b16 v[64:65], v5 offset:12288
    v_mfma_f32_16x16x32_bf16 v[160:163], v[40:43], a[192:195], v[160:163]
    ds_read_b64_tr_b16 v[66:67], v93 offset:28672
    ds_read_b64_tr_b16 v[68:69], v5 offset:13312
    v_mfma_f32_16x16x32_bf16 v[160:163], v[44:47], a[208:211], v[160:163]
    buffer_load_dwordx4 v37, s[20:23], s37 offen offset:2048 lds
    v_mfma_f32_16x16x32_bf16 v[160:163], v[48:51], a[224:227], v[160:163]
    ds_read_b64_tr_b16 v[70:71], v93 offset:29696
    v_mul_f32 v127, v127, v33
    v_mfma_f32_16x16x32_bf16 v[160:163], v[52:55], a[240:243], v[160:163]
    ds_read_b64_tr_b16 v[72:73], v5 offset:14336
    ds_read_b64_tr_b16 v[74:75], v93 offset:30720
    v_mfma_f32_16x16x32_bf16 v[160:163], v[56:59], v[224:227], v[160:163]
    s_mov_b32 s37, 0xc00
    ds_read_b64_tr_b16 v[76:77], v5 offset:15360
    v_cvt_pk_bf16_f32 v116, v116, v117
    v_mfma_f32_16x16x32_bf16 v[160:163], v[60:63], v[240:243], v[160:163]
    ds_read_b64_tr_b16 v[78:79], v93 offset:31744
    ds_read_b64_tr_b16 v[80:81], v5 offset:16384
    v_mfma_f32_16x16x32_bf16 v[164:167], v[60:63], v[244:247], v[164:167]
    buffer_load_dwordx4 v37, s[20:23], s37 offen offset:3072 lds
    v_mfma_f32_16x16x32_bf16 v[164:167], v[56:59], v[228:231], v[164:167]
    ds_read_b64_tr_b16 v[82:83], v93 offset:32768
    ds_read_b64_tr_b16 v[84:85], v5 offset:17408
    v_mfma_f32_16x16x32_bf16 v[164:167], v[52:55], a[244:247], v[164:167]
    s_add_u32 m0, s33, 0x1000
    ds_read_b64_tr_b16 v[86:87], v93 offset:33792
    v_cvt_pk_bf16_f32 v117, v118, v119
    v_mfma_f32_16x16x32_bf16 v[164:167], v[48:51], a[228:231], v[164:167]
    v_cvt_pk_bf16_f32 v118, v124, v125
    v_cvt_pk_bf16_f32 v119, v126, v127
    v_mfma_f32_16x16x32_bf16 v[164:167], v[44:47], a[212:215], v[164:167]
    s_mov_b32 s37, 0x6000
    v_mul_f32 v144, v144, v34
    v_mul_f32 v145, v145, v34
    v_mfma_f32_16x16x32_bf16 v[164:167], v[40:43], a[196:199], v[164:167]
    s_waitcnt lgkmcnt(0)
    ds_read_b64_tr_b16 v[40:41], v4 offset:53248
    v_mul_f32 v146, v146, v34
    v_mfma_f32_16x16x32_bf16 v[172:175], v[64:67], a[196:199], v[172:175]
    buffer_load_dwordx4 v36, s[16:19], s37 offen offset:0 lds
    v_mfma_f32_16x16x32_bf16 v[172:175], v[68:71], a[212:215], v[172:175]
    ds_read_b64_tr_b16 v[42:43], v94 offset:4096
    ds_read_b64_tr_b16 v[44:45], v4 offset:54272
    v_mfma_f32_16x16x32_bf16 v[172:175], v[72:75], a[228:231], v[172:175]
    s_mov_b32 s37, 0x6c00
    ds_read_b64_tr_b16 v[46:47], v94 offset:5120
    v_mul_f32 v147, v147, v34
    v_mfma_f32_16x16x32_bf16 v[172:175], v[76:79], a[244:247], v[172:175]
    ds_read_b64_tr_b16 v[48:49], v4 offset:55296
    ds_read_b64_tr_b16 v[50:51], v94 offset:6144
    v_mfma_f32_16x16x32_bf16 v[172:175], v[80:83], v[228:231], v[172:175]
    ds_read_b64_tr_b16 v[52:53], v4 offset:56320
    v_mul_f32 v152, v152, v34
    v_mfma_f32_16x16x32_bf16 v[172:175], v[84:87], v[244:247], v[172:175]
    ds_read_b64_tr_b16 v[54:55], v94 offset:7168
    ds_read_b64_tr_b16 v[56:57], v4 offset:57344
    v_mfma_f32_16x16x32_bf16 v[168:171], v[84:87], v[240:243], v[168:171]
    buffer_load_dwordx4 v36, s[16:19], s37 offen offset:1024 lds
    v_mfma_f32_16x16x32_bf16 v[168:171], v[80:83], v[224:227], v[168:171]
    s_mov_b32 s37, 0x2000
    ds_read_b64_tr_b16 v[58:59], v94 offset:8192
    ds_read_b64_tr_b16 v[60:61], v4 offset:58368
    v_mfma_f32_16x16x32_bf16 v[168:171], v[76:79], a[240:243], v[168:171]
    ds_read_b64_tr_b16 v[62:63], v94 offset:9216
    v_mul_f32 v153, v153, v34
    v_mfma_f32_16x16x32_bf16 v[168:171], v[72:75], a[224:227], v[168:171]
    buffer_load_dwordx4 v37, s[20:23], s37 offen offset:2048 lds
    v_mfma_f32_16x16x32_bf16 v[168:171], v[68:71], a[208:211], v[168:171]
    v_mul_f32 v154, v154, v34
    v_mul_f32 v155, v155, v34
    v_mfma_f32_16x16x32_bf16 v[168:171], v[64:67], a[192:195], v[168:171]
    s_waitcnt lgkmcnt(0)
    s_mov_b32 s37, 0x2c00
    v_cvt_pk_bf16_f32 v120, v144, v145
    v_mfma_f32_16x16x32_bf16 v[176:179], v[40:43], a[192:195], v[176:179]
    ds_read_b64_tr_b16 v[64:65], v5 offset:53248
    v_cvt_pk_bf16_f32 v121, v146, v147
    v_mfma_f32_16x16x32_bf16 v[176:179], v[44:47], a[208:211], v[176:179]
    ds_read_b64_tr_b16 v[66:67], v95 offset:4096
    ds_read_b64_tr_b16 v[68:69], v5 offset:54272
    v_mfma_f32_16x16x32_bf16 v[176:179], v[48:51], a[224:227], v[176:179]
    buffer_load_dwordx4 v37, s[20:23], s37 offen offset:3072 lds
    v_mfma_f32_16x16x32_bf16 v[176:179], v[52:55], a[240:243], v[176:179]
    ds_read_b64_tr_b16 v[70:71], v95 offset:5120
    ds_read_b64_tr_b16 v[72:73], v5 offset:55296
    v_mfma_f32_16x16x32_bf16 v[176:179], v[56:59], v[224:227], v[176:179]
    ds_read_b64_tr_b16 v[74:75], v95 offset:6144
    ds_read_b64_tr_b16 v[76:77], v5 offset:56320
    v_mfma_f32_16x16x32_bf16 v[176:179], v[60:63], v[240:243], v[176:179]
    ds_read_b64_tr_b16 v[78:79], v95 offset:7168
    ds_read_b64_tr_b16 v[80:81], v5 offset:57344
    v_mfma_f32_16x16x32_bf16 v[180:183], v[60:63], v[244:247], v[180:183]
    ds_read_b64_tr_b16 v[82:83], v95 offset:8192
    v_cvt_pk_bf16_f32 v122, v152, v153
    v_mfma_f32_16x16x32_bf16 v[180:183], v[56:59], v[228:231], v[180:183]
    ds_read_b64_tr_b16 v[84:85], v5 offset:58368
    ds_read_b64_tr_b16 v[86:87], v95 offset:9216
    v_mfma_f32_16x16x32_bf16 v[180:183], v[52:55], a[244:247], v[180:183]
    v_cvt_pk_bf16_f32 v123, v154, v155
    v_mul_f32 v148, v148, v35
    v_mfma_f32_16x16x32_bf16 v[180:183], v[48:51], a[228:231], v[180:183]
    v_mul_f32 v149, v149, v35
    v_mul_f32 v150, v150, v35
    v_mfma_f32_16x16x32_bf16 v[180:183], v[44:47], a[212:215], v[180:183]
    v_mul_f32 v151, v151, v35
    v_mul_f32 v156, v156, v35
    v_mfma_f32_16x16x32_bf16 v[180:183], v[40:43], a[196:199], v[180:183]
    s_waitcnt lgkmcnt(0)
    s_waitcnt vmcnt(25)
    s_barrier
    v_mfma_f32_16x16x32_bf16 v[188:191], v[64:67], a[196:199], v[188:191]
    s_add_u32 m0, s33, 0x2000
    ds_read_b64_tr_b16 v[40:41], v6 offset:18432
    v_mul_f32 v157, v157, v35
    v_mfma_f32_16x16x32_bf16 v[188:191], v[68:71], a[212:215], v[188:191]
    ds_read_b64_tr_b16 v[42:43], v6 offset:18944
    ds_read_b64_tr_b16 v[44:45], v6 offset:19456
    v_mfma_f32_16x16x32_bf16 v[188:191], v[72:75], a[228:231], v[188:191]
    ds_read_b64_tr_b16 v[46:47], v6 offset:19968
    v_mul_f32 v158, v158, v35
    v_mfma_f32_16x16x32_bf16 v[188:191], v[76:79], a[244:247], v[188:191]
    ds_read_b64_tr_b16 v[48:49], v6 offset:20480
    ds_read_b64_tr_b16 v[50:51], v6 offset:20992
    v_mfma_f32_16x16x32_bf16 v[188:191], v[80:83], v[228:231], v[188:191]
    ds_read_b64_tr_b16 v[52:53], v6 offset:21504
    v_mul_f32 v159, v159, v35
    v_mfma_f32_16x16x32_bf16 v[188:191], v[84:87], v[244:247], v[188:191]
    s_mov_b32 s37, 0x8000
    ds_read_b64_tr_b16 v[54:55], v6 offset:22016
    ds_read_b64_tr_b16 v[56:57], v6 offset:22528
    v_mfma_f32_16x16x32_bf16 v[184:187], v[84:87], v[240:243], v[184:187]
    ds_read_b64_tr_b16 v[58:59], v6 offset:23040
    v_cvt_pk_bf16_f32 v124, v148, v149
    v_mfma_f32_16x16x32_bf16 v[184:187], v[80:83], v[224:227], v[184:187]
    ds_read_b64_tr_b16 v[60:61], v6 offset:23552
    ds_read_b64_tr_b16 v[62:63], v6 offset:24064
    v_mfma_f32_16x16x32_bf16 v[184:187], v[76:79], a[240:243], v[184:187]
    v_cvt_pk_bf16_f32 v125, v150, v151
    v_cvt_pk_bf16_f32 v126, v156, v157
    v_mfma_f32_16x16x32_bf16 v[184:187], v[72:75], a[224:227], v[184:187]
    buffer_load_dwordx4 v36, s[16:19], s37 offen offset:0 lds
    v_mfma_f32_16x16x32_bf16 v[184:187], v[68:71], a[208:211], v[184:187]
    v_cvt_pk_bf16_f32 v127, v158, v159
    v_mul_f32 v24, v160, v160
    v_mfma_f32_16x16x32_bf16 v[184:187], v[64:67], a[192:195], v[184:187]
    s_waitcnt lgkmcnt(0)
    ds_read_b64_tr_b16 v[64:65], v6 offset:18440
    ds_read_b64_tr_b16 v[66:67], v6 offset:18952
    v_mfma_f32_16x16x32_bf16 v[192:195], v[40:43], a[0:3], 0
    ds_read_b64_tr_b16 v[68:69], v6 offset:19464
    v_mul_f32 v26, v161, v161
    v_mfma_f32_16x16x32_bf16 v[192:195], v[44:47], a[16:19], v[192:195]
    s_mov_b32 s37, 0x8c00
    ds_read_b64_tr_b16 v[70:71], v6 offset:19976
    v_fma_f32 v24, v24, v12, v8
    v_mfma_f32_16x16x32_bf16 v[192:195], v[48:51], a[32:35], v[192:195]
    ds_read_b64_tr_b16 v[72:73], v6 offset:20488
    v_fma_f32 v26, v26, v12, v8
    v_mfma_f32_16x16x32_bf16 v[192:195], v[52:55], a[48:51], v[192:195]
    ds_read_b64_tr_b16 v[74:75], v6 offset:21000
    v_mul_f32 v24, v24, v160
    v_mfma_f32_16x16x32_bf16 v[192:195], v[56:59], a[64:67], v[192:195]
    ds_read_b64_tr_b16 v[76:77], v6 offset:21512
    v_mul_f32 v26, v26, v161
    v_mfma_f32_16x16x32_bf16 v[192:195], v[60:63], a[80:83], v[192:195]
    buffer_load_dwordx4 v36, s[16:19], s37 offen offset:1024 lds
    v_mfma_f32_16x16x32_bf16 v[196:199], v[60:63], a[84:87], 0
    ds_read_b64_tr_b16 v[78:79], v6 offset:22024
    v_mul_f32 v25, v160, v176
    v_mfma_f32_16x16x32_bf16 v[196:199], v[56:59], a[68:71], v[196:199]
    ds_read_b64_tr_b16 v[80:81], v6 offset:22536
    v_mul_f32 v27, v161, v177
    v_mfma_f32_16x16x32_bf16 v[196:199], v[52:55], a[52:55], v[196:199]
    v_exp_f32 v24, v24
    v_mfma_f32_16x16x32_bf16 v[196:199], v[48:51], a[36:39], v[196:199]
    s_mov_b32 s37, 0x4000
    v_exp_f32 v26, v26
    v_mfma_f32_16x16x32_bf16 v[196:199], v[44:47], a[20:23], v[196:199]
    ds_read_b64_tr_b16 v[82:83], v6 offset:23048
    v_fma_f32 v24, v24, v16, v16
    v_mfma_f32_16x16x32_bf16 v[196:199], v[40:43], a[4:7], v[196:199]
    ds_read_b64_tr_b16 v[84:85], v6 offset:23560
    v_fma_f32 v26, v26, v16, v16
    v_mfma_f32_16x16x32_bf16 v[128:131], v[40:43], a[8:11], 0
    v_rcp_f32 v24, v24
    v_mfma_f32_16x16x32_bf16 v[128:131], v[44:47], a[24:27], v[128:131]
    buffer_load_dwordx4 v37, s[20:23], s37 offen offset:2048 lds
    v_mfma_f32_16x16x32_bf16 v[128:131], v[48:51], a[40:43], v[128:131]
    ds_read_b64_tr_b16 v[86:87], v6 offset:24072
    v_mul_f32 v25, v25, v24
    v_mfma_f32_16x16x32_bf16 v[128:131], v[52:55], a[56:59], v[128:131]
    v_rcp_f32 v26, v26
    v_mfma_f32_16x16x32_bf16 v[128:131], v[56:59], a[72:75], v[128:131]
    v_mul_f32 v27, v27, v26
    v_cvt_pk_bf16_f32 v88, v25, v27
    v_mfma_f32_16x16x32_bf16 v[128:131], v[60:63], a[88:91], v[128:131]
    v_mul_f32 v28, v162, v162
    v_mul_f32 v30, v163, v163
    v_mfma_f32_16x16x32_bf16 v[132:135], v[60:63], a[92:95], 0
    s_mov_b32 s37, 0x4c00
    v_fma_f32 v28, v28, v12, v8
    v_fma_f32 v30, v30, v12, v8
    v_mfma_f32_16x16x32_bf16 v[132:135], v[56:59], a[76:79], v[132:135]
    v_mul_f32 v28, v28, v162
    v_mul_f32 v30, v30, v163
    v_mfma_f32_16x16x32_bf16 v[132:135], v[52:55], a[60:63], v[132:135]
    v_mul_f32 v29, v162, v178
    v_mul_f32 v31, v163, v179
    v_mfma_f32_16x16x32_bf16 v[132:135], v[48:51], a[44:47], v[132:135]
    v_exp_f32 v28, v28
    v_mfma_f32_16x16x32_bf16 v[132:135], v[44:47], a[28:31], v[132:135]
    buffer_load_dwordx4 v37, s[20:23], s37 offen offset:3072 lds
    v_mfma_f32_16x16x32_bf16 v[132:135], v[40:43], a[12:15], v[132:135]
    s_waitcnt lgkmcnt(0)
    ds_read_b64_tr_b16 v[40:41], v7 offset:18432
    ds_read_b64_tr_b16 v[42:43], v7 offset:18944
    v_mfma_f32_16x16x32_bf16 v[140:143], v[64:67], a[12:15], 0
    ds_read_b64_tr_b16 v[44:45], v7 offset:19456
    ds_read_b64_tr_b16 v[46:47], v7 offset:19968
    v_mfma_f32_16x16x32_bf16 v[140:143], v[68:71], a[28:31], v[140:143]
    v_exp_f32 v30, v30
    v_mfma_f32_16x16x32_bf16 v[140:143], v[72:75], a[44:47], v[140:143]
    s_add_u32 m0, s33, 0x3000
    ds_read_b64_tr_b16 v[48:49], v7 offset:20480
    v_fma_f32 v28, v28, v16, v16
    v_mfma_f32_16x16x32_bf16 v[140:143], v[76:79], a[60:63], v[140:143]
    ds_read_b64_tr_b16 v[50:51], v7 offset:20992
    v_fma_f32 v30, v30, v16, v16
    v_mfma_f32_16x16x32_bf16 v[140:143], v[80:83], a[76:79], v[140:143]
    v_rcp_f32 v28, v28
    v_mfma_f32_16x16x32_bf16 v[140:143], v[84:87], a[92:95], v[140:143]
    ds_read_b64_tr_b16 v[52:53], v7 offset:21504
    ds_read_b64_tr_b16 v[54:55], v7 offset:22016
    v_mfma_f32_16x16x32_bf16 v[136:139], v[84:87], a[88:91], 0
    s_mov_b32 s37, 0xa000
    v_rcp_f32 v30, v30
    v_mfma_f32_16x16x32_bf16 v[136:139], v[80:83], a[72:75], v[136:139]
    ds_read_b64_tr_b16 v[56:57], v7 offset:22528
    v_mul_f32 v29, v29, v28
    v_mfma_f32_16x16x32_bf16 v[136:139], v[76:79], a[56:59], v[136:139]
    ds_read_b64_tr_b16 v[58:59], v7 offset:23040
    v_mul_f32 v31, v31, v30
    v_mfma_f32_16x16x32_bf16 v[136:139], v[72:75], a[40:43], v[136:139]
    ds_read_b64_tr_b16 v[60:61], v7 offset:23552
    v_cvt_pk_bf16_f32 v89, v29, v31
    v_mfma_f32_16x16x32_bf16 v[136:139], v[68:71], a[24:27], v[136:139]
    buffer_load_dwordx4 v36, s[16:19], s37 offen offset:0 lds
    v_mfma_f32_16x16x32_bf16 v[136:139], v[64:67], a[8:11], v[136:139]
    ds_read_b64_tr_b16 v[62:63], v7 offset:24064
    v_mul_f32 v20, v168, v168
    v_mfma_f32_16x16x32_bf16 v[204:207], v[64:67], a[4:7], 0
    v_mul_f32 v22, v169, v169
    v_fma_f32 v20, v20, v12, v8
    v_mfma_f32_16x16x32_bf16 v[204:207], v[68:71], a[20:23], v[204:207]
    v_fma_f32 v22, v22, v12, v8
    v_mul_f32 v20, v20, v168
    v_mfma_f32_16x16x32_bf16 v[204:207], v[72:75], a[36:39], v[204:207]
    s_mov_b32 s37, 0xac00
    v_mul_f32 v22, v22, v169
    v_mul_f32 v21, v168, v184
    v_mfma_f32_16x16x32_bf16 v[204:207], v[76:79], a[52:55], v[204:207]
    v_exp_f32 v20, v20
    v_mfma_f32_16x16x32_bf16 v[204:207], v[80:83], a[68:71], v[204:207]
    v_mul_f32 v23, v169, v185
    v_fma_f32 v20, v20, v16, v16
    v_mfma_f32_16x16x32_bf16 v[204:207], v[84:87], a[84:87], v[204:207]
    v_exp_f32 v22, v22
    v_mfma_f32_16x16x32_bf16 v[200:203], v[84:87], a[80:83], 0
    v_rcp_f32 v20, v20
    v_mfma_f32_16x16x32_bf16 v[200:203], v[80:83], a[64:67], v[200:203]
    buffer_load_dwordx4 v36, s[16:19], s37 offen offset:1024 lds
    v_mfma_f32_16x16x32_bf16 v[200:203], v[76:79], a[48:51], v[200:203]
    v_fma_f32 v22, v22, v16, v16
    v_mfma_f32_16x16x32_bf16 v[200:203], v[72:75], a[32:35], v[200:203]
    v_rcp_f32 v22, v22
    v_mfma_f32_16x16x32_bf16 v[200:203], v[68:71], a[16:19], v[200:203]
    v_mul_f32 v21, v21, v20
    v_mul_f32 v23, v23, v22
    v_mfma_f32_16x16x32_bf16 v[200:203], v[64:67], a[0:3], v[200:203]
    s_mov_b32 s37, 0x6000
    s_waitcnt lgkmcnt(0)
    ds_read_b64_tr_b16 v[64:65], v7 offset:18440
    v_mfma_f32_16x16x32_bf16 v[208:211], v[40:43], a[0:3], 0
    ds_read_b64_tr_b16 v[66:67], v7 offset:18952
    ds_read_b64_tr_b16 v[68:69], v7 offset:19464
    v_mfma_f32_16x16x32_bf16 v[208:211], v[44:47], a[16:19], v[208:211]
    ds_read_b64_tr_b16 v[70:71], v7 offset:19976
    ds_read_b64_tr_b16 v[72:73], v7 offset:20488
    v_mfma_f32_16x16x32_bf16 v[208:211], v[48:51], a[32:35], v[208:211]
    ds_read_b64_tr_b16 v[74:75], v7 offset:21000
    v_cvt_pk_bf16_f32 v90, v21, v23
    v_mfma_f32_16x16x32_bf16 v[208:211], v[52:55], a[48:51], v[208:211]
    buffer_load_dwordx4 v37, s[20:23], s37 offen offset:2048 lds
    v_mfma_f32_16x16x32_bf16 v[208:211], v[56:59], a[64:67], v[208:211]
    ds_read_b64_tr_b16 v[76:77], v7 offset:21512
    v_mul_f32 v24, v170, v170
    v_mfma_f32_16x16x32_bf16 v[208:211], v[60:63], a[80:83], v[208:211]
    ds_read_b64_tr_b16 v[78:79], v7 offset:22024
    v_mul_f32 v26, v171, v171
    v_mfma_f32_16x16x32_bf16 v[212:215], v[60:63], a[84:87], 0
    ds_read_b64_tr_b16 v[80:81], v7 offset:22536
    v_fma_f32 v24, v24, v12, v8
    v_mfma_f32_16x16x32_bf16 v[212:215], v[56:59], a[68:71], v[212:215]
    s_mov_b32 s37, 0x6c00
    ds_read_b64_tr_b16 v[82:83], v7 offset:23048
    v_fma_f32 v26, v26, v12, v8
    v_mfma_f32_16x16x32_bf16 v[212:215], v[52:55], a[52:55], v[212:215]
    ds_read_b64_tr_b16 v[84:85], v7 offset:23560
    v_mul_f32 v24, v24, v170
    v_mfma_f32_16x16x32_bf16 v[212:215], v[48:51], a[36:39], v[212:215]
    ds_read_b64_tr_b16 v[86:87], v7 offset:24072
    v_mul_f32 v26, v26, v171
    v_mfma_f32_16x16x32_bf16 v[212:215], v[44:47], a[20:23], v[212:215]
    v_mul_f32 v25, v170, v186
    v_mul_f32 v27, v171, v187
    v_mfma_f32_16x16x32_bf16 v[212:215], v[40:43], a[4:7], v[212:215]
    buffer_load_dwordx4 v37, s[20:23], s37 offen offset:3072 lds
    v_mfma_f32_16x16x32_bf16 v[144:147], v[40:43], a[8:11], 0
    v_exp_f32 v24, v24
    v_mfma_f32_16x16x32_bf16 v[144:147], v[44:47], a[24:27], v[144:147]
    v_exp_f32 v26, v26
    v_mfma_f32_16x16x32_bf16 v[144:147], v[48:51], a[40:43], v[144:147]
    v_fma_f32 v24, v24, v16, v16
    v_fma_f32 v26, v26, v16, v16
    v_mfma_f32_16x16x32_bf16 v[144:147], v[52:55], a[56:59], v[144:147]
    v_rcp_f32 v24, v24
    v_mfma_f32_16x16x32_bf16 v[144:147], v[56:59], a[72:75], v[144:147]
    v_rcp_f32 v26, v26
    v_mfma_f32_16x16x32_bf16 v[144:147], v[60:63], a[88:91], v[144:147]
    v_mul_f32 v25, v25, v24
    v_mul_f32 v27, v27, v26
    v_mfma_f32_16x16x32_bf16 v[148:151], v[60:63], a[92:95], 0
    v_cvt_pk_bf16_f32 v91, v25, v27
    v_mfma_f32_16x16x32_bf16 v[148:151], v[56:59], a[76:79], v[148:151]
    v_mfma_f32_16x16x32_bf16 v[148:151], v[52:55], a[60:63], v[148:151]
    v_mul_f32 v28, v164, v164
    v_mfma_f32_16x16x32_bf16 v[148:151], v[48:51], a[44:47], v[148:151]
    v_mul_f32 v30, v165, v165
    v_mfma_f32_16x16x32_bf16 v[148:151], v[44:47], a[28:31], v[148:151]
    v_fma_f32 v28, v28, v13, v9
    v_mfma_f32_16x16x32_bf16 v[148:151], v[40:43], a[12:15], v[148:151]
    s_waitcnt lgkmcnt(0)
    s_waitcnt vmcnt(26)
    s_barrier
    v_mfma_f32_16x16x32_bf16 v[156:159], v[64:67], a[12:15], 0
    s_add_u32 m0, s33, 0x4000
    ds_read_b64_tr_b16 v[40:41], v6 offset:24576
    ds_read_b64_tr_b16 v[42:43], v6 offset:25088
    v_mfma_f32_16x16x32_bf16 v[156:159], v[68:71], a[28:31], v[156:159]
    s_lshl_b32 s38, s35, 6
    s_add_u32 s38, s38, s40
    ds_read_b64_tr_b16 v[44:45], v6 offset:25600
    v_mfma_f32_16x16x32_bf16 v[156:159], v[72:75], a[44:47], v[156:159]
    s_add_u32 s38, s38, 0x80000
    ds_read_b64_tr_b16 v[46:47], v6 offset:26112
    ds_read_b64_tr_b16 v[48:49], v6 offset:26624
    v_mfma_f32_16x16x32_bf16 v[156:159], v[76:79], a[60:63], v[156:159]
    buffer_store_dwordx4 v[88:91], v1, s[28:31], s38 offen sc1
    v_mfma_f32_16x16x32_bf16 v[156:159], v[80:83], a[76:79], v[156:159]
    ds_read_b64_tr_b16 v[50:51], v6 offset:27136
    v_fma_f32 v30, v30, v13, v9
    v_mfma_f32_16x16x32_bf16 v[156:159], v[84:87], a[92:95], v[156:159]
    s_mov_b32 s37, 0xc000
    ds_read_b64_tr_b16 v[52:53], v6 offset:27648
    v_mul_f32 v28, v28, v164
    v_mfma_f32_16x16x32_bf16 v[152:155], v[84:87], a[88:91], 0
    ds_read_b64_tr_b16 v[54:55], v6 offset:28160
    v_mul_f32 v30, v30, v165
    v_mfma_f32_16x16x32_bf16 v[152:155], v[80:83], a[72:75], v[152:155]
    ds_read_b64_tr_b16 v[56:57], v6 offset:28672
    v_mul_f32 v29, v164, v180
    v_mfma_f32_16x16x32_bf16 v[152:155], v[76:79], a[56:59], v[152:155]
    ds_read_b64_tr_b16 v[58:59], v6 offset:29184
    v_mul_f32 v31, v165, v181
    v_mfma_f32_16x16x32_bf16 v[152:155], v[72:75], a[40:43], v[152:155]
    v_exp_f32 v28, v28
    v_mfma_f32_16x16x32_bf16 v[152:155], v[68:71], a[24:27], v[152:155]
    buffer_load_dwordx4 v36, s[16:19], s37 offen offset:0 lds
    v_mfma_f32_16x16x32_bf16 v[152:155], v[64:67], a[8:11], v[152:155]
    v_exp_f32 v30, v30
    v_mfma_f32_16x16x32_bf16 v[220:223], v[64:67], a[4:7], 0
    ds_read_b64_tr_b16 v[60:61], v6 offset:29696
    v_fma_f32 v28, v28, v17, v17
    v_mfma_f32_16x16x32_bf16 v[220:223], v[68:71], a[20:23], v[220:223]
    ds_read_b64_tr_b16 v[62:63], v6 offset:30208
    v_fma_f32 v30, v30, v17, v17
    v_mfma_f32_16x16x32_bf16 v[220:223], v[72:75], a[36:39], v[220:223]
    v_rcp_f32 v28, v28
    v_mfma_f32_16x16x32_bf16 v[220:223], v[76:79], a[52:55], v[220:223]
    s_mov_b32 s37, 0xcc00
    v_rcp_f32 v30, v30
    v_mfma_f32_16x16x32_bf16 v[220:223], v[80:83], a[68:71], v[220:223]
    v_mul_f32 v29, v29, v28
    v_mul_f32 v31, v31, v30
    v_mfma_f32_16x16x32_bf16 v[220:223], v[84:87], a[84:87], v[220:223]
    v_cvt_pk_bf16_f32 v88, v29, v31
    v_mul_f32 v20, v166, v166
    v_mfma_f32_16x16x32_bf16 v[216:219], v[84:87], a[80:83], 0
    v_mul_f32 v22, v167, v167
    v_fma_f32 v20, v20, v13, v9
    v_mfma_f32_16x16x32_bf16 v[216:219], v[80:83], a[64:67], v[216:219]
    v_fma_f32 v22, v22, v13, v9
    v_mul_f32 v20, v20, v166
    v_mfma_f32_16x16x32_bf16 v[216:219], v[76:79], a[48:51], v[216:219]
    buffer_load_dwordx4 v36, s[16:19], s37 offen offset:1024 lds
    v_mfma_f32_16x16x32_bf16 v[216:219], v[72:75], a[32:35], v[216:219]
    v_mul_f32 v22, v22, v167
    v_mul_f32 v21, v166, v182
    v_mfma_f32_16x16x32_bf16 v[216:219], v[68:71], a[16:19], v[216:219]
    v_mul_f32 v23, v167, v183
    v_accvgpr_write_b32 a4, v100
    v_mfma_f32_16x16x32_bf16 v[216:219], v[64:67], a[0:3], v[216:219]
    s_waitcnt lgkmcnt(0)
    ds_read_b64_tr_b16 v[64:65], v6 offset:24584
    ds_read_b64_tr_b16 v[66:67], v6 offset:25096
    v_mfma_f32_16x16x32_bf16 v[192:195], v[40:43], a[96:99], v[192:195]
    ds_read_b64_tr_b16 v[68:69], v6 offset:25608
    v_accvgpr_write_b32 a0, v96
    v_mfma_f32_16x16x32_bf16 v[192:195], v[44:47], a[112:115], v[192:195]
    s_mov_b32 s37, 0x8000
    ds_read_b64_tr_b16 v[70:71], v6 offset:26120
    v_accvgpr_write_b32 a1, v97
    v_mfma_f32_16x16x32_bf16 v[192:195], v[48:51], a[128:131], v[192:195]
    ds_read_b64_tr_b16 v[72:73], v6 offset:26632
    v_accvgpr_write_b32 a2, v98
    v_mfma_f32_16x16x32_bf16 v[192:195], v[52:55], a[144:147], v[192:195]
    v_exp_f32 v20, v20
    v_mfma_f32_16x16x32_bf16 v[192:195], v[56:59], a[160:163], v[192:195]
    ds_read_b64_tr_b16 v[74:75], v6 offset:27144
    v_accvgpr_write_b32 a3, v99
    v_mfma_f32_16x16x32_bf16 v[192:195], v[60:63], a[176:179], v[192:195]
    buffer_load_dwordx4 v37, s[20:23], s37 offen offset:2048 lds
    v_mfma_f32_16x16x32_bf16 v[196:199], v[60:63], a[180:183], v[196:199]
    v_exp_f32 v22, v22
    v_mfma_f32_16x16x32_bf16 v[196:199], v[56:59], a[164:167], v[196:199]
    ds_read_b64_tr_b16 v[76:77], v6 offset:27656
    v_accvgpr_write_b32 a5, v101
    v_mfma_f32_16x16x32_bf16 v[196:199], v[52:55], a[148:151], v[196:199]
    ds_read_b64_tr_b16 v[78:79], v6 offset:28168
    v_fma_f32 v20, v20, v17, v17
    v_mfma_f32_16x16x32_bf16 v[196:199], v[48:51], a[132:135], v[196:199]
    ds_read_b64_tr_b16 v[80:81], v6 offset:28680
    v_fma_f32 v22, v22, v17, v17
    v_mfma_f32_16x16x32_bf16 v[196:199], v[44:47], a[116:119], v[196:199]
    s_mov_b32 s37, 0x8c00
    ds_read_b64_tr_b16 v[82:83], v6 offset:29192
    v_accvgpr_write_b32 a6, v102
    v_mfma_f32_16x16x32_bf16 v[196:199], v[40:43], a[100:103], v[196:199]
    v_rcp_f32 v20, v20
    v_mfma_f32_16x16x32_bf16 v[128:131], v[40:43], a[104:107], v[128:131]
    ds_read_b64_tr_b16 v[84:85], v6 offset:29704
    v_accvgpr_write_b32 a7, v103
    v_mfma_f32_16x16x32_bf16 v[128:131], v[44:47], a[120:123], v[128:131]
    v_rcp_f32 v22, v22
    v_mfma_f32_16x16x32_bf16 v[128:131], v[48:51], a[136:139], v[128:131]
    ds_read_b64_tr_b16 v[86:87], v6 offset:30216
    v_accvgpr_write_b32 a8, v104
    v_mfma_f32_16x16x32_bf16 v[128:131], v[52:55], a[152:155], v[128:131]
    buffer_load_dwordx4 v37, s[20:23], s37 offen offset:3072 lds
    v_mfma_f32_16x16x32_bf16 v[128:131], v[56:59], a[168:171], v[128:131]
    v_accvgpr_write_b32 a9, v105
    v_mul_f32 v21, v21, v20
    v_mfma_f32_16x16x32_bf16 v[128:131], v[60:63], a[184:187], v[128:131]
    v_accvgpr_write_b32 a10, v106
    v_mul_f32 v23, v23, v22
    v_mfma_f32_16x16x32_bf16 v[132:135], v[60:63], a[188:191], v[132:135]
    v_cvt_pk_bf16_f32 v89, v21, v23
    v_accvgpr_write_b32 a11, v107
    v_mfma_f32_16x16x32_bf16 v[132:135], v[56:59], a[172:175], v[132:135]
    v_mul_f32 v24, v172, v172
    v_accvgpr_write_b32 a12, v108
    v_mfma_f32_16x16x32_bf16 v[132:135], v[52:55], a[156:159], v[132:135]
    s_add_u32 m0, s33, 0x5000
    v_mul_f32 v26, v173, v173
    v_fma_f32 v24, v24, v13, v9
    v_mfma_f32_16x16x32_bf16 v[132:135], v[48:51], a[140:143], v[132:135]
    v_accvgpr_write_b32 a13, v109
    v_fma_f32 v26, v26, v13, v9
    v_mfma_f32_16x16x32_bf16 v[132:135], v[44:47], a[124:127], v[132:135]
    v_accvgpr_write_b32 a14, v110
    v_mul_f32 v24, v24, v172
    v_mfma_f32_16x16x32_bf16 v[132:135], v[40:43], a[108:111], v[132:135]
    s_waitcnt lgkmcnt(0)
    ds_read_b64_tr_b16 v[40:41], v7 offset:24576
    v_mul_f32 v26, v26, v173
    v_mfma_f32_16x16x32_bf16 v[140:143], v[64:67], a[108:111], v[140:143]
    ds_read_b64_tr_b16 v[42:43], v7 offset:25088
    v_accvgpr_write_b32 a15, v111
    v_mfma_f32_16x16x32_bf16 v[140:143], v[68:71], a[124:127], v[140:143]
    s_mov_b32 s37, 0xe000
    ds_read_b64_tr_b16 v[44:45], v7 offset:25600
    v_mul_f32 v25, v172, v188
    v_mfma_f32_16x16x32_bf16 v[140:143], v[72:75], a[140:143], v[140:143]
    ds_read_b64_tr_b16 v[46:47], v7 offset:26112
    v_accvgpr_write_b32 a16, v112
    v_mfma_f32_16x16x32_bf16 v[140:143], v[76:79], a[156:159], v[140:143]
    ds_read_b64_tr_b16 v[48:49], v7 offset:26624
    v_mul_f32 v27, v173, v189
    v_mfma_f32_16x16x32_bf16 v[140:143], v[80:83], a[172:175], v[140:143]
    ds_read_b64_tr_b16 v[50:51], v7 offset:27136
    v_accvgpr_write_b32 a17, v113
    v_mfma_f32_16x16x32_bf16 v[140:143], v[84:87], a[188:191], v[140:143]
    v_exp_f32 v24, v24
    v_mfma_f32_16x16x32_bf16 v[136:139], v[84:87], a[184:187], v[136:139]
    buffer_load_dwordx4 v36, s[16:19], s37 offen offset:0 lds
    v_mfma_f32_16x16x32_bf16 v[136:139], v[80:83], a[168:171], v[136:139]
    ds_read_b64_tr_b16 v[52:53], v7 offset:27648
    v_accvgpr_write_b32 a18, v114
    v_mfma_f32_16x16x32_bf16 v[136:139], v[76:79], a[152:155], v[136:139]
    v_exp_f32 v26, v26
    v_mfma_f32_16x16x32_bf16 v[136:139], v[72:75], a[136:139], v[136:139]
    ds_read_b64_tr_b16 v[54:55], v7 offset:28160
    v_accvgpr_write_b32 a19, v115
    v_mfma_f32_16x16x32_bf16 v[136:139], v[68:71], a[120:123], v[136:139]
    s_mov_b32 s37, 0xec00
    ds_read_b64_tr_b16 v[56:57], v7 offset:28672
    v_fma_f32 v24, v24, v17, v17
    v_mfma_f32_16x16x32_bf16 v[136:139], v[64:67], a[104:107], v[136:139]
    ds_read_b64_tr_b16 v[58:59], v7 offset:29184
    v_accvgpr_write_b32 a20, v116
    v_mfma_f32_16x16x32_bf16 v[204:207], v[64:67], a[100:103], v[204:207]
    ds_read_b64_tr_b16 v[60:61], v7 offset:29696
    v_fma_f32 v26, v26, v17, v17
    v_mfma_f32_16x16x32_bf16 v[204:207], v[68:71], a[116:119], v[204:207]
    ds_read_b64_tr_b16 v[62:63], v7 offset:30208
    v_accvgpr_write_b32 a21, v117
    v_mfma_f32_16x16x32_bf16 v[204:207], v[72:75], a[132:135], v[204:207]
    v_rcp_f32 v24, v24
    v_mfma_f32_16x16x32_bf16 v[204:207], v[76:79], a[148:151], v[204:207]
    buffer_load_dwordx4 v36, s[16:19], s37 offen offset:1024 lds
    v_mfma_f32_16x16x32_bf16 v[204:207], v[80:83], a[164:167], v[204:207]
    v_accvgpr_write_b32 a22, v118
    v_accvgpr_write_b32 a23, v119
    v_mfma_f32_16x16x32_bf16 v[204:207], v[84:87], a[180:183], v[204:207]
    v_rcp_f32 v26, v26
    v_mfma_f32_16x16x32_bf16 v[200:203], v[84:87], a[176:179], v[200:203]
    v_accvgpr_write_b32 a24, v120
    v_mul_f32 v25, v25, v24
    v_mfma_f32_16x16x32_bf16 v[200:203], v[80:83], a[160:163], v[200:203]
    v_mul_f32 v27, v27, v26
    v_accvgpr_write_b32 a25, v121
    v_mfma_f32_16x16x32_bf16 v[200:203], v[76:79], a[144:147], v[200:203]
    s_mov_b32 s37, 0xa000
    v_cvt_pk_bf16_f32 v90, v25, v27
    v_accvgpr_write_b32 a26, v122
    v_mfma_f32_16x16x32_bf16 v[200:203], v[72:75], a[128:131], v[200:203]
    v_mul_f32 v28, v174, v174
    v_mul_f32 v30, v175, v175
    v_mfma_f32_16x16x32_bf16 v[200:203], v[68:71], a[112:115], v[200:203]
    v_accvgpr_write_b32 a27, v123
    v_fma_f32 v28, v28, v13, v9
    v_mfma_f32_16x16x32_bf16 v[200:203], v[64:67], a[96:99], v[200:203]
    s_waitcnt lgkmcnt(0)
    ds_read_b64_tr_b16 v[64:65], v7 offset:24584
    v_accvgpr_write_b32 a28, v124
    v_mfma_f32_16x16x32_bf16 v[208:211], v[40:43], a[96:99], v[208:211]
    ds_read_b64_tr_b16 v[66:67], v7 offset:25096
    v_fma_f32 v30, v30, v13, v9
    v_mfma_f32_16x16x32_bf16 v[208:211], v[44:47], a[112:115], v[208:211]
    buffer_load_dwordx4 v37, s[20:23], s37 offen offset:2048 lds
    v_mfma_f32_16x16x32_bf16 v[208:211], v[48:51], a[128:131], v[208:211]
    s_lshl_b32 s38, s35, 6
    ds_read_b64_tr_b16 v[68:69], v7 offset:25608
    v_accvgpr_write_b32 a29, v125
    v_mfma_f32_16x16x32_bf16 v[208:211], v[52:55], a[144:147], v[208:211]
    s_add_u32 s38, s38, s41
    ds_read_b64_tr_b16 v[70:71], v7 offset:26120
    v_mul_f32 v28, v28, v174
    v_mfma_f32_16x16x32_bf16 v[208:211], v[56:59], a[160:163], v[208:211]
    s_add_u32 s38, s38, 0x80000
    ds_read_b64_tr_b16 v[72:73], v7 offset:26632
    v_mul_f32 v30, v30, v175
    v_mfma_f32_16x16x32_bf16 v[208:211], v[60:63], a[176:179], v[208:211]
    ds_read_b64_tr_b16 v[74:75], v7 offset:27144
    v_accvgpr_write_b32 a30, v126
    v_mfma_f32_16x16x32_bf16 v[212:215], v[60:63], a[180:183], v[212:215]
    s_mov_b32 s37, 0xac00
    ds_read_b64_tr_b16 v[76:77], v7 offset:27656
    v_mul_f32 v29, v174, v190
    v_mfma_f32_16x16x32_bf16 v[212:215], v[56:59], a[164:167], v[212:215]
    ds_read_b64_tr_b16 v[78:79], v7 offset:28168
    v_accvgpr_write_b32 a31, v127
    v_mfma_f32_16x16x32_bf16 v[212:215], v[52:55], a[148:151], v[212:215]
    ds_read_b64_tr_b16 v[80:81], v7 offset:28680
    v_mul_f32 v31, v175, v191
    v_mfma_f32_16x16x32_bf16 v[212:215], v[48:51], a[132:135], v[212:215]
    v_exp_f32 v28, v28
    v_mfma_f32_16x16x32_bf16 v[212:215], v[44:47], a[116:119], v[212:215]
    v_exp_f32 v30, v30
    v_mfma_f32_16x16x32_bf16 v[212:215], v[40:43], a[100:103], v[212:215]
    buffer_load_dwordx4 v37, s[20:23], s37 offen offset:3072 lds
    v_mfma_f32_16x16x32_bf16 v[144:147], v[40:43], a[104:107], v[144:147]
    ds_read_b64_tr_b16 v[82:83], v7 offset:29192
    v_fma_f32 v28, v28, v17, v17
    v_mfma_f32_16x16x32_bf16 v[144:147], v[44:47], a[120:123], v[144:147]
    ds_read_b64_tr_b16 v[84:85], v7 offset:29704
    v_fma_f32 v30, v30, v17, v17
    v_mfma_f32_16x16x32_bf16 v[144:147], v[48:51], a[136:139], v[144:147]
    v_rcp_f32 v28, v28
    v_mfma_f32_16x16x32_bf16 v[144:147], v[52:55], a[152:155], v[144:147]
    ds_read_b64_tr_b16 v[86:87], v7 offset:30216
    v_mul_f32 v29, v29, v28
    v_mfma_f32_16x16x32_bf16 v[144:147], v[56:59], a[168:171], v[144:147]
    v_rcp_f32 v30, v30
    v_mfma_f32_16x16x32_bf16 v[144:147], v[60:63], a[184:187], v[144:147]
    v_mul_f32 v31, v31, v30
    v_cvt_pk_bf16_f32 v91, v29, v31
    v_mfma_f32_16x16x32_bf16 v[148:151], v[60:63], a[188:191], v[148:151]
    buffer_store_dwordx4 v[88:91], v1, s[28:31], s38 offen sc1
    v_mfma_f32_16x16x32_bf16 v[148:151], v[56:59], a[172:175], v[148:151]
    v_and_b32 v8, 15, v0
    v_bfe_u32 v88, v0, 2, 2
    v_mfma_f32_16x16x32_bf16 v[148:151], v[52:55], a[156:159], v[148:151]
    v_mul_u32_u24 v89, 40960, v88
    v_and_b32 v90, 3, v0
    v_mfma_f32_16x16x32_bf16 v[148:151], v[48:51], a[140:143], v[148:151]
    v_lshl_add_u32 v89, v90, 8, v89
    v_lshrrev_b32 v91, 4, v0
    v_mfma_f32_16x16x32_bf16 v[148:151], v[44:47], a[124:127], v[148:151]
    v_xor_b32 v8, v8, v91
    v_lshl_add_u32 v8, v8, 4, v89
    v_mfma_f32_16x16x32_bf16 v[148:151], v[40:43], a[108:111], v[148:151]
    s_waitcnt lgkmcnt(0)
    s_waitcnt vmcnt(26)
    s_barrier
    v_mfma_f32_16x16x32_bf16 v[156:159], v[64:67], a[108:111], v[156:159]
    ds_read_b64_tr_b16 v[40:41], v6 offset:30720
    ds_read_b64_tr_b16 v[42:43], v6 offset:31232
    v_mfma_f32_16x16x32_bf16 v[156:159], v[68:71], a[124:127], v[156:159]
    ds_read_b64_tr_b16 v[44:45], v6 offset:31744
    v_xor_b32 v9, 64, v8
    v_mfma_f32_16x16x32_bf16 v[156:159], v[72:75], a[140:143], v[156:159]
    ds_read_b64_tr_b16 v[46:47], v6 offset:32256
    v_xor_b32 v10, 128, v8
    v_mfma_f32_16x16x32_bf16 v[156:159], v[76:79], a[156:159], v[156:159]
    ds_read_b64_tr_b16 v[48:49], v6 offset:32768
    v_xor_b32 v11, 192, v8
    v_mfma_f32_16x16x32_bf16 v[156:159], v[80:83], a[172:175], v[156:159]
    ds_read_b64_tr_b16 v[50:51], v6 offset:33280
    v_mul_u32_u24 v89, 40960, v91
    v_mfma_f32_16x16x32_bf16 v[156:159], v[84:87], a[188:191], v[156:159]
    ds_read_b64_tr_b16 v[52:53], v6 offset:33792
    v_lshl_add_u32 v89, v88, 8, v89
    v_mfma_f32_16x16x32_bf16 v[152:155], v[84:87], a[184:187], v[152:155]
    ds_read_b64_tr_b16 v[54:55], v6 offset:34304
    v_lshl_add_u32 v89, v90, 3, v89
    v_mfma_f32_16x16x32_bf16 v[152:155], v[80:83], a[168:171], v[152:155]
    ds_read_b64_tr_b16 v[56:57], v6 offset:34816
    v_bfe_u32 v88, v0, 2, 3
    v_mfma_f32_16x16x32_bf16 v[152:155], v[76:79], a[152:155], v[152:155]
    ds_read_b64_tr_b16 v[58:59], v6 offset:35328
    v_lshl_add_u32 v89, v88, 5, v89
    v_mfma_f32_16x16x32_bf16 v[152:155], v[72:75], a[136:139], v[152:155]
    ds_read_b64_tr_b16 v[60:61], v6 offset:35840
    v_add_u32 v12, 2048, v89
    v_mfma_f32_16x16x32_bf16 v[152:155], v[68:71], a[120:123], v[152:155]
    ds_read_b64_tr_b16 v[62:63], v6 offset:36352
    v_xor_b32 v13, 32, v12
    v_mfma_f32_16x16x32_bf16 v[152:155], v[64:67], a[104:107], v[152:155]
    v_xor_b32 v14, 64, v12
    v_xor_b32 v15, 96, v12
    v_mfma_f32_16x16x32_bf16 v[220:223], v[64:67], a[100:103], v[220:223]
    v_xor_b32 v16, 128, v12
    v_xor_b32 v17, 160, v12
    v_mfma_f32_16x16x32_bf16 v[220:223], v[68:71], a[116:119], v[220:223]
    v_xor_b32 v18, 192, v12
    v_xor_b32 v19, 224, v12
    v_mfma_f32_16x16x32_bf16 v[220:223], v[72:75], a[132:135], v[220:223]
    v_mul_u32_u24 v89, 40960, v91
    v_and_b32 v88, 3, v88
    v_mfma_f32_16x16x32_bf16 v[220:223], v[76:79], a[148:151], v[220:223]
    v_lshl_add_u32 v89, v88, 7, v89
    v_lshl_add_u32 v89, v90, 3, v89
    v_mfma_f32_16x16x32_bf16 v[220:223], v[80:83], a[164:167], v[220:223]
    v_mfma_f32_16x16x32_bf16 v[220:223], v[84:87], a[180:183], v[220:223]
    v_mfma_f32_16x16x32_bf16 v[216:219], v[84:87], a[176:179], v[216:219]
    v_bfe_u32 v88, v0, 3, 2
    v_mfma_f32_16x16x32_bf16 v[216:219], v[80:83], a[160:163], v[216:219]
    v_mfma_f32_16x16x32_bf16 v[216:219], v[76:79], a[144:147], v[216:219]
    v_mfma_f32_16x16x32_bf16 v[216:219], v[72:75], a[128:131], v[216:219]
    v_mfma_f32_16x16x32_bf16 v[216:219], v[68:71], a[112:115], v[216:219]
    v_mfma_f32_16x16x32_bf16 v[216:219], v[64:67], a[96:99], v[216:219]
    s_lshl_b32 s38, s32, 5
    s_waitcnt lgkmcnt(0)
    ds_read_b64_tr_b16 v[64:65], v6 offset:30728
    v_mfma_f32_16x16x32_bf16 v[192:195], v[40:43], a[192:195], v[192:195]
    s_add_u32 s38, s38, 0x8400
    ds_read_b64_tr_b16 v[66:67], v6 offset:31240
    v_add_u32 v25, s38, v89
    v_mfma_f32_16x16x32_bf16 v[192:195], v[44:47], a[208:211], v[192:195]
    ds_read_b64_tr_b16 v[68:69], v6 offset:31752
    v_lshrrev_b32 v89, 5, v0
    v_mfma_f32_16x16x32_bf16 v[192:195], v[48:51], a[224:227], v[192:195]
    ds_read_b64_tr_b16 v[70:71], v6 offset:32264
    v_lshl_add_u32 v88, v89, 4, v88
    v_mfma_f32_16x16x32_bf16 v[192:195], v[52:55], a[240:243], v[192:195]
    ds_read_b64_tr_b16 v[72:73], v6 offset:32776
    ds_read_b64_tr_b16 v[74:75], v6 offset:33288
    v_mfma_f32_16x16x32_bf16 v[192:195], v[56:59], v[224:227], v[192:195]
    ds_read_b64_tr_b16 v[76:77], v6 offset:33800
    v_and_b32 v89, 7, v0
    v_mfma_f32_16x16x32_bf16 v[192:195], v[60:63], v[240:243], v[192:195]
    s_lshl_b32 s38, s32, 2
    ds_read_b64_tr_b16 v[78:79], v6 offset:34312
    v_add_u32 v88, s38, v88
    v_mfma_f32_16x16x32_bf16 v[196:199], v[60:63], v[244:247], v[196:199]
    ds_read_b64_tr_b16 v[80:81], v6 offset:34824
    v_mul_u32_u24 v88, 1152, v88
    v_mfma_f32_16x16x32_bf16 v[196:199], v[56:59], v[228:231], v[196:199]
    ds_read_b64_tr_b16 v[82:83], v6 offset:35336
    v_lshl_add_u32 v24, v89, 4, v88
    v_mfma_f32_16x16x32_bf16 v[196:199], v[52:55], a[244:247], v[196:199]
    ds_read_b64_tr_b16 v[84:85], v6 offset:35848
    v_mov_b32 v88, 0x3f803f80
    v_mfma_f32_16x16x32_bf16 v[196:199], v[48:51], a[228:231], v[196:199]
    ds_read_b64_tr_b16 v[86:87], v6 offset:36360
    v_accvgpr_write_b32 a144, v88
    v_mfma_f32_16x16x32_bf16 v[196:199], v[44:47], a[212:215], v[196:199]
    s_mov_b32 s34, 0x4000
    v_accvgpr_write_b32 a145, v88
    v_accvgpr_write_b32 a146, v88
    v_mfma_f32_16x16x32_bf16 v[196:199], v[40:43], a[196:199], v[196:199]
    s_lshl_b32 s15, s32, 8
    v_accvgpr_write_b32 a147, v88
    v_mov_b32 v26, 0
    v_mfma_f32_16x16x32_bf16 v[128:131], v[40:43], a[200:203], v[128:131]
    s_add_u32 s15, s15, 2
    v_mfma_f32_16x16x32_bf16 v[128:131], v[44:47], a[216:219], v[128:131]
    v_mfma_f32_16x16x32_bf16 v[128:131], v[48:51], a[232:235], v[128:131]
    v_mfma_f32_16x16x32_bf16 v[128:131], v[52:55], a[248:251], v[128:131]
    v_mfma_f32_16x16x32_bf16 v[128:131], v[56:59], v[232:235], v[128:131]
    v_mfma_f32_16x16x32_bf16 v[128:131], v[60:63], v[248:251], v[128:131]
    v_mfma_f32_16x16x32_bf16 v[132:135], v[60:63], v[252:255], v[132:135]
    v_mfma_f32_16x16x32_bf16 v[132:135], v[56:59], v[236:239], v[132:135]
    v_mfma_f32_16x16x32_bf16 v[132:135], v[52:55], a[252:255], v[132:135]
    v_mfma_f32_16x16x32_bf16 v[132:135], v[48:51], a[236:239], v[132:135]
    v_mfma_f32_16x16x32_bf16 v[132:135], v[44:47], a[220:223], v[132:135]
    v_mfma_f32_16x16x32_bf16 v[132:135], v[40:43], a[204:207], v[132:135]
    s_waitcnt lgkmcnt(0)
    ds_read_b64_tr_b16 v[40:41], v7 offset:30720
    ds_read_b64_tr_b16 v[42:43], v7 offset:31232
    v_mfma_f32_16x16x32_bf16 v[140:143], v[64:67], a[204:207], v[140:143]
    ds_read_b64_tr_b16 v[44:45], v7 offset:31744
    ds_read_b64_tr_b16 v[46:47], v7 offset:32256
    v_mfma_f32_16x16x32_bf16 v[140:143], v[68:71], a[220:223], v[140:143]
    ds_read_b64_tr_b16 v[48:49], v7 offset:32768
    ds_read_b64_tr_b16 v[50:51], v7 offset:33280
    v_mfma_f32_16x16x32_bf16 v[140:143], v[72:75], a[236:239], v[140:143]
    ds_read_b64_tr_b16 v[52:53], v7 offset:33792
    ds_read_b64_tr_b16 v[54:55], v7 offset:34304
    v_mfma_f32_16x16x32_bf16 v[140:143], v[76:79], a[252:255], v[140:143]
    ds_read_b64_tr_b16 v[56:57], v7 offset:34816
    v_mfma_f32_16x16x32_bf16 v[140:143], v[80:83], v[236:239], v[140:143]
    ds_read_b64_tr_b16 v[58:59], v7 offset:35328
    v_mfma_f32_16x16x32_bf16 v[140:143], v[84:87], v[252:255], v[140:143]
    v_mfma_f32_16x16x32_bf16 v[136:139], v[84:87], v[248:251], v[136:139]
    ds_read_b64_tr_b16 v[60:61], v7 offset:35840
    v_mfma_f32_16x16x32_bf16 v[136:139], v[80:83], v[232:235], v[136:139]
    ds_read_b64_tr_b16 v[62:63], v7 offset:36352
    v_mfma_f32_16x16x32_bf16 v[136:139], v[76:79], a[248:251], v[136:139]
    v_mfma_f32_16x16x32_bf16 v[136:139], v[72:75], a[232:235], v[136:139]
    v_mfma_f32_16x16x32_bf16 v[136:139], v[68:71], a[216:219], v[136:139]
    v_mfma_f32_16x16x32_bf16 v[136:139], v[64:67], a[200:203], v[136:139]
    v_mfma_f32_16x16x32_bf16 v[204:207], v[64:67], a[196:199], v[204:207]
    v_mfma_f32_16x16x32_bf16 v[204:207], v[68:71], a[212:215], v[204:207]
    v_mfma_f32_16x16x32_bf16 v[204:207], v[72:75], a[228:231], v[204:207]
    v_mfma_f32_16x16x32_bf16 v[204:207], v[76:79], a[244:247], v[204:207]
    v_mfma_f32_16x16x32_bf16 v[204:207], v[80:83], v[228:231], v[204:207]
    v_mfma_f32_16x16x32_bf16 v[204:207], v[84:87], v[244:247], v[204:207]
    v_mfma_f32_16x16x32_bf16 v[200:203], v[84:87], v[240:243], v[200:203]
    v_mul_f32 v192, v192, v32
    v_mfma_f32_16x16x32_bf16 v[200:203], v[80:83], v[224:227], v[200:203]
    v_mul_f32 v193, v193, v32
    v_mul_f32 v194, v194, v32
    v_mfma_f32_16x16x32_bf16 v[200:203], v[76:79], a[240:243], v[200:203]
    v_mul_f32 v195, v195, v32
    v_mfma_f32_16x16x32_bf16 v[200:203], v[72:75], a[224:227], v[200:203]
    v_mfma_f32_16x16x32_bf16 v[200:203], v[68:71], a[208:211], v[200:203]
    v_cvt_pk_bf16_f32 v192, v192, v193
    v_cvt_pk_bf16_f32 v193, v194, v195
    v_mfma_f32_16x16x32_bf16 v[200:203], v[64:67], a[192:195], v[200:203]
    s_waitcnt lgkmcnt(0)
    ds_read_b64_tr_b16 v[64:65], v7 offset:30728
    ds_read_b64_tr_b16 v[66:67], v7 offset:31240
    v_mfma_f32_16x16x32_bf16 v[208:211], v[40:43], a[192:195], v[208:211]
    ds_read_b64_tr_b16 v[68:69], v7 offset:31752
    ds_read_b64_tr_b16 v[70:71], v7 offset:32264
    v_mfma_f32_16x16x32_bf16 v[208:211], v[44:47], a[208:211], v[208:211]
    ds_read_b64_tr_b16 v[72:73], v7 offset:32776
    ds_read_b64_tr_b16 v[74:75], v7 offset:33288
    v_mfma_f32_16x16x32_bf16 v[208:211], v[48:51], a[224:227], v[208:211]
    ds_read_b64_tr_b16 v[76:77], v7 offset:33800
    ds_read_b64_tr_b16 v[78:79], v7 offset:34312
    v_mfma_f32_16x16x32_bf16 v[208:211], v[52:55], a[240:243], v[208:211]
    ds_read_b64_tr_b16 v[80:81], v7 offset:34824
    ds_read_b64_tr_b16 v[82:83], v7 offset:35336
    v_mfma_f32_16x16x32_bf16 v[208:211], v[56:59], v[224:227], v[208:211]
    ds_read_b64_tr_b16 v[84:85], v7 offset:35848
    ds_read_b64_tr_b16 v[86:87], v7 offset:36360
    v_mfma_f32_16x16x32_bf16 v[208:211], v[60:63], v[240:243], v[208:211]
    v_mul_f32 v200, v200, v32
    v_mul_f32 v201, v201, v32
    v_mfma_f32_16x16x32_bf16 v[212:215], v[40:43], a[196:199], v[212:215]
    v_mul_f32 v202, v202, v32
    v_mul_f32 v203, v203, v32
    v_mfma_f32_16x16x32_bf16 v[212:215], v[44:47], a[212:215], v[212:215]
    v_cvt_pk_bf16_f32 v194, v200, v201
    v_cvt_pk_bf16_f32 v195, v202, v203
    v_mfma_f32_16x16x32_bf16 v[212:215], v[48:51], a[228:231], v[212:215]
    v_accvgpr_write_b32 a32, v192
    v_accvgpr_write_b32 a33, v193
    v_mfma_f32_16x16x32_bf16 v[212:215], v[52:55], a[244:247], v[212:215]
    v_accvgpr_write_b32 a34, v194
    v_accvgpr_write_b32 a35, v195
    v_mfma_f32_16x16x32_bf16 v[212:215], v[56:59], v[228:231], v[212:215]
    v_mul_f32 v196, v196, v33
    v_mul_f32 v197, v197, v33
    v_mfma_f32_16x16x32_bf16 v[212:215], v[60:63], v[244:247], v[212:215]
    s_waitcnt lgkmcnt(0)
    ds_read_b128 a[64:67], v8 offset:36864
    v_mul_f32 v198, v198, v33
    v_mfma_f32_16x16x32_bf16 v[216:219], v[64:67], a[192:195], v[216:219]
    ds_read_b128 a[68:71], v9 offset:36864
    v_mul_f32 v199, v199, v33
    v_mfma_f32_16x16x32_bf16 v[216:219], v[68:71], a[208:211], v[216:219]
    ds_read_b128 a[72:75], v10 offset:36864
    v_mul_f32 v204, v204, v33
    v_mfma_f32_16x16x32_bf16 v[216:219], v[72:75], a[224:227], v[216:219]
    ds_read_b128 a[76:79], v11 offset:36864
    v_mul_f32 v205, v205, v33
    v_mfma_f32_16x16x32_bf16 v[216:219], v[76:79], a[240:243], v[216:219]
    ds_read_b128 a[80:83], v8 offset:37888
    v_mul_f32 v208, v208, v32
    v_mfma_f32_16x16x32_bf16 v[216:219], v[80:83], v[224:227], v[216:219]
    ds_read_b128 a[84:87], v9 offset:37888
    v_mul_f32 v209, v209, v32
    v_mfma_f32_16x16x32_bf16 v[216:219], v[84:87], v[240:243], v[216:219]
    ds_read_b128 a[88:91], v10 offset:37888
    v_mul_f32 v210, v210, v32
    v_mfma_f32_16x16x32_bf16 v[220:223], v[64:67], a[196:199], v[220:223]
    ds_read_b128 a[92:95], v11 offset:37888
    v_mul_f32 v211, v211, v32
    v_mfma_f32_16x16x32_bf16 v[220:223], v[68:71], a[212:215], v[220:223]
    ds_read_b128 a[160:163], v8 offset:38912
    v_mul_f32 v206, v206, v33
    v_mfma_f32_16x16x32_bf16 v[220:223], v[72:75], a[228:231], v[220:223]
    v_mul_f32 v216, v216, v32
    v_mul_f32 v217, v217, v32
    v_mfma_f32_16x16x32_bf16 v[220:223], v[76:79], a[244:247], v[220:223]
    ds_read_b128 a[164:167], v9 offset:38912
    v_mul_f32 v218, v218, v32
    v_mfma_f32_16x16x32_bf16 v[220:223], v[80:83], v[228:231], v[220:223]
    v_mul_f32 v219, v219, v32
    v_cvt_pk_bf16_f32 v208, v208, v209
    v_mfma_f32_16x16x32_bf16 v[220:223], v[84:87], v[244:247], v[220:223]
    ds_read_b128 a[168:171], v10 offset:38912
    v_cvt_pk_bf16_f32 v209, v210, v211
    v_mfma_f32_16x16x32_bf16 v[144:147], v[40:43], a[200:203], v[144:147]
    v_cvt_pk_bf16_f32 v210, v216, v217
    v_cvt_pk_bf16_f32 v211, v218, v219
    v_mfma_f32_16x16x32_bf16 v[144:147], v[44:47], a[216:219], v[144:147]
    ds_read_b128 a[172:175], v11 offset:38912
    v_mul_f32 v207, v207, v33
    v_mfma_f32_16x16x32_bf16 v[144:147], v[48:51], a[232:235], v[144:147]
    ds_read_b128 a[176:179], v8 offset:39936
    v_accvgpr_write_b32 a48, v208
    v_mfma_f32_16x16x32_bf16 v[144:147], v[52:55], a[248:251], v[144:147]
    v_accvgpr_write_b32 a49, v209
    v_accvgpr_write_b32 a50, v210
    v_mfma_f32_16x16x32_bf16 v[144:147], v[56:59], v[232:235], v[144:147]
    ds_read_b128 a[180:183], v9 offset:39936
    v_accvgpr_write_b32 a51, v211
    v_mfma_f32_16x16x32_bf16 v[144:147], v[60:63], v[248:251], v[144:147]
    v_cvt_pk_bf16_f32 v196, v196, v197
    v_cvt_pk_bf16_f32 v197, v198, v199
    v_mfma_f32_16x16x32_bf16 v[152:155], v[64:67], a[200:203], v[152:155]
    ds_read_b128 a[184:187], v10 offset:39936
    v_cvt_pk_bf16_f32 v198, v204, v205
    v_mfma_f32_16x16x32_bf16 v[152:155], v[68:71], a[216:219], v[152:155]
    v_cvt_pk_bf16_f32 v199, v206, v207
    v_accvgpr_write_b32 a36, v196
    v_mfma_f32_16x16x32_bf16 v[152:155], v[72:75], a[232:235], v[152:155]
    ds_read_b128 a[188:191], v11 offset:39936
    v_accvgpr_write_b32 a37, v197
    v_mfma_f32_16x16x32_bf16 v[152:155], v[76:79], a[248:251], v[152:155]
    v_accvgpr_write_b32 a38, v198
    v_accvgpr_write_b32 a39, v199
    v_mfma_f32_16x16x32_bf16 v[152:155], v[80:83], v[232:235], v[152:155]
    v_mul_f32 v128, v128, v34
    v_mul_f32 v129, v129, v34
    v_mfma_f32_16x16x32_bf16 v[152:155], v[84:87], v[248:251], v[152:155]
    v_mul_f32 v130, v130, v34
    v_mul_f32 v131, v131, v34
    v_mfma_f32_16x16x32_bf16 v[148:151], v[40:43], a[204:207], v[148:151]
    v_mul_f32 v136, v136, v34
    v_mul_f32 v137, v137, v34
    v_mfma_f32_16x16x32_bf16 v[148:151], v[44:47], a[220:223], v[148:151]
    v_mul_f32 v212, v212, v33
    v_mul_f32 v138, v138, v34
    v_mfma_f32_16x16x32_bf16 v[148:151], v[48:51], a[236:239], v[148:151]
    v_mul_f32 v213, v213, v33
    v_mul_f32 v214, v214, v33
    v_mfma_f32_16x16x32_bf16 v[148:151], v[52:55], a[252:255], v[148:151]
    v_mul_f32 v215, v215, v33
    v_mul_f32 v220, v220, v33
    v_mfma_f32_16x16x32_bf16 v[148:151], v[56:59], v[236:239], v[148:151]
    v_mul_f32 v221, v221, v33
    v_mul_f32 v222, v222, v33
    v_mfma_f32_16x16x32_bf16 v[148:151], v[60:63], v[252:255], v[148:151]
    v_mul_f32 v223, v223, v33
    v_mul_f32 v139, v139, v34
    v_mfma_f32_16x16x32_bf16 v[156:159], v[64:67], a[204:207], v[156:159]
    v_cvt_pk_bf16_f32 v212, v212, v213
    v_cvt_pk_bf16_f32 v213, v214, v215
    v_mfma_f32_16x16x32_bf16 v[156:159], v[68:71], a[220:223], v[156:159]
    v_cvt_pk_bf16_f32 v214, v220, v221
    v_cvt_pk_bf16_f32 v215, v222, v223
    v_mfma_f32_16x16x32_bf16 v[156:159], v[72:75], a[236:239], v[156:159]
    v_accvgpr_write_b32 a52, v212
    v_accvgpr_write_b32 a53, v213
    v_mfma_f32_16x16x32_bf16 v[156:159], v[76:79], a[252:255], v[156:159]
    v_cvt_pk_bf16_f32 v128, v128, v129
    v_accvgpr_write_b32 a54, v214
    v_mfma_f32_16x16x32_bf16 v[156:159], v[80:83], v[236:239], v[156:159]
    v_accvgpr_write_b32 a55, v215
    v_cvt_pk_bf16_f32 v129, v130, v131
    v_mfma_f32_16x16x32_bf16 v[156:159], v[84:87], v[252:255], v[156:159]
    s_waitcnt lgkmcnt(0)
    v_cvt_pk_bf16_f32 v130, v136, v137
    v_cvt_pk_bf16_f32 v131, v138, v139
    v_mfma_f32_16x16x32_bf16 v[40:43], a[64:67], a[0:3], 0
    v_accvgpr_write_b32 a40, v128
    v_accvgpr_write_b32 a41, v129
    v_mfma_f32_16x16x32_bf16 v[40:43], a[68:71], a[16:19], v[40:43]
    v_accvgpr_write_b32 a42, v130
    v_accvgpr_write_b32 a43, v131
    v_mfma_f32_16x16x32_bf16 v[40:43], a[72:75], a[32:35], v[40:43]
    v_mul_f32 v132, v132, v35
    v_mul_f32 v133, v133, v35
    v_mfma_f32_16x16x32_bf16 v[40:43], a[76:79], a[48:51], v[40:43]
    v_mul_f32 v134, v134, v35
    v_mul_f32 v135, v135, v35
    v_mfma_f32_16x16x32_bf16 v[44:47], a[92:95], a[48:51], 0
    v_mul_f32 v140, v140, v35
    v_mul_f32 v141, v141, v35
    v_mfma_f32_16x16x32_bf16 v[44:47], a[88:91], a[32:35], v[44:47]
    v_mul_f32 v142, v142, v35
    v_mul_f32 v143, v143, v35
    v_mfma_f32_16x16x32_bf16 v[44:47], a[84:87], a[16:19], v[44:47]
    v_cvt_pk_bf16_f32 v132, v132, v133
    v_cvt_pk_bf16_f32 v133, v134, v135
    v_mfma_f32_16x16x32_bf16 v[44:47], a[80:83], a[0:3], v[44:47]
    v_cvt_pk_bf16_f32 v134, v140, v141
    v_cvt_pk_bf16_f32 v135, v142, v143
    v_mfma_f32_16x16x32_bf16 v[96:99], a[160:163], a[0:3], 0
    v_accvgpr_write_b32 a44, v132
    v_accvgpr_write_b32 a45, v133
    v_mfma_f32_16x16x32_bf16 v[96:99], a[164:167], a[16:19], v[96:99]
    v_accvgpr_write_b32 a46, v134
    v_accvgpr_write_b32 a47, v135
    v_mfma_f32_16x16x32_bf16 v[96:99], a[168:171], a[32:35], v[96:99]
    v_mul_f32 v144, v144, v34
    v_mul_f32 v145, v145, v34
    v_mfma_f32_16x16x32_bf16 v[96:99], a[172:175], a[48:51], v[96:99]
    v_mul_f32 v146, v146, v34
    v_mul_f32 v147, v147, v34
    v_mfma_f32_16x16x32_bf16 v[100:103], a[188:191], a[48:51], 0
    v_mul_f32 v152, v152, v34
    v_mul_f32 v153, v153, v34
    v_mfma_f32_16x16x32_bf16 v[100:103], a[184:187], a[32:35], v[100:103]
    v_mul_f32 v154, v154, v34
    v_mul_f32 v155, v155, v34
    v_mfma_f32_16x16x32_bf16 v[100:103], a[180:183], a[16:19], v[100:103]
    v_cvt_pk_bf16_f32 v144, v144, v145
    v_cvt_pk_bf16_f32 v145, v146, v147
    v_mfma_f32_16x16x32_bf16 v[100:103], a[176:179], a[0:3], v[100:103]
    v_cvt_pk_bf16_f32 v146, v152, v153
    v_cvt_pk_bf16_f32 v147, v154, v155
    v_mfma_f32_16x16x32_bf16 v[52:55], a[80:83], a[4:7], 0
    v_accvgpr_write_b32 a56, v144
    v_accvgpr_write_b32 a57, v145
    v_mfma_f32_16x16x32_bf16 v[52:55], a[84:87], a[20:23], v[52:55]
    v_accvgpr_write_b32 a58, v146
    v_accvgpr_write_b32 a59, v147
    v_mfma_f32_16x16x32_bf16 v[52:55], a[88:91], a[36:39], v[52:55]
    v_mul_f32 v148, v148, v35
    v_mul_f32 v149, v149, v35
    v_mfma_f32_16x16x32_bf16 v[52:55], a[92:95], a[52:55], v[52:55]
    v_mul_f32 v150, v150, v35
    v_mul_f32 v151, v151, v35
    v_mfma_f32_16x16x32_bf16 v[48:51], a[76:79], a[52:55], 0
    v_mul_f32 v156, v156, v35
    v_mul_f32 v157, v157, v35
    v_mfma_f32_16x16x32_bf16 v[48:51], a[72:75], a[36:39], v[48:51]
    v_mul_f32 v158, v158, v35
    v_mul_f32 v159, v159, v35
    v_mfma_f32_16x16x32_bf16 v[48:51], a[68:71], a[20:23], v[48:51]
    v_cvt_pk_bf16_f32 v148, v148, v149
    v_cvt_pk_bf16_f32 v149, v150, v151
    v_mfma_f32_16x16x32_bf16 v[48:51], a[64:67], a[4:7], v[48:51]
    v_cvt_pk_bf16_f32 v150, v156, v157
    v_cvt_pk_bf16_f32 v151, v158, v159
    v_mfma_f32_16x16x32_bf16 v[116:119], a[176:179], a[4:7], 0
    v_accvgpr_write_b32 a60, v148
    v_accvgpr_write_b32 a61, v149
    v_mfma_f32_16x16x32_bf16 v[116:119], a[180:183], a[20:23], v[116:119]
    v_accvgpr_write_b32 a62, v150
    v_accvgpr_write_b32 a63, v151
    v_mfma_f32_16x16x32_bf16 v[116:119], a[184:187], a[36:39], v[116:119]
    v_max3_f32 v72, v40, v41, v42
    v_max3_f32 v73, v43, v44, v45
    v_mfma_f32_16x16x32_bf16 v[116:119], a[188:191], a[52:55], v[116:119]
    v_max3_f32 v72, v72, v46, v47
    v_max3_f32 v73, v73, v96, v97
    v_mfma_f32_16x16x32_bf16 v[112:115], a[172:175], a[52:55], 0
    v_max3_f32 v72, v72, v98, v99
    v_max3_f32 v73, v73, v100, v101
    v_mfma_f32_16x16x32_bf16 v[112:115], a[168:171], a[36:39], v[112:115]
    s_waitcnt vmcnt(18)
    v_max3_f32 v72, v72, v102, v103
    v_max_f32 v72, v72, v73
    v_mfma_f32_16x16x32_bf16 v[112:115], a[164:167], a[20:23], v[112:115]
    s_waitcnt vmcnt(15) lgkmcnt(0)
    v_mov_b32 v73, v72
    v_max3_f32 v76, v48, v49, v50
    v_mfma_f32_16x16x32_bf16 v[112:115], a[160:163], a[4:7], v[112:115]
    s_barrier
    ds_read_b64_tr_b16 a[96:97], v12 offset:0
    v_permlane16_swap_b32 v72, v73
    v_mfma_f32_16x16x32_bf16 v[56:59], a[64:67], a[8:11], 0
    ds_read_b64_tr_b16 a[98:99], v12 offset:1024
    v_max_f32 v72, v72, v73
    v_mfma_f32_16x16x32_bf16 v[56:59], a[68:71], a[24:27], v[56:59]
    s_mov_b32 m0, s48
    ds_read_b64_tr_b16 a[100:101], v13 offset:0
    v_mov_b32 v73, v72
    v_mfma_f32_16x16x32_bf16 v[56:59], a[72:75], a[40:43], v[56:59]
    ds_read_b64_tr_b16 a[102:103], v13 offset:1024
    v_permlane32_swap_b32 v72, v73
    v_mfma_f32_16x16x32_bf16 v[56:59], a[76:79], a[56:59], v[56:59]
    ds_read_b64_tr_b16 a[104:105], v14 offset:0
    v_max_f32 v72, v72, v73
    v_mfma_f32_16x16x32_bf16 v[60:63], a[92:95], a[56:59], 0
    ds_read_b64_tr_b16 a[106:107], v14 offset:1024
    v_sub_f32 v72, 0xc2cc0000, v72
    v_mfma_f32_16x16x32_bf16 v[60:63], a[88:91], a[40:43], v[60:63]
    ds_read_b64_tr_b16 a[108:109], v15 offset:0
    v_add_f32 v40, v40, v72
    v_mfma_f32_16x16x32_bf16 v[60:63], a[84:87], a[24:27], v[60:63]
    buffer_load_dwordx4 v24, s[76:79], s44 offen lds
    v_mfma_f32_16x16x32_bf16 v[60:63], a[80:83], a[8:11], v[60:63]
    ds_read_b64_tr_b16 a[110:111], v15 offset:1024
    v_add_f32 v41, v41, v72
    v_mfma_f32_16x16x32_bf16 v[160:163], a[160:163], a[8:11], 0
    ds_read_b64_tr_b16 a[112:113], v16 offset:0
    v_add_f32 v42, v42, v72
    v_mfma_f32_16x16x32_bf16 v[160:163], a[164:167], a[24:27], v[160:163]
    ds_read_b64_tr_b16 a[114:115], v16 offset:1024
    v_add_f32 v43, v43, v72
    v_mfma_f32_16x16x32_bf16 v[160:163], a[168:171], a[40:43], v[160:163]
    s_xor_b32 s48, s48, 1024
    ds_read_b64_tr_b16 a[116:117], v17 offset:0
    v_add_f32 v44, v44, v72
    v_mfma_f32_16x16x32_bf16 v[160:163], a[172:175], a[56:59], v[160:163]
    ds_read_b64_tr_b16 a[118:119], v17 offset:1024
    v_add_f32 v45, v45, v72
    v_mfma_f32_16x16x32_bf16 v[164:167], a[188:191], a[56:59], 0
    ds_read_b64_tr_b16 a[120:121], v18 offset:0
    v_add_f32 v46, v46, v72
    v_mfma_f32_16x16x32_bf16 v[164:167], a[184:187], a[40:43], v[164:167]
    ds_read_b64_tr_b16 a[122:123], v18 offset:1024
    v_add_f32 v47, v47, v72
    v_mfma_f32_16x16x32_bf16 v[164:167], a[180:183], a[24:27], v[164:167]
    ds_read_b64_tr_b16 a[124:125], v19 offset:0
    v_mov_b32 v73, v72
    v_mfma_f32_16x16x32_bf16 v[164:167], a[176:179], a[8:11], v[164:167]
    s_add_u32 m0, s33, s51
    ds_read_b64_tr_b16 a[126:127], v19 offset:1024
    v_mov_b32 v74, v72
    v_mfma_f32_16x16x32_bf16 v[68:71], a[80:83], a[12:15], 0
    ds_read_b64_tr_b16 a[148:149], v25 offset:0
    v_mov_b32 v75, v72
    v_mfma_f32_16x16x32_bf16 v[68:71], a[84:87], a[28:31], v[68:71]
    v_exp_f32 v40, v40
    v_mfma_f32_16x16x32_bf16 v[68:71], a[88:91], a[44:47], v[68:71]
    v_exp_f32 v41, v41
    v_mfma_f32_16x16x32_bf16 v[68:71], a[92:95], a[60:63], v[68:71]
    s_add_u32 s37, s50, 0x4000
    ds_read_b64_tr_b16 a[150:151], v25 offset:512
    v_cvt_pk_bf16_f32 v224, v40, v41
    v_mfma_f32_16x16x32_bf16 v[64:67], a[76:79], a[60:63], 0
    v_add_f32 v26, v26, v40
    v_add_f32 v26, v26, v41
    v_mfma_f32_16x16x32_bf16 v[64:67], a[72:75], a[44:47], v[64:67]
    v_exp_f32 v42, v42
    v_mfma_f32_16x16x32_bf16 v[64:67], a[68:71], a[28:31], v[64:67]
    v_exp_f32 v43, v43
    v_mfma_f32_16x16x32_bf16 v[64:67], a[64:67], a[12:15], v[64:67]
    v_cvt_pk_bf16_f32 v225, v42, v43
    v_add_f32 v26, v26, v42
    v_mfma_f32_16x16x32_bf16 v[180:183], a[176:179], a[12:15], 0
    buffer_load_dwordx4 v36, s[16:19], s37 offen offset:0 lds
    v_mfma_f32_16x16x32_bf16 v[180:183], a[180:183], a[28:31], v[180:183]
    v_add_f32 v26, v26, v43
    v_max3_f32 v77, v51, v52, v53
    v_mfma_f32_16x16x32_bf16 v[180:183], a[184:187], a[44:47], v[180:183]
    v_exp_f32 v44, v44
    v_mfma_f32_16x16x32_bf16 v[180:183], a[188:191], a[60:63], v[180:183]
    v_exp_f32 v45, v45
    v_mfma_f32_16x16x32_bf16 v[176:179], a[172:175], a[60:63], 0
    s_add_u32 s37, s50, 0x4c00
    v_cvt_pk_bf16_f32 v226, v44, v45
    v_add_f32 v26, v26, v44
    v_mfma_f32_16x16x32_bf16 v[176:179], a[168:171], a[44:47], v[176:179]
    v_add_f32 v26, v26, v45
    v_max3_f32 v76, v76, v54, v55
    v_mfma_f32_16x16x32_bf16 v[176:179], a[164:167], a[28:31], v[176:179]
    s_waitcnt lgkmcnt(0)
    v_exp_f32 v46, v46
    v_mfma_f32_16x16x32_bf16 v[176:179], a[160:163], a[12:15], v[176:179]
    v_exp_f32 v47, v47
    v_max3_f32 v80, v56, v57, v58
    v_max3_f32 v81, v59, v60, v61
    v_max3_f32 v80, v80, v62, v63
    v_max3_f32 v81, v81, v160, v161
    v_max3_f32 v80, v80, v162, v163
    v_max3_f32 v81, v81, v164, v165
    v_max3_f32 v80, v80, v166, v167
    v_max_f32 v80, v80, v81
    v_mov_b32 v81, v80
    v_cvt_pk_bf16_f32 v227, v46, v47
    v_add_f32 v26, v26, v46
    v_permlane16_swap_b32 v80, v81
    v_max_f32 v80, v80, v81
    v_mov_b32 v81, v80
    v_add_f32 v26, v26, v47
    v_max3_f32 v77, v77, v112, v113
    v_permlane32_swap_b32 v80, v81
    v_max_f32 v80, v80, v81
    v_sub_f32 v80, 0xc2cc0000, v80
    v_add_f32 v56, v56, v80
    v_add_f32 v57, v57, v80
    v_add_f32 v58, v58, v80
    v_add_f32 v59, v59, v80
    v_add_f32 v60, v60, v80
    v_add_f32 v61, v61, v80
    v_add_f32 v62, v62, v80
    v_add_f32 v63, v63, v80
    v_exp_f32 v56, v56
    v_exp_f32 v57, v57
    v_exp_f32 v58, v58
    v_cvt_pk_bf16_f32 v232, v56, v57
    v_exp_f32 v59, v59
    v_exp_f32 v60, v60
    v_cvt_pk_bf16_f32 v233, v58, v59
    v_exp_f32 v61, v61
    v_exp_f32 v62, v62
    v_cvt_pk_bf16_f32 v234, v60, v61
    v_exp_f32 v63, v63
    v_max3_f32 v76, v76, v114, v115
    v_cvt_pk_bf16_f32 v235, v62, v63
    v_max3_f32 v77, v77, v116, v117
    v_max3_f32 v76, v76, v118, v119
    v_mfma_f32_16x16x32_bf16 a[136:139], a[144:147], v[232:235], 0
    ds_read_b128 a[64:67], v8 offset:0
    v_max_f32 v76, v76, v77
    v_max3_f32 v84, v64, v65, v66
    v_max3_f32 v85, v67, v68, v69
    v_max3_f32 v84, v84, v70, v71
    v_max3_f32 v85, v85, v176, v177
    v_max3_f32 v84, v84, v178, v179
    v_max3_f32 v85, v85, v180, v181
    v_max3_f32 v84, v84, v182, v183
    v_max_f32 v84, v84, v85
    v_mov_b32 v85, v84
    v_mov_b32 v77, v76
    v_mov_b32 v81, v80
    v_permlane16_swap_b32 v84, v85
    v_max_f32 v84, v84, v85
    v_mov_b32 v85, v84
    v_permlane16_swap_b32 v76, v77
    v_max_f32 v76, v76, v77
    v_permlane32_swap_b32 v84, v85
    v_max_f32 v84, v84, v85
    v_sub_f32 v84, 0xc2cc0000, v84
    v_add_f32 v64, v64, v84
    v_add_f32 v65, v65, v84
    v_add_f32 v66, v66, v84
    v_add_f32 v67, v67, v84
    v_add_f32 v68, v68, v84
    v_add_f32 v69, v69, v84
    v_add_f32 v70, v70, v84
    v_add_f32 v71, v71, v84
    v_exp_f32 v68, v68
    v_exp_f32 v69, v69
    v_exp_f32 v70, v70
    v_cvt_pk_bf16_f32 v238, v68, v69
    v_exp_f32 v71, v71
    v_exp_f32 v64, v64
    v_cvt_pk_bf16_f32 v239, v70, v71
    v_exp_f32 v65, v65
    v_exp_f32 v66, v66
    v_cvt_pk_bf16_f32 v236, v64, v65
    v_exp_f32 v67, v67
    v_mov_b32 v77, v76
    v_cvt_pk_bf16_f32 v237, v66, v67
    v_mov_b32 v82, v80
    v_permlane32_swap_b32 v76, v77
    v_mfma_f32_16x16x32_bf16 v[108:111], a[96:99], v[236:239], 0
    buffer_load_dwordx4 v36, s[16:19], s37 offen offset:1024 lds
    v_mfma_f32_16x16x32_bf16 v[104:107], a[96:99], v[232:235], 0
    ds_read_b128 a[68:71], v9 offset:0
    v_max_f32 v76, v76, v77
    v_mfma_f32_16x16x32_bf16 v[120:123], a[100:103], v[232:235], 0
    s_add_u32 s44, s44, 128
    ds_read_b128 a[72:75], v10 offset:0
    v_sub_f32 v76, 0xc2cc0000, v76
    v_mfma_f32_16x16x32_bf16 v[124:127], a[100:103], v[236:239], 0
    ds_read_b128 a[76:79], v11 offset:0
    v_add_f32 v48, v48, v76
    v_mfma_f32_16x16x32_bf16 v[140:143], a[104:107], v[236:239], 0
    buffer_load_dwordx4 v37, s[20:23], s50 offen offset:2048 lds
    v_mfma_f32_16x16x32_bf16 v[136:139], a[104:107], v[232:235], 0
    ds_read_b128 a[80:83], v8 offset:1024
    v_add_f32 v49, v49, v76
    v_mfma_f32_16x16x32_bf16 v[152:155], a[108:111], v[232:235], 0
    ds_read_b128 a[84:87], v9 offset:1024
    v_add_f32 v50, v50, v76
    v_mfma_f32_16x16x32_bf16 v[156:159], a[108:111], v[236:239], 0
    v_add_f32 v51, v51, v76
    v_add_f32 v52, v52, v76
    v_mfma_f32_16x16x32_bf16 v[172:175], a[112:115], v[236:239], 0
    s_and_b32 s38, s45, 255
    v_add_f32 v53, v53, v76
    v_add_f32 v54, v54, v76
    v_mfma_f32_16x16x32_bf16 v[168:171], a[112:115], v[232:235], 0
    s_add_u32 s37, s50, 0xc00
    ds_read_b128 a[88:91], v10 offset:1024
    v_add_f32 v55, v55, v76
    v_mfma_f32_16x16x32_bf16 v[184:187], a[116:119], v[232:235], 0
    v_mov_b32 v77, v76
    v_mov_b32 v78, v76
    v_mfma_f32_16x16x32_bf16 v[188:191], a[116:119], v[236:239], 0
    s_mul_i32 s39, s38, 57
    v_mov_b32 v79, v76
    v_mov_b32 v83, v80
    v_mfma_f32_16x16x32_bf16 v[204:207], a[120:123], v[236:239], 0
    v_exp_f32 v52, v52
    v_mfma_f32_16x16x32_bf16 v[200:203], a[120:123], v[232:235], 0
    buffer_load_dwordx4 v37, s[20:23], s37 offen offset:3072 lds
    v_mfma_f32_16x16x32_bf16 v[216:219], a[124:127], v[232:235], 0
    s_lshr_b32 s39, s39, 9
    v_exp_f32 v53, v53
    v_mfma_f32_16x16x32_bf16 v[220:223], a[124:127], v[236:239], 0
    ds_read_b128 a[92:95], v11 offset:1024
    s_waitcnt lgkmcnt(0)
    v_mfma_f32_16x16x32_bf16 a[140:143], a[144:147], v[236:239], 0
    s_mul_i32 s39, s39, 2497536
    ds_read_b64_tr_b16 a[224:225], v12 offset:4096
    v_cvt_pk_bf16_f32 v230, v52, v53
    v_add_f32 v56, v160, v80
    v_add_f32 v57, v161, v80
    v_add_f32 v58, v162, v80
    v_add_f32 v59, v163, v80
    v_exp_f32 v56, v56
    v_exp_f32 v57, v57
    v_exp_f32 v58, v58
    v_cvt_pk_bf16_f32 v248, v56, v57
    v_exp_f32 v59, v59
    v_exp_f32 v54, v54
    v_cvt_pk_bf16_f32 v249, v58, v59
    v_mfma_f32_16x16x32_bf16 v[56:59], a[64:67], a[8:11], v[80:83]
    v_exp_f32 v55, v55
    v_mfma_f32_16x16x32_bf16 v[56:59], a[68:71], a[24:27], v[56:59]
    s_add_u32 s50, s50, 0x2000
    ds_read_b64_tr_b16 a[226:227], v12 offset:5120
    s_lshl_b32 s38, s38, 10
    v_mfma_f32_16x16x32_bf16 v[56:59], a[72:75], a[40:43], v[56:59]
    ds_read_b64_tr_b16 a[228:229], v13 offset:4096
    v_cvt_pk_bf16_f32 v231, v54, v55
    v_mfma_f32_16x16x32_bf16 v[56:59], a[76:79], a[56:59], v[56:59]
    v_exp_f32 v48, v48
    v_add_f32 v60, v164, v80
    v_add_f32 v61, v165, v80
    v_add_f32 v62, v166, v80
    v_add_f32 v63, v167, v80
    v_exp_f32 v60, v60
    v_exp_f32 v61, v61
    v_exp_f32 v62, v62
    v_cvt_pk_bf16_f32 v250, v60, v61
    v_exp_f32 v63, v63
    v_exp_f32 v49, v49
    v_cvt_pk_bf16_f32 v251, v62, v63
    v_mfma_f32_16x16x32_bf16 v[60:63], a[92:95], a[56:59], v[80:83]
    ds_read_b64_tr_b16 a[230:231], v13 offset:5120
    v_cvt_pk_bf16_f32 v228, v48, v49
    v_mfma_f32_16x16x32_bf16 v[60:63], a[88:91], a[40:43], v[60:63]
    s_add_u32 s51, s51, 0x1000
    s_add_u32 m0, s33, s51
    v_mov_b32 v85, v84
    v_mfma_f32_16x16x32_bf16 v[60:63], a[84:87], a[24:27], v[60:63]
    ds_read_b64_tr_b16 a[232:233], v14 offset:4096
    v_mov_b32 v86, v84
    v_mfma_f32_16x16x32_bf16 v[60:63], a[80:83], a[8:11], v[60:63]
    s_add_u32 s37, s50, 0x4000
    ds_read_b64_tr_b16 a[234:235], v14 offset:5120
    v_mov_b32 v87, v84
    v_add_f32 v68, v180, v84
    v_add_f32 v69, v181, v84
    v_add_f32 v70, v182, v84
    v_add_f32 v71, v183, v84
    v_exp_f32 v68, v68
    v_exp_f32 v69, v69
    v_exp_f32 v70, v70
    v_cvt_pk_bf16_f32 v254, v68, v69
    v_exp_f32 v71, v71
    v_exp_f32 v50, v50
    v_cvt_pk_bf16_f32 v255, v70, v71
    v_mfma_f32_16x16x32_bf16 v[68:71], a[80:83], a[12:15], v[84:87]
    v_exp_f32 v51, v51
    v_mfma_f32_16x16x32_bf16 v[68:71], a[84:87], a[28:31], v[68:71]
    ds_read_b64_tr_b16 a[236:237], v15 offset:4096
    v_cvt_pk_bf16_f32 v229, v50, v51
    v_mfma_f32_16x16x32_bf16 v[68:71], a[88:91], a[44:47], v[68:71]
    ds_read_b64_tr_b16 a[238:239], v15 offset:5120
    v_xor_b32 v25, 1024, v25
    v_mfma_f32_16x16x32_bf16 v[68:71], a[92:95], a[60:63], v[68:71]
    buffer_store_dwordx4 a[148:151], v1, s[80:83], s49 offen sc1
    v_add_f32 v64, v176, v84
    v_add_f32 v65, v177, v84
    v_add_f32 v66, v178, v84
    v_add_f32 v67, v179, v84
    v_exp_f32 v64, v64
    v_exp_f32 v65, v65
    v_exp_f32 v66, v66
    v_cvt_pk_bf16_f32 v252, v64, v65
    v_exp_f32 v67, v67
    v_add_f32 v40, v96, v72
    v_cvt_pk_bf16_f32 v253, v66, v67
    v_mfma_f32_16x16x32_bf16 v[64:67], a[76:79], a[60:63], v[84:87]
    s_lshr_b32 s49, s45, 8
    s_mul_i32 s49, s49, 9216
    s_add_u32 s49, s49, s38
    v_mfma_f32_16x16x32_bf16 v[64:67], a[72:75], a[44:47], v[64:67]
    s_add_u32 s49, s49, s39
    s_add_u32 s45, s45, 4
    ds_read_b64_tr_b16 a[240:241], v16 offset:4096
    v_mfma_f32_16x16x32_bf16 v[64:67], a[68:71], a[28:31], v[64:67]
    buffer_load_dwordx4 v36, s[16:19], s37 offen offset:0 lds
    v_mfma_f32_16x16x32_bf16 v[64:67], a[64:67], a[12:15], v[64:67]
    ds_read_b64_tr_b16 a[242:243], v16 offset:5120
    ds_read_b64_tr_b16 a[244:245], v17 offset:4096
    v_add_f32 v41, v97, v72
    v_add_f32 v42, v98, v72
    v_add_f32 v43, v99, v72
    v_exp_f32 v40, v40
    v_exp_f32 v41, v41
    v_add_f32 v26, v26, v40
    v_cvt_pk_bf16_f32 v240, v40, v41
    v_add_f32 v26, v26, v41
    v_exp_f32 v42, v42
    v_exp_f32 v43, v43
    v_add_f32 v26, v26, v42
    v_cvt_pk_bf16_f32 v241, v42, v43
    v_add_f32 v26, v26, v43
    v_mfma_f32_16x16x32_bf16 v[40:43], a[64:67], a[0:3], v[72:75]
    ds_read_b64_tr_b16 a[246:247], v17 offset:5120
    v_add_f32 v44, v100, v72
    v_mfma_f32_16x16x32_bf16 v[40:43], a[68:71], a[16:19], v[40:43]
    s_add_u32 s37, s50, 0x4c00
    ds_read_b64_tr_b16 a[248:249], v18 offset:4096
    v_add_f32 v45, v101, v72
    v_mfma_f32_16x16x32_bf16 v[40:43], a[72:75], a[32:35], v[40:43]
    ds_read_b64_tr_b16 a[250:251], v18 offset:5120
    v_add_f32 v46, v102, v72
    v_mfma_f32_16x16x32_bf16 v[40:43], a[76:79], a[48:51], v[40:43]
    s_cmp_le_u32 s52, 6
    s_cselect_b64 s[44:45], s[46:47], s[44:45]
    v_add_f32 v47, v103, v72
    v_exp_f32 v44, v44
    v_exp_f32 v45, v45
    v_add_f32 v26, v26, v44
    v_cvt_pk_bf16_f32 v242, v44, v45
    v_add_f32 v26, v26, v45
    v_exp_f32 v46, v46
    v_exp_f32 v47, v47
    v_add_f32 v26, v26, v46
    v_cvt_pk_bf16_f32 v243, v46, v47
    v_add_f32 v26, v26, v47
    v_mfma_f32_16x16x32_bf16 v[44:47], a[92:95], a[48:51], v[72:75]
    v_exp_f32 v56, v56
    v_mfma_f32_16x16x32_bf16 v[44:47], a[88:91], a[32:35], v[44:47]
    ds_read_b64_tr_b16 a[252:253], v19 offset:4096
    v_add_f32 v48, v112, v76
    v_mfma_f32_16x16x32_bf16 v[44:47], a[84:87], a[16:19], v[44:47]
    ds_read_b64_tr_b16 a[254:255], v19 offset:5120
    v_add_f32 v49, v113, v76
    v_mfma_f32_16x16x32_bf16 v[44:47], a[80:83], a[0:3], v[44:47]
    buffer_load_dwordx4 v36, s[16:19], s37 offen offset:1024 lds
    v_add_f32 v52, v116, v76
    v_add_f32 v53, v117, v76
    v_add_f32 v54, v118, v76
    v_add_f32 v55, v119, v76
    v_exp_f32 v52, v52
    v_exp_f32 v53, v53
    v_exp_f32 v54, v54
    v_cvt_pk_bf16_f32 v246, v52, v53
    v_exp_f32 v55, v55
    v_exp_f32 v57, v57
    v_cvt_pk_bf16_f32 v247, v54, v55
    v_mfma_f32_16x16x32_bf16 v[52:55], a[80:83], a[4:7], v[76:79]
    s_cmp_le_u32 s52, 6
    s_cselect_b64 s[46:47], s[24:25], s[46:47]
    v_cvt_pk_bf16_f32 v232, v56, v57
    v_mfma_f32_16x16x32_bf16 v[52:55], a[84:87], a[20:23], v[52:55]
    v_exp_f32 v58, v58
    v_mfma_f32_16x16x32_bf16 v[52:55], a[88:91], a[36:39], v[52:55]
    v_exp_f32 v59, v59
    v_mfma_f32_16x16x32_bf16 v[52:55], a[92:95], a[52:55], v[52:55]
    s_cmp_le_u32 s52, 6
    s_cselect_b64 s[24:25], s[26:27], s[24:25]
    v_cvt_pk_bf16_f32 v233, v58, v59
    v_add_f32 v50, v114, v76
    v_add_f32 v51, v115, v76
    v_exp_f32 v48, v48
    v_exp_f32 v49, v49
    v_exp_f32 v50, v50
    v_cvt_pk_bf16_f32 v244, v48, v49
    v_exp_f32 v51, v51
    v_exp_f32 v60, v60
    v_cvt_pk_bf16_f32 v245, v50, v51
    v_mfma_f32_16x16x32_bf16 v[48:51], a[76:79], a[52:55], v[76:79]
    buffer_load_dwordx4 v37, s[20:23], s50 offen offset:2048 lds
    v_mfma_f32_16x16x32_bf16 v[48:51], a[72:75], a[36:39], v[48:51]
    v_exp_f32 v61, v61
    v_mfma_f32_16x16x32_bf16 v[48:51], a[68:71], a[20:23], v[48:51]
    s_waitcnt lgkmcnt(0)
    v_cvt_pk_bf16_f32 v234, v60, v61
    v_mfma_f32_16x16x32_bf16 v[48:51], a[64:67], a[4:7], v[48:51]
    v_exp_f32 v62, v62
    v_mfma_f32_16x16x32_bf16 v[100:103], a[96:99], v[228:231], 0
    ds_read_b128 a[64:67], v8 offset:4096
    ds_read_b128 a[68:71], v9 offset:4096
    v_mfma_f32_16x16x32_bf16 v[100:103], a[224:227], v[244:247], v[100:103]
    s_add_u32 s37, s50, 0xc00
    v_exp_f32 v63, v63
    v_mfma_f32_16x16x32_bf16 v[96:99], a[224:227], v[240:243], 0
    ds_read_b128 a[72:75], v10 offset:4096
    v_cvt_pk_bf16_f32 v235, v62, v63
    v_mfma_f32_16x16x32_bf16 v[96:99], a[96:99], v[224:227], v[96:99]
    v_exp_f32 v68, v68
    v_mfma_f32_16x16x32_bf16 v[112:115], a[100:103], v[224:227], 0
    v_exp_f32 v69, v69
    v_mfma_f32_16x16x32_bf16 v[112:115], a[228:231], v[240:243], v[112:115]
    ds_read_b128 a[76:79], v11 offset:4096
    v_cvt_pk_bf16_f32 v238, v68, v69
    v_mfma_f32_16x16x32_bf16 v[116:119], a[228:231], v[244:247], 0
    buffer_load_dwordx4 v37, s[20:23], s37 offen offset:3072 lds
    v_mfma_f32_16x16x32_bf16 v[116:119], a[100:103], v[228:231], v[116:119]
    v_exp_f32 v70, v70
    v_mfma_f32_16x16x32_bf16 v[132:135], a[104:107], v[228:231], 0
    v_exp_f32 v71, v71
    v_mfma_f32_16x16x32_bf16 v[132:135], a[232:235], v[244:247], v[132:135]
    ds_read_b128 a[80:83], v8 offset:5120
    v_cvt_pk_bf16_f32 v239, v70, v71
    v_mfma_f32_16x16x32_bf16 v[128:131], a[232:235], v[240:243], 0
    v_exp_f32 v64, v64
    v_mfma_f32_16x16x32_bf16 v[128:131], a[104:107], v[224:227], v[128:131]
    v_exp_f32 v65, v65
    v_mfma_f32_16x16x32_bf16 v[144:147], a[108:111], v[224:227], 0
    s_add_u32 s50, s50, 0x2000
    ds_read_b128 a[84:87], v9 offset:5120
    v_cvt_pk_bf16_f32 v236, v64, v65
    v_mfma_f32_16x16x32_bf16 v[144:147], a[236:239], v[240:243], v[144:147]
    v_exp_f32 v66, v66
    v_mfma_f32_16x16x32_bf16 v[148:151], a[236:239], v[244:247], 0
    v_exp_f32 v67, v67
    v_mfma_f32_16x16x32_bf16 v[148:151], a[108:111], v[228:231], v[148:151]
    ds_read_b128 a[88:91], v10 offset:5120
    v_cvt_pk_bf16_f32 v237, v66, v67
    v_mfma_f32_16x16x32_bf16 v[164:167], a[112:115], v[228:231], 0
    v_exp_f32 v40, v40
    v_mfma_f32_16x16x32_bf16 v[164:167], a[240:243], v[244:247], v[164:167]
    s_add_u32 s51, s51, 0x1000
    v_exp_f32 v41, v41
    v_mfma_f32_16x16x32_bf16 v[160:163], a[240:243], v[240:243], 0
    v_exp_f32 v42, v42
    v_mfma_f32_16x16x32_bf16 v[160:163], a[112:115], v[224:227], v[160:163]
    v_exp_f32 v43, v43
    v_mfma_f32_16x16x32_bf16 v[176:179], a[116:119], v[224:227], 0
    ds_read_b128 a[92:95], v11 offset:5120
    v_add_f32 v26, v26, v40
    v_mfma_f32_16x16x32_bf16 v[176:179], a[244:247], v[240:243], v[176:179]
    v_exp_f32 v44, v44
    v_mfma_f32_16x16x32_bf16 v[180:183], a[244:247], v[244:247], 0
    s_and_b32 s51, s51, 0x7fff
    v_add_f32 v26, v26, v41
    v_add_f32 v26, v26, v42
    v_mfma_f32_16x16x32_bf16 v[180:183], a[116:119], v[228:231], v[180:183]
    v_exp_f32 v45, v45
    v_mfma_f32_16x16x32_bf16 v[196:199], a[120:123], v[228:231], 0
    v_exp_f32 v46, v46
    v_mfma_f32_16x16x32_bf16 v[196:199], a[248:251], v[244:247], v[196:199]
    v_add_f32 v26, v26, v43
    v_add_f32 v26, v26, v44
    v_mfma_f32_16x16x32_bf16 v[192:195], a[248:251], v[240:243], 0
    v_exp_f32 v47, v47
    v_mfma_f32_16x16x32_bf16 v[192:195], a[120:123], v[224:227], v[192:195]
    v_exp_f32 v52, v52
    v_mfma_f32_16x16x32_bf16 v[208:211], a[124:127], v[224:227], 0
    v_cvt_pk_bf16_f32 v224, v40, v41
    v_cvt_pk_bf16_f32 v225, v42, v43
    v_mfma_f32_16x16x32_bf16 v[208:211], a[252:255], v[240:243], v[208:211]
    v_cvt_pk_bf16_f32 v226, v44, v45
    v_cvt_pk_bf16_f32 v227, v46, v47
    v_mfma_f32_16x16x32_bf16 v[212:215], a[252:255], v[244:247], 0
    v_exp_f32 v53, v53
    v_mfma_f32_16x16x32_bf16 v[212:215], a[124:127], v[228:231], v[212:215]
    v_add_f32 v26, v26, v45
    v_add_f32 v26, v26, v46
    v_mfma_f32_16x16x32_bf16 a[132:135], a[144:147], v[228:231], 0
    s_waitcnt vmcnt(16) lgkmcnt(0)
    v_cvt_pk_bf16_f32 v230, v52, v53
    v_add_f32 v26, v26, v47
    v_mfma_f32_16x16x32_bf16 a[132:135], a[144:147], v[244:247], a[132:135]
    s_barrier
    v_exp_f32 v54, v54
    v_mfma_f32_16x16x32_bf16 v[40:43], a[64:67], a[0:3], v[72:75]
    ds_read_b64_tr_b16 a[96:97], v12 offset:8192
    ds_read_b64_tr_b16 a[98:99], v12 offset:9216
    v_mfma_f32_16x16x32_bf16 v[40:43], a[68:71], a[16:19], v[40:43]
    s_add_u32 m0, s33, s51
    v_exp_f32 v55, v55
    v_mfma_f32_16x16x32_bf16 v[40:43], a[72:75], a[32:35], v[40:43]
    ds_read_b64_tr_b16 a[100:101], v13 offset:8192
    v_cvt_pk_bf16_f32 v231, v54, v55
    v_mfma_f32_16x16x32_bf16 v[40:43], a[76:79], a[48:51], v[40:43]
    v_exp_f32 v48, v48
    v_mfma_f32_16x16x32_bf16 v[44:47], a[92:95], a[48:51], v[72:75]
    ds_read_b64_tr_b16 a[102:103], v13 offset:9216
    ds_read_b64_tr_b16 a[104:105], v14 offset:8192
    v_mfma_f32_16x16x32_bf16 v[44:47], a[88:91], a[32:35], v[44:47]
    v_exp_f32 v49, v49
    v_mfma_f32_16x16x32_bf16 v[44:47], a[84:87], a[16:19], v[44:47]
    ds_read_b64_tr_b16 a[106:107], v14 offset:9216
    v_cvt_pk_bf16_f32 v228, v48, v49
    v_mfma_f32_16x16x32_bf16 v[44:47], a[80:83], a[0:3], v[44:47]
    s_add_u32 s37, s50, 0x4000
    v_exp_f32 v50, v50
    v_mfma_f32_16x16x32_bf16 v[52:55], a[80:83], a[4:7], v[76:79]
    v_exp_f32 v51, v51
    v_mfma_f32_16x16x32_bf16 v[52:55], a[84:87], a[20:23], v[52:55]
    ds_read_b64_tr_b16 a[108:109], v15 offset:8192
    v_cvt_pk_bf16_f32 v229, v50, v51
    v_mfma_f32_16x16x32_bf16 v[52:55], a[88:91], a[36:39], v[52:55]
    ds_read_b64_tr_b16 a[110:111], v15 offset:9216
    ds_read_b64_tr_b16 a[112:113], v16 offset:8192
    v_mfma_f32_16x16x32_bf16 v[52:55], a[92:95], a[52:55], v[52:55]
    v_exp_f32 v40, v40
    v_mfma_f32_16x16x32_bf16 v[48:51], a[76:79], a[52:55], v[76:79]
    v_exp_f32 v41, v41
    v_mfma_f32_16x16x32_bf16 v[48:51], a[72:75], a[36:39], v[48:51]
    buffer_load_dwordx4 v36, s[16:19], s37 offen offset:0 lds
    v_mfma_f32_16x16x32_bf16 v[48:51], a[68:71], a[20:23], v[48:51]
    ds_read_b64_tr_b16 a[114:115], v16 offset:9216
    v_cvt_pk_bf16_f32 v240, v40, v41
    v_mfma_f32_16x16x32_bf16 v[48:51], a[64:67], a[4:7], v[48:51]
    ds_read_b64_tr_b16 a[116:117], v17 offset:8192
    v_add_f32 v26, v26, v40
    v_mfma_f32_16x16x32_bf16 v[56:59], a[64:67], a[8:11], v[80:83]
    ds_read_b64_tr_b16 a[118:119], v17 offset:9216
    ds_read_b64_tr_b16 a[120:121], v18 offset:8192
    v_mfma_f32_16x16x32_bf16 v[56:59], a[68:71], a[24:27], v[56:59]
    v_exp_f32 v42, v42
    v_mfma_f32_16x16x32_bf16 v[56:59], a[72:75], a[40:43], v[56:59]
    v_exp_f32 v43, v43
    v_mfma_f32_16x16x32_bf16 v[56:59], a[76:79], a[56:59], v[56:59]
    s_add_u32 s37, s50, 0x4c00
    ds_read_b64_tr_b16 a[122:123], v18 offset:9216
    v_cvt_pk_bf16_f32 v241, v42, v43
    v_mfma_f32_16x16x32_bf16 v[60:63], a[92:95], a[56:59], v[80:83]
    v_exp_f32 v44, v44
    v_mfma_f32_16x16x32_bf16 v[60:63], a[88:91], a[40:43], v[60:63]
    ds_read_b64_tr_b16 a[124:125], v19 offset:8192
    v_add_f32 v26, v26, v41
    v_mfma_f32_16x16x32_bf16 v[60:63], a[84:87], a[24:27], v[60:63]
    ds_read_b64_tr_b16 a[126:127], v19 offset:9216
    v_add_f32 v26, v26, v42
    v_mfma_f32_16x16x32_bf16 v[60:63], a[80:83], a[8:11], v[60:63]
    v_exp_f32 v45, v45
    v_mfma_f32_16x16x32_bf16 v[68:71], a[80:83], a[12:15], v[84:87]
    v_cvt_pk_bf16_f32 v242, v44, v45
    v_add_f32 v26, v26, v43
    v_mfma_f32_16x16x32_bf16 v[68:71], a[84:87], a[28:31], v[68:71]
    buffer_load_dwordx4 v36, s[16:19], s37 offen offset:1024 lds
    v_mfma_f32_16x16x32_bf16 v[68:71], a[88:91], a[44:47], v[68:71]
    v_exp_f32 v46, v46
    v_mfma_f32_16x16x32_bf16 v[68:71], a[92:95], a[60:63], v[68:71]
    v_exp_f32 v47, v47
    v_mfma_f32_16x16x32_bf16 v[64:67], a[76:79], a[60:63], v[84:87]
    v_add_f32 v26, v26, v44
    v_cvt_pk_bf16_f32 v243, v46, v47
    v_mfma_f32_16x16x32_bf16 v[64:67], a[72:75], a[44:47], v[64:67]
    v_exp_f32 v52, v52
    v_mfma_f32_16x16x32_bf16 v[64:67], a[68:71], a[28:31], v[64:67]
    buffer_load_dwordx4 v37, s[20:23], s50 offen offset:2048 lds
    v_mfma_f32_16x16x32_bf16 v[64:67], a[64:67], a[12:15], v[64:67]
    s_waitcnt lgkmcnt(0)
    ds_read_b128 a[64:67], v8 offset:8192
    v_add_f32 v26, v26, v45
    v_mfma_f32_16x16x32_bf16 a[136:139], a[144:147], v[248:251], a[136:139]
    v_exp_f32 v53, v53
    v_mfma_f32_16x16x32_bf16 a[136:139], a[144:147], v[232:235], a[136:139]
    ds_read_b128 a[68:71], v9 offset:8192
    v_add_f32 v26, v26, v46
    v_mfma_f32_16x16x32_bf16 v[108:111], a[224:227], v[252:255], v[108:111]
    ds_read_b128 a[72:75], v10 offset:8192
    v_cvt_pk_bf16_f32 v246, v52, v53
    v_mfma_f32_16x16x32_bf16 v[108:111], a[96:99], v[236:239], v[108:111]
    v_exp_f32 v54, v54
    v_mfma_f32_16x16x32_bf16 v[104:107], a[96:99], v[232:235], v[104:107]
    s_add_u32 s37, s50, 0xc00
    ds_read_b128 a[76:79], v11 offset:8192
    v_add_f32 v26, v26, v47
    v_mfma_f32_16x16x32_bf16 v[104:107], a[224:227], v[248:251], v[104:107]
    v_exp_f32 v55, v55
    v_mfma_f32_16x16x32_bf16 v[120:123], a[228:231], v[248:251], v[120:123]
    ds_read_b128 a[80:83], v8 offset:9216
    v_cvt_pk_bf16_f32 v247, v54, v55
    v_mfma_f32_16x16x32_bf16 v[120:123], a[100:103], v[232:235], v[120:123]
    v_exp_f32 v48, v48
    v_mfma_f32_16x16x32_bf16 v[124:127], a[100:103], v[236:239], v[124:127]
    v_exp_f32 v49, v49
    v_mfma_f32_16x16x32_bf16 v[124:127], a[228:231], v[252:255], v[124:127]
    ds_read_b128 a[84:87], v9 offset:9216
    v_cvt_pk_bf16_f32 v244, v48, v49
    v_mfma_f32_16x16x32_bf16 v[140:143], a[232:235], v[252:255], v[140:143]
    buffer_load_dwordx4 v37, s[20:23], s37 offen offset:3072 lds
    v_mfma_f32_16x16x32_bf16 v[140:143], a[104:107], v[236:239], v[140:143]
    v_exp_f32 v50, v50
    v_mfma_f32_16x16x32_bf16 v[136:139], a[104:107], v[232:235], v[136:139]
    v_exp_f32 v51, v51
    v_mfma_f32_16x16x32_bf16 v[136:139], a[232:235], v[248:251], v[136:139]
    ds_read_b128 a[88:91], v10 offset:9216
    v_cvt_pk_bf16_f32 v245, v50, v51
    v_mfma_f32_16x16x32_bf16 v[152:155], a[236:239], v[248:251], v[152:155]
    v_exp_f32 v56, v56
    v_mfma_f32_16x16x32_bf16 v[152:155], a[108:111], v[232:235], v[152:155]
    v_exp_f32 v57, v57
    v_mfma_f32_16x16x32_bf16 v[156:159], a[108:111], v[236:239], v[156:159]
    s_add_u32 s50, s50, 0x2000
    v_exp_f32 v58, v58
    v_mfma_f32_16x16x32_bf16 v[156:159], a[236:239], v[252:255], v[156:159]
    v_exp_f32 v59, v59
    v_mfma_f32_16x16x32_bf16 v[172:175], a[240:243], v[252:255], v[172:175]
    v_exp_f32 v60, v60
    v_mfma_f32_16x16x32_bf16 v[172:175], a[112:115], v[236:239], v[172:175]
    v_exp_f32 v61, v61
    v_mfma_f32_16x16x32_bf16 v[168:171], a[112:115], v[232:235], v[168:171]
    v_exp_f32 v62, v62
    v_mfma_f32_16x16x32_bf16 v[168:171], a[240:243], v[248:251], v[168:171]
    v_exp_f32 v63, v63
    v_mfma_f32_16x16x32_bf16 v[184:187], a[244:247], v[248:251], v[184:187]
    s_add_u32 s51, s51, 0x1000
    v_exp_f32 v68, v68
    v_mfma_f32_16x16x32_bf16 v[184:187], a[116:119], v[232:235], v[184:187]
    v_exp_f32 v69, v69
    v_mfma_f32_16x16x32_bf16 v[188:191], a[116:119], v[236:239], v[188:191]
    v_exp_f32 v70, v70
    v_mfma_f32_16x16x32_bf16 v[188:191], a[244:247], v[252:255], v[188:191]
    v_exp_f32 v71, v71
    v_mfma_f32_16x16x32_bf16 v[204:207], a[248:251], v[252:255], v[204:207]
    v_exp_f32 v64, v64
    v_mfma_f32_16x16x32_bf16 v[204:207], a[120:123], v[236:239], v[204:207]
    ds_read_b128 a[92:95], v11 offset:9216
    v_mfma_f32_16x16x32_bf16 v[200:203], a[120:123], v[232:235], v[200:203]
    v_exp_f32 v65, v65
    v_mfma_f32_16x16x32_bf16 v[200:203], a[248:251], v[248:251], v[200:203]
    v_exp_f32 v66, v66
    v_mfma_f32_16x16x32_bf16 v[216:219], a[252:255], v[248:251], v[216:219]
    v_cvt_pk_bf16_f32 v248, v56, v57
    v_cvt_pk_bf16_f32 v249, v58, v59
    v_mfma_f32_16x16x32_bf16 v[216:219], a[124:127], v[232:235], v[216:219]
    v_cvt_pk_bf16_f32 v250, v60, v61
    v_cvt_pk_bf16_f32 v251, v62, v63
    v_mfma_f32_16x16x32_bf16 v[220:223], a[124:127], v[236:239], v[220:223]
    v_exp_f32 v67, v67
    v_mfma_f32_16x16x32_bf16 v[220:223], a[252:255], v[252:255], v[220:223]
    v_mfma_f32_16x16x32_bf16 a[140:143], a[144:147], v[252:255], a[140:143]
    s_waitcnt lgkmcnt(0)
    ds_read_b64_tr_b16 a[224:225], v12 offset:12288
    v_cvt_pk_bf16_f32 v254, v68, v69
    v_mfma_f32_16x16x32_bf16 a[140:143], a[144:147], v[236:239], a[140:143]
    ds_read_b64_tr_b16 a[226:227], v12 offset:13312
    v_cvt_pk_bf16_f32 v255, v70, v71
    v_mfma_f32_16x16x32_bf16 v[56:59], a[64:67], a[8:11], v[80:83]
    ds_read_b64_tr_b16 a[228:229], v13 offset:12288
    v_cvt_pk_bf16_f32 v252, v64, v65
    v_mfma_f32_16x16x32_bf16 v[56:59], a[68:71], a[24:27], v[56:59]
    s_add_u32 m0, s33, s51
    ds_read_b64_tr_b16 a[230:231], v13 offset:13312
    v_cvt_pk_bf16_f32 v253, v66, v67
    v_mfma_f32_16x16x32_bf16 v[56:59], a[72:75], a[40:43], v[56:59]
    ds_read_b64_tr_b16 a[232:233], v14 offset:12288
    ds_read_b64_tr_b16 a[234:235], v14 offset:13312
    v_mfma_f32_16x16x32_bf16 v[56:59], a[76:79], a[56:59], v[56:59]
    ds_read_b64_tr_b16 a[236:237], v15 offset:12288
    ds_read_b64_tr_b16 a[238:239], v15 offset:13312
    v_mfma_f32_16x16x32_bf16 v[60:63], a[92:95], a[56:59], v[80:83]
    ds_read_b64_tr_b16 a[240:241], v16 offset:12288
    v_mfma_f32_16x16x32_bf16 v[60:63], a[88:91], a[40:43], v[60:63]
    ds_read_b64_tr_b16 a[242:243], v16 offset:13312
    v_mfma_f32_16x16x32_bf16 v[60:63], a[84:87], a[24:27], v[60:63]
    v_mfma_f32_16x16x32_bf16 v[60:63], a[80:83], a[8:11], v[60:63]
    s_add_u32 s37, s50, 0x4000
    v_exp_f32 v56, v56
    v_mfma_f32_16x16x32_bf16 v[68:71], a[80:83], a[12:15], v[84:87]
    v_exp_f32 v57, v57
    v_mfma_f32_16x16x32_bf16 v[68:71], a[84:87], a[28:31], v[68:71]
    ds_read_b64_tr_b16 a[244:245], v17 offset:12288
    v_cvt_pk_bf16_f32 v232, v56, v57
    v_mfma_f32_16x16x32_bf16 v[68:71], a[88:91], a[44:47], v[68:71]
    v_exp_f32 v58, v58
    v_mfma_f32_16x16x32_bf16 v[68:71], a[92:95], a[60:63], v[68:71]
    v_exp_f32 v59, v59
    v_mfma_f32_16x16x32_bf16 v[64:67], a[76:79], a[60:63], v[84:87]
    buffer_load_dwordx4 v36, s[16:19], s37 offen offset:0 lds
    v_mfma_f32_16x16x32_bf16 v[64:67], a[72:75], a[44:47], v[64:67]
    ds_read_b64_tr_b16 a[246:247], v17 offset:13312
    v_cvt_pk_bf16_f32 v233, v58, v59
    v_mfma_f32_16x16x32_bf16 v[64:67], a[68:71], a[28:31], v[64:67]
    v_exp_f32 v60, v60
    v_mfma_f32_16x16x32_bf16 v[64:67], a[64:67], a[12:15], v[64:67]
    s_sub_u32 s52, s52, 1
    ds_read_b64_tr_b16 a[248:249], v18 offset:12288
    ds_read_b64_tr_b16 a[250:251], v18 offset:13312
    v_mfma_f32_16x16x32_bf16 v[40:43], a[64:67], a[0:3], v[72:75]
    v_exp_f32 v61, v61
    v_mfma_f32_16x16x32_bf16 v[40:43], a[68:71], a[16:19], v[40:43]
    s_add_u32 s37, s50, 0x4c00
    ds_read_b64_tr_b16 a[252:253], v19 offset:12288
    v_cvt_pk_bf16_f32 v234, v60, v61
    v_mfma_f32_16x16x32_bf16 v[40:43], a[72:75], a[32:35], v[40:43]
    v_exp_f32 v62, v62
    v_mfma_f32_16x16x32_bf16 v[40:43], a[76:79], a[48:51], v[40:43]
    v_exp_f32 v63, v63
    v_mfma_f32_16x16x32_bf16 v[44:47], a[92:95], a[48:51], v[72:75]
    ds_read_b64_tr_b16 a[254:255], v19 offset:13312
    v_cvt_pk_bf16_f32 v235, v62, v63
    v_mfma_f32_16x16x32_bf16 v[44:47], a[88:91], a[32:35], v[44:47]
    v_exp_f32 v68, v68
    v_mfma_f32_16x16x32_bf16 v[44:47], a[84:87], a[16:19], v[44:47]
    v_exp_f32 v69, v69
    v_mfma_f32_16x16x32_bf16 v[44:47], a[80:83], a[0:3], v[44:47]
    buffer_load_dwordx4 v36, s[16:19], s37 offen offset:1024 lds
    v_mfma_f32_16x16x32_bf16 v[52:55], a[80:83], a[4:7], v[76:79]
    v_cvt_pk_bf16_f32 v238, v68, v69
    v_add_u32 v12, s34, v12
    v_mfma_f32_16x16x32_bf16 v[52:55], a[84:87], a[20:23], v[52:55]
    v_exp_f32 v70, v70
    v_mfma_f32_16x16x32_bf16 v[52:55], a[88:91], a[36:39], v[52:55]
    v_exp_f32 v71, v71
    v_mfma_f32_16x16x32_bf16 v[52:55], a[92:95], a[52:55], v[52:55]
    v_add_u32 v13, s34, v13
    v_cvt_pk_bf16_f32 v239, v70, v71
    v_mfma_f32_16x16x32_bf16 v[48:51], a[76:79], a[52:55], v[76:79]
    buffer_load_dwordx4 v37, s[20:23], s50 offen offset:2048 lds
    v_mfma_f32_16x16x32_bf16 v[48:51], a[72:75], a[36:39], v[48:51]
    v_exp_f32 v64, v64
    v_mfma_f32_16x16x32_bf16 v[48:51], a[68:71], a[20:23], v[48:51]
    s_waitcnt lgkmcnt(0)
    v_exp_f32 v65, v65
    v_mfma_f32_16x16x32_bf16 v[48:51], a[64:67], a[4:7], v[48:51]
    ds_read_b128 a[64:67], v8 offset:12288
    v_add_u32 v14, s34, v14
    v_mfma_f32_16x16x32_bf16 v[100:103], a[96:99], v[228:231], v[100:103]
    ds_read_b128 a[68:71], v9 offset:12288
    v_cvt_pk_bf16_f32 v236, v64, v65
    v_mfma_f32_16x16x32_bf16 v[100:103], a[224:227], v[244:247], v[100:103]
    s_add_u32 s37, s50, 0xc00
    v_exp_f32 v66, v66
    v_mfma_f32_16x16x32_bf16 v[96:99], a[224:227], v[240:243], v[96:99]
    ds_read_b128 a[72:75], v10 offset:12288
    v_add_u32 v15, s34, v15
    v_mfma_f32_16x16x32_bf16 v[96:99], a[96:99], v[224:227], v[96:99]
    v_exp_f32 v67, v67
    v_mfma_f32_16x16x32_bf16 v[112:115], a[100:103], v[224:227], v[112:115]
    ds_read_b128 a[76:79], v11 offset:12288
    v_cvt_pk_bf16_f32 v237, v66, v67
    v_mfma_f32_16x16x32_bf16 v[112:115], a[228:231], v[240:243], v[112:115]
    ds_read_b128 a[80:83], v8 offset:13312
    v_add_u32 v16, s34, v16
    v_mfma_f32_16x16x32_bf16 v[116:119], a[228:231], v[244:247], v[116:119]
    buffer_load_dwordx4 v37, s[20:23], s37 offen offset:3072 lds
    v_mfma_f32_16x16x32_bf16 v[116:119], a[100:103], v[228:231], v[116:119]
    v_exp_f32 v40, v40
    v_mfma_f32_16x16x32_bf16 v[132:135], a[104:107], v[228:231], v[132:135]
    v_exp_f32 v41, v41
    v_mfma_f32_16x16x32_bf16 v[132:135], a[232:235], v[244:247], v[132:135]
    ds_read_b128 a[84:87], v9 offset:13312
    v_add_u32 v17, s34, v17
    v_mfma_f32_16x16x32_bf16 v[128:131], a[232:235], v[240:243], v[128:131]
    v_exp_f32 v42, v42
    v_mfma_f32_16x16x32_bf16 v[128:131], a[104:107], v[224:227], v[128:131]
    v_exp_f32 v43, v43
    v_mfma_f32_16x16x32_bf16 v[144:147], a[108:111], v[224:227], v[144:147]
    s_add_u32 s50, s50, 0x2000
    ds_read_b128 a[88:91], v10 offset:13312
    v_add_u32 v18, s34, v18
    v_mfma_f32_16x16x32_bf16 v[144:147], a[236:239], v[240:243], v[144:147]
    ds_read_b128 a[92:95], v11 offset:13312
    v_add_f32 v26, v26, v40
    v_mfma_f32_16x16x32_bf16 v[148:151], a[236:239], v[244:247], v[148:151]
    v_exp_f32 v44, v44
    v_mfma_f32_16x16x32_bf16 v[148:151], a[108:111], v[228:231], v[148:151]
    v_add_u32 v19, s34, v19
    v_add_f32 v26, v26, v41
    v_mfma_f32_16x16x32_bf16 v[164:167], a[112:115], v[228:231], v[164:167]
    v_exp_f32 v45, v45
    v_mfma_f32_16x16x32_bf16 v[164:167], a[240:243], v[244:247], v[164:167]
    s_add_u32 s51, s51, 0x1000
    v_add_f32 v26, v26, v42
    v_add_u32 v8, s34, v8
    v_mfma_f32_16x16x32_bf16 v[160:163], a[240:243], v[240:243], v[160:163]
    v_exp_f32 v46, v46
    v_mfma_f32_16x16x32_bf16 v[160:163], a[112:115], v[224:227], v[160:163]
    v_add_f32 v26, v26, v43
    v_add_u32 v9, s34, v9
    v_mfma_f32_16x16x32_bf16 v[176:179], a[116:119], v[224:227], v[176:179]
    v_exp_f32 v47, v47
    v_mfma_f32_16x16x32_bf16 v[176:179], a[244:247], v[240:243], v[176:179]
    v_add_f32 v26, v26, v44
    v_add_f32 v26, v26, v45
    v_mfma_f32_16x16x32_bf16 v[180:183], a[244:247], v[244:247], v[180:183]
    s_and_b32 s51, s51, 0x7fff
    v_exp_f32 v52, v52
    v_mfma_f32_16x16x32_bf16 v[180:183], a[116:119], v[228:231], v[180:183]
    v_exp_f32 v53, v53
    v_mfma_f32_16x16x32_bf16 v[196:199], a[120:123], v[228:231], v[196:199]
    v_add_u32 v10, s34, v10
    v_add_f32 v26, v26, v46
    v_mfma_f32_16x16x32_bf16 v[196:199], a[248:251], v[244:247], v[196:199]
    v_exp_f32 v54, v54
    v_mfma_f32_16x16x32_bf16 v[192:195], a[248:251], v[240:243], v[192:195]
    v_add_u32 v11, s34, v11
    v_add_f32 v26, v26, v47
    v_mfma_f32_16x16x32_bf16 v[192:195], a[120:123], v[224:227], v[192:195]
    v_exp_f32 v55, v55
    v_mfma_f32_16x16x32_bf16 v[208:211], a[124:127], v[224:227], v[208:211]
    v_cvt_pk_bf16_f32 v224, v40, v41
    v_cvt_pk_bf16_f32 v225, v42, v43
    v_mfma_f32_16x16x32_bf16 v[208:211], a[252:255], v[240:243], v[208:211]
    v_cvt_pk_bf16_f32 v226, v44, v45
    v_cvt_pk_bf16_f32 v227, v46, v47
    v_mfma_f32_16x16x32_bf16 v[212:215], a[252:255], v[244:247], v[212:215]
    v_mfma_f32_16x16x32_bf16 v[212:215], a[124:127], v[228:231], v[212:215]
    v_mfma_f32_16x16x32_bf16 a[132:135], a[144:147], v[228:231], a[132:135]
    s_sub_u32 s34, 0, s34
    v_mfma_f32_16x16x32_bf16 a[132:135], a[144:147], v[244:247], a[132:135]
att_k1_7:
    s_waitcnt vmcnt(15) lgkmcnt(0)
    v_cvt_pk_bf16_f32 v230, v52, v53
    v_cvt_pk_bf16_f32 v231, v54, v55
    v_mfma_f32_16x16x32_bf16 v[40:43], a[64:67], a[0:3], v[72:75]
    s_barrier
    v_exp_f32 v48, v48
    v_mfma_f32_16x16x32_bf16 v[40:43], a[68:71], a[16:19], v[40:43]
    s_mov_b32 m0, s48
    v_exp_f32 v49, v49
    v_mfma_f32_16x16x32_bf16 v[40:43], a[72:75], a[32:35], v[40:43]
    ds_read_b64_tr_b16 a[96:97], v12 offset:0
    v_cvt_pk_bf16_f32 v228, v48, v49
    v_mfma_f32_16x16x32_bf16 v[40:43], a[76:79], a[48:51], v[40:43]
    v_exp_f32 v50, v50
    v_mfma_f32_16x16x32_bf16 v[44:47], a[92:95], a[48:51], v[72:75]
    ds_read_b64_tr_b16 a[98:99], v12 offset:1024
    ds_read_b64_tr_b16 a[100:101], v13 offset:0
    v_mfma_f32_16x16x32_bf16 v[44:47], a[88:91], a[32:35], v[44:47]
    v_exp_f32 v51, v51
    v_mfma_f32_16x16x32_bf16 v[44:47], a[84:87], a[16:19], v[44:47]
    ds_read_b64_tr_b16 a[102:103], v13 offset:1024
    v_cvt_pk_bf16_f32 v229, v50, v51
    v_mfma_f32_16x16x32_bf16 v[44:47], a[80:83], a[0:3], v[44:47]
    ds_read_b64_tr_b16 a[104:105], v14 offset:0
    ds_read_b64_tr_b16 a[106:107], v14 offset:1024
    v_mfma_f32_16x16x32_bf16 v[52:55], a[80:83], a[4:7], v[76:79]
    buffer_load_dwordx4 v24, s[76:79], s44 offen lds
    v_mfma_f32_16x16x32_bf16 v[52:55], a[84:87], a[20:23], v[52:55]
    v_exp_f32 v40, v40
    v_mfma_f32_16x16x32_bf16 v[52:55], a[88:91], a[36:39], v[52:55]
    s_xor_b32 s48, s48, 1024
    ds_read_b64_tr_b16 a[108:109], v15 offset:0
    ds_read_b64_tr_b16 a[110:111], v15 offset:1024
    v_mfma_f32_16x16x32_bf16 v[52:55], a[92:95], a[52:55], v[52:55]
    v_exp_f32 v41, v41
    v_mfma_f32_16x16x32_bf16 v[48:51], a[76:79], a[52:55], v[76:79]
    ds_read_b64_tr_b16 a[112:113], v16 offset:0
    v_cvt_pk_bf16_f32 v240, v40, v41
    v_mfma_f32_16x16x32_bf16 v[48:51], a[72:75], a[36:39], v[48:51]
    v_exp_f32 v42, v42
    v_mfma_f32_16x16x32_bf16 v[48:51], a[68:71], a[20:23], v[48:51]
    ds_read_b64_tr_b16 a[114:115], v16 offset:1024
    ds_read_b64_tr_b16 a[116:117], v17 offset:0
    v_mfma_f32_16x16x32_bf16 v[48:51], a[64:67], a[4:7], v[48:51]
    s_add_u32 m0, s33, s51
    v_exp_f32 v43, v43
    v_mfma_f32_16x16x32_bf16 v[56:59], a[64:67], a[8:11], v[80:83]
    ds_read_b64_tr_b16 a[118:119], v17 offset:1024
    v_add_f32 v26, v26, v40
    v_mfma_f32_16x16x32_bf16 v[56:59], a[68:71], a[24:27], v[56:59]
    ds_read_b64_tr_b16 a[120:121], v18 offset:0
    v_cvt_pk_bf16_f32 v241, v42, v43
    v_mfma_f32_16x16x32_bf16 v[56:59], a[72:75], a[40:43], v[56:59]
    v_exp_f32 v44, v44
    v_mfma_f32_16x16x32_bf16 v[56:59], a[76:79], a[56:59], v[56:59]
    s_add_u32 s37, s50, 0x4000
    ds_read_b64_tr_b16 a[122:123], v18 offset:1024
    v_add_f32 v26, v26, v41
    v_mfma_f32_16x16x32_bf16 v[60:63], a[92:95], a[56:59], v[80:83]
    v_exp_f32 v45, v45
    v_mfma_f32_16x16x32_bf16 v[60:63], a[88:91], a[40:43], v[60:63]
    ds_read_b64_tr_b16 a[124:125], v19 offset:0
    v_add_f32 v26, v26, v42
    v_mfma_f32_16x16x32_bf16 v[60:63], a[84:87], a[24:27], v[60:63]
    ds_read_b64_tr_b16 a[126:127], v19 offset:1024
    v_cvt_pk_bf16_f32 v242, v44, v45
    v_mfma_f32_16x16x32_bf16 v[60:63], a[80:83], a[8:11], v[60:63]
    ds_read_b64_tr_b16 a[148:149], v25 offset:0
    ds_read_b64_tr_b16 a[150:151], v25 offset:512
    v_mfma_f32_16x16x32_bf16 v[68:71], a[80:83], a[12:15], v[84:87]
    v_exp_f32 v46, v46
    v_mfma_f32_16x16x32_bf16 v[68:71], a[84:87], a[28:31], v[68:71]
    v_add_f32 v26, v26, v43
    v_add_f32 v26, v26, v44
    v_mfma_f32_16x16x32_bf16 v[68:71], a[88:91], a[44:47], v[68:71]
    v_exp_f32 v47, v47
    v_mfma_f32_16x16x32_bf16 v[68:71], a[92:95], a[60:63], v[68:71]
    v_cvt_pk_bf16_f32 v243, v46, v47
    v_add_f32 v26, v26, v45
    v_mfma_f32_16x16x32_bf16 v[64:67], a[76:79], a[60:63], v[84:87]
    buffer_load_dwordx4 v36, s[16:19], s37 offen offset:0 lds
    v_mfma_f32_16x16x32_bf16 v[64:67], a[72:75], a[44:47], v[64:67]
    s_add_u32 s37, s50, 0x4c00
    v_exp_f32 v52, v52
    v_mfma_f32_16x16x32_bf16 v[64:67], a[68:71], a[28:31], v[64:67]
    s_waitcnt lgkmcnt(0)
    v_exp_f32 v53, v53
    v_mfma_f32_16x16x32_bf16 v[64:67], a[64:67], a[12:15], v[64:67]
    ds_read_b128 a[64:67], v8 offset:0
    v_add_f32 v26, v26, v46
    v_mfma_f32_16x16x32_bf16 a[136:139], a[144:147], v[248:251], a[136:139]
    ds_read_b128 a[68:71], v9 offset:0
    v_cvt_pk_bf16_f32 v246, v52, v53
    v_mfma_f32_16x16x32_bf16 a[136:139], a[144:147], v[232:235], a[136:139]
    v_exp_f32 v54, v54
    v_mfma_f32_16x16x32_bf16 v[108:111], a[224:227], v[252:255], v[108:111]
    ds_read_b128 a[72:75], v10 offset:0
    v_add_f32 v26, v26, v47
    v_mfma_f32_16x16x32_bf16 v[108:111], a[96:99], v[236:239], v[108:111]
    s_add_u32 s44, s44, 128
    v_exp_f32 v55, v55
    v_mfma_f32_16x16x32_bf16 v[104:107], a[96:99], v[232:235], v[104:107]
    ds_read_b128 a[76:79], v11 offset:0
    v_cvt_pk_bf16_f32 v247, v54, v55
    v_mfma_f32_16x16x32_bf16 v[104:107], a[224:227], v[248:251], v[104:107]
    buffer_store_dwordx4 a[148:151], v1, s[80:83], s49 offen sc1
    v_mfma_f32_16x16x32_bf16 v[120:123], a[228:231], v[248:251], v[120:123]
    s_lshr_b32 s49, s45, 8
    v_exp_f32 v48, v48
    v_mfma_f32_16x16x32_bf16 v[120:123], a[100:103], v[232:235], v[120:123]
    buffer_load_dwordx4 v36, s[16:19], s37 offen offset:1024 lds
    v_mfma_f32_16x16x32_bf16 v[124:127], a[100:103], v[236:239], v[124:127]
    s_mul_i32 s49, s49, 9216
    v_exp_f32 v49, v49
    v_mfma_f32_16x16x32_bf16 v[124:127], a[228:231], v[252:255], v[124:127]
    s_and_b32 s38, s45, 255
    ds_read_b128 a[80:83], v8 offset:1024
    v_cvt_pk_bf16_f32 v244, v48, v49
    v_mfma_f32_16x16x32_bf16 v[140:143], a[232:235], v[252:255], v[140:143]
    s_add_u32 s37, s50, 0xc00
    v_exp_f32 v50, v50
    v_mfma_f32_16x16x32_bf16 v[140:143], a[104:107], v[236:239], v[140:143]
    buffer_load_dwordx4 v37, s[20:23], s50 offen offset:2048 lds
    v_mfma_f32_16x16x32_bf16 v[136:139], a[104:107], v[232:235], v[136:139]
    s_mul_i32 s39, s38, 57
    v_exp_f32 v51, v51
    v_mfma_f32_16x16x32_bf16 v[136:139], a[232:235], v[248:251], v[136:139]
    ds_read_b128 a[84:87], v9 offset:1024
    v_xor_b32 v25, 1024, v25
    v_mfma_f32_16x16x32_bf16 v[152:155], a[236:239], v[248:251], v[152:155]
    s_lshr_b32 s39, s39, 9
    ds_read_b128 a[88:91], v10 offset:1024
    v_cvt_pk_bf16_f32 v245, v50, v51
    v_mfma_f32_16x16x32_bf16 v[152:155], a[108:111], v[232:235], v[152:155]
    v_exp_f32 v56, v56
    v_mfma_f32_16x16x32_bf16 v[156:159], a[108:111], v[236:239], v[156:159]
    v_exp_f32 v57, v57
    v_mfma_f32_16x16x32_bf16 v[156:159], a[236:239], v[252:255], v[156:159]
    s_mul_i32 s39, s39, 2497536
    v_exp_f32 v58, v58
    v_mfma_f32_16x16x32_bf16 v[172:175], a[240:243], v[252:255], v[172:175]
    v_exp_f32 v59, v59
    v_mfma_f32_16x16x32_bf16 v[172:175], a[112:115], v[236:239], v[172:175]
    buffer_load_dwordx4 v37, s[20:23], s37 offen offset:3072 lds
    v_mfma_f32_16x16x32_bf16 v[168:171], a[112:115], v[232:235], v[168:171]
    s_add_u32 s50, s50, 0x2000
    v_exp_f32 v60, v60
    v_mfma_f32_16x16x32_bf16 v[168:171], a[240:243], v[248:251], v[168:171]
    s_lshl_b32 s38, s38, 10
    v_exp_f32 v61, v61
    v_mfma_f32_16x16x32_bf16 v[184:187], a[244:247], v[248:251], v[184:187]
    s_add_u32 s49, s49, s38
    v_exp_f32 v62, v62
    v_mfma_f32_16x16x32_bf16 v[184:187], a[116:119], v[232:235], v[184:187]
    s_add_u32 s51, s51, 0x1000
    v_exp_f32 v63, v63
    v_mfma_f32_16x16x32_bf16 v[188:191], a[116:119], v[236:239], v[188:191]
    s_add_u32 s49, s49, s39
    v_exp_f32 v68, v68
    v_mfma_f32_16x16x32_bf16 v[188:191], a[244:247], v[252:255], v[188:191]
    v_exp_f32 v69, v69
    v_mfma_f32_16x16x32_bf16 v[204:207], a[248:251], v[252:255], v[204:207]
    v_exp_f32 v70, v70
    v_mfma_f32_16x16x32_bf16 v[204:207], a[120:123], v[236:239], v[204:207]
    s_add_u32 s45, s45, 4
    ds_read_b128 a[92:95], v11 offset:1024
    v_mfma_f32_16x16x32_bf16 v[200:203], a[120:123], v[232:235], v[200:203]
    v_exp_f32 v71, v71
    v_mfma_f32_16x16x32_bf16 v[200:203], a[248:251], v[248:251], v[200:203]
    v_exp_f32 v64, v64
    v_mfma_f32_16x16x32_bf16 v[216:219], a[252:255], v[248:251], v[216:219]
    v_cvt_pk_bf16_f32 v248, v56, v57
    v_cvt_pk_bf16_f32 v249, v58, v59
    v_mfma_f32_16x16x32_bf16 v[216:219], a[124:127], v[232:235], v[216:219]
    v_cvt_pk_bf16_f32 v250, v60, v61
    v_cvt_pk_bf16_f32 v251, v62, v63
    v_mfma_f32_16x16x32_bf16 v[220:223], a[124:127], v[236:239], v[220:223]
    v_exp_f32 v65, v65
    v_mfma_f32_16x16x32_bf16 v[220:223], a[252:255], v[252:255], v[220:223]
    v_exp_f32 v66, v66
    v_mfma_f32_16x16x32_bf16 a[140:143], a[144:147], v[252:255], a[140:143]
    s_waitcnt lgkmcnt(0)
    ds_read_b64_tr_b16 a[224:225], v12 offset:4096
    v_cvt_pk_bf16_f32 v254, v68, v69
    v_mfma_f32_16x16x32_bf16 a[140:143], a[144:147], v[236:239], a[140:143]
    ds_read_b64_tr_b16 a[226:227], v12 offset:5120
    v_cvt_pk_bf16_f32 v255, v70, v71
    v_mfma_f32_16x16x32_bf16 v[56:59], a[64:67], a[8:11], v[80:83]
    ds_read_b64_tr_b16 a[228:229], v13 offset:4096
    v_cvt_pk_bf16_f32 v252, v64, v65
    v_mfma_f32_16x16x32_bf16 v[56:59], a[68:71], a[24:27], v[56:59]
    s_cmp_le_u32 s52, 6
    s_cselect_b64 s[44:45], s[46:47], s[44:45]
    s_add_u32 m0, s33, s51
    v_mfma_f32_16x16x32_bf16 v[56:59], a[72:75], a[40:43], v[56:59]
    v_exp_f32 v67, v67
    v_mfma_f32_16x16x32_bf16 v[56:59], a[76:79], a[56:59], v[56:59]
    ds_read_b64_tr_b16 a[230:231], v13 offset:5120
    v_cvt_pk_bf16_f32 v253, v66, v67
    v_mfma_f32_16x16x32_bf16 v[60:63], a[92:95], a[56:59], v[80:83]
    ds_read_b64_tr_b16 a[232:233], v14 offset:4096
    ds_read_b64_tr_b16 a[234:235], v14 offset:5120
    v_mfma_f32_16x16x32_bf16 v[60:63], a[88:91], a[40:43], v[60:63]
    s_cmp_le_u32 s52, 6
    s_cselect_b64 s[46:47], s[24:25], s[46:47]
    ds_read_b64_tr_b16 a[236:237], v15 offset:4096
    v_mfma_f32_16x16x32_bf16 v[60:63], a[84:87], a[24:27], v[60:63]
    v_exp_f32 v56, v56
    v_mfma_f32_16x16x32_bf16 v[60:63], a[80:83], a[8:11], v[60:63]
    s_add_u32 s37, s50, 0x4000
    v_exp_f32 v57, v57
    v_mfma_f32_16x16x32_bf16 v[68:71], a[80:83], a[12:15], v[84:87]
    ds_read_b64_tr_b16 a[238:239], v15 offset:5120
    v_cvt_pk_bf16_f32 v232, v56, v57
    v_mfma_f32_16x16x32_bf16 v[68:71], a[84:87], a[28:31], v[68:71]
    s_cmp_le_u32 s52, 6
    s_cselect_b64 s[24:25], s[26:27], s[24:25]
    ds_read_b64_tr_b16 a[240:241], v16 offset:4096
    v_mfma_f32_16x16x32_bf16 v[68:71], a[88:91], a[44:47], v[68:71]
    v_exp_f32 v58, v58
    v_mfma_f32_16x16x32_bf16 v[68:71], a[92:95], a[60:63], v[68:71]
    ds_read_b64_tr_b16 a[242:243], v16 offset:5120
    ds_read_b64_tr_b16 a[244:245], v17 offset:4096
    v_mfma_f32_16x16x32_bf16 v[64:67], a[76:79], a[60:63], v[84:87]
    buffer_load_dwordx4 v36, s[16:19], s37 offen offset:0 lds
    v_mfma_f32_16x16x32_bf16 v[64:67], a[72:75], a[44:47], v[64:67]
    v_exp_f32 v59, v59
    v_mfma_f32_16x16x32_bf16 v[64:67], a[68:71], a[28:31], v[64:67]
    ds_read_b64_tr_b16 a[246:247], v17 offset:5120
    v_cvt_pk_bf16_f32 v233, v58, v59
    v_mfma_f32_16x16x32_bf16 v[64:67], a[64:67], a[12:15], v[64:67]
    v_exp_f32 v60, v60
    v_mfma_f32_16x16x32_bf16 v[40:43], a[64:67], a[0:3], v[72:75]
    ds_read_b64_tr_b16 a[248:249], v18 offset:4096
    ds_read_b64_tr_b16 a[250:251], v18 offset:5120
    v_mfma_f32_16x16x32_bf16 v[40:43], a[68:71], a[16:19], v[40:43]
    s_add_u32 s37, s50, 0x4c00
    v_exp_f32 v61, v61
    v_mfma_f32_16x16x32_bf16 v[40:43], a[72:75], a[32:35], v[40:43]
    ds_read_b64_tr_b16 a[252:253], v19 offset:4096
    v_cvt_pk_bf16_f32 v234, v60, v61
    v_mfma_f32_16x16x32_bf16 v[40:43], a[76:79], a[48:51], v[40:43]
    v_exp_f32 v62, v62
    v_mfma_f32_16x16x32_bf16 v[44:47], a[92:95], a[48:51], v[72:75]
    v_exp_f32 v63, v63
    v_mfma_f32_16x16x32_bf16 v[44:47], a[88:91], a[32:35], v[44:47]
    ds_read_b64_tr_b16 a[254:255], v19 offset:5120
    v_cvt_pk_bf16_f32 v235, v62, v63
    v_mfma_f32_16x16x32_bf16 v[44:47], a[84:87], a[16:19], v[44:47]
    v_exp_f32 v68, v68
    v_mfma_f32_16x16x32_bf16 v[44:47], a[80:83], a[0:3], v[44:47]
    buffer_load_dwordx4 v36, s[16:19], s37 offen offset:1024 lds
    v_mfma_f32_16x16x32_bf16 v[52:55], a[80:83], a[4:7], v[76:79]
    v_exp_f32 v69, v69
    v_mfma_f32_16x16x32_bf16 v[52:55], a[84:87], a[20:23], v[52:55]
    v_exp_f32 v70, v70
    v_mfma_f32_16x16x32_bf16 v[52:55], a[88:91], a[36:39], v[52:55]
    v_exp_f32 v71, v71
    v_mfma_f32_16x16x32_bf16 v[52:55], a[92:95], a[52:55], v[52:55]
    v_cvt_pk_bf16_f32 v238, v68, v69
    v_cvt_pk_bf16_f32 v239, v70, v71
    v_mfma_f32_16x16x32_bf16 v[48:51], a[76:79], a[52:55], v[76:79]
    buffer_load_dwordx4 v37, s[20:23], s50 offen offset:2048 lds
    v_mfma_f32_16x16x32_bf16 v[48:51], a[72:75], a[36:39], v[48:51]
    v_exp_f32 v64, v64
    v_mfma_f32_16x16x32_bf16 v[48:51], a[68:71], a[20:23], v[48:51]
    s_waitcnt lgkmcnt(0)
    v_exp_f32 v65, v65
    v_mfma_f32_16x16x32_bf16 v[48:51], a[64:67], a[4:7], v[48:51]
    ds_read_b128 a[64:67], v8 offset:4096
    v_cvt_pk_bf16_f32 v236, v64, v65
    v_mfma_f32_16x16x32_bf16 v[100:103], a[96:99], v[228:231], v[100:103]
    ds_read_b128 a[68:71], v9 offset:4096
    ds_read_b128 a[72:75], v10 offset:4096
    v_mfma_f32_16x16x32_bf16 v[100:103], a[224:227], v[244:247], v[100:103]
    s_add_u32 s37, s50, 0xc00
    v_exp_f32 v66, v66
    v_mfma_f32_16x16x32_bf16 v[96:99], a[224:227], v[240:243], v[96:99]
    v_exp_f32 v67, v67
    v_mfma_f32_16x16x32_bf16 v[96:99], a[96:99], v[224:227], v[96:99]
    ds_read_b128 a[76:79], v11 offset:4096
    v_cvt_pk_bf16_f32 v237, v66, v67
    v_mfma_f32_16x16x32_bf16 v[112:115], a[100:103], v[224:227], v[112:115]
    v_exp_f32 v40, v40
    v_mfma_f32_16x16x32_bf16 v[112:115], a[228:231], v[240:243], v[112:115]
    v_exp_f32 v41, v41
    v_mfma_f32_16x16x32_bf16 v[116:119], a[228:231], v[244:247], v[116:119]
    buffer_load_dwordx4 v37, s[20:23], s37 offen offset:3072 lds
    v_mfma_f32_16x16x32_bf16 v[116:119], a[100:103], v[228:231], v[116:119]
    v_exp_f32 v42, v42
    v_mfma_f32_16x16x32_bf16 v[132:135], a[104:107], v[228:231], v[132:135]
    ds_read_b128 a[80:83], v8 offset:5120
    v_add_f32 v26, v26, v40
    v_mfma_f32_16x16x32_bf16 v[132:135], a[232:235], v[244:247], v[132:135]
    v_exp_f32 v43, v43
    v_mfma_f32_16x16x32_bf16 v[128:131], a[232:235], v[240:243], v[128:131]
    ds_read_b128 a[84:87], v9 offset:5120
    v_add_f32 v26, v26, v41
    v_mfma_f32_16x16x32_bf16 v[128:131], a[104:107], v[224:227], v[128:131]
    v_exp_f32 v44, v44
    v_mfma_f32_16x16x32_bf16 v[144:147], a[108:111], v[224:227], v[144:147]
    s_add_u32 s50, s50, 0x2000
    v_exp_f32 v45, v45
    v_mfma_f32_16x16x32_bf16 v[144:147], a[236:239], v[240:243], v[144:147]
    ds_read_b128 a[88:91], v10 offset:5120
    v_add_f32 v26, v26, v42
    v_mfma_f32_16x16x32_bf16 v[148:151], a[236:239], v[244:247], v[148:151]
    v_exp_f32 v46, v46
    v_mfma_f32_16x16x32_bf16 v[148:151], a[108:111], v[228:231], v[148:151]
    ds_read_b128 a[92:95], v11 offset:5120
    v_add_f32 v26, v26, v43
    v_mfma_f32_16x16x32_bf16 v[164:167], a[112:115], v[228:231], v[164:167]
    v_exp_f32 v47, v47
    v_mfma_f32_16x16x32_bf16 v[164:167], a[240:243], v[244:247], v[164:167]
    s_add_u32 s51, s51, 0x1000
    v_add_f32 v26, v26, v44
    v_add_f32 v26, v26, v45
    v_mfma_f32_16x16x32_bf16 v[160:163], a[240:243], v[240:243], v[160:163]
    v_exp_f32 v52, v52
    v_mfma_f32_16x16x32_bf16 v[160:163], a[112:115], v[224:227], v[160:163]
    v_exp_f32 v53, v53
    v_mfma_f32_16x16x32_bf16 v[176:179], a[116:119], v[224:227], v[176:179]
    v_exp_f32 v54, v54
    v_mfma_f32_16x16x32_bf16 v[176:179], a[244:247], v[240:243], v[176:179]
    v_add_f32 v26, v26, v46
    v_add_f32 v26, v26, v47
    v_mfma_f32_16x16x32_bf16 v[180:183], a[244:247], v[244:247], v[180:183]
    s_and_b32 s51, s51, 0x7fff
    v_exp_f32 v55, v55
    v_mfma_f32_16x16x32_bf16 v[180:183], a[116:119], v[228:231], v[180:183]
    v_exp_f32 v48, v48
    v_mfma_f32_16x16x32_bf16 v[196:199], a[120:123], v[228:231], v[196:199]
    v_exp_f32 v49, v49
    v_mfma_f32_16x16x32_bf16 v[196:199], a[248:251], v[244:247], v[196:199]
    v_mfma_f32_16x16x32_bf16 v[192:195], a[248:251], v[240:243], v[192:195]
    v_mfma_f32_16x16x32_bf16 v[192:195], a[120:123], v[224:227], v[192:195]
    v_exp_f32 v50, v50
    v_mfma_f32_16x16x32_bf16 v[208:211], a[124:127], v[224:227], v[208:211]
    v_cvt_pk_bf16_f32 v224, v40, v41
    v_cvt_pk_bf16_f32 v225, v42, v43
    v_mfma_f32_16x16x32_bf16 v[208:211], a[252:255], v[240:243], v[208:211]
    v_cvt_pk_bf16_f32 v226, v44, v45
    v_cvt_pk_bf16_f32 v227, v46, v47
    v_mfma_f32_16x16x32_bf16 v[212:215], a[252:255], v[244:247], v[212:215]
    v_exp_f32 v51, v51
    v_mfma_f32_16x16x32_bf16 v[212:215], a[124:127], v[228:231], v[212:215]
    v_mfma_f32_16x16x32_bf16 a[132:135], a[144:147], v[228:231], a[132:135]
    s_waitcnt vmcnt(16) lgkmcnt(0)
    v_cvt_pk_bf16_f32 v230, v52, v53
    v_cvt_pk_bf16_f32 v231, v54, v55
    v_mfma_f32_16x16x32_bf16 a[132:135], a[144:147], v[244:247], a[132:135]
    s_barrier
    v_cvt_pk_bf16_f32 v228, v48, v49
    v_cvt_pk_bf16_f32 v229, v50, v51
    v_mfma_f32_16x16x32_bf16 v[40:43], a[64:67], a[0:3], v[72:75]
    s_cmp_eq_u32 s52, s15
    s_cbranch_scc1 sig_k1_6
    sig_k1_6r:
    ds_read_b64_tr_b16 a[96:97], v12 offset:8192
    v_mfma_f32_16x16x32_bf16 v[40:43], a[68:71], a[16:19], v[40:43]
    s_add_u32 m0, s33, s51
    ds_read_b64_tr_b16 a[98:99], v12 offset:9216
    ds_read_b64_tr_b16 a[100:101], v13 offset:8192
    v_mfma_f32_16x16x32_bf16 v[40:43], a[72:75], a[32:35], v[40:43]
    ds_read_b64_tr_b16 a[102:103], v13 offset:9216
    ds_read_b64_tr_b16 a[104:105], v14 offset:8192
    v_mfma_f32_16x16x32_bf16 v[40:43], a[76:79], a[48:51], v[40:43]
    ds_read_b64_tr_b16 a[106:107], v14 offset:9216
    ds_read_b64_tr_b16 a[108:109], v15 offset:8192
    v_mfma_f32_16x16x32_bf16 v[44:47], a[92:95], a[48:51], v[72:75]
    ds_read_b64_tr_b16 a[110:111], v15 offset:9216
    ds_read_b64_tr_b16 a[112:113], v16 offset:8192
    v_mfma_f32_16x16x32_bf16 v[44:47], a[88:91], a[32:35], v[44:47]
    ds_read_b64_tr_b16 a[114:115], v16 offset:9216
    v_mfma_f32_16x16x32_bf16 v[44:47], a[84:87], a[16:19], v[44:47]
    v_exp_f32 v40, v40
    v_mfma_f32_16x16x32_bf16 v[44:47], a[80:83], a[0:3], v[44:47]
    s_add_u32 s37, s50, 0x4000
    v_exp_f32 v41, v41
    v_mfma_f32_16x16x32_bf16 v[52:55], a[80:83], a[4:7], v[76:79]
    ds_read_b64_tr_b16 a[116:117], v17 offset:8192
    v_cvt_pk_bf16_f32 v240, v40, v41
    v_mfma_f32_16x16x32_bf16 v[52:55], a[84:87], a[20:23], v[52:55]
    v_exp_f32 v42, v42
    v_mfma_f32_16x16x32_bf16 v[52:55], a[88:91], a[36:39], v[52:55]
    v_exp_f32 v43, v43
    v_mfma_f32_16x16x32_bf16 v[52:55], a[92:95], a[52:55], v[52:55]
    ds_read_b64_tr_b16 a[118:119], v17 offset:9216
    v_add_f32 v26, v26, v40
    v_mfma_f32_16x16x32_bf16 v[48:51], a[76:79], a[52:55], v[76:79]
    ds_read_b64_tr_b16 a[120:121], v18 offset:8192
    v_cvt_pk_bf16_f32 v241, v42, v43
    v_mfma_f32_16x16x32_bf16 v[48:51], a[72:75], a[36:39], v[48:51]
    buffer_load_dwordx4 v36, s[16:19], s37 offen offset:0 lds
    v_mfma_f32_16x16x32_bf16 v[48:51], a[68:71], a[20:23], v[48:51]
    v_exp_f32 v44, v44
    v_mfma_f32_16x16x32_bf16 v[48:51], a[64:67], a[4:7], v[48:51]
    ds_read_b64_tr_b16 a[122:123], v18 offset:9216
    v_add_f32 v26, v26, v41
    v_mfma_f32_16x16x32_bf16 v[56:59], a[64:67], a[8:11], v[80:83]
    v_exp_f32 v45, v45
    v_mfma_f32_16x16x32_bf16 v[56:59], a[68:71], a[24:27], v[56:59]
    ds_read_b64_tr_b16 a[124:125], v19 offset:8192
    v_add_f32 v26, v26, v42
    v_mfma_f32_16x16x32_bf16 v[56:59], a[72:75], a[40:43], v[56:59]
    ds_read_b64_tr_b16 a[126:127], v19 offset:9216
    v_cvt_pk_bf16_f32 v242, v44, v45
    v_mfma_f32_16x16x32_bf16 v[56:59], a[76:79], a[56:59], v[56:59]
    s_add_u32 s37, s50, 0x4c00
    v_exp_f32 v46, v46
    v_mfma_f32_16x16x32_bf16 v[60:63], a[92:95], a[56:59], v[80:83]
    v_add_f32 v26, v26, v43
    v_add_f32 v26, v26, v44
    v_mfma_f32_16x16x32_bf16 v[60:63], a[88:91], a[40:43], v[60:63]
    v_exp_f32 v47, v47
    v_mfma_f32_16x16x32_bf16 v[60:63], a[84:87], a[24:27], v[60:63]
    v_cvt_pk_bf16_f32 v243, v46, v47
    v_add_f32 v26, v26, v45
    v_mfma_f32_16x16x32_bf16 v[60:63], a[80:83], a[8:11], v[60:63]
    v_exp_f32 v52, v52
    v_mfma_f32_16x16x32_bf16 v[68:71], a[80:83], a[12:15], v[84:87]
    v_exp_f32 v53, v53
    v_mfma_f32_16x16x32_bf16 v[68:71], a[84:87], a[28:31], v[68:71]
    buffer_load_dwordx4 v36, s[16:19], s37 offen offset:1024 lds
    v_mfma_f32_16x16x32_bf16 v[68:71], a[88:91], a[44:47], v[68:71]
    v_add_f32 v26, v26, v46
    v_cvt_pk_bf16_f32 v246, v52, v53
    v_mfma_f32_16x16x32_bf16 v[68:71], a[92:95], a[60:63], v[68:71]
    v_exp_f32 v54, v54
    v_mfma_f32_16x16x32_bf16 v[64:67], a[76:79], a[60:63], v[84:87]
    v_exp_f32 v55, v55
    v_mfma_f32_16x16x32_bf16 v[64:67], a[72:75], a[44:47], v[64:67]
    v_add_f32 v26, v26, v47
    v_cvt_pk_bf16_f32 v247, v54, v55
    v_mfma_f32_16x16x32_bf16 v[64:67], a[68:71], a[28:31], v[64:67]
    buffer_load_dwordx4 v37, s[20:23], s50 offen offset:2048 lds
    v_mfma_f32_16x16x32_bf16 v[64:67], a[64:67], a[12:15], v[64:67]
    s_waitcnt lgkmcnt(0)
    ds_read_b128 a[64:67], v8 offset:8192
    ds_read_b128 a[68:71], v9 offset:8192
    v_mfma_f32_16x16x32_bf16 a[136:139], a[144:147], v[248:251], a[136:139]
    v_exp_f32 v48, v48
    v_mfma_f32_16x16x32_bf16 a[136:139], a[144:147], v[232:235], a[136:139]
    v_exp_f32 v49, v49
    v_mfma_f32_16x16x32_bf16 v[108:111], a[224:227], v[252:255], v[108:111]
    ds_read_b128 a[72:75], v10 offset:8192
    v_cvt_pk_bf16_f32 v244, v48, v49
    v_mfma_f32_16x16x32_bf16 v[108:111], a[96:99], v[236:239], v[108:111]
    v_exp_f32 v50, v50
    v_mfma_f32_16x16x32_bf16 v[104:107], a[96:99], v[232:235], v[104:107]
    s_add_u32 s37, s50, 0xc00
    v_exp_f32 v51, v51
    v_mfma_f32_16x16x32_bf16 v[104:107], a[224:227], v[248:251], v[104:107]
    ds_read_b128 a[76:79], v11 offset:8192
    v_cvt_pk_bf16_f32 v245, v50, v51
    v_mfma_f32_16x16x32_bf16 v[120:123], a[228:231], v[248:251], v[120:123]
    v_exp_f32 v56, v56
    v_mfma_f32_16x16x32_bf16 v[120:123], a[100:103], v[232:235], v[120:123]
    v_exp_f32 v57, v57
    v_mfma_f32_16x16x32_bf16 v[124:127], a[100:103], v[236:239], v[124:127]
    ds_read_b128 a[80:83], v8 offset:9216
    ds_read_b128 a[84:87], v9 offset:9216
    v_mfma_f32_16x16x32_bf16 v[124:127], a[228:231], v[252:255], v[124:127]
    v_exp_f32 v58, v58
    v_mfma_f32_16x16x32_bf16 v[140:143], a[232:235], v[252:255], v[140:143]
    buffer_load_dwordx4 v37, s[20:23], s37 offen offset:3072 lds
    v_mfma_f32_16x16x32_bf16 v[140:143], a[104:107], v[236:239], v[140:143]
    v_exp_f32 v59, v59
    v_mfma_f32_16x16x32_bf16 v[136:139], a[104:107], v[232:235], v[136:139]
    v_exp_f32 v60, v60
    v_mfma_f32_16x16x32_bf16 v[136:139], a[232:235], v[248:251], v[136:139]
    ds_read_b128 a[88:91], v10 offset:9216
    ds_read_b128 a[92:95], v11 offset:9216
    v_mfma_f32_16x16x32_bf16 v[152:155], a[236:239], v[248:251], v[152:155]
    v_exp_f32 v61, v61
    v_mfma_f32_16x16x32_bf16 v[152:155], a[108:111], v[232:235], v[152:155]
    v_exp_f32 v62, v62
    v_mfma_f32_16x16x32_bf16 v[156:159], a[108:111], v[236:239], v[156:159]
    s_add_u32 s50, s50, 0x2000
    v_exp_f32 v63, v63
    v_mfma_f32_16x16x32_bf16 v[156:159], a[236:239], v[252:255], v[156:159]
    v_exp_f32 v68, v68
    v_mfma_f32_16x16x32_bf16 v[172:175], a[240:243], v[252:255], v[172:175]
    v_exp_f32 v69, v69
    v_mfma_f32_16x16x32_bf16 v[172:175], a[112:115], v[236:239], v[172:175]
    v_mfma_f32_16x16x32_bf16 v[168:171], a[112:115], v[232:235], v[168:171]
    v_exp_f32 v70, v70
    v_mfma_f32_16x16x32_bf16 v[168:171], a[240:243], v[248:251], v[168:171]
    v_mfma_f32_16x16x32_bf16 v[184:187], a[244:247], v[248:251], v[184:187]
    s_add_u32 s51, s51, 0x1000
    v_exp_f32 v71, v71
    v_mfma_f32_16x16x32_bf16 v[184:187], a[116:119], v[232:235], v[184:187]
    v_mfma_f32_16x16x32_bf16 v[188:191], a[116:119], v[236:239], v[188:191]
    v_exp_f32 v64, v64
    v_mfma_f32_16x16x32_bf16 v[188:191], a[244:247], v[252:255], v[188:191]
    v_mfma_f32_16x16x32_bf16 v[204:207], a[248:251], v[252:255], v[204:207]
    v_exp_f32 v65, v65
    v_mfma_f32_16x16x32_bf16 v[204:207], a[120:123], v[236:239], v[204:207]
    v_mfma_f32_16x16x32_bf16 v[200:203], a[120:123], v[232:235], v[200:203]
    v_exp_f32 v66, v66
    v_mfma_f32_16x16x32_bf16 v[200:203], a[248:251], v[248:251], v[200:203]
    v_mfma_f32_16x16x32_bf16 v[216:219], a[252:255], v[248:251], v[216:219]
    v_cvt_pk_bf16_f32 v248, v56, v57
    v_cvt_pk_bf16_f32 v249, v58, v59
    v_mfma_f32_16x16x32_bf16 v[216:219], a[124:127], v[232:235], v[216:219]
    v_cvt_pk_bf16_f32 v250, v60, v61
    v_cvt_pk_bf16_f32 v251, v62, v63
    v_mfma_f32_16x16x32_bf16 v[220:223], a[124:127], v[236:239], v[220:223]
    v_exp_f32 v67, v67
    v_mfma_f32_16x16x32_bf16 v[220:223], a[252:255], v[252:255], v[220:223]
    v_mfma_f32_16x16x32_bf16 a[140:143], a[144:147], v[252:255], a[140:143]
    s_waitcnt lgkmcnt(0)
    ds_read_b64_tr_b16 a[224:225], v12 offset:12288
    v_cvt_pk_bf16_f32 v254, v68, v69
    v_mfma_f32_16x16x32_bf16 a[140:143], a[144:147], v[236:239], a[140:143]
    ds_read_b64_tr_b16 a[226:227], v12 offset:13312
    v_cvt_pk_bf16_f32 v255, v70, v71
    v_mfma_f32_16x16x32_bf16 v[56:59], a[64:67], a[8:11], v[80:83]
    ds_read_b64_tr_b16 a[228:229], v13 offset:12288
    v_cvt_pk_bf16_f32 v252, v64, v65
    v_mfma_f32_16x16x32_bf16 v[56:59], a[68:71], a[24:27], v[56:59]
    s_add_u32 m0, s33, s51
    ds_read_b64_tr_b16 a[230:231], v13 offset:13312
    v_cvt_pk_bf16_f32 v253, v66, v67
    v_mfma_f32_16x16x32_bf16 v[56:59], a[72:75], a[40:43], v[56:59]
    ds_read_b64_tr_b16 a[232:233], v14 offset:12288
    ds_read_b64_tr_b16 a[234:235], v14 offset:13312
    v_mfma_f32_16x16x32_bf16 v[56:59], a[76:79], a[56:59], v[56:59]
    ds_read_b64_tr_b16 a[236:237], v15 offset:12288
    ds_read_b64_tr_b16 a[238:239], v15 offset:13312
    v_mfma_f32_16x16x32_bf16 v[60:63], a[92:95], a[56:59], v[80:83]
    ds_read_b64_tr_b16 a[240:241], v16 offset:12288
    v_mfma_f32_16x16x32_bf16 v[60:63], a[88:91], a[40:43], v[60:63]
    ds_read_b64_tr_b16 a[242:243], v16 offset:13312
    v_mfma_f32_16x16x32_bf16 v[60:63], a[84:87], a[24:27], v[60:63]
    v_mfma_f32_16x16x32_bf16 v[60:63], a[80:83], a[8:11], v[60:63]
    s_add_u32 s37, s50, 0x4000
    v_exp_f32 v56, v56
    v_mfma_f32_16x16x32_bf16 v[68:71], a[80:83], a[12:15], v[84:87]
    v_exp_f32 v57, v57
    v_mfma_f32_16x16x32_bf16 v[68:71], a[84:87], a[28:31], v[68:71]
    ds_read_b64_tr_b16 a[244:245], v17 offset:12288
    v_cvt_pk_bf16_f32 v232, v56, v57
    v_mfma_f32_16x16x32_bf16 v[68:71], a[88:91], a[44:47], v[68:71]
    v_exp_f32 v58, v58
    v_mfma_f32_16x16x32_bf16 v[68:71], a[92:95], a[60:63], v[68:71]
    v_exp_f32 v59, v59
    v_mfma_f32_16x16x32_bf16 v[64:67], a[76:79], a[60:63], v[84:87]
    buffer_load_dwordx4 v36, s[16:19], s37 offen offset:0 lds
    v_mfma_f32_16x16x32_bf16 v[64:67], a[72:75], a[44:47], v[64:67]
    ds_read_b64_tr_b16 a[246:247], v17 offset:13312
    v_cvt_pk_bf16_f32 v233, v58, v59
    v_mfma_f32_16x16x32_bf16 v[64:67], a[68:71], a[28:31], v[64:67]
    v_exp_f32 v60, v60
    v_mfma_f32_16x16x32_bf16 v[64:67], a[64:67], a[12:15], v[64:67]
    ds_read_b64_tr_b16 a[248:249], v18 offset:12288
    ds_read_b64_tr_b16 a[250:251], v18 offset:13312
    v_mfma_f32_16x16x32_bf16 v[40:43], a[64:67], a[0:3], v[72:75]
    v_exp_f32 v61, v61
    v_mfma_f32_16x16x32_bf16 v[40:43], a[68:71], a[16:19], v[40:43]
    s_add_u32 s37, s50, 0x4c00
    ds_read_b64_tr_b16 a[252:253], v19 offset:12288
    v_cvt_pk_bf16_f32 v234, v60, v61
    v_mfma_f32_16x16x32_bf16 v[40:43], a[72:75], a[32:35], v[40:43]
    v_exp_f32 v62, v62
    v_mfma_f32_16x16x32_bf16 v[40:43], a[76:79], a[48:51], v[40:43]
    v_exp_f32 v63, v63
    v_mfma_f32_16x16x32_bf16 v[44:47], a[92:95], a[48:51], v[72:75]
    ds_read_b64_tr_b16 a[254:255], v19 offset:13312
    v_cvt_pk_bf16_f32 v235, v62, v63
    v_mfma_f32_16x16x32_bf16 v[44:47], a[88:91], a[32:35], v[44:47]
    v_exp_f32 v68, v68
    v_mfma_f32_16x16x32_bf16 v[44:47], a[84:87], a[16:19], v[44:47]
    v_exp_f32 v69, v69
    v_mfma_f32_16x16x32_bf16 v[44:47], a[80:83], a[0:3], v[44:47]
    buffer_load_dwordx4 v36, s[16:19], s37 offen offset:1024 lds
    v_mfma_f32_16x16x32_bf16 v[52:55], a[80:83], a[4:7], v[76:79]
    v_cvt_pk_bf16_f32 v238, v68, v69
    v_add_u32 v12, s34, v12
    v_mfma_f32_16x16x32_bf16 v[52:55], a[84:87], a[20:23], v[52:55]
    v_exp_f32 v70, v70
    v_mfma_f32_16x16x32_bf16 v[52:55], a[88:91], a[36:39], v[52:55]
    v_exp_f32 v71, v71
    v_mfma_f32_16x16x32_bf16 v[52:55], a[92:95], a[52:55], v[52:55]
    v_add_u32 v13, s34, v13
    v_cvt_pk_bf16_f32 v239, v70, v71
    v_mfma_f32_16x16x32_bf16 v[48:51], a[76:79], a[52:55], v[76:79]
    buffer_load_dwordx4 v37, s[20:23], s50 offen offset:2048 lds
    v_mfma_f32_16x16x32_bf16 v[48:51], a[72:75], a[36:39], v[48:51]
    v_exp_f32 v64, v64
    v_mfma_f32_16x16x32_bf16 v[48:51], a[68:71], a[20:23], v[48:51]
    s_waitcnt lgkmcnt(0)
    v_exp_f32 v65, v65
    v_mfma_f32_16x16x32_bf16 v[48:51], a[64:67], a[4:7], v[48:51]
    ds_read_b128 a[64:67], v8 offset:12288
    v_add_u32 v14, s34, v14
    v_mfma_f32_16x16x32_bf16 v[100:103], a[96:99], v[228:231], v[100:103]
    ds_read_b128 a[68:71], v9 offset:12288
    v_cvt_pk_bf16_f32 v236, v64, v65
    v_mfma_f32_16x16x32_bf16 v[100:103], a[224:227], v[244:247], v[100:103]
    s_add_u32 s37, s50, 0xc00
    v_exp_f32 v66, v66
    v_mfma_f32_16x16x32_bf16 v[96:99], a[224:227], v[240:243], v[96:99]
    ds_read_b128 a[72:75], v10 offset:12288
    v_add_u32 v15, s34, v15
    v_mfma_f32_16x16x32_bf16 v[96:99], a[96:99], v[224:227], v[96:99]
    v_exp_f32 v67, v67
    v_mfma_f32_16x16x32_bf16 v[112:115], a[100:103], v[224:227], v[112:115]
    ds_read_b128 a[76:79], v11 offset:12288
    v_cvt_pk_bf16_f32 v237, v66, v67
    v_mfma_f32_16x16x32_bf16 v[112:115], a[228:231], v[240:243], v[112:115]
    ds_read_b128 a[80:83], v8 offset:13312
    v_add_u32 v16, s34, v16
    v_mfma_f32_16x16x32_bf16 v[116:119], a[228:231], v[244:247], v[116:119]
    buffer_load_dwordx4 v37, s[20:23], s37 offen offset:3072 lds
    v_mfma_f32_16x16x32_bf16 v[116:119], a[100:103], v[228:231], v[116:119]
    v_exp_f32 v40, v40
    v_mfma_f32_16x16x32_bf16 v[132:135], a[104:107], v[228:231], v[132:135]
    v_exp_f32 v41, v41
    v_mfma_f32_16x16x32_bf16 v[132:135], a[232:235], v[244:247], v[132:135]
    ds_read_b128 a[84:87], v9 offset:13312
    v_add_u32 v17, s34, v17
    v_mfma_f32_16x16x32_bf16 v[128:131], a[232:235], v[240:243], v[128:131]
    v_exp_f32 v42, v42
    v_mfma_f32_16x16x32_bf16 v[128:131], a[104:107], v[224:227], v[128:131]
    v_exp_f32 v43, v43
    v_mfma_f32_16x16x32_bf16 v[144:147], a[108:111], v[224:227], v[144:147]
    s_add_u32 s50, s50, 0x2000
    ds_read_b128 a[88:91], v10 offset:13312
    v_add_u32 v18, s34, v18
    v_mfma_f32_16x16x32_bf16 v[144:147], a[236:239], v[240:243], v[144:147]
    ds_read_b128 a[92:95], v11 offset:13312
    v_add_f32 v26, v26, v40
    v_mfma_f32_16x16x32_bf16 v[148:151], a[236:239], v[244:247], v[148:151]
    v_exp_f32 v44, v44
    v_mfma_f32_16x16x32_bf16 v[148:151], a[108:111], v[228:231], v[148:151]
    v_add_u32 v19, s34, v19
    v_add_f32 v26, v26, v41
    v_mfma_f32_16x16x32_bf16 v[164:167], a[112:115], v[228:231], v[164:167]
    v_exp_f32 v45, v45
    v_mfma_f32_16x16x32_bf16 v[164:167], a[240:243], v[244:247], v[164:167]
    s_add_u32 s51, s51, 0x1000
    v_add_f32 v26, v26, v42
    v_add_u32 v8, s34, v8
    v_mfma_f32_16x16x32_bf16 v[160:163], a[240:243], v[240:243], v[160:163]
    v_exp_f32 v46, v46
    v_mfma_f32_16x16x32_bf16 v[160:163], a[112:115], v[224:227], v[160:163]
    v_add_f32 v26, v26, v43
    v_add_u32 v9, s34, v9
    v_mfma_f32_16x16x32_bf16 v[176:179], a[116:119], v[224:227], v[176:179]
    v_exp_f32 v47, v47
    v_mfma_f32_16x16x32_bf16 v[176:179], a[244:247], v[240:243], v[176:179]
    v_add_f32 v26, v26, v44
    v_add_f32 v26, v26, v45
    v_mfma_f32_16x16x32_bf16 v[180:183], a[244:247], v[244:247], v[180:183]
    s_and_b32 s51, s51, 0x7fff
    v_exp_f32 v52, v52
    v_mfma_f32_16x16x32_bf16 v[180:183], a[116:119], v[228:231], v[180:183]
    v_exp_f32 v53, v53
    v_mfma_f32_16x16x32_bf16 v[196:199], a[120:123], v[228:231], v[196:199]
    v_add_u32 v10, s34, v10
    v_add_f32 v26, v26, v46
    v_mfma_f32_16x16x32_bf16 v[196:199], a[248:251], v[244:247], v[196:199]
    v_exp_f32 v54, v54
    v_mfma_f32_16x16x32_bf16 v[192:195], a[248:251], v[240:243], v[192:195]
    v_add_u32 v11, s34, v11
    v_add_f32 v26, v26, v47
    v_mfma_f32_16x16x32_bf16 v[192:195], a[120:123], v[224:227], v[192:195]
    v_exp_f32 v55, v55
    v_mfma_f32_16x16x32_bf16 v[208:211], a[124:127], v[224:227], v[208:211]
    v_cvt_pk_bf16_f32 v224, v40, v41
    v_cvt_pk_bf16_f32 v225, v42, v43
    v_mfma_f32_16x16x32_bf16 v[208:211], a[252:255], v[240:243], v[208:211]
    v_cvt_pk_bf16_f32 v226, v44, v45
    v_cvt_pk_bf16_f32 v227, v46, v47
    v_mfma_f32_16x16x32_bf16 v[212:215], a[252:255], v[244:247], v[212:215]
    v_mfma_f32_16x16x32_bf16 v[212:215], a[124:127], v[228:231], v[212:215]
    v_mfma_f32_16x16x32_bf16 a[132:135], a[144:147], v[228:231], a[132:135]
    s_sub_u32 s34, 0, s34
    v_mfma_f32_16x16x32_bf16 a[132:135], a[144:147], v[244:247], a[132:135]
    s_sub_u32 s52, s52, 1
    s_cbranch_scc0 att_k1_7
tail_k1_3:
    s_waitcnt vmcnt(0) lgkmcnt(0)
    v_cvt_pk_bf16_f32 v230, v52, v53
    v_cvt_pk_bf16_f32 v231, v54, v55
    v_mfma_f32_16x16x32_bf16 v[40:43], a[64:67], a[0:3], v[72:75]
    s_barrier
    v_exp_f32 v48, v48
    v_mfma_f32_16x16x32_bf16 v[40:43], a[68:71], a[16:19], v[40:43]
    v_exp_f32 v49, v49
    v_mfma_f32_16x16x32_bf16 v[40:43], a[72:75], a[32:35], v[40:43]
    ds_read_b64_tr_b16 a[96:97], v12 offset:0
    v_cvt_pk_bf16_f32 v228, v48, v49
    v_mfma_f32_16x16x32_bf16 v[40:43], a[76:79], a[48:51], v[40:43]
    s_add_u32 s76, s6, 0x6000000
    s_addc_u32 s77, s7, 0
    v_min_u32 v38, 11, v0
    v_mfma_f32_16x16x32_bf16 v[44:47], a[92:95], a[48:51], v[72:75]
    s_and_b32 s77, s77, 0xffff
    v_exp_f32 v50, v50
    v_mfma_f32_16x16x32_bf16 v[44:47], a[88:91], a[32:35], v[44:47]
    s_mov_b32 s79, 0x00020000
    ds_read_b64_tr_b16 a[98:99], v12 offset:1024
    v_lshlrev_b32 v38, 2, v38
    v_mfma_f32_16x16x32_bf16 v[44:47], a[84:87], a[16:19], v[44:47]
    global_load_dword v34, v38, s[94:95] sc1
    v_mfma_f32_16x16x32_bf16 v[44:47], a[80:83], a[0:3], v[44:47]
    s_mov_b32 s78, 0x900000
    v_exp_f32 v51, v51
    v_mfma_f32_16x16x32_bf16 v[52:55], a[80:83], a[4:7], v[76:79]
    s_bfe_u32 s49, s2, 0x20001
    ds_read_b64_tr_b16 a[100:101], v13 offset:0
    v_cvt_pk_bf16_f32 v229, v50, v51
    v_mfma_f32_16x16x32_bf16 v[52:55], a[84:87], a[20:23], v[52:55]
    s_add_u32 s49, s49, 8
    ds_read_b64_tr_b16 a[102:103], v13 offset:1024
    ds_read_b64_tr_b16 a[104:105], v14 offset:0
    v_mfma_f32_16x16x32_bf16 v[52:55], a[88:91], a[36:39], v[52:55]
    ds_read_b64_tr_b16 a[106:107], v14 offset:1024
    ds_read_b64_tr_b16 a[108:109], v15 offset:0
    v_mfma_f32_16x16x32_bf16 v[52:55], a[92:95], a[52:55], v[52:55]
    v_exp_f32 v40, v40
    v_mfma_f32_16x16x32_bf16 v[48:51], a[76:79], a[52:55], v[76:79]
    v_exp_f32 v41, v41
    v_mfma_f32_16x16x32_bf16 v[48:51], a[72:75], a[36:39], v[48:51]
    ds_read_b64_tr_b16 a[110:111], v15 offset:1024
    v_cvt_pk_bf16_f32 v240, v40, v41
    v_mfma_f32_16x16x32_bf16 v[48:51], a[68:71], a[20:23], v[48:51]
    ds_read_b64_tr_b16 a[112:113], v16 offset:0
    ds_read_b64_tr_b16 a[114:115], v16 offset:1024
    v_mfma_f32_16x16x32_bf16 v[48:51], a[64:67], a[4:7], v[48:51]
    v_exp_f32 v42, v42
    v_mfma_f32_16x16x32_bf16 v[56:59], a[64:67], a[8:11], v[80:83]
    v_exp_f32 v43, v43
    v_mfma_f32_16x16x32_bf16 v[56:59], a[68:71], a[24:27], v[56:59]
    ds_read_b64_tr_b16 a[116:117], v17 offset:0
    v_add_f32 v26, v26, v40
    v_mfma_f32_16x16x32_bf16 v[56:59], a[72:75], a[40:43], v[56:59]
    ds_read_b64_tr_b16 a[118:119], v17 offset:1024
    v_cvt_pk_bf16_f32 v241, v42, v43
    v_mfma_f32_16x16x32_bf16 v[56:59], a[76:79], a[56:59], v[56:59]
    v_exp_f32 v44, v44
    v_mfma_f32_16x16x32_bf16 v[60:63], a[92:95], a[56:59], v[80:83]
    ds_read_b64_tr_b16 a[120:121], v18 offset:0
    v_add_f32 v26, v26, v41
    v_mfma_f32_16x16x32_bf16 v[60:63], a[88:91], a[40:43], v[60:63]
    v_exp_f32 v45, v45
    v_mfma_f32_16x16x32_bf16 v[60:63], a[84:87], a[24:27], v[60:63]
    ds_read_b64_tr_b16 a[122:123], v18 offset:1024
    v_add_f32 v26, v26, v42
    v_mfma_f32_16x16x32_bf16 v[60:63], a[80:83], a[8:11], v[60:63]
    ds_read_b64_tr_b16 a[124:125], v19 offset:0
    v_cvt_pk_bf16_f32 v242, v44, v45
    v_mfma_f32_16x16x32_bf16 v[68:71], a[80:83], a[12:15], v[84:87]
    v_exp_f32 v46, v46
    v_mfma_f32_16x16x32_bf16 v[68:71], a[84:87], a[28:31], v[68:71]
    ds_read_b64_tr_b16 a[126:127], v19 offset:1024
    v_add_f32 v26, v26, v43
    v_mfma_f32_16x16x32_bf16 v[68:71], a[88:91], a[44:47], v[68:71]
    v_exp_f32 v47, v47
    v_mfma_f32_16x16x32_bf16 v[68:71], a[92:95], a[60:63], v[68:71]
    v_add_f32 v26, v26, v44
    v_cvt_pk_bf16_f32 v243, v46, v47
    v_mfma_f32_16x16x32_bf16 v[64:67], a[76:79], a[60:63], v[84:87]
    v_exp_f32 v52, v52
    v_mfma_f32_16x16x32_bf16 v[64:67], a[72:75], a[44:47], v[64:67]
    v_add_f32 v26, v26, v45
    v_add_f32 v26, v26, v46
    v_mfma_f32_16x16x32_bf16 v[64:67], a[68:71], a[28:31], v[64:67]
    s_waitcnt lgkmcnt(0)
    v_exp_f32 v53, v53
    v_mfma_f32_16x16x32_bf16 v[64:67], a[64:67], a[12:15], v[64:67]
    ds_read_b128 a[64:67], v8 offset:0
    v_cvt_pk_bf16_f32 v246, v52, v53
    v_mfma_f32_16x16x32_bf16 a[136:139], a[144:147], v[248:251], a[136:139]
    v_exp_f32 v54, v54
    v_mfma_f32_16x16x32_bf16 a[136:139], a[144:147], v[232:235], a[136:139]
    ds_read_b128 a[68:71], v9 offset:0
    v_add_f32 v26, v26, v47
    v_mfma_f32_16x16x32_bf16 v[108:111], a[224:227], v[252:255], v[108:111]
    v_exp_f32 v55, v55
    v_mfma_f32_16x16x32_bf16 v[108:111], a[96:99], v[236:239], v[108:111]
    ds_read_b128 a[72:75], v10 offset:0
    v_cvt_pk_bf16_f32 v247, v54, v55
    v_mfma_f32_16x16x32_bf16 v[104:107], a[96:99], v[232:235], v[104:107]
    v_exp_f32 v48, v48
    v_mfma_f32_16x16x32_bf16 v[104:107], a[224:227], v[248:251], v[104:107]
    v_exp_f32 v49, v49
    v_mfma_f32_16x16x32_bf16 v[120:123], a[228:231], v[248:251], v[120:123]
    ds_read_b128 a[76:79], v11 offset:0
    v_cvt_pk_bf16_f32 v244, v48, v49
    v_mfma_f32_16x16x32_bf16 v[120:123], a[100:103], v[232:235], v[120:123]
    v_exp_f32 v50, v50
    v_mfma_f32_16x16x32_bf16 v[124:127], a[100:103], v[236:239], v[124:127]
    v_exp_f32 v51, v51
    v_mfma_f32_16x16x32_bf16 v[124:127], a[228:231], v[252:255], v[124:127]
    ds_read_b128 a[80:83], v8 offset:1024
    v_cvt_pk_bf16_f32 v245, v50, v51
    v_mfma_f32_16x16x32_bf16 v[140:143], a[232:235], v[252:255], v[140:143]
    v_exp_f32 v56, v56
    v_mfma_f32_16x16x32_bf16 v[140:143], a[104:107], v[236:239], v[140:143]
    v_exp_f32 v57, v57
    v_mfma_f32_16x16x32_bf16 v[136:139], a[104:107], v[232:235], v[136:139]
    v_exp_f32 v58, v58
    v_mfma_f32_16x16x32_bf16 v[136:139], a[232:235], v[248:251], v[136:139]
    v_exp_f32 v59, v59
    v_mfma_f32_16x16x32_bf16 v[152:155], a[236:239], v[248:251], v[152:155]
    ds_read_b128 a[84:87], v9 offset:1024
    s_waitcnt vmcnt(0)
    v_readlane_b32 s52, v34, s49
    v_mfma_f32_16x16x32_bf16 v[152:155], a[108:111], v[232:235], v[152:155]
    v_exp_f32 v60, v60
    v_mfma_f32_16x16x32_bf16 v[156:159], a[108:111], v[236:239], v[156:159]
    s_and_b32 s52, s52, 1
    ds_read_b128 a[88:91], v10 offset:1024
    v_cmp_gt_u32 s[82:83], 32, v34
    v_mfma_f32_16x16x32_bf16 v[156:159], a[236:239], v[252:255], v[156:159]
    s_xor_b32 s49, s2, s52
    v_exp_f32 v61, v61
    v_mfma_f32_16x16x32_bf16 v[172:175], a[240:243], v[252:255], v[172:175]
    s_bfe_u32 s34, s2, 0x10001
    v_exp_f32 v62, v62
    v_mfma_f32_16x16x32_bf16 v[172:175], a[112:115], v[236:239], v[172:175]
    s_andn2_b32 s4, 1, s49
    v_exp_f32 v63, v63
    v_mfma_f32_16x16x32_bf16 v[168:171], a[112:115], v[232:235], v[168:171]
    s_lshl_b32 s4, s4, 1
    s_or_b32 s34, s34, s4
    ds_read_b128 a[92:95], v11 offset:1024
    v_mfma_f32_16x16x32_bf16 v[168:171], a[240:243], v[248:251], v[168:171]
    s_and_b32 s35, s2, 4
    v_exp_f32 v68, v68
    v_mfma_f32_16x16x32_bf16 v[184:187], a[244:247], v[248:251], v[184:187]
    s_lshl_b32 s35, s35, 1
    v_exp_f32 v69, v69
    v_mfma_f32_16x16x32_bf16 v[184:187], a[116:119], v[232:235], v[184:187]
    s_lshr_b32 s4, s2, 5
    v_exp_f32 v70, v70
    v_mfma_f32_16x16x32_bf16 v[188:191], a[116:119], v[236:239], v[188:191]
    s_add_u32 s35, s35, s4
    v_exp_f32 v71, v71
    v_mfma_f32_16x16x32_bf16 v[188:191], a[244:247], v[252:255], v[188:191]
    s_bfe_u32 s36, s2, 0x20003
    s_and_b32 s39, s34, 2
    v_mfma_f32_16x16x32_bf16 v[204:207], a[248:251], v[252:255], v[204:207]
    s_lshl_b32 s5, s39, 6
    v_exp_f32 v64, v64
    v_mfma_f32_16x16x32_bf16 v[204:207], a[120:123], v[236:239], v[204:207]
    s_lshl_b32 s39, s39, 2
    v_exp_f32 v65, v65
    v_mfma_f32_16x16x32_bf16 v[200:203], a[120:123], v[232:235], v[200:203]
    s_add_u32 s39, s39, 64
    v_exp_f32 v66, v66
    v_mfma_f32_16x16x32_bf16 v[200:203], a[248:251], v[248:251], v[200:203]
    s_and_b32 s4, s34, 1
    v_mfma_f32_16x16x32_bf16 v[216:219], a[252:255], v[248:251], v[216:219]
    s_mul_i32 s4, s4, s39
    v_cvt_pk_bf16_f32 v248, v56, v57
    v_cvt_pk_bf16_f32 v249, v58, v59
    v_mfma_f32_16x16x32_bf16 v[216:219], a[124:127], v[232:235], v[216:219]
    s_add_u32 s3, s4, s5
    v_cvt_pk_bf16_f32 v250, v60, v61
    v_cvt_pk_bf16_f32 v251, v62, v63
    v_mfma_f32_16x16x32_bf16 v[220:223], a[124:127], v[236:239], v[220:223]
    s_mul_i32 s4, s36, 272
    s_add_u32 s4, s4, s3
    v_mfma_f32_16x16x32_bf16 v[220:223], a[252:255], v[252:255], v[220:223]
    s_mul_i32 s4, s4, 9216
    v_exp_f32 v67, v67
    v_mfma_f32_16x16x32_bf16 a[140:143], a[144:147], v[252:255], a[140:143]
    s_add_u32 s4, s4, 0x4000000
    v_cvt_pk_bf16_f32 v254, v68, v69
    v_cvt_pk_bf16_f32 v255, v70, v71
    v_mfma_f32_16x16x32_bf16 a[140:143], a[144:147], v[236:239], a[140:143]
    s_add_u32 s8, s6, s4
    s_addc_u32 s9, s7, 0
    s_waitcnt lgkmcnt(0)
    v_mfma_f32_16x16x32_bf16 v[56:59], a[64:67], a[8:11], v[80:83]
    s_and_b32 s9, s9, 0xffff
    ds_read_b64_tr_b16 a[224:225], v12 offset:4096
    v_cvt_pk_bf16_f32 v252, v64, v65
    v_mfma_f32_16x16x32_bf16 v[56:59], a[68:71], a[24:27], v[56:59]
    s_mov_b32 s11, 0x00020000
    ds_read_b64_tr_b16 a[226:227], v12 offset:5120
    ds_read_b64_tr_b16 a[228:229], v13 offset:4096
    v_mfma_f32_16x16x32_bf16 v[56:59], a[72:75], a[40:43], v[56:59]
    s_mul_i32 s10, s39, 9216
    ds_read_b64_tr_b16 a[230:231], v13 offset:5120
    v_cvt_pk_bf16_f32 v253, v66, v67
    v_mfma_f32_16x16x32_bf16 v[56:59], a[76:79], a[56:59], v[56:59]
    s_lshl_b32 s4, s35, 1
    s_lshr_b32 s5, s32, 1
    ds_read_b64_tr_b16 a[232:233], v14 offset:4096
    v_mfma_f32_16x16x32_bf16 v[60:63], a[92:95], a[56:59], v[80:83]
    s_add_u32 s4, s4, s5
    ds_read_b64_tr_b16 a[234:235], v14 offset:5120
    ds_read_b64_tr_b16 a[236:237], v15 offset:4096
    v_mfma_f32_16x16x32_bf16 v[60:63], a[88:91], a[40:43], v[60:63]
    s_mul_i32 s4, s4, 272
    v_exp_f32 v56, v56
    v_mfma_f32_16x16x32_bf16 v[60:63], a[84:87], a[24:27], v[60:63]
    s_add_u32 s4, s4, s3
    v_exp_f32 v57, v57
    v_mfma_f32_16x16x32_bf16 v[60:63], a[80:83], a[8:11], v[60:63]
    s_lshl_b32 s4, s4, 12
    ds_read_b64_tr_b16 a[238:239], v15 offset:5120
    v_cvt_pk_bf16_f32 v232, v56, v57
    v_mfma_f32_16x16x32_bf16 v[68:71], a[80:83], a[12:15], v[84:87]
    s_add_u32 s4, s4, 0x400000
    s_add_u32 s12, s6, s4
    s_addc_u32 s13, s7, 0
    v_mfma_f32_16x16x32_bf16 v[68:71], a[84:87], a[28:31], v[68:71]
    ds_read_b64_tr_b16 a[240:241], v16 offset:4096
    ds_read_b64_tr_b16 a[242:243], v16 offset:5120
    v_mfma_f32_16x16x32_bf16 v[68:71], a[88:91], a[44:47], v[68:71]
    s_and_b32 s13, s13, 0xffff
    v_exp_f32 v58, v58
    v_mfma_f32_16x16x32_bf16 v[68:71], a[92:95], a[60:63], v[68:71]
    s_mov_b32 s15, 0x00020000
    v_exp_f32 v59, v59
    v_mfma_f32_16x16x32_bf16 v[64:67], a[76:79], a[60:63], v[84:87]
    s_lshl_b32 s14, s39, 12
    ds_read_b64_tr_b16 a[244:245], v17 offset:4096
    v_cvt_pk_bf16_f32 v233, v58, v59
    v_mfma_f32_16x16x32_bf16 v[64:67], a[72:75], a[44:47], v[64:67]
    s_and_b32 s48, s49, 3
    s_add_u32 s48, s48, 1
    ds_read_b64_tr_b16 a[246:247], v17 offset:5120
    v_mfma_f32_16x16x32_bf16 v[64:67], a[68:71], a[28:31], v[64:67]
    s_and_b32 s48, s48, 4
    v_exp_f32 v60, v60
    v_mfma_f32_16x16x32_bf16 v[64:67], a[64:67], a[12:15], v[64:67]
    s_lshl_b32 s48, s48, 8
    ds_read_b64_tr_b16 a[248:249], v18 offset:4096
    v_add_u32 v5, s48, v1
    v_mfma_f32_16x16x32_bf16 v[40:43], a[64:67], a[0:3], v[72:75]
    s_lshl_b32 s80, s32, 10
    v_exp_f32 v61, v61
    v_mfma_f32_16x16x32_bf16 v[40:43], a[68:71], a[16:19], v[40:43]
    s_and_b32 s81, s32, 1
    s_lshl_b32 s81, s81, 11
    ds_read_b64_tr_b16 a[250:251], v18 offset:5120
    v_mfma_f32_16x16x32_bf16 v[40:43], a[72:75], a[32:35], v[40:43]
    ds_read_b64_tr_b16 a[252:253], v19 offset:4096
    v_xor_b32 v6, 1024, v5
    v_mfma_f32_16x16x32_bf16 v[40:43], a[76:79], a[48:51], v[40:43]
    ds_read_b64_tr_b16 a[254:255], v19 offset:5120
    v_cvt_pk_bf16_f32 v234, v60, v61
    v_mfma_f32_16x16x32_bf16 v[44:47], a[92:95], a[48:51], v[72:75]
    s_lshr_b32 s4, s35, 1
    v_exp_f32 v62, v62
    v_mfma_f32_16x16x32_bf16 v[44:47], a[88:91], a[32:35], v[44:47]
    s_lshl_b32 s4, s4, 2
    v_exp_f32 v63, v63
    v_mfma_f32_16x16x32_bf16 v[44:47], a[84:87], a[16:19], v[44:47]
    s_and_b32 s5, s2, 2
    s_add_u32 s4, s4, s5
    v_cvt_pk_bf16_f32 v235, v62, v63
    v_mfma_f32_16x16x32_bf16 v[44:47], a[80:83], a[0:3], v[44:47]
    s_lshl_b32 s4, s4, 1
    v_exp_f32 v68, v68
    v_mfma_f32_16x16x32_bf16 v[52:55], a[80:83], a[4:7], v[76:79]
    s_and_b32 s5, s35, 1
    v_exp_f32 v69, v69
    v_mfma_f32_16x16x32_bf16 v[52:55], a[84:87], a[20:23], v[52:55]
    s_add_u32 s4, s4, s5
    v_cvt_pk_bf16_f32 v238, v68, v69
    v_and_b32 v39, 15, v0
    v_mfma_f32_16x16x32_bf16 v[52:55], a[88:91], a[36:39], v[52:55]
    s_mul_i32 s4, s4, 36864
    v_exp_f32 v70, v70
    v_mfma_f32_16x16x32_bf16 v[52:55], a[92:95], a[52:55], v[52:55]
    s_and_b32 s5, s34, 2
    s_lshl_b32 s5, s5, 29
    v_lshlrev_b32 v39, 2, v39
    v_mfma_f32_16x16x32_bf16 v[48:51], a[76:79], a[52:55], v[76:79]
    s_add_u32 s4, s4, s5
    v_exp_f32 v71, v71
    v_mfma_f32_16x16x32_bf16 v[48:51], a[72:75], a[36:39], v[48:51]
    s_add_u32 m0, s33, 0
    v_add_u32 v39, s4, v39
    v_cvt_pk_bf16_f32 v239, v70, v71
    v_mfma_f32_16x16x32_bf16 v[48:51], a[68:71], a[20:23], v[48:51]
    s_waitcnt lgkmcnt(0)
    v_exp_f32 v64, v64
    v_mfma_f32_16x16x32_bf16 v[48:51], a[64:67], a[4:7], v[48:51]
    ds_read_b128 a[64:67], v8 offset:4096
    ds_read_b128 a[68:71], v9 offset:4096
    v_mfma_f32_16x16x32_bf16 v[100:103], a[96:99], v[228:231], v[100:103]
    buffer_load_dwordx4 v1, s[8:11], s80 offen sc1 lds
    v_mfma_f32_16x16x32_bf16 v[100:103], a[224:227], v[244:247], v[100:103]
    v_exp_f32 v65, v65
    v_mfma_f32_16x16x32_bf16 v[96:99], a[224:227], v[240:243], v[96:99]
    s_add_u32 s80, s80, 4096
    ds_read_b128 a[72:75], v10 offset:4096
    v_cvt_pk_bf16_f32 v236, v64, v65
    v_mfma_f32_16x16x32_bf16 v[96:99], a[96:99], v[224:227], v[96:99]
    v_exp_f32 v66, v66
    v_mfma_f32_16x16x32_bf16 v[112:115], a[100:103], v[224:227], v[112:115]
    s_add_u32 m0, s33, 1024
    v_exp_f32 v67, v67
    v_mfma_f32_16x16x32_bf16 v[112:115], a[228:231], v[240:243], v[112:115]
    ds_read_b128 a[76:79], v11 offset:4096
    v_cvt_pk_bf16_f32 v237, v66, v67
    v_mfma_f32_16x16x32_bf16 v[116:119], a[228:231], v[244:247], v[116:119]
    buffer_load_dwordx4 v1, s[8:11], s80 offen sc1 lds
    v_mfma_f32_16x16x32_bf16 v[116:119], a[100:103], v[228:231], v[116:119]
    v_exp_f32 v40, v40
    v_mfma_f32_16x16x32_bf16 v[132:135], a[104:107], v[228:231], v[132:135]
    s_add_u32 s80, s80, 4096
    v_exp_f32 v41, v41
    v_mfma_f32_16x16x32_bf16 v[132:135], a[232:235], v[244:247], v[132:135]
    v_exp_f32 v42, v42
    v_mfma_f32_16x16x32_bf16 v[128:131], a[232:235], v[240:243], v[128:131]
    s_add_u32 m0, s33, 2048
    ds_read_b128 a[80:83], v8 offset:5120
    v_add_f32 v26, v26, v40
    v_mfma_f32_16x16x32_bf16 v[128:131], a[104:107], v[224:227], v[128:131]
    v_exp_f32 v43, v43
    v_mfma_f32_16x16x32_bf16 v[144:147], a[108:111], v[224:227], v[144:147]
    buffer_load_dwordx4 v1, s[8:11], s80 offen sc1 lds
    v_mfma_f32_16x16x32_bf16 v[144:147], a[236:239], v[240:243], v[144:147]
    ds_read_b128 a[84:87], v9 offset:5120
    v_add_f32 v26, v26, v41
    v_mfma_f32_16x16x32_bf16 v[148:151], a[236:239], v[244:247], v[148:151]
    v_exp_f32 v44, v44
    v_mfma_f32_16x16x32_bf16 v[148:151], a[108:111], v[228:231], v[148:151]
    s_add_u32 s80, s80, 4096
    v_exp_f32 v45, v45
    v_mfma_f32_16x16x32_bf16 v[164:167], a[112:115], v[228:231], v[164:167]
    ds_read_b128 a[88:91], v10 offset:5120
    v_add_f32 v26, v26, v42
    v_mfma_f32_16x16x32_bf16 v[164:167], a[240:243], v[244:247], v[164:167]
    s_add_u32 m0, s33, 3072
    v_exp_f32 v46, v46
    v_mfma_f32_16x16x32_bf16 v[160:163], a[240:243], v[240:243], v[160:163]
    ds_read_b128 a[92:95], v11 offset:5120
    v_add_f32 v26, v26, v43
    v_mfma_f32_16x16x32_bf16 v[160:163], a[112:115], v[224:227], v[160:163]
    buffer_load_dwordx4 v1, s[8:11], s80 offen sc1 lds
    v_mfma_f32_16x16x32_bf16 v[176:179], a[116:119], v[224:227], v[176:179]
    v_exp_f32 v47, v47
    v_mfma_f32_16x16x32_bf16 v[176:179], a[244:247], v[240:243], v[176:179]
    s_add_u32 s80, s80, 4096
    v_add_f32 v26, v26, v44
    v_add_f32 v26, v26, v45
    v_mfma_f32_16x16x32_bf16 v[180:183], a[244:247], v[244:247], v[180:183]
    v_exp_f32 v52, v52
    v_mfma_f32_16x16x32_bf16 v[180:183], a[116:119], v[228:231], v[180:183]
    s_add_u32 m0, s33, 4096
    v_exp_f32 v53, v53
    v_mfma_f32_16x16x32_bf16 v[196:199], a[120:123], v[228:231], v[196:199]
    v_add_f32 v26, v26, v46
    v_add_f32 v26, v26, v47
    v_mfma_f32_16x16x32_bf16 v[196:199], a[248:251], v[244:247], v[196:199]
    buffer_load_dwordx4 v1, s[8:11], s80 offen sc1 lds
    v_mfma_f32_16x16x32_bf16 v[192:195], a[248:251], v[240:243], v[192:195]
    v_exp_f32 v54, v54
    v_mfma_f32_16x16x32_bf16 v[192:195], a[120:123], v[224:227], v[192:195]
    s_add_u32 s80, s80, 4096
    v_exp_f32 v55, v55
    v_mfma_f32_16x16x32_bf16 v[208:211], a[124:127], v[224:227], v[208:211]
    v_cvt_pk_bf16_f32 v224, v40, v41
    v_cvt_pk_bf16_f32 v225, v42, v43
    v_mfma_f32_16x16x32_bf16 v[208:211], a[252:255], v[240:243], v[208:211]
    v_cvt_pk_bf16_f32 v226, v44, v45
    v_cvt_pk_bf16_f32 v227, v46, v47
    v_mfma_f32_16x16x32_bf16 v[212:215], a[252:255], v[244:247], v[212:215]
    v_exp_f32 v48, v48
    v_mfma_f32_16x16x32_bf16 v[212:215], a[124:127], v[228:231], v[212:215]
    v_exp_f32 v49, v49
    v_mfma_f32_16x16x32_bf16 a[132:135], a[144:147], v[228:231], a[132:135]
    s_waitcnt vmcnt(63) lgkmcnt(0)
    v_cvt_pk_bf16_f32 v230, v52, v53
    v_cvt_pk_bf16_f32 v231, v54, v55
    v_mfma_f32_16x16x32_bf16 a[132:135], a[144:147], v[244:247], a[132:135]
    s_barrier
    ds_read_b64_tr_b16 a[96:97], v12 offset:8192
    v_cvt_pk_bf16_f32 v228, v48, v49
    v_mfma_f32_16x16x32_bf16 v[40:43], a[64:67], a[0:3], v[72:75]
    v_exp_f32 v50, v50
    v_mfma_f32_16x16x32_bf16 v[40:43], a[68:71], a[16:19], v[40:43]
    s_add_u32 m0, s33, 5120
    ds_read_b64_tr_b16 a[98:99], v12 offset:9216
    ds_read_b64_tr_b16 a[100:101], v13 offset:8192
    v_mfma_f32_16x16x32_bf16 v[40:43], a[72:75], a[32:35], v[40:43]
    v_exp_f32 v51, v51
    v_mfma_f32_16x16x32_bf16 v[40:43], a[76:79], a[48:51], v[40:43]
    ds_read_b64_tr_b16 a[102:103], v13 offset:9216
    v_cvt_pk_bf16_f32 v229, v50, v51
    v_mfma_f32_16x16x32_bf16 v[44:47], a[92:95], a[48:51], v[72:75]
    buffer_load_dwordx4 v1, s[8:11], s80 offen sc1 lds
    v_mfma_f32_16x16x32_bf16 v[44:47], a[88:91], a[32:35], v[44:47]
    ds_read_b64_tr_b16 a[104:105], v14 offset:8192
    ds_read_b64_tr_b16 a[106:107], v14 offset:9216
    v_mfma_f32_16x16x32_bf16 v[44:47], a[84:87], a[16:19], v[44:47]
    s_add_u32 s80, s80, 4096
    v_exp_f32 v40, v40
    v_mfma_f32_16x16x32_bf16 v[44:47], a[80:83], a[0:3], v[44:47]
    ds_read_b64_tr_b16 a[108:109], v15 offset:8192
    ds_read_b64_tr_b16 a[110:111], v15 offset:9216
    v_mfma_f32_16x16x32_bf16 v[52:55], a[80:83], a[4:7], v[76:79]
    s_add_u32 m0, s33, 6144
    v_exp_f32 v41, v41
    v_mfma_f32_16x16x32_bf16 v[52:55], a[84:87], a[20:23], v[52:55]
    ds_read_b64_tr_b16 a[112:113], v16 offset:8192
    v_cvt_pk_bf16_f32 v240, v40, v41
    v_mfma_f32_16x16x32_bf16 v[52:55], a[88:91], a[36:39], v[52:55]
    buffer_load_dwordx4 v1, s[8:11], s80 offen sc1 lds
    v_mfma_f32_16x16x32_bf16 v[52:55], a[92:95], a[52:55], v[52:55]
    v_exp_f32 v42, v42
    v_mfma_f32_16x16x32_bf16 v[48:51], a[76:79], a[52:55], v[76:79]
    s_add_u32 s80, s80, 4096
    ds_read_b64_tr_b16 a[114:115], v16 offset:9216
    ds_read_b64_tr_b16 a[116:117], v17 offset:8192
    v_mfma_f32_16x16x32_bf16 v[48:51], a[72:75], a[36:39], v[48:51]
    v_exp_f32 v43, v43
    v_mfma_f32_16x16x32_bf16 v[48:51], a[68:71], a[20:23], v[48:51]
    s_add_u32 m0, s33, 7168
    ds_read_b64_tr_b16 a[118:119], v17 offset:9216
    v_add_f32 v26, v26, v40
    v_mfma_f32_16x16x32_bf16 v[48:51], a[64:67], a[4:7], v[48:51]
    ds_read_b64_tr_b16 a[120:121], v18 offset:8192
    v_cvt_pk_bf16_f32 v241, v42, v43
    v_mfma_f32_16x16x32_bf16 v[56:59], a[64:67], a[8:11], v[80:83]
    buffer_load_dwordx4 v1, s[8:11], s80 offen sc1 lds
    v_mfma_f32_16x16x32_bf16 v[56:59], a[68:71], a[24:27], v[56:59]
    v_exp_f32 v44, v44
    v_mfma_f32_16x16x32_bf16 v[56:59], a[72:75], a[40:43], v[56:59]
    s_add_u32 s80, s80, 4096
    ds_read_b64_tr_b16 a[122:123], v18 offset:9216
    v_add_f32 v26, v26, v41
    v_mfma_f32_16x16x32_bf16 v[56:59], a[76:79], a[56:59], v[56:59]
    v_exp_f32 v45, v45
    v_mfma_f32_16x16x32_bf16 v[60:63], a[92:95], a[56:59], v[80:83]
    s_add_u32 m0, s33, 8192
    ds_read_b64_tr_b16 a[124:125], v19 offset:8192
    v_add_f32 v26, v26, v42
    v_mfma_f32_16x16x32_bf16 v[60:63], a[88:91], a[40:43], v[60:63]
    ds_read_b64_tr_b16 a[126:127], v19 offset:9216
    v_cvt_pk_bf16_f32 v242, v44, v45
    v_mfma_f32_16x16x32_bf16 v[60:63], a[84:87], a[24:27], v[60:63]
    v_exp_f32 v46, v46
    v_mfma_f32_16x16x32_bf16 v[60:63], a[80:83], a[8:11], v[60:63]
    v_add_f32 v26, v26, v43
    v_add_f32 v26, v26, v44
    v_mfma_f32_16x16x32_bf16 v[68:71], a[80:83], a[12:15], v[84:87]
    v_exp_f32 v47, v47
    v_mfma_f32_16x16x32_bf16 v[68:71], a[84:87], a[28:31], v[68:71]
    buffer_load_dwordx4 v1, s[8:11], s80 offen sc1 lds
    v_mfma_f32_16x16x32_bf16 v[68:71], a[88:91], a[44:47], v[68:71]
    s_add_u32 s80, s80, 4096
    v_cvt_pk_bf16_f32 v243, v46, v47
    v_add_f32 v26, v26, v45
    v_mfma_f32_16x16x32_bf16 v[68:71], a[92:95], a[60:63], v[68:71]
    s_add_u32 m0, s33, 9216
    v_exp_f32 v52, v52
    v_mfma_f32_16x16x32_bf16 v[64:67], a[76:79], a[60:63], v[84:87]
    v_exp_f32 v53, v53
    v_mfma_f32_16x16x32_bf16 v[64:67], a[72:75], a[44:47], v[64:67]
    buffer_load_dword v35, v39, s[76:79], 0 offen sc1
    v_mfma_f32_16x16x32_bf16 v[64:67], a[68:71], a[28:31], v[64:67]
    s_waitcnt lgkmcnt(0)
    v_add_f32 v26, v26, v46
    v_cvt_pk_bf16_f32 v246, v52, v53
    v_mfma_f32_16x16x32_bf16 v[64:67], a[64:67], a[12:15], v[64:67]
    buffer_load_dwordx4 v1, s[8:11], s80 offen sc1 lds
    v_mfma_f32_16x16x32_bf16 a[136:139], a[144:147], v[248:251], a[136:139]
    s_add_u32 s80, s80, 4096
    v_exp_f32 v54, v54
    v_mfma_f32_16x16x32_bf16 a[136:139], a[144:147], v[232:235], a[136:139]
    s_add_u32 m0, s33, 10240
    ds_read_b64_tr_b16 a[64:65], v12 offset:12288
    v_add_f32 v26, v26, v47
    v_mfma_f32_16x16x32_bf16 v[108:111], a[224:227], v[252:255], v[108:111]
    v_exp_f32 v55, v55
    v_mfma_f32_16x16x32_bf16 v[108:111], a[96:99], v[236:239], v[108:111]
    ds_read_b64_tr_b16 a[66:67], v12 offset:13312
    v_cvt_pk_bf16_f32 v247, v54, v55
    v_mfma_f32_16x16x32_bf16 v[104:107], a[96:99], v[232:235], v[104:107]
    v_exp_f32 v48, v48
    v_mfma_f32_16x16x32_bf16 v[104:107], a[224:227], v[248:251], v[104:107]
    v_exp_f32 v49, v49
    v_mfma_f32_16x16x32_bf16 v[120:123], a[228:231], v[248:251], v[120:123]
    buffer_load_dwordx4 v1, s[8:11], s80 offen sc1 lds
    v_mfma_f32_16x16x32_bf16 v[120:123], a[100:103], v[232:235], v[120:123]
    s_add_u32 s80, s80, 4096
    ds_read_b64_tr_b16 a[68:69], v13 offset:12288
    v_cvt_pk_bf16_f32 v244, v48, v49
    v_mfma_f32_16x16x32_bf16 v[124:127], a[100:103], v[236:239], v[124:127]
    s_add_u32 m0, s33, 11264
    v_exp_f32 v50, v50
    v_mfma_f32_16x16x32_bf16 v[124:127], a[228:231], v[252:255], v[124:127]
    ds_read_b64_tr_b16 a[70:71], v13 offset:13312
    ds_read_b64_tr_b16 a[72:73], v14 offset:12288
    v_mfma_f32_16x16x32_bf16 v[140:143], a[232:235], v[252:255], v[140:143]
    v_exp_f32 v51, v51
    v_mfma_f32_16x16x32_bf16 v[140:143], a[104:107], v[236:239], v[140:143]
    ds_read_b64_tr_b16 a[74:75], v14 offset:13312
    v_cvt_pk_bf16_f32 v245, v50, v51
    v_mfma_f32_16x16x32_bf16 v[136:139], a[104:107], v[232:235], v[136:139]
    v_exp_f32 v56, v56
    v_mfma_f32_16x16x32_bf16 v[136:139], a[232:235], v[248:251], v[136:139]
    buffer_load_dwordx4 v1, s[8:11], s80 offen sc1 lds
    v_mfma_f32_16x16x32_bf16 v[152:155], a[236:239], v[248:251], v[152:155]
    s_add_u32 s80, s80, 4096
    ds_read_b64_tr_b16 a[76:77], v15 offset:12288
    ds_read_b64_tr_b16 a[78:79], v15 offset:13312
    v_mfma_f32_16x16x32_bf16 v[152:155], a[108:111], v[232:235], v[152:155]
    s_add_u32 m0, s33, 12288
    v_exp_f32 v57, v57
    v_mfma_f32_16x16x32_bf16 v[156:159], a[108:111], v[236:239], v[156:159]
    ds_read_b64_tr_b16 a[80:81], v16 offset:12288
    ds_read_b64_tr_b16 a[82:83], v16 offset:13312
    v_mfma_f32_16x16x32_bf16 v[156:159], a[236:239], v[252:255], v[156:159]
    v_exp_f32 v58, v58
    v_mfma_f32_16x16x32_bf16 v[172:175], a[240:243], v[252:255], v[172:175]
    v_exp_f32 v59, v59
    v_mfma_f32_16x16x32_bf16 v[172:175], a[112:115], v[236:239], v[172:175]
    ds_read_b64_tr_b16 a[84:85], v17 offset:12288
    ds_read_b64_tr_b16 a[86:87], v17 offset:13312
    v_mfma_f32_16x16x32_bf16 v[168:171], a[112:115], v[232:235], v[168:171]
    buffer_load_dwordx4 v1, s[8:11], s80 offen sc1 lds
    v_mfma_f32_16x16x32_bf16 v[168:171], a[240:243], v[248:251], v[168:171]
    s_add_u32 s80, s80, 4096
    v_exp_f32 v60, v60
    v_mfma_f32_16x16x32_bf16 v[184:187], a[244:247], v[248:251], v[184:187]
    s_add_u32 m0, s33, 13312
    ds_read_b64_tr_b16 a[88:89], v18 offset:12288
    ds_read_b64_tr_b16 a[90:91], v18 offset:13312
    v_mfma_f32_16x16x32_bf16 v[184:187], a[116:119], v[232:235], v[184:187]
    v_exp_f32 v61, v61
    v_mfma_f32_16x16x32_bf16 v[188:191], a[116:119], v[236:239], v[188:191]
    v_exp_f32 v62, v62
    v_mfma_f32_16x16x32_bf16 v[188:191], a[244:247], v[252:255], v[188:191]
    ds_read_b64_tr_b16 a[92:93], v19 offset:12288
    ds_read_b64_tr_b16 a[94:95], v19 offset:13312
    v_mfma_f32_16x16x32_bf16 v[204:207], a[248:251], v[252:255], v[204:207]
    buffer_load_dwordx4 v1, s[8:11], s80 offen sc1 lds
    v_mfma_f32_16x16x32_bf16 v[204:207], a[120:123], v[236:239], v[204:207]
    s_add_u32 s80, s80, 4096
    v_exp_f32 v63, v63
    v_mfma_f32_16x16x32_bf16 v[200:203], a[120:123], v[232:235], v[200:203]
    v_exp_f32 v68, v68
    v_mfma_f32_16x16x32_bf16 v[200:203], a[248:251], v[248:251], v[200:203]
    v_exp_f32 v69, v69
    v_mfma_f32_16x16x32_bf16 v[216:219], a[252:255], v[248:251], v[216:219]
    v_cvt_pk_bf16_f32 v248, v56, v57
    v_cvt_pk_bf16_f32 v249, v58, v59
    v_mfma_f32_16x16x32_bf16 v[216:219], a[124:127], v[232:235], v[216:219]
    v_cvt_pk_bf16_f32 v250, v60, v61
    v_cvt_pk_bf16_f32 v251, v62, v63
    v_mfma_f32_16x16x32_bf16 v[220:223], a[124:127], v[236:239], v[220:223]
    v_exp_f32 v70, v70
    v_mfma_f32_16x16x32_bf16 v[220:223], a[252:255], v[252:255], v[220:223]
    v_exp_f32 v71, v71
    v_mfma_f32_16x16x32_bf16 a[140:143], a[144:147], v[252:255], a[140:143]
    s_waitcnt lgkmcnt(0)
    v_cvt_pk_bf16_f32 v254, v68, v69
    v_cvt_pk_bf16_f32 v255, v70, v71
    v_mfma_f32_16x16x32_bf16 a[140:143], a[144:147], v[236:239], a[140:143]
    s_barrier
    v_exp_f32 v64, v64
    v_mfma_f32_16x16x32_bf16 v[96:99], a[64:67], v[240:243], v[96:99]
    v_exp_f32 v65, v65
    v_mfma_f32_16x16x32_bf16 v[96:99], a[96:99], v[224:227], v[96:99]
    s_waitcnt vmcnt(5)
    v_cmp_eq_u32 s[50:51], -1, v35
    v_cvt_pk_bf16_f32 v252, v64, v65
    v_mfma_f32_16x16x32_bf16 v[112:115], a[100:103], v[224:227], v[112:115]
    v_exp_f32 v66, v66
    v_mfma_f32_16x16x32_bf16 v[112:115], a[68:71], v[240:243], v[112:115]
    v_exp_f32 v67, v67
    v_mfma_f32_16x16x32_bf16 v[128:131], a[72:75], v[240:243], v[128:131]
    buffer_load_dwordx4 a[160:163], v5, s[12:15], s81 offen sc1
    v_mfma_f32_16x16x32_bf16 v[128:131], a[104:107], v[224:227], v[128:131]
    buffer_load_dwordx4 a[164:167], v6, s[12:15], s81 offen sc1
    v_mfma_f32_16x16x32_bf16 v[144:147], a[108:111], v[224:227], v[144:147]
    s_add_u32 s81, s81, 4096
    v_cvt_pk_bf16_f32 v253, v66, v67
    v_mfma_f32_16x16x32_bf16 v[144:147], a[76:79], v[240:243], v[144:147]
    buffer_load_dwordx4 a[168:171], v5, s[12:15], s81 offen sc1
    v_mfma_f32_16x16x32_bf16 v[160:163], a[80:83], v[240:243], v[160:163]
    buffer_load_dwordx4 a[172:175], v6, s[12:15], s81 offen sc1
    v_mfma_f32_16x16x32_bf16 v[160:163], a[112:115], v[224:227], v[160:163]
    s_add_u32 s81, s81, 4096
    v_mfma_f32_16x16x32_bf16 v[176:179], a[116:119], v[224:227], v[176:179]
    buffer_load_dwordx4 a[176:179], v5, s[12:15], s81 offen sc1
    v_mfma_f32_16x16x32_bf16 v[176:179], a[84:87], v[240:243], v[176:179]
    buffer_load_dwordx4 a[180:183], v6, s[12:15], s81 offen sc1
    v_mfma_f32_16x16x32_bf16 v[192:195], a[88:91], v[240:243], v[192:195]
    s_add_u32 s81, s81, 4096
    v_mov_b32 v72, v26
    v_max3_f32 v74, abs(v96), abs(v113), abs(v130)
    v_mfma_f32_16x16x32_bf16 v[192:195], a[120:123], v[224:227], v[192:195]
    buffer_load_dwordx4 a[184:187], v5, s[12:15], s81 offen sc1
    v_mfma_f32_16x16x32_bf16 v[208:211], a[124:127], v[224:227], v[208:211]
    buffer_load_dwordx4 a[188:191], v6, s[12:15], s81 offen sc1
    v_mfma_f32_16x16x32_bf16 v[208:211], a[92:95], v[240:243], v[208:211]
    s_add_u32 s81, s81, 4096
    v_permlane16_swap_b32 v26, v72
    v_add_f32 v26, v26, v72
    v_mfma_f32_16x16x32_bf16 a[132:135], a[144:147], v[228:231], a[132:135]
    v_mov_b32 v72, v26
    v_max3_f32 v74, v74, abs(v147), abs(v160)
    v_mfma_f32_16x16x32_bf16 a[132:135], a[144:147], v[244:247], a[132:135]
    v_permlane32_swap_b32 v26, v72
    v_add_f32 v26, v26, v72
    v_mfma_f32_16x16x32_bf16 v[100:103], a[64:67], v[244:247], v[100:103]
    v_rcp_f32 v72, v26
    v_mfma_f32_16x16x32_bf16 v[100:103], a[96:99], v[228:231], v[100:103]
    s_lshl_b32 s38, s53, 14
    v_mov_b32 v73, 0x49800000
    v_cmp_gt_f32 vcc, 0x05800000, v74
    v_mfma_f32_16x16x32_bf16 v[116:119], a[100:103], v[228:231], v[116:119]
    s_add_u32 s38, s38, s40
    v_cndmask_b32 v73, v73, 0, vcc
    v_cmp_nlt_f32 s[44:45], v26, v73
    v_mfma_f32_16x16x32_bf16 v[116:119], a[68:71], v[244:247], v[116:119]
    v_mul_f32 v96, v96, v72
    v_mul_f32 v97, v97, v72
    v_mfma_f32_16x16x32_bf16 v[132:135], a[72:75], v[244:247], v[132:135]
    v_mul_f32 v98, v98, v72
    v_mul_f32 v99, v99, v72
    v_mfma_f32_16x16x32_bf16 v[132:135], a[104:107], v[228:231], v[132:135]
    v_cvt_pk_bf16_f32 v40, v96, v97
    v_cvt_pk_bf16_f32 v41, v98, v99
    v_mfma_f32_16x16x32_bf16 v[148:151], a[108:111], v[228:231], v[148:151]
    v_mul_f32 v112, v112, v72
    v_mul_f32 v113, v113, v72
    v_mfma_f32_16x16x32_bf16 v[148:151], a[76:79], v[244:247], v[148:151]
    v_mul_f32 v114, v114, v72
    v_mul_f32 v115, v115, v72
    v_mfma_f32_16x16x32_bf16 v[164:167], a[80:83], v[244:247], v[164:167]
    v_cvt_pk_bf16_f32 v42, v112, v113
    v_cvt_pk_bf16_f32 v43, v114, v115
    v_mfma_f32_16x16x32_bf16 v[164:167], a[112:115], v[228:231], v[164:167]
    buffer_store_dwordx4 v[40:43], v1, s[28:31], s38 offen sc1
    v_mfma_f32_16x16x32_bf16 v[180:183], a[116:119], v[228:231], v[180:183]
    s_add_u32 s38, s38, 4096
    v_mul_f32 v128, v128, v72
    v_mul_f32 v129, v129, v72
    v_mfma_f32_16x16x32_bf16 v[180:183], a[84:87], v[244:247], v[180:183]
    v_mul_f32 v130, v130, v72
    v_mul_f32 v131, v131, v72
    v_mfma_f32_16x16x32_bf16 v[196:199], a[88:91], v[244:247], v[196:199]
    v_cvt_pk_bf16_f32 v44, v128, v129
    v_cvt_pk_bf16_f32 v45, v130, v131
    v_mfma_f32_16x16x32_bf16 v[196:199], a[120:123], v[228:231], v[196:199]
    v_mul_f32 v144, v144, v72
    v_mul_f32 v145, v145, v72
    v_mfma_f32_16x16x32_bf16 v[212:215], a[124:127], v[228:231], v[212:215]
    v_mul_f32 v146, v146, v72
    v_mul_f32 v147, v147, v72
    v_mfma_f32_16x16x32_bf16 v[212:215], a[92:95], v[244:247], v[212:215]
    v_cvt_pk_bf16_f32 v46, v144, v145
    v_cvt_pk_bf16_f32 v47, v146, v147
    v_mfma_f32_16x16x32_bf16 a[136:139], a[144:147], v[248:251], a[136:139]
    buffer_store_dwordx4 v[44:47], v1, s[28:31], s38 offen sc1
    v_mfma_f32_16x16x32_bf16 v[104:107], a[64:67], v[248:251], v[104:107]
    s_add_u32 s38, s38, 4096
    v_mul_f32 v160, v160, v72
    v_mul_f32 v161, v161, v72
    v_mfma_f32_16x16x32_bf16 v[120:123], a[68:71], v[248:251], v[120:123]
    v_mul_f32 v162, v162, v72
    v_mul_f32 v163, v163, v72
    v_mfma_f32_16x16x32_bf16 v[136:139], a[72:75], v[248:251], v[136:139]
    s_lshl_b32 s37, s53, 14
    v_cvt_pk_bf16_f32 v40, v160, v161
    v_cvt_pk_bf16_f32 v41, v162, v163
    v_mfma_f32_16x16x32_bf16 v[152:155], a[76:79], v[248:251], v[152:155]
    s_add_u32 s37, s37, s41
    v_mul_f32 v176, v176, v72
    v_mul_f32 v177, v177, v72
    v_mfma_f32_16x16x32_bf16 v[168:171], a[80:83], v[248:251], v[168:171]
    v_mul_f32 v178, v178, v72
    v_mul_f32 v179, v179, v72
    v_mfma_f32_16x16x32_bf16 v[184:187], a[84:87], v[248:251], v[184:187]
    v_cvt_pk_bf16_f32 v42, v176, v177
    v_cvt_pk_bf16_f32 v43, v178, v179
    v_mfma_f32_16x16x32_bf16 v[200:203], a[88:91], v[248:251], v[200:203]
    buffer_store_dwordx4 v[40:43], v1, s[28:31], s38 offen sc1
    v_mfma_f32_16x16x32_bf16 v[216:219], a[92:95], v[248:251], v[216:219]
    s_add_u32 s38, s38, 4096
    v_mul_f32 v192, v192, v72
    v_mul_f32 v193, v193, v72
    v_mfma_f32_16x16x32_bf16 a[140:143], a[144:147], v[252:255], a[140:143]
    v_mul_f32 v194, v194, v72
    v_mul_f32 v195, v195, v72
    v_mfma_f32_16x16x32_bf16 v[108:111], a[64:67], v[252:255], v[108:111]
    v_cvt_pk_bf16_f32 v44, v192, v193
    v_cvt_pk_bf16_f32 v45, v194, v195
    v_mfma_f32_16x16x32_bf16 v[124:127], a[68:71], v[252:255], v[124:127]
    v_mul_f32 v208, v208, v72
    v_mul_f32 v209, v209, v72
    v_mfma_f32_16x16x32_bf16 v[140:143], a[72:75], v[252:255], v[140:143]
    v_mul_f32 v210, v210, v72
    v_mul_f32 v211, v211, v72
    v_mfma_f32_16x16x32_bf16 v[156:159], a[76:79], v[252:255], v[156:159]
    v_cvt_pk_bf16_f32 v46, v208, v209
    v_cvt_pk_bf16_f32 v47, v210, v211
    v_mfma_f32_16x16x32_bf16 v[172:175], a[80:83], v[252:255], v[172:175]
    buffer_store_dwordx4 v[44:47], v1, s[28:31], s38 offen sc1
    v_mfma_f32_16x16x32_bf16 v[188:191], a[84:87], v[252:255], v[188:191]
    s_lshl_b32 s38, s53, 14
    v_accvgpr_read_b32 v27, a132
    v_max3_f32 v78, abs(v100), abs(v117), abs(v134)
    v_mfma_f32_16x16x32_bf16 v[204:207], a[88:91], v[252:255], v[204:207]
    s_add_u32 s38, s38, s42
    v_rcp_f32 v76, v27
    v_mfma_f32_16x16x32_bf16 v[220:223], a[92:95], v[252:255], v[220:223]
    v_max3_f32 v78, v78, abs(v151), abs(v164)
    v_mov_b32 v77, 0x49800000
    v_cmp_gt_f32 vcc, 0x05800000, v78
    v_accvgpr_read_b32 v28, a136
    v_rcp_f32 v80, v28
    v_cndmask_b32 v77, v77, 0, vcc
    v_cmp_nlt_f32 s[46:47], v27, v77
    v_pk_mul_f32 v[100:101], v[100:101], v[76:77] op_sel_hi:[1,0]
    v_pk_mul_f32 v[102:103], v[102:103], v[76:77] op_sel_hi:[1,0]
    v_cvt_pk_bf16_f32 v48, v100, v101
    v_cvt_pk_bf16_f32 v49, v102, v103
    v_pk_mul_f32 v[116:117], v[116:117], v[76:77] op_sel_hi:[1,0]
    v_pk_mul_f32 v[118:119], v[118:119], v[76:77] op_sel_hi:[1,0]
    v_cvt_pk_bf16_f32 v50, v116, v117
    v_cvt_pk_bf16_f32 v51, v118, v119
    buffer_store_dwordx4 v[48:51], v1, s[28:31], s37 offen sc1
    s_add_u32 s37, s37, 4096
    v_pk_mul_f32 v[132:133], v[132:133], v[76:77] op_sel_hi:[1,0]
    v_pk_mul_f32 v[134:135], v[134:135], v[76:77] op_sel_hi:[1,0]
    v_cvt_pk_bf16_f32 v52, v132, v133
    v_cvt_pk_bf16_f32 v53, v134, v135
    v_pk_mul_f32 v[148:149], v[148:149], v[76:77] op_sel_hi:[1,0]
    v_pk_mul_f32 v[150:151], v[150:151], v[76:77] op_sel_hi:[1,0]
    v_cvt_pk_bf16_f32 v54, v148, v149
    v_cvt_pk_bf16_f32 v55, v150, v151
    buffer_store_dwordx4 v[52:55], v1, s[28:31], s37 offen sc1
    s_add_u32 s37, s37, 4096
    v_pk_mul_f32 v[164:165], v[164:165], v[76:77] op_sel_hi:[1,0]
    v_pk_mul_f32 v[166:167], v[166:167], v[76:77] op_sel_hi:[1,0]
    v_cvt_pk_bf16_f32 v48, v164, v165
    v_cvt_pk_bf16_f32 v49, v166, v167
    v_pk_mul_f32 v[180:181], v[180:181], v[76:77] op_sel_hi:[1,0]
    v_pk_mul_f32 v[182:183], v[182:183], v[76:77] op_sel_hi:[1,0]
    v_cvt_pk_bf16_f32 v50, v180, v181
    v_cvt_pk_bf16_f32 v51, v182, v183
    buffer_store_dwordx4 v[48:51], v1, s[28:31], s37 offen sc1
    s_add_u32 s37, s37, 4096
    v_pk_mul_f32 v[196:197], v[196:197], v[76:77] op_sel_hi:[1,0]
    v_pk_mul_f32 v[198:199], v[198:199], v[76:77] op_sel_hi:[1,0]
    v_cvt_pk_bf16_f32 v52, v196, v197
    v_cvt_pk_bf16_f32 v53, v198, v199
    v_pk_mul_f32 v[212:213], v[212:213], v[76:77] op_sel_hi:[1,0]
    v_pk_mul_f32 v[214:215], v[214:215], v[76:77] op_sel_hi:[1,0]
    v_cvt_pk_bf16_f32 v54, v212, v213
    v_cvt_pk_bf16_f32 v55, v214, v215
    buffer_store_dwordx4 v[52:55], v1, s[28:31], s37 offen sc1
    v_max3_f32 v82, abs(v104), abs(v121), abs(v138)
    v_max3_f32 v82, v82, abs(v155), abs(v168)
    v_mov_b32 v81, 0x49800000
    v_cmp_gt_f32 vcc, 0x05800000, v82
    v_accvgpr_read_b32 v29, a140
    v_rcp_f32 v84, v29
    v_cndmask_b32 v81, v81, 0, vcc
    v_cmp_nlt_f32 s[24:25], v28, v81
    v_pk_mul_f32 v[104:105], v[104:105], v[80:81] op_sel_hi:[1,0]
    v_pk_mul_f32 v[106:107], v[106:107], v[80:81] op_sel_hi:[1,0]
    v_cvt_pk_bf16_f32 v56, v104, v105
    v_cvt_pk_bf16_f32 v57, v106, v107
    v_pk_mul_f32 v[120:121], v[120:121], v[80:81] op_sel_hi:[1,0]
    v_pk_mul_f32 v[122:123], v[122:123], v[80:81] op_sel_hi:[1,0]
    v_cvt_pk_bf16_f32 v58, v120, v121
    v_cvt_pk_bf16_f32 v59, v122, v123
    buffer_store_dwordx4 v[56:59], v1, s[28:31], s38 offen sc1
    s_add_u32 s38, s38, 4096
    v_pk_mul_f32 v[136:137], v[136:137], v[80:81] op_sel_hi:[1,0]
    v_pk_mul_f32 v[138:139], v[138:139], v[80:81] op_sel_hi:[1,0]
    v_cvt_pk_bf16_f32 v60, v136, v137
    v_cvt_pk_bf16_f32 v61, v138, v139
    v_pk_mul_f32 v[152:153], v[152:153], v[80:81] op_sel_hi:[1,0]
    v_pk_mul_f32 v[154:155], v[154:155], v[80:81] op_sel_hi:[1,0]
    v_cvt_pk_bf16_f32 v62, v152, v153
    v_cvt_pk_bf16_f32 v63, v154, v155
    buffer_store_dwordx4 v[60:63], v1, s[28:31], s38 offen sc1
    s_add_u32 s38, s38, 4096
    v_pk_mul_f32 v[168:169], v[168:169], v[80:81] op_sel_hi:[1,0]
    v_pk_mul_f32 v[170:171], v[170:171], v[80:81] op_sel_hi:[1,0]
    v_cvt_pk_bf16_f32 v56, v168, v169
    v_cvt_pk_bf16_f32 v57, v170, v171
    v_pk_mul_f32 v[184:185], v[184:185], v[80:81] op_sel_hi:[1,0]
    v_pk_mul_f32 v[186:187], v[186:187], v[80:81] op_sel_hi:[1,0]
    v_cvt_pk_bf16_f32 v58, v184, v185
    v_cvt_pk_bf16_f32 v59, v186, v187
    buffer_store_dwordx4 v[56:59], v1, s[28:31], s38 offen sc1
    s_add_u32 s38, s38, 4096
    v_pk_mul_f32 v[200:201], v[200:201], v[80:81] op_sel_hi:[1,0]
    v_pk_mul_f32 v[202:203], v[202:203], v[80:81] op_sel_hi:[1,0]
    v_cvt_pk_bf16_f32 v60, v200, v201
    v_cvt_pk_bf16_f32 v61, v202, v203
    v_pk_mul_f32 v[216:217], v[216:217], v[80:81] op_sel_hi:[1,0]
    v_pk_mul_f32 v[218:219], v[218:219], v[80:81] op_sel_hi:[1,0]
    v_cvt_pk_bf16_f32 v62, v216, v217
    v_cvt_pk_bf16_f32 v63, v218, v219
    buffer_store_dwordx4 v[60:63], v1, s[28:31], s38 offen sc1
    buffer_load_dword v7, v39, s[76:79], 0 offen sc1
    v_max3_f32 v86, abs(v108), abs(v125), abs(v142)
    v_max3_f32 v86, v86, abs(v159), abs(v172)
    v_mov_b32 v85, 0x49800000
    v_cmp_gt_f32 vcc, 0x05800000, v86
    s_lshl_b32 s37, s53, 14
    s_add_u32 s37, s37, s43
    v_cndmask_b32 v85, v85, 0, vcc
    v_cmp_nlt_f32 s[26:27], v29, v85
    v_pk_mul_f32 v[108:109], v[108:109], v[84:85] op_sel_hi:[1,0]
    v_pk_mul_f32 v[110:111], v[110:111], v[84:85] op_sel_hi:[1,0]
    v_cvt_pk_bf16_f32 v64, v108, v109
    v_cvt_pk_bf16_f32 v65, v110, v111
    v_pk_mul_f32 v[124:125], v[124:125], v[84:85] op_sel_hi:[1,0]
    v_pk_mul_f32 v[126:127], v[126:127], v[84:85] op_sel_hi:[1,0]
    v_cvt_pk_bf16_f32 v66, v124, v125
    v_cvt_pk_bf16_f32 v67, v126, v127
    buffer_store_dwordx4 v[64:67], v1, s[28:31], s37 offen sc1
    s_add_u32 s37, s37, 4096
    v_pk_mul_f32 v[140:141], v[140:141], v[84:85] op_sel_hi:[1,0]
    v_pk_mul_f32 v[142:143], v[142:143], v[84:85] op_sel_hi:[1,0]
    v_cvt_pk_bf16_f32 v68, v140, v141
    v_cvt_pk_bf16_f32 v69, v142, v143
    v_pk_mul_f32 v[156:157], v[156:157], v[84:85] op_sel_hi:[1,0]
    v_pk_mul_f32 v[158:159], v[158:159], v[84:85] op_sel_hi:[1,0]
    v_cvt_pk_bf16_f32 v70, v156, v157
    v_cvt_pk_bf16_f32 v71, v158, v159
    buffer_store_dwordx4 v[68:71], v1, s[28:31], s37 offen sc1
    s_add_u32 s37, s37, 4096
    v_pk_mul_f32 v[172:173], v[172:173], v[84:85] op_sel_hi:[1,0]
    v_pk_mul_f32 v[174:175], v[174:175], v[84:85] op_sel_hi:[1,0]
    v_cvt_pk_bf16_f32 v64, v172, v173
    v_cvt_pk_bf16_f32 v65, v174, v175
    v_pk_mul_f32 v[188:189], v[188:189], v[84:85] op_sel_hi:[1,0]
    v_pk_mul_f32 v[190:191], v[190:191], v[84:85] op_sel_hi:[1,0]
    v_cvt_pk_bf16_f32 v66, v188, v189
    v_cvt_pk_bf16_f32 v67, v190, v191
    buffer_store_dwordx4 v[64:67], v1, s[28:31], s37 offen sc1
    s_add_u32 s37, s37, 4096
    v_pk_mul_f32 v[204:205], v[204:205], v[84:85] op_sel_hi:[1,0]
    v_pk_mul_f32 v[206:207], v[206:207], v[84:85] op_sel_hi:[1,0]
    v_cvt_pk_bf16_f32 v68, v204, v205
    v_cvt_pk_bf16_f32 v69, v206, v207
    v_pk_mul_f32 v[220:221], v[220:221], v[84:85] op_sel_hi:[1,0]
    v_pk_mul_f32 v[222:223], v[222:223], v[84:85] op_sel_hi:[1,0]
    v_cvt_pk_bf16_f32 v70, v220, v221
    v_cvt_pk_bf16_f32 v71, v222, v223
    buffer_store_dwordx4 v[68:71], v1, s[28:31], s37 offen sc1
    s_or_b64 s[44:45], s[44:45], s[46:47]
    s_or_b64 s[24:25], s[24:25], s[26:27]
    s_or_b64 s[44:45], s[44:45], s[24:25]
    s_cbranch_scc1 fallback_k1_9
ok_k1_8:
    s_load_dwordx2 s[60:61], s[0:1], 0
    s_load_dwordx2 s[66:67], s[0:1], 72
    s_mov_b32 s44, s48
    s_lshr_b32 s5, s32, 1
    s_and_b32 s45, s2, 4
    s_lshr_b32 s46, s2, 6
    s_add_u32 s45, s45, s46
    s_lshl_b32 s45, s45, 2
    s_and_b32 s46, s2, 3
    s_add_u32 s45, s45, s46
    s_lshl_b32 s45, s45, 1
    s_add_u32 s45, s45, s5
    s_mul_i32 s45, s45, 36864
    s_bfe_u32 s46, s2, 0x30003
    s_lshl_b32 s46, s46, 1
    s_and_b32 s47, s32, 1
    s_add_u32 s46, s46, s47
    s_lshl_b32 s46, s46, 2
    s_add_u32 s45, s45, s46
    v_lshlrev_b32 v40, 25, v0
    v_add_u32 v40, s45, v40
    v_mov_b32 v41, 0
    s_or_b64 vcc, s[50:51], s[82:83]
    s_cbranch_scc0 slowA_k1_10r
    s_cmp_lg_u64 s[82:83], 0
    s_cbranch_scc1 full_k1_13
    s_waitcnt vmcnt(4)
    v_cmp_eq_u32 vcc, -1, v7
    s_nop 4
    s_cbranch_vccz ldB_k1_12
full_k1_13:
    s_mov_b32 s53, 131072
spin_k1_14:
    global_load_dword v34, v38, s[94:95] sc1
    s_waitcnt vmcnt(0)
    v_cmp_gt_u32 vcc, 32, v34
    s_nop 4
    s_cbranch_vccz spun_k1_15
    s_sleep 2
    s_sub_u32 s53, s53, 1
    s_cbranch_scc0 spin_k1_14
spun_k1_15:
    buffer_store_dword v41, v40, s[76:79], 0 offen sc1
    s_cmp_eq_u64 s[82:83], 0
    s_cbranch_scc1 noA_k1_11
    s_lshl_b32 s80, s32, 10
    s_add_u32 m0, s33, 0
    s_nop 0
    buffer_load_dwordx4 v1, s[8:11], s80 offen sc1 lds
    s_add_u32 s80, s80, 4096
    s_add_u32 m0, s33, 1024
    s_nop 0
    buffer_load_dwordx4 v1, s[8:11], s80 offen sc1 lds
    s_add_u32 s80, s80, 4096
    s_add_u32 m0, s33, 2048
    s_nop 0
    buffer_load_dwordx4 v1, s[8:11], s80 offen sc1 lds
    s_add_u32 s80, s80, 4096
    s_add_u32 m0, s33, 3072
    s_nop 0
    buffer_load_dwordx4 v1, s[8:11], s80 offen sc1 lds
    s_add_u32 s80, s80, 4096
    s_add_u32 m0, s33, 4096
    s_nop 0
    buffer_load_dwordx4 v1, s[8:11], s80 offen sc1 lds
    s_add_u32 s80, s80, 4096
    s_add_u32 m0, s33, 5120
    s_nop 0
    buffer_load_dwordx4 v1, s[8:11], s80 offen sc1 lds
    s_add_u32 s80, s80, 4096
    s_add_u32 m0, s33, 6144
    s_nop 0
    buffer_load_dwordx4 v1, s[8:11], s80 offen sc1 lds
    s_add_u32 s80, s80, 4096
    s_add_u32 m0, s33, 7168
    s_nop 0
    buffer_load_dwordx4 v1, s[8:11], s80 offen sc1 lds
    s_add_u32 s80, s80, 4096
    s_add_u32 m0, s33, 8192
    s_nop 0
    buffer_load_dwordx4 v1, s[8:11], s80 offen sc1 lds
    s_add_u32 s80, s80, 4096
    s_add_u32 m0, s33, 9216
    s_nop 0
    buffer_load_dwordx4 v1, s[8:11], s80 offen sc1 lds
    s_add_u32 s80, s80, 4096
    s_add_u32 m0, s33, 10240
    s_nop 0
    buffer_load_dwordx4 v1, s[8:11], s80 offen sc1 lds
    s_add_u32 s80, s80, 4096
    s_add_u32 m0, s33, 11264
    s_nop 0
    buffer_load_dwordx4 v1, s[8:11], s80 offen sc1 lds
    s_add_u32 s80, s80, 4096
    s_add_u32 m0, s33, 12288
    s_nop 0
    buffer_load_dwordx4 v1, s[8:11], s80 offen sc1 lds
    s_add_u32 s80, s80, 4096
    s_add_u32 m0, s33, 13312
    s_nop 0
    buffer_load_dwordx4 v1, s[8:11], s80 offen sc1 lds
    s_add_u32 s80, s80, 4096
noA_k1_11:
    s_mov_b32 s53, 131072
spin_k1_16:
    buffer_load_dword v35, v39, s[76:79], 0 offen sc1
    s_waitcnt vmcnt(0)
    v_cmp_eq_u32 vcc, -1, v35
    s_nop 4
    s_cbranch_vccz spun_k1_17
    s_sleep 2
    s_sub_u32 s53, s53, 1
    s_cbranch_scc0 spin_k1_16
spun_k1_17:
ldB_k1_12:
    s_and_b32 s81, s32, 1
    s_lshl_b32 s81, s81, 11
    buffer_load_dwordx4 a[160:163], v5, s[12:15], s81 offen sc1
    buffer_load_dwordx4 a[164:167], v6, s[12:15], s81 offen sc1
    s_add_u32 s81, s81, 4096
    buffer_load_dwordx4 a[168:171], v5, s[12:15], s81 offen sc1
    buffer_load_dwordx4 a[172:175], v6, s[12:15], s81 offen sc1
    s_add_u32 s81, s81, 4096
    buffer_load_dwordx4 a[176:179], v5, s[12:15], s81 offen sc1
    buffer_load_dwordx4 a[180:183], v6, s[12:15], s81 offen sc1
    s_add_u32 s81, s81, 4096
    buffer_load_dwordx4 a[184:187], v5, s[12:15], s81 offen sc1
    buffer_load_dwordx4 a[188:191], v6, s[12:15], s81 offen sc1
    s_add_u32 s81, s81, 4096
    s_waitcnt vmcnt(0)
    buffer_store_dword v41, v40, s[76:79], 0 offen sc1
slowA_k1_10r:
    v_add_u32 v37, 0x20000, v1
    v_add_u32 v2, 0x10000, v1
    s_barrier
    ds_read_b128 a[0:3], v1 offset:0
    ds_read_b128 a[36:39], v1 offset:43008
    ds_read_b128 a[4:7], v1 offset:40960
    ds_read_b128 a[40:43], v2 offset:18432
    ds_read_b128 a[8:11], v2 offset:16384
    ds_read_b128 a[44:47], v2 offset:59392
    ds_read_b128 a[12:15], v2 offset:57344
    ds_read_b128 a[48:51], v1 offset:3072
    ds_read_b128 a[16:19], v1 offset:1024
    ds_read_b128 a[52:55], v1 offset:44032
    ds_read_b128 a[20:23], v1 offset:41984
    ds_read_b128 a[56:59], v2 offset:19456
    ds_read_b128 a[24:27], v2 offset:17408
    ds_read_b128 a[60:63], v2 offset:60416
    ds_read_b128 a[28:31], v2 offset:58368
    ds_read_b128 a[64:67], v1 offset:4096
    ds_read_b128 a[32:35], v1 offset:2048
    ds_read_b128 a[68:71], v1 offset:45056
    s_waitcnt lgkmcnt(0)
    s_waitcnt lgkmcnt(0)
    s_add_u32 m0, s33, 14336
    s_waitcnt vmcnt(24)
    v_mfma_f32_16x16x32_bf16 v[48:51], a[0:3], a[160:163], 0
    s_barrier
    ds_read_b128 a[72:75], v2 offset:20480
    v_lshlrev_b32 v3, 3, v0
    s_waitcnt vmcnt(22)
    v_mfma_f32_16x16x32_bf16 v[48:51], a[36:39], a[168:171], v[48:51]
    buffer_load_dwordx4 v1, s[8:11], s80 offen sc1 lds
    s_waitcnt vmcnt(22)
    v_mfma_f32_16x16x32_bf16 v[84:87], a[36:39], a[172:175], 0
    s_add_u32 s80, s80, 4096
    s_mov_b32 s16, s60
    ds_read_b128 a[108:111], v2 offset:63488
    v_mfma_f32_16x16x32_bf16 v[84:87], a[0:3], a[164:167], v[84:87]
    s_and_b32 s17, s61, 0xffff
    ds_read_b128 a[76:79], v2 offset:61440
    s_mov_b32 s18, 0x240000
    v_mfma_f32_16x16x32_bf16 v[88:91], a[4:7], a[164:167], 0
    s_mov_b32 s19, 0x00020000
    v_mov_b32 v36, 0
    v_mfma_f32_16x16x32_bf16 v[88:91], a[40:43], a[172:175], v[88:91]
    buffer_load_dwordx4 a[192:195], v5, s[12:15], s81 offen sc1
    v_mfma_f32_16x16x32_bf16 v[52:55], a[40:43], a[168:171], 0
    s_mov_b32 s20, s66
    ds_read_b128 a[112:115], v1 offset:7168
    s_and_b32 s21, s67, 0xffff
    v_mfma_f32_16x16x32_bf16 v[52:55], a[4:7], a[160:163], v[52:55]
    s_mov_b32 s22, 0x240000
    ds_read_b128 a[80:83], v1 offset:5120
    s_add_u32 m0, s33, 15360
    v_mfma_f32_16x16x32_bf16 v[56:59], a[8:11], a[160:163], 0
    s_mov_b32 s23, 0x00020000
    ds_read_b128 a[116:119], v1 offset:48128
    v_mfma_f32_16x16x32_bf16 v[56:59], a[44:47], a[168:171], v[56:59]
    buffer_load_dwordx4 v1, s[8:11], s80 offen sc1 lds
    v_mfma_f32_16x16x32_bf16 v[92:95], a[44:47], a[172:175], 0
    s_lshr_b32 s41, s39, 3
    s_add_u32 s80, s80, 4096
    ds_read_b128 a[84:87], v1 offset:46080
    v_mfma_f32_16x16x32_bf16 v[92:95], a[8:11], a[164:167], v[92:95]
    s_sub_u32 s41, s41, 3
    s_mov_b32 s42, 73728
    ds_read_b128 a[120:123], v2 offset:23552
    v_mfma_f32_16x16x32_bf16 v[96:99], a[12:15], a[164:167], 0
    s_lshl_b32 s70, s35, 2
    v_mfma_f32_16x16x32_bf16 v[96:99], a[48:51], a[172:175], v[96:99]
    s_add_u32 s70, s70, s36
    ds_read_b128 a[88:91], v2 offset:21504
    v_mfma_f32_16x16x32_bf16 v[60:63], a[48:51], a[168:171], 0
    buffer_load_dwordx4 a[196:199], v6, s[12:15], s81 offen sc1
    v_mfma_f32_16x16x32_bf16 v[60:63], a[12:15], a[160:163], v[60:63]
    s_add_u32 s81, s81, 4096
    s_lshl_b32 s70, s70, 2
    s_add_u32 s70, s70, s32
    v_mfma_f32_16x16x32_bf16 v[64:67], a[16:19], a[160:163], 0
    s_mul_i32 s70, s70, 36864
    ds_read_b128 a[124:127], v2 offset:64512
    s_add_u32 m0, s33, 16384
    v_mfma_f32_16x16x32_bf16 v[64:67], a[52:55], a[168:171], v[64:67]
    buffer_load_dwordx4 v1, s[8:11], s80 offen sc1 lds
    v_mfma_f32_16x16x32_bf16 v[100:103], a[52:55], a[172:175], 0
    s_mul_i32 s71, s34, 9216
    ds_read_b128 a[92:95], v2 offset:62464
    s_add_u32 s46, s70, s71
    v_mfma_f32_16x16x32_bf16 v[100:103], a[16:19], a[164:167], v[100:103]
    s_add_u32 s80, s80, 4096
    ds_read_b128 a[128:131], v1 offset:8192
    s_lshr_b32 s45, s44, 10
    v_mfma_f32_16x16x32_bf16 v[104:107], a[20:23], a[164:167], 0
    s_mul_i32 s45, s45, 4608
    ds_read_b128 a[96:99], v1 offset:6144
    s_add_u32 s48, s46, 4608
    v_mfma_f32_16x16x32_bf16 v[104:107], a[56:59], a[172:175], v[104:107]
    s_sub_u32 s48, s48, s45
    ds_read_b128 a[132:135], v1 offset:49152
    v_mfma_f32_16x16x32_bf16 v[68:71], a[56:59], a[168:171], 0
    buffer_load_dwordx4 a[200:203], v5, s[12:15], s81 offen sc1
    v_mfma_f32_16x16x32_bf16 v[68:71], a[20:23], a[160:163], v[68:71]
    s_add_u32 s47, s46, 4096
    ds_read_b128 a[100:103], v1 offset:47104
    s_add_u32 s49, s48, 4096
    v_mfma_f32_16x16x32_bf16 v[72:75], a[24:27], a[160:163], 0
    s_add_u32 s70, s70, s45
    s_add_u32 m0, s33, 17408
    v_mfma_f32_16x16x32_bf16 v[72:75], a[60:63], a[168:171], v[72:75]
    s_xor_b32 s74, s34, 1
    ds_read_b128 a[136:139], v2 offset:24576
    v_mfma_f32_16x16x32_bf16 v[108:111], a[60:63], a[172:175], 0
    buffer_load_dwordx4 v1, s[8:11], s80 offen sc1 lds
    v_mfma_f32_16x16x32_bf16 v[108:111], a[24:27], a[164:167], v[108:111]
    s_mul_i32 s74, s74, 9216
    ds_read_b128 a[104:107], v2 offset:22528
    s_add_u32 s80, s80, 4096
    v_mfma_f32_16x16x32_bf16 v[112:115], a[28:31], a[164:167], 0
    s_add_u32 s74, s74, s70
    ds_read_b128 a[140:143], v37 offset:0
    s_add_u32 s75, s74, 4096
    v_mfma_f32_16x16x32_bf16 v[112:115], a[64:67], a[172:175], v[112:115]
    s_add_u32 s70, s70, 18432
    v_mfma_f32_16x16x32_bf16 v[76:79], a[64:67], a[168:171], 0
    s_add_u32 s71, s70, 4096
    v_mfma_f32_16x16x32_bf16 v[76:79], a[28:31], a[160:163], v[76:79]
    buffer_load_dwordx4 a[204:207], v6, s[12:15], s81 offen sc1
    v_mfma_f32_16x16x32_bf16 v[80:83], a[32:35], a[160:163], 0
    s_add_u32 s81, s81, 4096
    s_add_u32 s72, s70, 9216
    s_add_u32 s73, s70, 13312
    v_mfma_f32_16x16x32_bf16 v[80:83], a[68:71], a[168:171], v[80:83]
    s_lshl_b32 s50, s35, 7
    v_mfma_f32_16x16x32_bf16 v[116:119], a[68:71], a[172:175], 0
    s_lshl_b32 s51, s32, 5
    v_mfma_f32_16x16x32_bf16 v[116:119], a[32:35], a[164:167], v[116:119]
    buffer_load_dwordx4 a[208:211], v5, s[12:15], s81 offen sc1
    s_waitcnt lgkmcnt(0)
    s_waitcnt vmcnt(29)
    v_mfma_f32_16x16x32_bf16 v[48:51], a[72:75], a[176:179], v[48:51]
    s_add_u32 s50, s50, s51
    s_barrier
    s_waitcnt vmcnt(27)
    v_mfma_f32_16x16x32_bf16 v[48:51], a[108:111], a[184:187], v[48:51]
    s_lshr_b32 s51, s44, 6
    ds_read_b128 a[0:3], v1 offset:9216
    s_add_u32 s50, s50, s51
    s_waitcnt vmcnt(26)
    v_mfma_f32_16x16x32_bf16 v[84:87], a[108:111], a[188:191], v[84:87]
    s_add_u32 m0, s33, 0
    s_mul_i32 s50, s50, 1152
    ds_read_b128 a[36:39], v1 offset:52224
    v_mfma_f32_16x16x32_bf16 v[84:87], a[72:75], a[180:183], v[84:87]
    buffer_load_dwordx4 v1, s[8:11], s80 offen sc1 lds
    v_mfma_f32_16x16x32_bf16 v[88:91], a[76:79], a[180:183], v[88:91]
    s_mul_i32 s51, s36, 288
    s_add_u32 s80, s80, 4096
    ds_read_b128 a[4:7], v1 offset:50176
    v_mfma_f32_16x16x32_bf16 v[88:91], a[112:115], a[188:191], v[88:91]
    s_add_u32 s50, s50, s51
    s_and_b32 s51, s34, 2
    ds_read_b128 a[40:43], v2 offset:27648
    v_mfma_f32_16x16x32_bf16 v[52:55], a[112:115], a[184:187], v[52:55]
    s_add_u32 m0, s33, 1024
    s_lshl_b32 s51, s51, 28
    s_add_u32 s50, s50, s51
    v_mfma_f32_16x16x32_bf16 v[52:55], a[76:79], a[176:179], v[52:55]
    buffer_load_dwordx4 v1, s[8:11], s80 offen sc1 lds
    v_mfma_f32_16x16x32_bf16 v[56:59], a[80:83], a[176:179], v[56:59]
    s_add_u32 s80, s80, 4096
    ds_read_b128 a[8:11], v2 offset:25600
    s_add_u32 s51, s33, 20480
    v_mfma_f32_16x16x32_bf16 v[56:59], a[116:119], a[184:187], v[56:59]
    s_mov_b32 s52, 3641
    ds_read_b128 a[44:47], v37 offset:3072
    s_mov_b32 s68, 0x00003f80
    v_mfma_f32_16x16x32_bf16 v[92:95], a[116:119], a[188:191], v[92:95]
    s_mov_b32 s69, 0x3f800000
    ds_read_b128 a[12:15], v37 offset:1024
    v_mfma_f32_16x16x32_bf16 v[92:95], a[80:83], a[180:183], v[92:95]
    buffer_load_dwordx4 a[212:215], v6, s[12:15], s81 offen sc1
    v_mfma_f32_16x16x32_bf16 v[96:99], a[84:87], a[180:183], v[96:99]
    s_add_u32 s81, s81, 4096
    ds_read_b128 a[48:51], v1 offset:12288
    s_waitcnt vmcnt(12)
    v_mfma_f32_16x16x32_bf16 v[96:99], a[120:123], a[188:191], v[96:99]
    buffer_store_dword v41, v40, s[76:79], 0 offen sc1
    v_mfma_f32_16x16x32_bf16 v[60:63], a[120:123], a[184:187], v[60:63]
    s_add_u32 m0, s33, 2048
    ds_read_b128 a[16:19], v1 offset:10240
    v_add_u32 v12, 0, v0
    v_mfma_f32_16x16x32_bf16 v[60:63], a[84:87], a[176:179], v[60:63]
    ds_read_b128 a[52:55], v1 offset:53248
    v_mul_u32_u24 v13, s52, v12
    v_mfma_f32_16x16x32_bf16 v[64:67], a[88:91], a[176:179], v[64:67]
    buffer_load_dwordx4 v1, s[8:11], s80 offen sc1 lds
    v_mfma_f32_16x16x32_bf16 v[64:67], a[124:127], a[184:187], v[64:67]
    s_add_u32 s80, s80, 4096
    ds_read_b128 a[20:23], v1 offset:51200
    v_lshrrev_b32 v13, 16, v13
    v_mfma_f32_16x16x32_bf16 v[100:103], a[124:127], a[188:191], v[100:103]
    s_add_u32 m0, s33, 3072
    ds_read_b128 a[56:59], v2 offset:28672
    v_mul_u32_u24 v13, 864, v13
    v_mfma_f32_16x16x32_bf16 v[100:103], a[88:91], a[180:183], v[100:103]
    buffer_load_dwordx4 v1, s[8:11], s80 offen sc1 lds
    v_mfma_f32_16x16x32_bf16 v[104:107], a[92:95], a[180:183], v[104:107]
    s_add_u32 s80, s80, 4096
    ds_read_b128 a[24:27], v2 offset:26624
    v_lshl_add_u32 v7, v12, 4, v13
    v_mfma_f32_16x16x32_bf16 v[104:107], a[128:131], a[188:191], v[104:107]
    ds_read_b128 a[60:63], v37 offset:4096
    v_add_u32 v12, 64, v0
    v_mfma_f32_16x16x32_bf16 v[68:71], a[128:131], a[184:187], v[68:71]
    v_mul_u32_u24 v13, s52, v12
    v_lshrrev_b32 v13, 16, v13
    v_mfma_f32_16x16x32_bf16 v[68:71], a[92:95], a[176:179], v[68:71]
    ds_read_b128 a[28:31], v37 offset:2048
    v_mul_u32_u24 v13, 864, v13
    v_mfma_f32_16x16x32_bf16 v[72:75], a[96:99], a[176:179], v[72:75]
    buffer_load_dwordx4 a[216:219], v5, s[12:15], s81 offen sc1
    v_mfma_f32_16x16x32_bf16 v[72:75], a[132:135], a[184:187], v[72:75]
    ds_read_b128 a[64:67], v1 offset:13312
    v_lshl_add_u32 v8, v12, 4, v13
    v_mfma_f32_16x16x32_bf16 v[108:111], a[132:135], a[188:191], v[108:111]
    s_add_u32 m0, s33, 4096
    ds_read_b128 a[32:35], v1 offset:11264
    v_add_u32 v12, 128, v0
    v_mfma_f32_16x16x32_bf16 v[108:111], a[96:99], a[180:183], v[108:111]
    v_mul_u32_u24 v13, s52, v12
    v_lshrrev_b32 v13, 16, v13
    v_mfma_f32_16x16x32_bf16 v[112:115], a[100:103], a[180:183], v[112:115]
    buffer_load_dwordx4 v1, s[8:11], s80 offen sc1 lds
    v_mfma_f32_16x16x32_bf16 v[112:115], a[136:139], a[188:191], v[112:115]
    s_add_u32 s80, s80, 4096
    ds_read_b128 a[68:71], v1 offset:54272
    v_mul_u32_u24 v13, 864, v13
    v_mfma_f32_16x16x32_bf16 v[76:79], a[136:139], a[184:187], v[76:79]
    v_lshl_add_u32 v9, v12, 4, v13
    v_add_u32 v12, 192, v0
    v_mfma_f32_16x16x32_bf16 v[76:79], a[100:103], a[176:179], v[76:79]
    v_mul_u32_u24 v13, s52, v12
    v_lshrrev_b32 v13, 16, v13
    v_mfma_f32_16x16x32_bf16 v[80:83], a[104:107], a[176:179], v[80:83]
    buffer_load_dwordx4 a[220:223], v6, s[12:15], s81 offen sc1
    v_mfma_f32_16x16x32_bf16 v[80:83], a[140:143], a[184:187], v[80:83]
    s_add_u32 s81, s81, 4096
    v_mul_u32_u24 v13, 864, v13
    v_lshl_add_u32 v10, v12, 4, v13
    v_mfma_f32_16x16x32_bf16 v[116:119], a[140:143], a[188:191], v[116:119]
    v_add_u32 v12, 256, v0
    v_mul_u32_u24 v13, s52, v12
    v_mfma_f32_16x16x32_bf16 v[116:119], a[104:107], a[180:183], v[116:119]
    s_waitcnt lgkmcnt(0)
    s_waitcnt vmcnt(11)
    s_barrier
    v_mfma_f32_16x16x32_bf16 v[48:51], a[0:3], a[192:195], v[48:51]
    ds_read_b128 a[72:75], v2 offset:29696
    v_lshrrev_b32 v13, 16, v13
    v_mfma_f32_16x16x32_bf16 v[48:51], a[36:39], a[200:203], v[48:51]
    buffer_load_dwordx4 a[160:163], v5, s[12:15], s81 offen sc1
    s_waitcnt vmcnt(11)
    v_mfma_f32_16x16x32_bf16 v[84:87], a[36:39], a[204:207], v[84:87]
    ds_read_b128 a[108:111], v37 offset:7168
    v_mul_u32_u24 v13, 864, v13
    v_mfma_f32_16x16x32_bf16 v[84:87], a[0:3], a[196:199], v[84:87]
    s_add_u32 m0, s33, 5120
    ds_read_b128 a[76:79], v37 offset:5120
    v_lshl_add_u32 v11, v12, 4, v13
    v_mfma_f32_16x16x32_bf16 v[88:91], a[4:7], a[196:199], v[88:91]
    buffer_load_dwordx4 v1, s[8:11], s80 offen sc1 lds
    v_mfma_f32_16x16x32_bf16 v[88:91], a[40:43], a[204:207], v[88:91]
    s_add_u32 s80, s80, 4096
    ds_read_b128 a[112:115], v1 offset:16384
    v_and_b32 v12, 32, v0
    v_mfma_f32_16x16x32_bf16 v[52:55], a[40:43], a[200:203], v[52:55]
    v_lshl_add_u32 v11, v12, 25, v11
    v_and_b32 v12, 15, v0
    v_mfma_f32_16x16x32_bf16 v[52:55], a[4:7], a[192:195], v[52:55]
    ds_read_b128 a[80:83], v1 offset:14336
    v_mul_u32_u24 v12, 288, v12
    v_mfma_f32_16x16x32_bf16 v[56:59], a[8:11], a[192:195], v[56:59]
    ds_read_b128 a[116:119], v1 offset:57344
    v_lshrrev_b32 v13, 4, v0
    v_mfma_f32_16x16x32_bf16 v[56:59], a[44:47], a[200:203], v[56:59]
    buffer_load_dwordx4 a[164:167], v6, s[12:15], s81 offen sc1
    v_mfma_f32_16x16x32_bf16 v[92:95], a[44:47], a[204:207], v[92:95]
    s_add_u32 s81, s81, 4096
    ds_read_b128 a[84:87], v1 offset:55296
    v_lshl_add_u32 v12, v13, 3, v12
    v_mfma_f32_16x16x32_bf16 v[92:95], a[8:11], a[196:199], v[92:95]
    s_add_u32 m0, s33, 6144
    ds_read_b128 a[120:123], v2 offset:32768
    v_add_u32 v4, s51, v12
    v_mfma_f32_16x16x32_bf16 v[96:99], a[12:15], a[196:199], v[96:99]
    v_mfma_f32_16x16x32_bf16 v[96:99], a[48:51], a[204:207], v[96:99]
    buffer_load_dwordx4 v1, s[8:11], s80 offen sc1 lds
    v_mfma_f32_16x16x32_bf16 v[60:63], a[48:51], a[200:203], v[60:63]
    s_add_u32 s80, s80, 4096
    ds_read_b128 a[88:91], v2 offset:30720
    v_mfma_f32_16x16x32_bf16 v[60:63], a[12:15], a[192:195], v[60:63]
    ds_read_b128 a[124:127], v37 offset:8192
    v_mfma_f32_16x16x32_bf16 v[64:67], a[16:19], a[192:195], v[64:67]
    ds_read_b128 a[92:95], v37 offset:6144
    v_mfma_f32_16x16x32_bf16 v[64:67], a[52:55], a[200:203], v[64:67]
    buffer_load_dwordx4 a[168:171], v5, s[12:15], s81 offen sc1
    v_mfma_f32_16x16x32_bf16 v[100:103], a[52:55], a[204:207], v[100:103]
    ds_read_b128 a[128:131], v1 offset:17408
    v_mfma_f32_16x16x32_bf16 v[100:103], a[16:19], a[196:199], v[100:103]
    v_mfma_f32_16x16x32_bf16 v[104:107], a[20:23], a[196:199], v[104:107]
    s_add_u32 m0, s33, 7168
    ds_read_b128 a[96:99], v1 offset:15360
    v_mfma_f32_16x16x32_bf16 v[104:107], a[56:59], a[204:207], v[104:107]
    buffer_load_dwordx4 v1, s[8:11], s80 offen sc1 lds
    v_mfma_f32_16x16x32_bf16 v[68:71], a[56:59], a[200:203], v[68:71]
    s_add_u32 s80, s80, 4096
    ds_read_b128 a[132:135], v1 offset:58368
    v_mfma_f32_16x16x32_bf16 v[68:71], a[20:23], a[192:195], v[68:71]
    ds_read_b128 a[100:103], v1 offset:56320
    v_mfma_f32_16x16x32_bf16 v[72:75], a[24:27], a[192:195], v[72:75]
    v_mfma_f32_16x16x32_bf16 v[72:75], a[60:63], a[200:203], v[72:75]
    buffer_load_dwordx4 a[172:175], v6, s[12:15], s81 offen sc1
    v_mfma_f32_16x16x32_bf16 v[108:111], a[60:63], a[204:207], v[108:111]
    s_add_u32 s81, s81, 4096
    ds_read_b128 a[136:139], v2 offset:33792
    ds_read_b128 a[104:107], v2 offset:31744
    v_mfma_f32_16x16x32_bf16 v[108:111], a[24:27], a[196:199], v[108:111]
    v_mfma_f32_16x16x32_bf16 v[112:115], a[28:31], a[196:199], v[112:115]
    s_add_u32 m0, s33, 8192
    ds_read_b128 a[140:143], v37 offset:9216
    v_mfma_f32_16x16x32_bf16 v[112:115], a[64:67], a[204:207], v[112:115]
    buffer_load_dwordx4 v1, s[8:11], s80 offen sc1 lds
    v_mfma_f32_16x16x32_bf16 v[76:79], a[64:67], a[200:203], v[76:79]
    s_add_u32 m0, s51, 0
    s_add_u32 s80, s80, 4096
    v_mfma_f32_16x16x32_bf16 v[76:79], a[28:31], a[192:195], v[76:79]
    buffer_load_dwordx4 v7, s[16:19], s50 offen lds
    v_mfma_f32_16x16x32_bf16 v[80:83], a[32:35], a[192:195], v[80:83]
    s_add_u32 m0, s51, 1024
    v_mfma_f32_16x16x32_bf16 v[80:83], a[68:71], a[200:203], v[80:83]
    buffer_load_dwordx4 v8, s[16:19], s50 offen lds
    v_mfma_f32_16x16x32_bf16 v[116:119], a[68:71], a[204:207], v[116:119]
    s_add_u32 m0, s51, 2048
    v_mfma_f32_16x16x32_bf16 v[116:119], a[32:35], a[196:199], v[116:119]
    buffer_load_dwordx4 v9, s[16:19], s50 offen lds
    s_waitcnt lgkmcnt(0)
    s_waitcnt vmcnt(20)
    v_mfma_f32_16x16x32_bf16 v[48:51], a[72:75], a[208:211], v[48:51]
    s_add_u32 m0, s51, 3072
    s_waitcnt vmcnt(13)
    v_mfma_f32_16x16x32_bf16 v[48:51], a[108:111], a[216:219], v[48:51]
    buffer_load_dwordx4 v10, s[16:19], s50 offen lds
    s_waitcnt vmcnt(12)
    v_mfma_f32_16x16x32_bf16 v[84:87], a[108:111], a[220:223], v[84:87]
    s_add_u32 m0, s51, 4096
    v_mfma_f32_16x16x32_bf16 v[84:87], a[72:75], a[212:215], v[84:87]
    buffer_load_dwordx4 v11, s[16:19], s50 offen lds
    v_mfma_f32_16x16x32_bf16 v[88:91], a[76:79], a[212:215], v[88:91]
    buffer_load_dwordx4 a[176:179], v5, s[12:15], s81 offen sc1
    v_mfma_f32_16x16x32_bf16 v[88:91], a[112:115], a[220:223], v[88:91]
    s_barrier
    ds_read_b128 a[0:3], v1 offset:0
    v_mfma_f32_16x16x32_bf16 v[52:55], a[112:115], a[216:219], v[52:55]
    s_add_u32 m0, s33, 9216
    ds_read_b128 a[36:39], v1 offset:43008
    ds_read_b128 a[4:7], v1 offset:40960
    v_mfma_f32_16x16x32_bf16 v[52:55], a[76:79], a[208:211], v[52:55]
    buffer_load_dwordx4 v1, s[8:11], s80 offen sc1 lds
    v_mfma_f32_16x16x32_bf16 v[56:59], a[80:83], a[208:211], v[56:59]
    s_add_u32 s80, s80, 4096
    s_add_u32 m0, s33, 10240
    ds_read_b128 a[40:43], v2 offset:18432
    v_mfma_f32_16x16x32_bf16 v[56:59], a[116:119], a[216:219], v[56:59]
    buffer_load_dwordx4 v1, s[8:11], s80 offen sc1 lds
    v_mfma_f32_16x16x32_bf16 v[92:95], a[116:119], a[220:223], v[92:95]
    s_add_u32 s80, s80, 4096
    ds_read_b128 a[8:11], v2 offset:16384
    ds_read_b128 a[44:47], v2 offset:59392
    v_mfma_f32_16x16x32_bf16 v[92:95], a[80:83], a[212:215], v[92:95]
    ds_read_b128 a[12:15], v2 offset:57344
    ds_read_b128 a[48:51], v1 offset:3072
    v_mfma_f32_16x16x32_bf16 v[96:99], a[84:87], a[212:215], v[96:99]
    buffer_load_dwordx4 a[180:183], v6, s[12:15], s81 offen sc1
    v_mfma_f32_16x16x32_bf16 v[96:99], a[120:123], a[220:223], v[96:99]
    s_add_u32 s81, s81, 4096
    s_add_u32 m0, s33, 11264
    ds_read_b128 a[16:19], v1 offset:1024
    v_mfma_f32_16x16x32_bf16 v[60:63], a[120:123], a[216:219], v[60:63]
    buffer_load_dwordx4 v1, s[8:11], s80 offen sc1 lds
    v_mfma_f32_16x16x32_bf16 v[60:63], a[84:87], a[208:211], v[60:63]
    s_add_u32 s80, s80, 4096
    ds_read_b128 a[52:55], v1 offset:44032
    v_mfma_f32_16x16x32_bf16 v[64:67], a[88:91], a[208:211], v[64:67]
    ds_read_b128 a[20:23], v1 offset:41984
    v_mfma_f32_16x16x32_bf16 v[64:67], a[124:127], a[216:219], v[64:67]
    s_add_u32 m0, s33, 12288
    v_mfma_f32_16x16x32_bf16 v[100:103], a[124:127], a[220:223], v[100:103]
    ds_read_b128 a[56:59], v2 offset:19456
    v_mfma_f32_16x16x32_bf16 v[100:103], a[88:91], a[212:215], v[100:103]
    buffer_load_dwordx4 v1, s[8:11], s80 offen sc1 lds
    v_mfma_f32_16x16x32_bf16 v[104:107], a[92:95], a[212:215], v[104:107]
    s_add_u32 s80, s80, 4096
    ds_read_b128 a[24:27], v2 offset:17408
    v_mfma_f32_16x16x32_bf16 v[104:107], a[128:131], a[220:223], v[104:107]
    ds_read_b128 a[60:63], v2 offset:60416
    v_mfma_f32_16x16x32_bf16 v[68:71], a[128:131], a[216:219], v[68:71]
    v_mfma_f32_16x16x32_bf16 v[68:71], a[92:95], a[208:211], v[68:71]
    buffer_load_dwordx4 a[184:187], v5, s[12:15], s81 offen sc1
    v_mfma_f32_16x16x32_bf16 v[72:75], a[96:99], a[208:211], v[72:75]
    ds_read_b128 a[28:31], v2 offset:58368
    v_mfma_f32_16x16x32_bf16 v[72:75], a[132:135], a[216:219], v[72:75]
    ds_read_b128 a[64:67], v1 offset:4096
    v_mfma_f32_16x16x32_bf16 v[108:111], a[132:135], a[220:223], v[108:111]
    s_add_u32 m0, s33, 13312
    ds_read_b128 a[32:35], v1 offset:2048
    v_mfma_f32_16x16x32_bf16 v[108:111], a[96:99], a[212:215], v[108:111]
    buffer_load_dwordx4 v1, s[8:11], s80 offen sc1 lds
    v_mfma_f32_16x16x32_bf16 v[112:115], a[100:103], a[212:215], v[112:115]
    s_add_u32 s80, s80, 4096
    ds_read_b128 a[68:71], v1 offset:45056
    v_mfma_f32_16x16x32_bf16 v[112:115], a[136:139], a[220:223], v[112:115]
    v_mfma_f32_16x16x32_bf16 v[76:79], a[136:139], a[216:219], v[76:79]
    v_mfma_f32_16x16x32_bf16 v[76:79], a[100:103], a[208:211], v[76:79]
    buffer_load_dwordx4 a[188:191], v6, s[12:15], s81 offen sc1
    v_mfma_f32_16x16x32_bf16 v[80:83], a[104:107], a[208:211], v[80:83]
    s_add_u32 s81, s81, 4096
    v_mfma_f32_16x16x32_bf16 v[80:83], a[140:143], a[216:219], v[80:83]
    v_mfma_f32_16x16x32_bf16 v[116:119], a[140:143], a[220:223], v[116:119]
    v_mfma_f32_16x16x32_bf16 v[116:119], a[104:107], a[212:215], v[116:119]
p2_k1_19:
    s_waitcnt lgkmcnt(0)
    s_add_u32 m0, s33, 14336
    v_cmp_eq_u32 vcc, -1, v36
    s_waitcnt vmcnt(16)
    v_mfma_f32_16x16x32_bf16 v[48:51], a[0:3], a[160:163], v[48:51]
    s_waitcnt vmcnt(9)
    s_barrier
    ds_read_b128 a[72:75], v2 offset:20480
    v_mfma_f32_16x16x32_bf16 v[48:51], a[36:39], a[168:171], v[48:51]
    buffer_load_dwordx4 v1, s[8:11], s80 offen sc1 lds
    v_mfma_f32_16x16x32_bf16 v[84:87], a[36:39], a[172:175], v[84:87]
    s_add_u32 s80, s80, 4096
    ds_read_b128 a[108:111], v2 offset:63488
    v_mfma_f32_16x16x32_bf16 v[84:87], a[0:3], a[164:167], v[84:87]
    s_cmp_eq_u32 s41, 3
    s_cselect_b64 vcc, vcc, 0
    s_cbranch_vccnz slowB_k1_18
    slowB_k1_18r:
    v_mfma_f32_16x16x32_bf16 v[88:91], a[4:7], a[164:167], v[88:91]
    ds_read_b128 a[76:79], v2 offset:61440
    v_mfma_f32_16x16x32_bf16 v[88:91], a[40:43], a[172:175], v[88:91]
    buffer_load_dwordx4 a[192:195], v5, s[12:15], s81 offen sc1
    v_mfma_f32_16x16x32_bf16 v[52:55], a[40:43], a[168:171], v[52:55]
    ds_read_b128 a[112:115], v1 offset:7168
    v_mfma_f32_16x16x32_bf16 v[52:55], a[4:7], a[160:163], v[52:55]
    s_add_u32 m0, s33, 15360
    ds_read_b128 a[80:83], v1 offset:5120
    v_mfma_f32_16x16x32_bf16 v[56:59], a[8:11], a[160:163], v[56:59]
    ds_read_b128 a[116:119], v1 offset:48128
    v_mfma_f32_16x16x32_bf16 v[56:59], a[44:47], a[168:171], v[56:59]
    buffer_load_dwordx4 v1, s[8:11], s80 offen sc1 lds
    v_mfma_f32_16x16x32_bf16 v[92:95], a[44:47], a[172:175], v[92:95]
    s_add_u32 s80, s80, 4096
    ds_read_b128 a[84:87], v1 offset:46080
    v_mfma_f32_16x16x32_bf16 v[92:95], a[8:11], a[164:167], v[92:95]
    ds_read_b128 a[120:123], v2 offset:23552
    v_mfma_f32_16x16x32_bf16 v[96:99], a[12:15], a[164:167], v[96:99]
    v_mfma_f32_16x16x32_bf16 v[96:99], a[48:51], a[172:175], v[96:99]
    buffer_load_dwordx4 a[196:199], v6, s[12:15], s81 offen sc1
    v_mfma_f32_16x16x32_bf16 v[60:63], a[48:51], a[168:171], v[60:63]
    s_add_u32 s81, s81, 4096
    ds_read_b128 a[88:91], v2 offset:21504
    v_mfma_f32_16x16x32_bf16 v[60:63], a[12:15], a[160:163], v[60:63]
    ds_read_b128 a[124:127], v2 offset:64512
    v_mfma_f32_16x16x32_bf16 v[64:67], a[16:19], a[160:163], v[64:67]
    s_add_u32 m0, s33, 16384
    ds_read_b128 a[92:95], v2 offset:62464
    v_mfma_f32_16x16x32_bf16 v[64:67], a[52:55], a[168:171], v[64:67]
    buffer_load_dwordx4 v1, s[8:11], s80 offen sc1 lds
    v_mfma_f32_16x16x32_bf16 v[100:103], a[52:55], a[172:175], v[100:103]
    s_add_u32 s80, s80, 4096
    ds_read_b128 a[128:131], v1 offset:8192
    v_mfma_f32_16x16x32_bf16 v[100:103], a[16:19], a[164:167], v[100:103]
    v_mfma_f32_16x16x32_bf16 v[104:107], a[20:23], a[164:167], v[104:107]
    ds_read_b128 a[96:99], v1 offset:6144
    v_mfma_f32_16x16x32_bf16 v[104:107], a[56:59], a[172:175], v[104:107]
    ds_read_b128 a[132:135], v1 offset:49152
    v_mfma_f32_16x16x32_bf16 v[68:71], a[56:59], a[168:171], v[68:71]
    buffer_load_dwordx4 a[200:203], v5, s[12:15], s81 offen sc1
    v_mfma_f32_16x16x32_bf16 v[68:71], a[20:23], a[160:163], v[68:71]
    ds_read_b128 a[100:103], v1 offset:47104
    v_mfma_f32_16x16x32_bf16 v[72:75], a[24:27], a[160:163], v[72:75]
    s_add_u32 m0, s33, 17408
    v_mfma_f32_16x16x32_bf16 v[72:75], a[60:63], a[168:171], v[72:75]
    ds_read_b128 a[136:139], v2 offset:24576
    v_mfma_f32_16x16x32_bf16 v[108:111], a[60:63], a[172:175], v[108:111]
    buffer_load_dwordx4 v1, s[8:11], s80 offen sc1 lds
    v_mfma_f32_16x16x32_bf16 v[108:111], a[24:27], a[164:167], v[108:111]
    s_add_u32 s80, s80, 4096
    ds_read_b128 a[104:107], v2 offset:22528
    v_mfma_f32_16x16x32_bf16 v[112:115], a[28:31], a[164:167], v[112:115]
    ds_read_b128 a[140:143], v37 offset:0
    v_mfma_f32_16x16x32_bf16 v[112:115], a[64:67], a[172:175], v[112:115]
    v_mfma_f32_16x16x32_bf16 v[76:79], a[64:67], a[168:171], v[76:79]
    buffer_load_dwordx4 a[204:207], v6, s[12:15], s81 offen sc1
    v_mfma_f32_16x16x32_bf16 v[76:79], a[28:31], a[160:163], v[76:79]
    s_add_u32 s81, s81, 4096
    v_mfma_f32_16x16x32_bf16 v[80:83], a[32:35], a[160:163], v[80:83]
    v_mfma_f32_16x16x32_bf16 v[80:83], a[68:71], a[168:171], v[80:83]
    v_mfma_f32_16x16x32_bf16 v[116:119], a[68:71], a[172:175], v[116:119]
    buffer_load_dwordx4 a[208:211], v5, s[12:15], s81 offen sc1
    v_mfma_f32_16x16x32_bf16 v[116:119], a[32:35], a[164:167], v[116:119]
    s_waitcnt lgkmcnt(0)
    s_waitcnt vmcnt(10)
    s_barrier
    v_mfma_f32_16x16x32_bf16 v[48:51], a[72:75], a[176:179], v[48:51]
    ds_read_b128 a[0:3], v1 offset:9216
    v_mfma_f32_16x16x32_bf16 v[48:51], a[108:111], a[184:187], v[48:51]
    s_add_u32 m0, s33, 0
    s_waitcnt vmcnt(9)
    v_mfma_f32_16x16x32_bf16 v[84:87], a[108:111], a[188:191], v[84:87]
    buffer_load_dwordx4 v1, s[8:11], s80 offen sc1 lds
    v_mfma_f32_16x16x32_bf16 v[84:87], a[72:75], a[180:183], v[84:87]
    s_add_u32 s80, s80, 4096
    ds_read_b128 a[36:39], v1 offset:52224
    ds_read_b128 a[4:7], v1 offset:50176
    v_mfma_f32_16x16x32_bf16 v[88:91], a[76:79], a[180:183], v[88:91]
    buffer_load_dword v36, v39, s[76:79], s42 offen sc1
    v_mfma_f32_16x16x32_bf16 v[88:91], a[112:115], a[188:191], v[88:91]
    s_add_u32 m0, s33, 1024
    ds_read_b128 a[40:43], v2 offset:27648
    v_mfma_f32_16x16x32_bf16 v[52:55], a[112:115], a[184:187], v[52:55]
    v_mfma_f32_16x16x32_bf16 v[52:55], a[76:79], a[176:179], v[52:55]
    buffer_load_dwordx4 v1, s[8:11], s80 offen sc1 lds
    v_mfma_f32_16x16x32_bf16 v[56:59], a[80:83], a[176:179], v[56:59]
    s_add_u32 s80, s80, 4096
    ds_read_b128 a[8:11], v2 offset:25600
    ds_read_b128 a[44:47], v37 offset:3072
    v_mfma_f32_16x16x32_bf16 v[56:59], a[116:119], a[184:187], v[56:59]
    v_mfma_f32_16x16x32_bf16 v[92:95], a[116:119], a[188:191], v[92:95]
    ds_read_b128 a[12:15], v37 offset:1024
    v_mfma_f32_16x16x32_bf16 v[92:95], a[80:83], a[180:183], v[92:95]
    buffer_load_dwordx4 a[212:215], v6, s[12:15], s81 offen sc1
    v_mfma_f32_16x16x32_bf16 v[96:99], a[84:87], a[180:183], v[96:99]
    s_add_u32 s81, s81, 4096
    ds_read_b128 a[48:51], v1 offset:12288
    v_mfma_f32_16x16x32_bf16 v[96:99], a[120:123], a[188:191], v[96:99]
    s_add_u32 m0, s33, 2048
    ds_read_b128 a[16:19], v1 offset:10240
    v_mfma_f32_16x16x32_bf16 v[60:63], a[120:123], a[184:187], v[60:63]
    v_mfma_f32_16x16x32_bf16 v[60:63], a[84:87], a[176:179], v[60:63]
    buffer_load_dwordx4 v1, s[8:11], s80 offen sc1 lds
    v_mfma_f32_16x16x32_bf16 v[64:67], a[88:91], a[176:179], v[64:67]
    s_add_u32 s80, s80, 4096
    ds_read_b128 a[52:55], v1 offset:53248
    ds_read_b128 a[20:23], v1 offset:51200
    v_mfma_f32_16x16x32_bf16 v[64:67], a[124:127], a[184:187], v[64:67]
    v_mfma_f32_16x16x32_bf16 v[100:103], a[124:127], a[188:191], v[100:103]
    s_add_u32 m0, s33, 3072
    ds_read_b128 a[56:59], v2 offset:28672
    v_mfma_f32_16x16x32_bf16 v[100:103], a[88:91], a[180:183], v[100:103]
    buffer_load_dwordx4 v1, s[8:11], s80 offen sc1 lds
    v_mfma_f32_16x16x32_bf16 v[104:107], a[92:95], a[180:183], v[104:107]
    s_add_u32 s80, s80, 4096
    ds_read_b128 a[24:27], v2 offset:26624
    v_mfma_f32_16x16x32_bf16 v[104:107], a[128:131], a[188:191], v[104:107]
    ds_read_b128 a[60:63], v37 offset:4096
    v_mfma_f32_16x16x32_bf16 v[68:71], a[128:131], a[184:187], v[68:71]
    v_mfma_f32_16x16x32_bf16 v[68:71], a[92:95], a[176:179], v[68:71]
    buffer_load_dwordx4 a[216:219], v5, s[12:15], s81 offen sc1
    v_mfma_f32_16x16x32_bf16 v[72:75], a[96:99], a[176:179], v[72:75]
    ds_read_b128 a[28:31], v37 offset:2048
    v_mfma_f32_16x16x32_bf16 v[72:75], a[132:135], a[184:187], v[72:75]
    ds_read_b128 a[64:67], v1 offset:13312
    v_mfma_f32_16x16x32_bf16 v[108:111], a[132:135], a[188:191], v[108:111]
    s_add_u32 m0, s33, 4096
    ds_read_b128 a[32:35], v1 offset:11264
    v_mfma_f32_16x16x32_bf16 v[108:111], a[96:99], a[180:183], v[108:111]
    v_mfma_f32_16x16x32_bf16 v[112:115], a[100:103], a[180:183], v[112:115]
    buffer_load_dwordx4 v1, s[8:11], s80 offen sc1 lds
    v_mfma_f32_16x16x32_bf16 v[112:115], a[136:139], a[188:191], v[112:115]
    s_add_u32 s80, s80, 4096
    ds_read_b128 a[68:71], v1 offset:54272
    v_mfma_f32_16x16x32_bf16 v[76:79], a[136:139], a[184:187], v[76:79]
    v_mfma_f32_16x16x32_bf16 v[76:79], a[100:103], a[176:179], v[76:79]
    v_mfma_f32_16x16x32_bf16 v[80:83], a[104:107], a[176:179], v[80:83]
    buffer_load_dwordx4 a[220:223], v6, s[12:15], s81 offen sc1
    v_mfma_f32_16x16x32_bf16 v[80:83], a[140:143], a[184:187], v[80:83]
    s_add_u32 s81, s81, 4096
    v_mfma_f32_16x16x32_bf16 v[116:119], a[140:143], a[188:191], v[116:119]
    v_mfma_f32_16x16x32_bf16 v[116:119], a[104:107], a[180:183], v[116:119]
    s_waitcnt lgkmcnt(0)
    s_waitcnt vmcnt(11)
    s_barrier
    v_mfma_f32_16x16x32_bf16 v[48:51], a[0:3], a[192:195], v[48:51]
    buffer_load_dwordx4 a[160:163], v5, s[12:15], s81 offen sc1
    v_mfma_f32_16x16x32_bf16 v[48:51], a[36:39], a[200:203], v[48:51]
    ds_read_b128 a[72:75], v2 offset:29696
    s_waitcnt vmcnt(11)
    v_mfma_f32_16x16x32_bf16 v[84:87], a[36:39], a[204:207], v[84:87]
    ds_read_b128 a[108:111], v37 offset:7168
    v_mfma_f32_16x16x32_bf16 v[84:87], a[0:3], a[196:199], v[84:87]
    s_add_u32 m0, s33, 5120
    ds_read_b128 a[76:79], v37 offset:5120
    v_mfma_f32_16x16x32_bf16 v[88:91], a[4:7], a[196:199], v[88:91]
    buffer_load_dwordx4 v1, s[8:11], s80 offen sc1 lds
    v_mfma_f32_16x16x32_bf16 v[88:91], a[40:43], a[204:207], v[88:91]
    s_add_u32 s80, s80, 4096
    ds_read_b128 a[112:115], v1 offset:16384
    v_mfma_f32_16x16x32_bf16 v[52:55], a[40:43], a[200:203], v[52:55]
    v_mfma_f32_16x16x32_bf16 v[52:55], a[4:7], a[192:195], v[52:55]
    ds_read_b128 a[80:83], v1 offset:14336
    v_mfma_f32_16x16x32_bf16 v[56:59], a[8:11], a[192:195], v[56:59]
    buffer_load_dwordx4 a[164:167], v6, s[12:15], s81 offen sc1
    v_mfma_f32_16x16x32_bf16 v[56:59], a[44:47], a[200:203], v[56:59]
    s_add_u32 s81, s81, 4096
    ds_read_b128 a[116:119], v1 offset:57344
    v_mfma_f32_16x16x32_bf16 v[92:95], a[44:47], a[204:207], v[92:95]
    ds_read_b128 a[84:87], v1 offset:55296
    v_mfma_f32_16x16x32_bf16 v[92:95], a[8:11], a[196:199], v[92:95]
    s_add_u32 m0, s33, 6144
    ds_read_b128 a[120:123], v2 offset:32768
    v_mfma_f32_16x16x32_bf16 v[96:99], a[12:15], a[196:199], v[96:99]
    v_mfma_f32_16x16x32_bf16 v[96:99], a[48:51], a[204:207], v[96:99]
    buffer_load_dwordx4 v1, s[8:11], s80 offen sc1 lds
    v_mfma_f32_16x16x32_bf16 v[60:63], a[48:51], a[200:203], v[60:63]
    s_add_u32 s80, s80, 4096
    ds_read_b128 a[88:91], v2 offset:30720
    v_mfma_f32_16x16x32_bf16 v[60:63], a[12:15], a[192:195], v[60:63]
    ds_read_b128 a[124:127], v37 offset:8192
    v_mfma_f32_16x16x32_bf16 v[64:67], a[16:19], a[192:195], v[64:67]
    ds_read_b128 a[92:95], v37 offset:6144
    v_mfma_f32_16x16x32_bf16 v[64:67], a[52:55], a[200:203], v[64:67]
    buffer_load_dwordx4 a[168:171], v5, s[12:15], s81 offen sc1
    v_mfma_f32_16x16x32_bf16 v[100:103], a[52:55], a[204:207], v[100:103]
    ds_read_b128 a[128:131], v1 offset:17408
    v_mfma_f32_16x16x32_bf16 v[100:103], a[16:19], a[196:199], v[100:103]
    v_mfma_f32_16x16x32_bf16 v[104:107], a[20:23], a[196:199], v[104:107]
    s_add_u32 m0, s33, 7168
    ds_read_b128 a[96:99], v1 offset:15360
    v_mfma_f32_16x16x32_bf16 v[104:107], a[56:59], a[204:207], v[104:107]
    buffer_load_dwordx4 v1, s[8:11], s80 offen sc1 lds
    v_mfma_f32_16x16x32_bf16 v[68:71], a[56:59], a[200:203], v[68:71]
    s_add_u32 s80, s80, 4096
    ds_read_b128 a[132:135], v1 offset:58368
    v_mfma_f32_16x16x32_bf16 v[68:71], a[20:23], a[192:195], v[68:71]
    ds_read_b128 a[100:103], v1 offset:56320
    v_mfma_f32_16x16x32_bf16 v[72:75], a[24:27], a[192:195], v[72:75]
    v_mfma_f32_16x16x32_bf16 v[72:75], a[60:63], a[200:203], v[72:75]
    buffer_load_dwordx4 a[172:175], v6, s[12:15], s81 offen sc1
    v_mfma_f32_16x16x32_bf16 v[108:111], a[60:63], a[204:207], v[108:111]
    s_add_u32 s81, s81, 4096
    ds_read_b128 a[136:139], v2 offset:33792
    ds_read_b128 a[104:107], v2 offset:31744
    v_mfma_f32_16x16x32_bf16 v[108:111], a[24:27], a[196:199], v[108:111]
    v_mfma_f32_16x16x32_bf16 v[112:115], a[28:31], a[196:199], v[112:115]
    s_add_u32 m0, s33, 8192
    ds_read_b128 a[140:143], v37 offset:9216
    v_mfma_f32_16x16x32_bf16 v[112:115], a[64:67], a[204:207], v[112:115]
    buffer_load_dwordx4 v1, s[8:11], s80 offen sc1 lds
    v_mfma_f32_16x16x32_bf16 v[76:79], a[64:67], a[200:203], v[76:79]
    s_add_u32 s80, s80, 4096
    v_mfma_f32_16x16x32_bf16 v[76:79], a[28:31], a[192:195], v[76:79]
    v_mfma_f32_16x16x32_bf16 v[80:83], a[32:35], a[192:195], v[80:83]
    v_mfma_f32_16x16x32_bf16 v[80:83], a[68:71], a[200:203], v[80:83]
    v_mfma_f32_16x16x32_bf16 v[116:119], a[68:71], a[204:207], v[116:119]
    buffer_load_dwordx4 a[176:179], v5, s[12:15], s81 offen sc1
    v_mfma_f32_16x16x32_bf16 v[116:119], a[32:35], a[196:199], v[116:119]
    s_waitcnt lgkmcnt(0)
    s_waitcnt vmcnt(10)
    s_barrier
    v_mfma_f32_16x16x32_bf16 v[48:51], a[72:75], a[208:211], v[48:51]
    s_add_u32 m0, s33, 9216
    ds_read_b128 a[0:3], v1 offset:0
    v_mfma_f32_16x16x32_bf16 v[48:51], a[108:111], a[216:219], v[48:51]
    s_waitcnt vmcnt(9)
    v_mfma_f32_16x16x32_bf16 v[84:87], a[108:111], a[220:223], v[84:87]
    buffer_load_dwordx4 v1, s[8:11], s80 offen sc1 lds
    v_mfma_f32_16x16x32_bf16 v[84:87], a[72:75], a[212:215], v[84:87]
    s_add_u32 s80, s80, 4096
    ds_read_b128 a[36:39], v1 offset:43008
    ds_read_b128 a[4:7], v1 offset:40960
    v_mfma_f32_16x16x32_bf16 v[88:91], a[76:79], a[212:215], v[88:91]
    v_mfma_f32_16x16x32_bf16 v[88:91], a[112:115], a[220:223], v[88:91]
    s_add_u32 m0, s33, 10240
    ds_read_b128 a[40:43], v2 offset:18432
    v_mfma_f32_16x16x32_bf16 v[52:55], a[112:115], a[216:219], v[52:55]
    buffer_load_dwordx4 v1, s[8:11], s80 offen sc1 lds
    v_mfma_f32_16x16x32_bf16 v[52:55], a[76:79], a[208:211], v[52:55]
    s_add_u32 s80, s80, 4096
    ds_read_b128 a[8:11], v2 offset:16384
    v_mfma_f32_16x16x32_bf16 v[56:59], a[80:83], a[208:211], v[56:59]
    ds_read_b128 a[44:47], v2 offset:59392
    v_mfma_f32_16x16x32_bf16 v[56:59], a[116:119], a[216:219], v[56:59]
    v_mfma_f32_16x16x32_bf16 v[92:95], a[116:119], a[220:223], v[92:95]
    buffer_load_dwordx4 a[180:183], v6, s[12:15], s81 offen sc1
    v_mfma_f32_16x16x32_bf16 v[92:95], a[80:83], a[212:215], v[92:95]
    s_add_u32 s81, s81, 4096
    ds_read_b128 a[12:15], v2 offset:57344
    ds_read_b128 a[48:51], v1 offset:3072
    v_mfma_f32_16x16x32_bf16 v[96:99], a[84:87], a[212:215], v[96:99]
    v_mfma_f32_16x16x32_bf16 v[96:99], a[120:123], a[220:223], v[96:99]
    s_add_u32 m0, s33, 11264
    ds_read_b128 a[16:19], v1 offset:1024
    v_mfma_f32_16x16x32_bf16 v[60:63], a[120:123], a[216:219], v[60:63]
    buffer_load_dwordx4 v1, s[8:11], s80 offen sc1 lds
    v_mfma_f32_16x16x32_bf16 v[60:63], a[84:87], a[208:211], v[60:63]
    s_add_u32 s80, s80, 4096
    ds_read_b128 a[52:55], v1 offset:44032
    v_mfma_f32_16x16x32_bf16 v[64:67], a[88:91], a[208:211], v[64:67]
    ds_read_b128 a[20:23], v1 offset:41984
    v_mfma_f32_16x16x32_bf16 v[64:67], a[124:127], a[216:219], v[64:67]
    s_add_u32 m0, s33, 12288
    v_mfma_f32_16x16x32_bf16 v[100:103], a[124:127], a[220:223], v[100:103]
    ds_read_b128 a[56:59], v2 offset:19456
    v_mfma_f32_16x16x32_bf16 v[100:103], a[88:91], a[212:215], v[100:103]
    buffer_load_dwordx4 v1, s[8:11], s80 offen sc1 lds
    v_mfma_f32_16x16x32_bf16 v[104:107], a[92:95], a[212:215], v[104:107]
    s_add_u32 s80, s80, 4096
    ds_read_b128 a[24:27], v2 offset:17408
    v_mfma_f32_16x16x32_bf16 v[104:107], a[128:131], a[220:223], v[104:107]
    ds_read_b128 a[60:63], v2 offset:60416
    v_mfma_f32_16x16x32_bf16 v[68:71], a[128:131], a[216:219], v[68:71]
    v_mfma_f32_16x16x32_bf16 v[68:71], a[92:95], a[208:211], v[68:71]
    buffer_load_dwordx4 a[184:187], v5, s[12:15], s81 offen sc1
    v_mfma_f32_16x16x32_bf16 v[72:75], a[96:99], a[208:211], v[72:75]
    ds_read_b128 a[28:31], v2 offset:58368
    v_mfma_f32_16x16x32_bf16 v[72:75], a[132:135], a[216:219], v[72:75]
    ds_read_b128 a[64:67], v1 offset:4096
    v_mfma_f32_16x16x32_bf16 v[108:111], a[132:135], a[220:223], v[108:111]
    s_add_u32 m0, s33, 13312
    ds_read_b128 a[32:35], v1 offset:2048
    v_mfma_f32_16x16x32_bf16 v[108:111], a[96:99], a[212:215], v[108:111]
    buffer_load_dwordx4 v1, s[8:11], s80 offen sc1 lds
    v_mfma_f32_16x16x32_bf16 v[112:115], a[100:103], a[212:215], v[112:115]
    s_add_u32 s80, s80, 4096
    ds_read_b128 a[68:71], v1 offset:45056
    v_mfma_f32_16x16x32_bf16 v[112:115], a[136:139], a[220:223], v[112:115]
    v_mfma_f32_16x16x32_bf16 v[76:79], a[136:139], a[216:219], v[76:79]
    v_mfma_f32_16x16x32_bf16 v[76:79], a[100:103], a[208:211], v[76:79]
    buffer_load_dwordx4 a[188:191], v6, s[12:15], s81 offen sc1
    v_mfma_f32_16x16x32_bf16 v[80:83], a[104:107], a[208:211], v[80:83]
    s_add_u32 s81, s81, 4096
    v_mfma_f32_16x16x32_bf16 v[80:83], a[140:143], a[216:219], v[80:83]
    v_mfma_f32_16x16x32_bf16 v[116:119], a[140:143], a[220:223], v[116:119]
    v_mfma_f32_16x16x32_bf16 v[116:119], a[104:107], a[212:215], v[116:119]
    s_sub_u32 s41, s41, 1
    s_cbranch_scc0 p2_k1_19
    s_cmp_ge_u32 s34, 2
    s_cbranch_scc1 isp_k1_22
    s_waitcnt lgkmcnt(0)
    s_waitcnt vmcnt(9)
    s_barrier
    v_mfma_f32_16x16x32_bf16 v[48:51], a[0:3], a[160:163], v[48:51]
    s_add_u32 m0, s33, 14336
    ds_read_b128 a[72:75], v2 offset:20480
    v_mfma_f32_16x16x32_bf16 v[48:51], a[36:39], a[168:171], v[48:51]
    v_mfma_f32_16x16x32_bf16 v[84:87], a[36:39], a[172:175], v[84:87]
    buffer_load_dwordx4 v1, s[8:11], s80 offen sc1 lds
    v_mfma_f32_16x16x32_bf16 v[84:87], a[0:3], a[164:167], v[84:87]
    s_add_u32 s80, s80, 4096
    ds_read_b128 a[108:111], v2 offset:63488
    ds_read_b128 a[76:79], v2 offset:61440
    v_mfma_f32_16x16x32_bf16 v[88:91], a[4:7], a[164:167], v[88:91]
    buffer_load_dwordx4 a[192:195], v5, s[12:15], s81 offen sc1
    v_mfma_f32_16x16x32_bf16 v[88:91], a[40:43], a[172:175], v[88:91]
    s_add_u32 m0, s33, 15360
    ds_read_b128 a[112:115], v1 offset:7168
    v_mfma_f32_16x16x32_bf16 v[52:55], a[40:43], a[168:171], v[52:55]
    buffer_load_dwordx4 a[196:199], v6, s[12:15], s81 offen sc1
    v_mfma_f32_16x16x32_bf16 v[52:55], a[4:7], a[160:163], v[52:55]
    buffer_load_dwordx4 v1, s[8:11], s80 offen sc1 lds
    v_mfma_f32_16x16x32_bf16 v[56:59], a[8:11], a[160:163], v[56:59]
    s_add_u32 s80, s80, 4096
    ds_read_b128 a[80:83], v1 offset:5120
    s_add_u32 s81, s81, 4096
    v_mfma_f32_16x16x32_bf16 v[56:59], a[44:47], a[168:171], v[56:59]
    s_add_u32 m0, s33, 16384
    ds_read_b128 a[116:119], v1 offset:48128
    v_mfma_f32_16x16x32_bf16 v[92:95], a[44:47], a[172:175], v[92:95]
    buffer_load_dwordx4 v1, s[8:11], s80 offen sc1 lds
    v_mfma_f32_16x16x32_bf16 v[92:95], a[8:11], a[164:167], v[92:95]
    s_add_u32 s80, s80, 4096
    ds_read_b128 a[84:87], v1 offset:46080
    ds_read_b128 a[120:123], v2 offset:23552
    v_mfma_f32_16x16x32_bf16 v[96:99], a[12:15], a[164:167], v[96:99]
    buffer_load_dwordx4 a[200:203], v5, s[12:15], s81 offen sc1
    v_mfma_f32_16x16x32_bf16 v[96:99], a[48:51], a[172:175], v[96:99]
    s_add_u32 m0, s33, 17408
    ds_read_b128 a[88:91], v2 offset:21504
    v_mfma_f32_16x16x32_bf16 v[60:63], a[48:51], a[168:171], v[60:63]
    buffer_load_dwordx4 a[204:207], v6, s[12:15], s81 offen sc1
    v_mfma_f32_16x16x32_bf16 v[60:63], a[12:15], a[160:163], v[60:63]
    buffer_load_dwordx4 v1, s[8:11], s80 offen sc1 lds
    v_mfma_f32_16x16x32_bf16 v[64:67], a[16:19], a[160:163], v[64:67]
    s_add_u32 s80, s80, 4096
    ds_read_b128 a[124:127], v2 offset:64512
    s_add_u32 s81, s81, 4096
    v_mfma_f32_16x16x32_bf16 v[64:67], a[52:55], a[168:171], v[64:67]
    ds_read_b128 a[92:95], v2 offset:62464
    v_mfma_f32_16x16x32_bf16 v[100:103], a[52:55], a[172:175], v[100:103]
    buffer_load_dwordx4 a[208:211], v5, s[12:15], s81 offen sc1
    v_mfma_f32_16x16x32_bf16 v[100:103], a[16:19], a[164:167], v[100:103]
    ds_read_b128 a[128:131], v1 offset:8192
    v_mfma_f32_16x16x32_bf16 v[104:107], a[20:23], a[164:167], v[104:107]
    ds_read_b128 a[96:99], v1 offset:6144
    v_mfma_f32_16x16x32_bf16 v[104:107], a[56:59], a[172:175], v[104:107]
    buffer_load_dwordx4 a[212:215], v6, s[12:15], s81 offen sc1
    v_mfma_f32_16x16x32_bf16 v[68:71], a[56:59], a[168:171], v[68:71]
    ds_read_b128 a[132:135], v1 offset:49152
    v_mfma_f32_16x16x32_bf16 v[68:71], a[20:23], a[160:163], v[68:71]
    s_add_u32 s81, s81, 4096
    ds_read_b128 a[100:103], v1 offset:47104
    v_mfma_f32_16x16x32_bf16 v[72:75], a[24:27], a[160:163], v[72:75]
    v_mfma_f32_16x16x32_bf16 v[72:75], a[60:63], a[168:171], v[72:75]
    ds_read_b128 a[136:139], v2 offset:24576
    v_mfma_f32_16x16x32_bf16 v[108:111], a[60:63], a[172:175], v[108:111]
    buffer_load_dwordx4 a[216:219], v5, s[12:15], s81 offen sc1
    v_mfma_f32_16x16x32_bf16 v[108:111], a[24:27], a[164:167], v[108:111]
    ds_read_b128 a[104:107], v2 offset:22528
    v_mfma_f32_16x16x32_bf16 v[112:115], a[28:31], a[164:167], v[112:115]
    buffer_load_dwordx4 a[220:223], v6, s[12:15], s81 offen sc1
    v_mfma_f32_16x16x32_bf16 v[112:115], a[64:67], a[172:175], v[112:115]
    ds_read_b128 a[140:143], v37 offset:0
    v_mfma_f32_16x16x32_bf16 v[76:79], a[64:67], a[168:171], v[76:79]
    v_mfma_f32_16x16x32_bf16 v[76:79], a[28:31], a[160:163], v[76:79]
    s_add_u32 s81, s81, 4096
    v_mfma_f32_16x16x32_bf16 v[80:83], a[32:35], a[160:163], v[80:83]
    v_mfma_f32_16x16x32_bf16 v[80:83], a[68:71], a[168:171], v[80:83]
    v_mfma_f32_16x16x32_bf16 v[116:119], a[68:71], a[172:175], v[116:119]
    v_mfma_f32_16x16x32_bf16 v[116:119], a[32:35], a[164:167], v[116:119]
    s_waitcnt lgkmcnt(0)
    s_waitcnt vmcnt(4)
    s_barrier
    v_mfma_f32_16x16x32_bf16 v[48:51], a[72:75], a[176:179], v[48:51]
    ds_read_b128 a[0:3], v1 offset:9216
    v_mfma_f32_16x16x32_bf16 v[48:51], a[108:111], a[184:187], v[48:51]
    v_mfma_f32_16x16x32_bf16 v[84:87], a[108:111], a[188:191], v[84:87]
    ds_read_b128 a[4:7], v1 offset:52224
    v_mfma_f32_16x16x32_bf16 v[84:87], a[72:75], a[180:183], v[84:87]
    v_mfma_f32_16x16x32_bf16 v[88:91], a[76:79], a[180:183], v[88:91]
    ds_read_b128 a[8:11], v2 offset:29696
    v_mfma_f32_16x16x32_bf16 v[88:91], a[112:115], a[188:191], v[88:91]
    v_mfma_f32_16x16x32_bf16 v[52:55], a[112:115], a[184:187], v[52:55]
    ds_read_b128 a[12:15], v37 offset:7168
    v_mfma_f32_16x16x32_bf16 v[52:55], a[76:79], a[176:179], v[52:55]
    ds_read_b128 a[16:19], v1 offset:50176
    v_mfma_f32_16x16x32_bf16 v[56:59], a[80:83], a[176:179], v[56:59]
    v_mfma_f32_16x16x32_bf16 v[56:59], a[116:119], a[184:187], v[56:59]
    ds_read_b128 a[20:23], v2 offset:27648
    v_mfma_f32_16x16x32_bf16 v[92:95], a[116:119], a[188:191], v[92:95]
    v_mfma_f32_16x16x32_bf16 v[92:95], a[80:83], a[180:183], v[92:95]
    ds_read_b128 a[24:27], v37 offset:5120
    v_mfma_f32_16x16x32_bf16 v[96:99], a[84:87], a[180:183], v[96:99]
    v_mfma_f32_16x16x32_bf16 v[96:99], a[120:123], a[188:191], v[96:99]
    ds_read_b128 a[28:31], v1 offset:16384
    v_mfma_f32_16x16x32_bf16 v[60:63], a[120:123], a[184:187], v[60:63]
    v_mfma_f32_16x16x32_bf16 v[60:63], a[84:87], a[176:179], v[60:63]
    ds_read_b64 v[176:177], v4 offset:0
    v_mfma_f32_16x16x32_bf16 v[64:67], a[88:91], a[176:179], v[64:67]
    v_mfma_f32_16x16x32_bf16 v[64:67], a[124:127], a[184:187], v[64:67]
    ds_read_b64 v[178:179], v4 offset:32
    v_mfma_f32_16x16x32_bf16 v[100:103], a[124:127], a[188:191], v[100:103]
    v_mfma_f32_16x16x32_bf16 v[100:103], a[88:91], a[180:183], v[100:103]
    buffer_load_dwordx4 v[120:123], v1, s[76:79], s70 offen offset:0 sc1
    v_mfma_f32_16x16x32_bf16 v[104:107], a[92:95], a[180:183], v[104:107]
    ds_read_b64 v[180:181], v4 offset:64
    ds_read_b64 v[182:183], v4 offset:96
    v_mfma_f32_16x16x32_bf16 v[104:107], a[128:131], a[188:191], v[104:107]
    v_mfma_f32_16x16x32_bf16 v[68:71], a[128:131], a[184:187], v[68:71]
    ds_read_b64 v[184:185], v4 offset:128
    v_mfma_f32_16x16x32_bf16 v[68:71], a[92:95], a[176:179], v[68:71]
    buffer_load_dwordx4 v[138:141], v1, s[76:79], s72 offen offset:0 sc1
    v_mfma_f32_16x16x32_bf16 v[72:75], a[96:99], a[176:179], v[72:75]
    ds_read_b64 v[186:187], v4 offset:160
    v_mfma_f32_16x16x32_bf16 v[72:75], a[132:135], a[184:187], v[72:75]
    ds_read_b64 v[188:189], v4 offset:192
    v_mfma_f32_16x16x32_bf16 v[108:111], a[132:135], a[188:191], v[108:111]
    buffer_load_dwordx4 v[124:127], v1, s[76:79], s70 offen offset:1024 sc1
    v_mfma_f32_16x16x32_bf16 v[108:111], a[96:99], a[180:183], v[108:111]
    ds_read_b64 v[190:191], v4 offset:224
    v_mfma_f32_16x16x32_bf16 v[112:115], a[100:103], a[180:183], v[112:115]
    ds_read_b64 v[192:193], v4 offset:256
    v_mfma_f32_16x16x32_bf16 v[112:115], a[136:139], a[188:191], v[112:115]
    buffer_load_dwordx4 v[142:145], v1, s[76:79], s72 offen offset:1024 sc1
    v_mfma_f32_16x16x32_bf16 v[76:79], a[136:139], a[184:187], v[76:79]
    v_mfma_f32_16x16x32_bf16 v[76:79], a[100:103], a[176:179], v[76:79]
    v_mfma_f32_16x16x32_bf16 v[80:83], a[104:107], a[176:179], v[80:83]
    buffer_load_dwordx4 v[128:131], v1, s[76:79], s70 offen offset:2048 sc1
    v_mfma_f32_16x16x32_bf16 v[80:83], a[140:143], a[184:187], v[80:83]
    v_mfma_f32_16x16x32_bf16 v[116:119], a[140:143], a[188:191], v[116:119]
    v_mfma_f32_16x16x32_bf16 v[116:119], a[104:107], a[180:183], v[116:119]
    buffer_load_dwordx4 v[146:149], v1, s[76:79], s72 offen offset:2048 sc1
    s_waitcnt lgkmcnt(15)
    v_mfma_f32_16x16x32_bf16 v[84:87], a[0:3], a[196:199], v[84:87]
    ds_read_b128 a[32:35], v2 offset:25600
    v_mfma_f32_16x16x32_bf16 v[84:87], a[4:7], a[204:207], v[84:87]
    s_waitcnt vmcnt(8) lgkmcnt(15)
    v_mfma_f32_16x16x32_bf16 v[84:87], a[8:11], a[212:215], v[84:87]
    buffer_load_dwordx4 v[132:135], v1, s[76:79], s70 offen offset:3072 sc1
    s_waitcnt vmcnt(7) lgkmcnt(14)
    v_mfma_f32_16x16x32_bf16 v[84:87], a[12:15], a[220:223], v[84:87]
    ds_read_b128 a[36:39], v37 offset:3072
    ds_read_b128 a[40:43], v1 offset:14336
    v_mfma_f32_16x16x32_bf16 v[48:51], a[12:15], a[216:219], v[48:51]
    v_mfma_f32_16x16x32_bf16 v[48:51], a[8:11], a[208:211], v[48:51]
    buffer_load_dwordx4 v[150:153], v1, s[76:79], s72 offen offset:3072 sc1
    v_mfma_f32_16x16x32_bf16 v[48:51], a[4:7], a[200:203], v[48:51]
    ds_read_b128 a[44:47], v1 offset:57344
    v_mfma_f32_16x16x32_bf16 v[48:51], a[0:3], a[192:195], v[48:51]
    s_waitcnt lgkmcnt(15)
    v_mfma_f32_16x16x32_bf16 v[88:91], a[16:19], a[196:199], v[88:91]
    buffer_load_dwordx2 v[136:137], v3, s[76:79], s71 offen sc1
    v_mfma_f32_16x16x32_bf16 v[88:91], a[20:23], a[204:207], v[88:91]
    ds_read_b128 a[48:51], v37 offset:1024
    s_waitcnt lgkmcnt(15)
    v_mfma_f32_16x16x32_bf16 v[88:91], a[24:27], a[212:215], v[88:91]
    ds_read_b128 a[52:55], v1 offset:12288
    s_waitcnt lgkmcnt(15)
    v_mfma_f32_16x16x32_bf16 v[88:91], a[28:31], a[220:223], v[88:91]
    buffer_load_dwordx2 v[154:155], v3, s[76:79], s73 offen sc1
    v_mfma_f32_16x16x32_bf16 v[52:55], a[28:31], a[216:219], v[52:55]
    ds_read_b128 a[56:59], v1 offset:55296
    v_mfma_f32_16x16x32_bf16 v[52:55], a[24:27], a[208:211], v[52:55]
    ds_read_b128 a[60:63], v2 offset:32768
    v_mfma_f32_16x16x32_bf16 v[52:55], a[20:23], a[200:203], v[52:55]
    v_cvt_pk_bf16_f32 v84, v84, v85
    v_mfma_f32_16x16x32_bf16 v[52:55], a[16:19], a[192:195], v[52:55]
    v_min_u32 v84, -2, v84
    s_waitcnt lgkmcnt(7)
    v_mfma_f32_16x16x32_bf16 v[92:95], a[32:35], a[196:199], v[92:95]
    ds_read_b128 a[0:3], v1 offset:10240
    v_cvt_pk_bf16_f32 v85, v86, v87
    s_waitcnt lgkmcnt(7)
    v_mfma_f32_16x16x32_bf16 v[92:95], a[36:39], a[204:207], v[92:95]
    v_min_u32 v85, -2, v85
    v_cvt_pk_bf16_f32 v86, v88, v89
    s_waitcnt lgkmcnt(6)
    v_mfma_f32_16x16x32_bf16 v[92:95], a[40:43], a[212:215], v[92:95]
    ds_read_b128 a[4:7], v1 offset:53248
    v_min_u32 v86, -2, v86
    s_waitcnt lgkmcnt(6)
    v_mfma_f32_16x16x32_bf16 v[92:95], a[44:47], a[220:223], v[92:95]
    ds_read_b128 a[8:11], v2 offset:30720
    v_cvt_pk_bf16_f32 v87, v90, v91
    v_mfma_f32_16x16x32_bf16 v[56:59], a[44:47], a[216:219], v[56:59]
    v_min_u32 v87, -2, v87
    v_mfma_f32_16x16x32_bf16 v[56:59], a[40:43], a[208:211], v[56:59]
    buffer_store_dwordx4 v[84:87], v1, s[76:79], s48 offen offset:0 sc1
    v_mfma_f32_16x16x32_bf16 v[56:59], a[36:39], a[200:203], v[56:59]
    ds_read_b128 a[12:15], v37 offset:8192
    v_mfma_f32_16x16x32_bf16 v[56:59], a[32:35], a[192:195], v[56:59]
    s_waitcnt lgkmcnt(7)
    v_mfma_f32_16x16x32_bf16 v[96:99], a[48:51], a[196:199], v[96:99]
    ds_read_b128 a[16:19], v1 offset:51200
    s_waitcnt lgkmcnt(7)
    v_mfma_f32_16x16x32_bf16 v[96:99], a[52:55], a[204:207], v[96:99]
    s_waitcnt lgkmcnt(6)
    v_mfma_f32_16x16x32_bf16 v[96:99], a[56:59], a[212:215], v[96:99]
    ds_read_b128 a[20:23], v2 offset:28672
    s_waitcnt lgkmcnt(6)
    v_mfma_f32_16x16x32_bf16 v[96:99], a[60:63], a[220:223], v[96:99]
    ds_read_b128 a[24:27], v37 offset:6144
    v_mfma_f32_16x16x32_bf16 v[60:63], a[60:63], a[216:219], v[60:63]
    v_mfma_f32_16x16x32_bf16 v[60:63], a[56:59], a[208:211], v[60:63]
    ds_read_b128 a[28:31], v1 offset:17408
    v_mfma_f32_16x16x32_bf16 v[60:63], a[52:55], a[200:203], v[60:63]
    v_cvt_pk_bf16_f32 v92, v92, v93
    v_mfma_f32_16x16x32_bf16 v[60:63], a[48:51], a[192:195], v[60:63]
    v_min_u32 v92, -2, v92
    s_waitcnt lgkmcnt(7)
    v_mfma_f32_16x16x32_bf16 v[100:103], a[0:3], a[196:199], v[100:103]
    ds_read_b128 a[32:35], v2 offset:26624
    v_cvt_pk_bf16_f32 v93, v94, v95
    s_waitcnt lgkmcnt(7)
    v_mfma_f32_16x16x32_bf16 v[100:103], a[4:7], a[204:207], v[100:103]
    v_min_u32 v93, -2, v93
    v_cvt_pk_bf16_f32 v94, v96, v97
    s_waitcnt lgkmcnt(6)
    v_mfma_f32_16x16x32_bf16 v[100:103], a[8:11], a[212:215], v[100:103]
    ds_read_b128 a[36:39], v37 offset:4096
    v_min_u32 v94, -2, v94
    s_waitcnt lgkmcnt(6)
    v_mfma_f32_16x16x32_bf16 v[100:103], a[12:15], a[220:223], v[100:103]
    ds_read_b128 a[40:43], v1 offset:15360
    v_cvt_pk_bf16_f32 v95, v98, v99
    v_mfma_f32_16x16x32_bf16 v[64:67], a[12:15], a[216:219], v[64:67]
    v_min_u32 v95, -2, v95
    v_mfma_f32_16x16x32_bf16 v[64:67], a[8:11], a[208:211], v[64:67]
    buffer_store_dwordx4 v[92:95], v1, s[76:79], s48 offen offset:1024 sc1
    v_mfma_f32_16x16x32_bf16 v[64:67], a[4:7], a[200:203], v[64:67]
    ds_read_b128 a[44:47], v1 offset:58368
    v_mfma_f32_16x16x32_bf16 v[64:67], a[0:3], a[192:195], v[64:67]
    s_waitcnt lgkmcnt(7)
    v_mfma_f32_16x16x32_bf16 v[104:107], a[16:19], a[196:199], v[104:107]
    ds_read_b128 a[48:51], v37 offset:2048
    s_waitcnt lgkmcnt(7)
    v_mfma_f32_16x16x32_bf16 v[104:107], a[20:23], a[204:207], v[104:107]
    s_waitcnt lgkmcnt(6)
    v_mfma_f32_16x16x32_bf16 v[104:107], a[24:27], a[212:215], v[104:107]
    ds_read_b128 a[52:55], v1 offset:13312
    s_waitcnt lgkmcnt(6)
    v_mfma_f32_16x16x32_bf16 v[104:107], a[28:31], a[220:223], v[104:107]
    ds_read_b128 a[56:59], v1 offset:56320
    v_mfma_f32_16x16x32_bf16 v[68:71], a[28:31], a[216:219], v[68:71]
    v_mfma_f32_16x16x32_bf16 v[68:71], a[24:27], a[208:211], v[68:71]
    ds_read_b128 a[60:63], v2 offset:33792
    v_mfma_f32_16x16x32_bf16 v[68:71], a[20:23], a[200:203], v[68:71]
    v_cvt_pk_bf16_f32 v100, v100, v101
    v_mfma_f32_16x16x32_bf16 v[68:71], a[16:19], a[192:195], v[68:71]
    v_min_u32 v100, -2, v100
    s_waitcnt lgkmcnt(7)
    v_mfma_f32_16x16x32_bf16 v[108:111], a[32:35], a[196:199], v[108:111]
    ds_read_b128 a[0:3], v1 offset:11264
    v_cvt_pk_bf16_f32 v101, v102, v103
    s_waitcnt lgkmcnt(7)
    v_mfma_f32_16x16x32_bf16 v[108:111], a[36:39], a[204:207], v[108:111]
    v_min_u32 v101, -2, v101
    v_cvt_pk_bf16_f32 v102, v104, v105
    s_waitcnt lgkmcnt(6)
    v_mfma_f32_16x16x32_bf16 v[108:111], a[40:43], a[212:215], v[108:111]
    ds_read_b128 a[4:7], v1 offset:54272
    v_min_u32 v102, -2, v102
    s_waitcnt lgkmcnt(6)
    v_mfma_f32_16x16x32_bf16 v[108:111], a[44:47], a[220:223], v[108:111]
    ds_read_b128 a[8:11], v2 offset:31744
    v_cvt_pk_bf16_f32 v103, v106, v107
    v_mfma_f32_16x16x32_bf16 v[72:75], a[44:47], a[216:219], v[72:75]
    v_min_u32 v103, -2, v103
    v_mfma_f32_16x16x32_bf16 v[72:75], a[40:43], a[208:211], v[72:75]
    buffer_store_dwordx4 v[100:103], v1, s[76:79], s48 offen offset:2048 sc1
    v_mfma_f32_16x16x32_bf16 v[72:75], a[36:39], a[200:203], v[72:75]
    ds_read_b128 a[12:15], v37 offset:9216
    v_mfma_f32_16x16x32_bf16 v[72:75], a[32:35], a[192:195], v[72:75]
    s_waitcnt lgkmcnt(7)
    v_mfma_f32_16x16x32_bf16 v[112:115], a[48:51], a[196:199], v[112:115]
    s_waitcnt lgkmcnt(6)
    v_mfma_f32_16x16x32_bf16 v[112:115], a[52:55], a[204:207], v[112:115]
    s_waitcnt lgkmcnt(5)
    v_mfma_f32_16x16x32_bf16 v[112:115], a[56:59], a[212:215], v[112:115]
    s_waitcnt lgkmcnt(4)
    v_mfma_f32_16x16x32_bf16 v[112:115], a[60:63], a[220:223], v[112:115]
    v_mfma_f32_16x16x32_bf16 v[76:79], a[60:63], a[216:219], v[76:79]
    v_mfma_f32_16x16x32_bf16 v[76:79], a[56:59], a[208:211], v[76:79]
    v_mfma_f32_16x16x32_bf16 v[76:79], a[52:55], a[200:203], v[76:79]
    v_cvt_pk_bf16_f32 v108, v108, v109
    v_mfma_f32_16x16x32_bf16 v[76:79], a[48:51], a[192:195], v[76:79]
    v_min_u32 v108, -2, v108
    s_waitcnt lgkmcnt(3)
    v_mfma_f32_16x16x32_bf16 v[116:119], a[0:3], a[196:199], v[116:119]
    v_cvt_pk_bf16_f32 v109, v110, v111
    v_min_u32 v109, -2, v109
    s_waitcnt lgkmcnt(2)
    v_mfma_f32_16x16x32_bf16 v[116:119], a[4:7], a[204:207], v[116:119]
    v_cvt_pk_bf16_f32 v110, v112, v113
    s_waitcnt lgkmcnt(1)
    v_mfma_f32_16x16x32_bf16 v[116:119], a[8:11], a[212:215], v[116:119]
    v_min_u32 v110, -2, v110
    v_cvt_pk_bf16_f32 v111, v114, v115
    s_waitcnt lgkmcnt(0)
    v_mfma_f32_16x16x32_bf16 v[116:119], a[12:15], a[220:223], v[116:119]
    v_min_u32 v111, -2, v111
    v_mfma_f32_16x16x32_bf16 v[80:83], a[12:15], a[216:219], v[80:83]
    buffer_store_dwordx4 v[108:111], v1, s[76:79], s48 offen offset:3072 sc1
    v_mfma_f32_16x16x32_bf16 v[80:83], a[8:11], a[208:211], v[80:83]
    v_mfma_f32_16x16x32_bf16 v[80:83], a[4:7], a[200:203], v[80:83]
    v_mfma_f32_16x16x32_bf16 v[80:83], a[0:3], a[192:195], v[80:83]
    s_nop 1
    v_cvt_pk_bf16_f32 v116, v116, v117
    v_min_u32 v116, -2, v116
    v_cvt_pk_bf16_f32 v117, v118, v119
    v_min_u32 v117, -2, v117
    buffer_store_dwordx2 v[116:117], v3, s[76:79], s49 offen sc1
    s_waitcnt vmcnt(14)
    v_max3_u32 v12, v120, v121, 0
    v_max3_u32 v13, v122, v123, 0
    s_waitcnt vmcnt(12)
    v_max3_u32 v12, v124, v125, v12
    v_max3_u32 v13, v126, v127, v13
    s_waitcnt vmcnt(10)
    v_max3_u32 v12, v128, v129, v12
    v_max3_u32 v13, v130, v131, v13
    s_waitcnt vmcnt(8)
    v_max3_u32 v12, v132, v133, v12
    v_max3_u32 v13, v134, v135, v13
    s_waitcnt vmcnt(6)
    v_max3_u32 v12, v136, v137, v12
    v_max3_u32 v13, v138, v139, v13
    v_max3_u32 v12, v140, v141, v12
    v_max3_u32 v13, v142, v143, v13
    v_max3_u32 v12, v144, v145, v12
    v_max3_u32 v13, v146, v147, v13
    v_max3_u32 v12, v148, v149, v12
    v_max3_u32 v13, v150, v151, v13
    v_max3_u32 v12, v152, v153, v12
    s_waitcnt vmcnt(5)
    v_max3_u32 v13, v154, v155, v13
    v_max_u32 v12, v12, v13
    v_cmp_eq_u32 vcc, -1, v12
    s_nop 4
    s_cbranch_vccz ok_k1_25
    s_mov_b32 s53, 131072
retry_k1_24:
    s_sleep 1
    buffer_load_dwordx4 v[120:123], v1, s[76:79], s70 offen offset:0 sc1
    buffer_load_dwordx4 v[138:141], v1, s[76:79], s72 offen offset:0 sc1
    buffer_load_dwordx4 v[124:127], v1, s[76:79], s70 offen offset:1024 sc1
    buffer_load_dwordx4 v[142:145], v1, s[76:79], s72 offen offset:1024 sc1
    buffer_load_dwordx4 v[128:131], v1, s[76:79], s70 offen offset:2048 sc1
    buffer_load_dwordx4 v[146:149], v1, s[76:79], s72 offen offset:2048 sc1
    buffer_load_dwordx4 v[132:135], v1, s[76:79], s70 offen offset:3072 sc1
    buffer_load_dwordx4 v[150:153], v1, s[76:79], s72 offen offset:3072 sc1
    buffer_load_dwordx2 v[136:137], v3, s[76:79], s71 offen sc1
    buffer_load_dwordx2 v[154:155], v3, s[76:79], s73 offen sc1
    s_waitcnt vmcnt(0)
    v_max3_u32 v12, v120, v121, 0
    v_max3_u32 v13, v122, v123, 0
    v_max3_u32 v12, v124, v125, v12
    v_max3_u32 v13, v126, v127, v13
    v_max3_u32 v12, v128, v129, v12
    v_max3_u32 v13, v130, v131, v13
    v_max3_u32 v12, v132, v133, v12
    v_max3_u32 v13, v134, v135, v13
    v_max3_u32 v12, v136, v137, v12
    v_max3_u32 v13, v138, v139, v13
    v_max3_u32 v12, v140, v141, v12
    v_max3_u32 v13, v142, v143, v13
    v_max3_u32 v12, v144, v145, v12
    v_max3_u32 v13, v146, v147, v13
    v_max3_u32 v12, v148, v149, v12
    v_max3_u32 v13, v150, v151, v13
    v_max3_u32 v12, v152, v153, v12
    v_max3_u32 v13, v154, v155, v13
    v_max_u32 v12, v12, v13
    v_cmp_eq_u32 vcc, -1, v12
    s_nop 4
    s_cbranch_vccz ok_k1_25
    s_sub_u32 s53, s53, 1
    s_cbranch_scc0 retry_k1_24
ok_k1_25:
    v_dot2_f32_bf16 v196, v120, s68, 0
    v_dot2_f32_bf16 v197, v120, s69, 0
    v_dot2_f32_bf16 v198, v121, s68, 0
    v_dot2_f32_bf16 v199, v121, s69, 0
    v_dot2_f32_bf16 v196, v138, s68, v196
    v_dot2_f32_bf16 v197, v138, s69, v197
    v_dot2_f32_bf16 v198, v139, s68, v198
    v_dot2_f32_bf16 v199, v139, s69, v199
    v_lshlrev_b32 v84, 16, v176
    v_and_b32 v85, 0xffff0000, v176
    v_lshlrev_b32 v86, 16, v177
    v_and_b32 v87, 0xffff0000, v177
    v_mul_f32 v16, 0xbfb8aa3b, v196
    v_mul_f32 v17, 0xbfb8aa3b, v197
    v_mul_f32 v18, 0xbfb8aa3b, v198
    v_mul_f32 v19, 0xbfb8aa3b, v199
    v_exp_f32 v16, v16
    v_exp_f32 v17, v17
    v_exp_f32 v18, v18
    v_exp_f32 v19, v19
    v_add_f32 v16, 1.0, v16
    v_add_f32 v17, 1.0, v17
    v_add_f32 v18, 1.0, v18
    v_add_f32 v19, 1.0, v19
    v_rcp_f32 v16, v16
    v_rcp_f32 v17, v17
    v_rcp_f32 v18, v18
    v_rcp_f32 v19, v19
    v_mul_f32 v196, v196, v16
    v_mul_f32 v197, v197, v17
    v_mul_f32 v198, v198, v18
    v_mul_f32 v199, v199, v19
    v_dot2_f32_bf16 v200, v122, s68, 0
    v_dot2_f32_bf16 v201, v122, s69, 0
    v_dot2_f32_bf16 v202, v123, s68, 0
    v_dot2_f32_bf16 v203, v123, s69, 0
    v_dot2_f32_bf16 v200, v140, s68, v200
    v_dot2_f32_bf16 v201, v140, s69, v201
    v_dot2_f32_bf16 v202, v141, s68, v202
    v_dot2_f32_bf16 v203, v141, s69, v203
    v_lshlrev_b32 v88, 16, v178
    v_and_b32 v89, 0xffff0000, v178
    v_lshlrev_b32 v90, 16, v179
    v_and_b32 v91, 0xffff0000, v179
    v_mul_f32 v16, 0xbfb8aa3b, v200
    v_mul_f32 v17, 0xbfb8aa3b, v201
    v_mul_f32 v18, 0xbfb8aa3b, v202
    v_mul_f32 v19, 0xbfb8aa3b, v203
    v_exp_f32 v16, v16
    v_exp_f32 v17, v17
    v_exp_f32 v18, v18
    v_exp_f32 v19, v19
    v_add_f32 v16, 1.0, v16
    v_add_f32 v17, 1.0, v17
    v_add_f32 v18, 1.0, v18
    v_add_f32 v19, 1.0, v19
    v_rcp_f32 v16, v16
    v_rcp_f32 v17, v17
    v_rcp_f32 v18, v18
    v_rcp_f32 v19, v19
    v_mul_f32 v200, v200, v16
    v_mul_f32 v201, v201, v17
    v_mul_f32 v202, v202, v18
    v_mul_f32 v203, v203, v19
    buffer_load_dwordx4 v[156:159], v1, s[76:79], s74 offen offset:0 sc1
    buffer_load_dwordx4 v[160:163], v1, s[76:79], s74 offen offset:1024 sc1
    buffer_load_dwordx4 v[164:167], v1, s[76:79], s74 offen offset:2048 sc1
    buffer_load_dwordx4 v[168:171], v1, s[76:79], s74 offen offset:3072 sc1
    buffer_load_dwordx2 v[172:173], v3, s[76:79], s75 offen sc1
    v_dot2_f32_bf16 v204, v124, s68, 0
    v_dot2_f32_bf16 v205, v124, s69, 0
    v_dot2_f32_bf16 v206, v125, s68, 0
    v_dot2_f32_bf16 v207, v125, s69, 0
    v_dot2_f32_bf16 v204, v142, s68, v204
    v_dot2_f32_bf16 v205, v142, s69, v205
    v_dot2_f32_bf16 v206, v143, s68, v206
    v_dot2_f32_bf16 v207, v143, s69, v207
    v_lshlrev_b32 v92, 16, v180
    v_and_b32 v93, 0xffff0000, v180
    v_lshlrev_b32 v94, 16, v181
    v_and_b32 v95, 0xffff0000, v181
    v_mul_f32 v16, 0xbfb8aa3b, v204
    v_mul_f32 v17, 0xbfb8aa3b, v205
    v_mul_f32 v18, 0xbfb8aa3b, v206
    v_mul_f32 v19, 0xbfb8aa3b, v207
    v_exp_f32 v16, v16
    v_exp_f32 v17, v17
    v_exp_f32 v18, v18
    v_exp_f32 v19, v19
    v_add_f32 v16, 1.0, v16
    v_add_f32 v17, 1.0, v17
    v_add_f32 v18, 1.0, v18
    v_add_f32 v19, 1.0, v19
    v_rcp_f32 v16, v16
    v_rcp_f32 v17, v17
    v_rcp_f32 v18, v18
    v_rcp_f32 v19, v19
    v_mul_f32 v204, v204, v16
    v_mul_f32 v205, v205, v17
    v_mul_f32 v206, v206, v18
    v_mul_f32 v207, v207, v19
    v_dot2_f32_bf16 v208, v126, s68, 0
    v_dot2_f32_bf16 v209, v126, s69, 0
    v_dot2_f32_bf16 v210, v127, s68, 0
    v_dot2_f32_bf16 v211, v127, s69, 0
    v_dot2_f32_bf16 v208, v144, s68, v208
    v_dot2_f32_bf16 v209, v144, s69, v209
    v_dot2_f32_bf16 v210, v145, s68, v210
    v_dot2_f32_bf16 v211, v145, s69, v211
    v_lshlrev_b32 v96, 16, v182
    v_and_b32 v97, 0xffff0000, v182
    v_lshlrev_b32 v98, 16, v183
    v_and_b32 v99, 0xffff0000, v183
    v_mul_f32 v16, 0xbfb8aa3b, v208
    v_mul_f32 v17, 0xbfb8aa3b, v209
    v_mul_f32 v18, 0xbfb8aa3b, v210
    v_mul_f32 v19, 0xbfb8aa3b, v211
    v_exp_f32 v16, v16
    v_exp_f32 v17, v17
    v_exp_f32 v18, v18
    v_exp_f32 v19, v19
    v_add_f32 v16, 1.0, v16
    v_add_f32 v17, 1.0, v17
    v_add_f32 v18, 1.0, v18
    v_add_f32 v19, 1.0, v19
    v_rcp_f32 v16, v16
    v_rcp_f32 v17, v17
    v_rcp_f32 v18, v18
    v_rcp_f32 v19, v19
    v_mul_f32 v208, v208, v16
    v_mul_f32 v209, v209, v17
    v_mul_f32 v210, v210, v18
    v_mul_f32 v211, v211, v19
    v_dot2_f32_bf16 v212, v128, s68, 0
    v_dot2_f32_bf16 v213, v128, s69, 0
    v_dot2_f32_bf16 v214, v129, s68, 0
    v_dot2_f32_bf16 v215, v129, s69, 0
    v_dot2_f32_bf16 v212, v146, s68, v212
    v_dot2_f32_bf16 v213, v146, s69, v213
    v_dot2_f32_bf16 v214, v147, s68, v214
    v_dot2_f32_bf16 v215, v147, s69, v215
    v_lshlrev_b32 v100, 16, v184
    v_and_b32 v101, 0xffff0000, v184
    v_lshlrev_b32 v102, 16, v185
    v_and_b32 v103, 0xffff0000, v185
    v_mul_f32 v16, 0xbfb8aa3b, v212
    v_mul_f32 v17, 0xbfb8aa3b, v213
    v_mul_f32 v18, 0xbfb8aa3b, v214
    v_mul_f32 v19, 0xbfb8aa3b, v215
    v_exp_f32 v16, v16
    v_exp_f32 v17, v17
    v_exp_f32 v18, v18
    v_exp_f32 v19, v19
    v_add_f32 v16, 1.0, v16
    v_add_f32 v17, 1.0, v17
    v_add_f32 v18, 1.0, v18
    v_add_f32 v19, 1.0, v19
    v_rcp_f32 v16, v16
    v_rcp_f32 v17, v17
    v_rcp_f32 v18, v18
    v_rcp_f32 v19, v19
    v_mul_f32 v212, v212, v16
    v_mul_f32 v213, v213, v17
    v_mul_f32 v214, v214, v18
    v_mul_f32 v215, v215, v19
    v_dot2_f32_bf16 v216, v130, s68, 0
    v_dot2_f32_bf16 v217, v130, s69, 0
    v_dot2_f32_bf16 v218, v131, s68, 0
    v_dot2_f32_bf16 v219, v131, s69, 0
    v_dot2_f32_bf16 v216, v148, s68, v216
    v_dot2_f32_bf16 v217, v148, s69, v217
    v_dot2_f32_bf16 v218, v149, s68, v218
    v_dot2_f32_bf16 v219, v149, s69, v219
    v_lshlrev_b32 v104, 16, v186
    v_and_b32 v105, 0xffff0000, v186
    v_lshlrev_b32 v106, 16, v187
    v_and_b32 v107, 0xffff0000, v187
    v_mul_f32 v16, 0xbfb8aa3b, v216
    v_mul_f32 v17, 0xbfb8aa3b, v217
    v_mul_f32 v18, 0xbfb8aa3b, v218
    v_mul_f32 v19, 0xbfb8aa3b, v219
    v_exp_f32 v16, v16
    v_exp_f32 v17, v17
    v_exp_f32 v18, v18
    v_exp_f32 v19, v19
    v_add_f32 v16, 1.0, v16
    v_add_f32 v17, 1.0, v17
    v_add_f32 v18, 1.0, v18
    v_add_f32 v19, 1.0, v19
    v_rcp_f32 v16, v16
    v_rcp_f32 v17, v17
    v_rcp_f32 v18, v18
    v_rcp_f32 v19, v19
    v_mul_f32 v216, v216, v16
    v_mul_f32 v217, v217, v17
    v_mul_f32 v218, v218, v18
    v_mul_f32 v219, v219, v19
    v_dot2_f32_bf16 v220, v132, s68, 0
    v_dot2_f32_bf16 v221, v132, s69, 0
    v_dot2_f32_bf16 v222, v133, s68, 0
    v_dot2_f32_bf16 v223, v133, s69, 0
    v_dot2_f32_bf16 v220, v150, s68, v220
    v_dot2_f32_bf16 v221, v150, s69, v221
    v_dot2_f32_bf16 v222, v151, s68, v222
    v_dot2_f32_bf16 v223, v151, s69, v223
    v_lshlrev_b32 v108, 16, v188
    v_and_b32 v109, 0xffff0000, v188
    v_lshlrev_b32 v110, 16, v189
    v_and_b32 v111, 0xffff0000, v189
    v_mul_f32 v16, 0xbfb8aa3b, v220
    v_mul_f32 v17, 0xbfb8aa3b, v221
    v_mul_f32 v18, 0xbfb8aa3b, v222
    v_mul_f32 v19, 0xbfb8aa3b, v223
    v_exp_f32 v16, v16
    v_exp_f32 v17, v17
    v_exp_f32 v18, v18
    v_exp_f32 v19, v19
    v_add_f32 v16, 1.0, v16
    v_add_f32 v17, 1.0, v17
    v_add_f32 v18, 1.0, v18
    v_add_f32 v19, 1.0, v19
    v_rcp_f32 v16, v16
    v_rcp_f32 v17, v17
    v_rcp_f32 v18, v18
    v_rcp_f32 v19, v19
    v_mul_f32 v220, v220, v16
    v_mul_f32 v221, v221, v17
    v_mul_f32 v222, v222, v18
    v_mul_f32 v223, v223, v19
    v_dot2_f32_bf16 v224, v134, s68, 0
    v_dot2_f32_bf16 v225, v134, s69, 0
    v_dot2_f32_bf16 v226, v135, s68, 0
    v_dot2_f32_bf16 v227, v135, s69, 0
    v_dot2_f32_bf16 v224, v152, s68, v224
    v_dot2_f32_bf16 v225, v152, s69, v225
    v_dot2_f32_bf16 v226, v153, s68, v226
    v_dot2_f32_bf16 v227, v153, s69, v227
    v_lshlrev_b32 v112, 16, v190
    v_and_b32 v113, 0xffff0000, v190
    v_lshlrev_b32 v114, 16, v191
    v_and_b32 v115, 0xffff0000, v191
    v_mul_f32 v16, 0xbfb8aa3b, v224
    v_mul_f32 v17, 0xbfb8aa3b, v225
    v_mul_f32 v18, 0xbfb8aa3b, v226
    v_mul_f32 v19, 0xbfb8aa3b, v227
    v_exp_f32 v16, v16
    v_exp_f32 v17, v17
    v_exp_f32 v18, v18
    v_exp_f32 v19, v19
    v_add_f32 v16, 1.0, v16
    v_add_f32 v17, 1.0, v17
    v_add_f32 v18, 1.0, v18
    v_add_f32 v19, 1.0, v19
    v_rcp_f32 v16, v16
    v_rcp_f32 v17, v17
    v_rcp_f32 v18, v18
    v_rcp_f32 v19, v19
    v_mul_f32 v224, v224, v16
    v_mul_f32 v225, v225, v17
    v_mul_f32 v226, v226, v18
    v_mul_f32 v227, v227, v19
    v_dot2_f32_bf16 v228, v136, s68, 0
    v_dot2_f32_bf16 v229, v136, s69, 0
    v_dot2_f32_bf16 v230, v137, s68, 0
    v_dot2_f32_bf16 v231, v137, s69, 0
    v_dot2_f32_bf16 v228, v154, s68, v228
    v_dot2_f32_bf16 v229, v154, s69, v229
    v_dot2_f32_bf16 v230, v155, s68, v230
    v_dot2_f32_bf16 v231, v155, s69, v231
    v_lshlrev_b32 v116, 16, v192
    v_and_b32 v117, 0xffff0000, v192
    v_lshlrev_b32 v118, 16, v193
    v_and_b32 v119, 0xffff0000, v193
    v_mul_f32 v16, 0xbfb8aa3b, v228
    v_mul_f32 v17, 0xbfb8aa3b, v229
    v_mul_f32 v18, 0xbfb8aa3b, v230
    v_mul_f32 v19, 0xbfb8aa3b, v231
    v_exp_f32 v16, v16
    v_exp_f32 v17, v17
    v_exp_f32 v18, v18
    v_exp_f32 v19, v19
    v_add_f32 v16, 1.0, v16
    v_add_f32 v17, 1.0, v17
    v_add_f32 v18, 1.0, v18
    v_add_f32 v19, 1.0, v19
    v_rcp_f32 v16, v16
    v_rcp_f32 v17, v17
    v_rcp_f32 v18, v18
    v_rcp_f32 v19, v19
    v_mul_f32 v228, v228, v16
    v_mul_f32 v229, v229, v17
    v_mul_f32 v230, v230, v18
    v_mul_f32 v231, v231, v19
    s_waitcnt vmcnt(4)
    v_max3_u32 v12, v156, v157, 0
    v_max3_u32 v13, v158, v159, 0
    s_waitcnt vmcnt(3)
    v_max3_u32 v12, v160, v161, v12
    v_max3_u32 v13, v162, v163, v13
    s_waitcnt vmcnt(2)
    v_max3_u32 v12, v164, v165, v12
    v_max3_u32 v13, v166, v167, v13
    s_waitcnt vmcnt(1)
    v_max3_u32 v12, v168, v169, v12
    v_max3_u32 v13, v170, v171, v13
    s_waitcnt vmcnt(0)
    v_max3_u32 v12, v172, v173, v12
    v_max_u32 v12, v12, v13
    v_cmp_eq_u32 vcc, -1, v12
    s_nop 4
    s_cbranch_vccz ok_k1_27
    s_mov_b32 s53, 131072
retry_k1_26:
    s_sleep 1
    buffer_load_dwordx4 v[156:159], v1, s[76:79], s74 offen offset:0 sc1
    buffer_load_dwordx4 v[160:163], v1, s[76:79], s74 offen offset:1024 sc1
    buffer_load_dwordx4 v[164:167], v1, s[76:79], s74 offen offset:2048 sc1
    buffer_load_dwordx4 v[168:171], v1, s[76:79], s74 offen offset:3072 sc1
    buffer_load_dwordx2 v[172:173], v3, s[76:79], s75 offen sc1
    s_waitcnt vmcnt(0)
    v_max3_u32 v12, v156, v157, 0
    v_max3_u32 v13, v158, v159, 0
    v_max3_u32 v12, v160, v161, v12
    v_max3_u32 v13, v162, v163, v13
    v_max3_u32 v12, v164, v165, v12
    v_max3_u32 v13, v166, v167, v13
    v_max3_u32 v12, v168, v169, v12
    v_max3_u32 v13, v170, v171, v13
    v_max3_u32 v12, v172, v173, v12
    v_max_u32 v12, v12, v13
    v_cmp_eq_u32 vcc, -1, v12
    s_nop 4
    s_cbranch_vccz ok_k1_27
    s_sub_u32 s53, s53, 1
    s_cbranch_scc0 retry_k1_26
ok_k1_27:
    v_dot2_f32_bf16 v48, v156, s68, v48
    v_dot2_f32_bf16 v49, v156, s69, v49
    v_dot2_f32_bf16 v50, v157, s68, v50
    v_dot2_f32_bf16 v51, v157, s69, v51
    v_dot2_f32_bf16 v52, v158, s68, v52
    v_dot2_f32_bf16 v53, v158, s69, v53
    v_dot2_f32_bf16 v54, v159, s68, v54
    v_dot2_f32_bf16 v55, v159, s69, v55
    v_dot2_f32_bf16 v56, v160, s68, v56
    v_dot2_f32_bf16 v57, v160, s69, v57
    v_dot2_f32_bf16 v58, v161, s68, v58
    v_dot2_f32_bf16 v59, v161, s69, v59
    v_dot2_f32_bf16 v60, v162, s68, v60
    v_dot2_f32_bf16 v61, v162, s69, v61
    v_dot2_f32_bf16 v62, v163, s68, v62
    v_dot2_f32_bf16 v63, v163, s69, v63
    v_dot2_f32_bf16 v64, v164, s68, v64
    v_dot2_f32_bf16 v65, v164, s69, v65
    v_dot2_f32_bf16 v66, v165, s68, v66
    v_dot2_f32_bf16 v67, v165, s69, v67
    v_dot2_f32_bf16 v68, v166, s68, v68
    v_dot2_f32_bf16 v69, v166, s69, v69
    v_dot2_f32_bf16 v70, v167, s68, v70
    v_dot2_f32_bf16 v71, v167, s69, v71
    v_dot2_f32_bf16 v72, v168, s68, v72
    v_dot2_f32_bf16 v73, v168, s69, v73
    v_dot2_f32_bf16 v74, v169, s68, v74
    v_dot2_f32_bf16 v75, v169, s69, v75
    v_dot2_f32_bf16 v76, v170, s68, v76
    v_dot2_f32_bf16 v77, v170, s69, v77
    v_dot2_f32_bf16 v78, v171, s68, v78
    v_dot2_f32_bf16 v79, v171, s69, v79
    v_dot2_f32_bf16 v80, v172, s68, v80
    v_dot2_f32_bf16 v81, v172, s69, v81
    v_dot2_f32_bf16 v82, v173, s68, v82
    v_dot2_f32_bf16 v83, v173, s69, v83
    v_fma_f32 v48, v48, v196, v84
    v_fma_f32 v49, v49, v197, v85
    v_fma_f32 v50, v50, v198, v86
    v_fma_f32 v51, v51, v199, v87
    v_cvt_pk_bf16_f32 v20, v48, v49
    v_cvt_pk_bf16_f32 v21, v50, v51
    ds_write_b64 v4, v[20:21] offset:0
    v_fma_f32 v52, v52, v200, v88
    v_fma_f32 v53, v53, v201, v89
    v_fma_f32 v54, v54, v202, v90
    v_fma_f32 v55, v55, v203, v91
    v_cvt_pk_bf16_f32 v22, v52, v53
    v_cvt_pk_bf16_f32 v23, v54, v55
    ds_write_b64 v4, v[22:23] offset:32
    v_fma_f32 v56, v56, v204, v92
    v_fma_f32 v57, v57, v205, v93
    v_fma_f32 v58, v58, v206, v94
    v_fma_f32 v59, v59, v207, v95
    v_cvt_pk_bf16_f32 v24, v56, v57
    v_cvt_pk_bf16_f32 v25, v58, v59
    ds_write_b64 v4, v[24:25] offset:64
    v_fma_f32 v60, v60, v208, v96
    v_fma_f32 v61, v61, v209, v97
    v_fma_f32 v62, v62, v210, v98
    v_fma_f32 v63, v63, v211, v99
    v_cvt_pk_bf16_f32 v26, v60, v61
    v_cvt_pk_bf16_f32 v27, v62, v63
    ds_write_b64 v4, v[26:27] offset:96
    v_fma_f32 v64, v64, v212, v100
    v_fma_f32 v65, v65, v213, v101
    v_fma_f32 v66, v66, v214, v102
    v_fma_f32 v67, v67, v215, v103
    v_cvt_pk_bf16_f32 v20, v64, v65
    v_cvt_pk_bf16_f32 v21, v66, v67
    ds_write_b64 v4, v[20:21] offset:128
    v_fma_f32 v68, v68, v216, v104
    v_fma_f32 v69, v69, v217, v105
    v_fma_f32 v70, v70, v218, v106
    v_fma_f32 v71, v71, v219, v107
    v_cvt_pk_bf16_f32 v22, v68, v69
    v_cvt_pk_bf16_f32 v23, v70, v71
    ds_write_b64 v4, v[22:23] offset:160
    v_fma_f32 v72, v72, v220, v108
    v_fma_f32 v73, v73, v221, v109
    v_fma_f32 v74, v74, v222, v110
    v_fma_f32 v75, v75, v223, v111
    v_cvt_pk_bf16_f32 v24, v72, v73
    v_cvt_pk_bf16_f32 v25, v74, v75
    ds_write_b64 v4, v[24:25] offset:192
    v_fma_f32 v76, v76, v224, v112
    v_fma_f32 v77, v77, v225, v113
    v_fma_f32 v78, v78, v226, v114
    v_fma_f32 v79, v79, v227, v115
    v_cvt_pk_bf16_f32 v26, v76, v77
    v_cvt_pk_bf16_f32 v27, v78, v79
    ds_write_b64 v4, v[26:27] offset:224
    v_fma_f32 v80, v80, v228, v116
    v_fma_f32 v81, v81, v229, v117
    v_fma_f32 v82, v82, v230, v118
    v_fma_f32 v83, v83, v231, v119
    v_cvt_pk_bf16_f32 v20, v80, v81
    v_cvt_pk_bf16_f32 v21, v82, v83
    ds_write_b64 v4, v[20:21] offset:256
    v_add_u32 v12, s51, v1
    s_waitcnt lgkmcnt(0)
    ds_read_b128 v[120:123], v12 offset:0
    ds_read_b128 v[124:127], v12 offset:1024
    ds_read_b128 v[128:131], v12 offset:2048
    ds_read_b128 v[132:135], v12 offset:3072
    ds_read_b128 v[136:139], v12 offset:4096
    s_waitcnt lgkmcnt(4)
    buffer_store_dwordx4 v[120:123], v7, s[20:23], s50 offen
    s_waitcnt lgkmcnt(3)
    buffer_store_dwordx4 v[124:127], v8, s[20:23], s50 offen
    s_waitcnt lgkmcnt(2)
    buffer_store_dwordx4 v[128:131], v9, s[20:23], s50 offen
    s_waitcnt lgkmcnt(1)
    buffer_store_dwordx4 v[132:135], v10, s[20:23], s50 offen
    s_waitcnt lgkmcnt(0)
    buffer_store_dwordx4 v[136:139], v11, s[20:23], s50 offen
    s_endpgm
isp_k1_22:
    s_nop 7
    s_waitcnt lgkmcnt(0)
    s_waitcnt vmcnt(9)
    s_barrier
    v_mfma_f32_16x16x32_bf16 v[48:51], a[0:3], a[160:163], v[48:51]
    s_add_u32 m0, s33, 14336
    ds_read_b128 a[72:75], v2 offset:20480
    v_mfma_f32_16x16x32_bf16 v[48:51], a[36:39], a[168:171], v[48:51]
    v_mfma_f32_16x16x32_bf16 v[84:87], a[36:39], a[172:175], v[84:87]
    buffer_load_dwordx4 v1, s[8:11], s80 offen sc1 lds
    v_mfma_f32_16x16x32_bf16 v[84:87], a[0:3], a[164:167], v[84:87]
    s_add_u32 s80, s80, 4096
    ds_read_b128 a[108:111], v2 offset:63488
    ds_read_b128 a[76:79], v2 offset:61440
    v_mfma_f32_16x16x32_bf16 v[88:91], a[4:7], a[164:167], v[88:91]
    buffer_load_dwordx4 a[192:195], v5, s[12:15], s81 offen sc1
    v_mfma_f32_16x16x32_bf16 v[88:91], a[40:43], a[172:175], v[88:91]
    s_add_u32 m0, s33, 15360
    ds_read_b128 a[112:115], v1 offset:7168
    v_mfma_f32_16x16x32_bf16 v[52:55], a[40:43], a[168:171], v[52:55]
    buffer_load_dwordx4 a[196:199], v6, s[12:15], s81 offen sc1
    v_mfma_f32_16x16x32_bf16 v[52:55], a[4:7], a[160:163], v[52:55]
    buffer_load_dwordx4 v1, s[8:11], s80 offen sc1 lds
    v_mfma_f32_16x16x32_bf16 v[56:59], a[8:11], a[160:163], v[56:59]
    s_add_u32 s80, s80, 4096
    ds_read_b128 a[80:83], v1 offset:5120
    s_add_u32 s81, s81, 4096
    v_mfma_f32_16x16x32_bf16 v[56:59], a[44:47], a[168:171], v[56:59]
    s_add_u32 m0, s33, 16384
    ds_read_b128 a[116:119], v1 offset:48128
    v_mfma_f32_16x16x32_bf16 v[92:95], a[44:47], a[172:175], v[92:95]
    buffer_load_dwordx4 v1, s[8:11], s80 offen sc1 lds
    v_mfma_f32_16x16x32_bf16 v[92:95], a[8:11], a[164:167], v[92:95]
    s_add_u32 s80, s80, 4096
    ds_read_b128 a[84:87], v1 offset:46080
    ds_read_b128 a[120:123], v2 offset:23552
    v_mfma_f32_16x16x32_bf16 v[96:99], a[12:15], a[164:167], v[96:99]
    buffer_load_dwordx4 a[200:203], v5, s[12:15], s81 offen sc1
    v_mfma_f32_16x16x32_bf16 v[96:99], a[48:51], a[172:175], v[96:99]
    s_add_u32 m0, s33, 17408
    ds_read_b128 a[88:91], v2 offset:21504
    v_mfma_f32_16x16x32_bf16 v[60:63], a[48:51], a[168:171], v[60:63]
    buffer_load_dwordx4 a[204:207], v6, s[12:15], s81 offen sc1
    v_mfma_f32_16x16x32_bf16 v[60:63], a[12:15], a[160:163], v[60:63]
    buffer_load_dwordx4 v1, s[8:11], s80 offen sc1 lds
    v_mfma_f32_16x16x32_bf16 v[64:67], a[16:19], a[160:163], v[64:67]
    s_add_u32 s80, s80, 4096
    ds_read_b128 a[124:127], v2 offset:64512
    s_add_u32 s81, s81, 4096
    v_mfma_f32_16x16x32_bf16 v[64:67], a[52:55], a[168:171], v[64:67]
    ds_read_b128 a[92:95], v2 offset:62464
    v_mfma_f32_16x16x32_bf16 v[100:103], a[52:55], a[172:175], v[100:103]
    buffer_load_dwordx4 a[208:211], v5, s[12:15], s81 offen sc1
    v_mfma_f32_16x16x32_bf16 v[100:103], a[16:19], a[164:167], v[100:103]
    ds_read_b128 a[128:131], v1 offset:8192
    v_mfma_f32_16x16x32_bf16 v[104:107], a[20:23], a[164:167], v[104:107]
    ds_read_b128 a[96:99], v1 offset:6144
    v_mfma_f32_16x16x32_bf16 v[104:107], a[56:59], a[172:175], v[104:107]
    buffer_load_dwordx4 a[212:215], v6, s[12:15], s81 offen sc1
    v_mfma_f32_16x16x32_bf16 v[68:71], a[56:59], a[168:171], v[68:71]
    ds_read_b128 a[132:135], v1 offset:49152
    v_mfma_f32_16x16x32_bf16 v[68:71], a[20:23], a[160:163], v[68:71]
    s_add_u32 s81, s81, 4096
    ds_read_b128 a[100:103], v1 offset:47104
    v_mfma_f32_16x16x32_bf16 v[72:75], a[24:27], a[160:163], v[72:75]
    v_mfma_f32_16x16x32_bf16 v[72:75], a[60:63], a[168:171], v[72:75]
    ds_read_b128 a[136:139], v2 offset:24576
    v_mfma_f32_16x16x32_bf16 v[108:111], a[60:63], a[172:175], v[108:111]
    buffer_load_dwordx4 a[216:219], v5, s[12:15], s81 offen sc1
    v_mfma_f32_16x16x32_bf16 v[108:111], a[24:27], a[164:167], v[108:111]
    ds_read_b128 a[104:107], v2 offset:22528
    v_mfma_f32_16x16x32_bf16 v[112:115], a[28:31], a[164:167], v[112:115]
    buffer_load_dwordx4 a[220:223], v6, s[12:15], s81 offen sc1
    v_mfma_f32_16x16x32_bf16 v[112:115], a[64:67], a[172:175], v[112:115]
    ds_read_b128 a[140:143], v37 offset:0
    v_mfma_f32_16x16x32_bf16 v[76:79], a[64:67], a[168:171], v[76:79]
    v_mfma_f32_16x16x32_bf16 v[76:79], a[28:31], a[160:163], v[76:79]
    s_add_u32 s81, s81, 4096
    v_mfma_f32_16x16x32_bf16 v[80:83], a[32:35], a[160:163], v[80:83]
    v_mfma_f32_16x16x32_bf16 v[80:83], a[68:71], a[168:171], v[80:83]
    v_mfma_f32_16x16x32_bf16 v[116:119], a[68:71], a[172:175], v[116:119]
    v_mfma_f32_16x16x32_bf16 v[116:119], a[32:35], a[164:167], v[116:119]
    s_waitcnt lgkmcnt(0)
    s_waitcnt vmcnt(4)
    s_barrier
    v_mfma_f32_16x16x32_bf16 v[48:51], a[72:75], a[176:179], v[48:51]
    ds_read_b128 a[0:3], v1 offset:9216
    v_mfma_f32_16x16x32_bf16 v[48:51], a[108:111], a[184:187], v[48:51]
    v_mfma_f32_16x16x32_bf16 v[84:87], a[108:111], a[188:191], v[84:87]
    ds_read_b128 a[4:7], v1 offset:52224
    v_mfma_f32_16x16x32_bf16 v[84:87], a[72:75], a[180:183], v[84:87]
    v_mfma_f32_16x16x32_bf16 v[88:91], a[76:79], a[180:183], v[88:91]
    ds_read_b128 a[8:11], v2 offset:29696
    v_mfma_f32_16x16x32_bf16 v[88:91], a[112:115], a[188:191], v[88:91]
    v_mfma_f32_16x16x32_bf16 v[52:55], a[112:115], a[184:187], v[52:55]
    ds_read_b128 a[12:15], v37 offset:7168
    v_mfma_f32_16x16x32_bf16 v[52:55], a[76:79], a[176:179], v[52:55]
    ds_read_b128 a[16:19], v1 offset:50176
    v_mfma_f32_16x16x32_bf16 v[56:59], a[80:83], a[176:179], v[56:59]
    v_mfma_f32_16x16x32_bf16 v[56:59], a[116:119], a[184:187], v[56:59]
    ds_read_b128 a[20:23], v2 offset:27648
    v_mfma_f32_16x16x32_bf16 v[92:95], a[116:119], a[188:191], v[92:95]
    v_mfma_f32_16x16x32_bf16 v[92:95], a[80:83], a[180:183], v[92:95]
    ds_read_b128 a[24:27], v37 offset:5120
    v_mfma_f32_16x16x32_bf16 v[96:99], a[84:87], a[180:183], v[96:99]
    v_mfma_f32_16x16x32_bf16 v[96:99], a[120:123], a[188:191], v[96:99]
    ds_read_b128 a[28:31], v1 offset:16384
    v_mfma_f32_16x16x32_bf16 v[60:63], a[120:123], a[184:187], v[60:63]
    v_mfma_f32_16x16x32_bf16 v[60:63], a[84:87], a[176:179], v[60:63]
    v_mfma_f32_16x16x32_bf16 v[64:67], a[88:91], a[176:179], v[64:67]
    v_mfma_f32_16x16x32_bf16 v[64:67], a[124:127], a[184:187], v[64:67]
    v_mfma_f32_16x16x32_bf16 v[100:103], a[124:127], a[188:191], v[100:103]
    v_mfma_f32_16x16x32_bf16 v[100:103], a[88:91], a[180:183], v[100:103]
    v_mfma_f32_16x16x32_bf16 v[104:107], a[92:95], a[180:183], v[104:107]
    v_mfma_f32_16x16x32_bf16 v[104:107], a[128:131], a[188:191], v[104:107]
    v_mfma_f32_16x16x32_bf16 v[68:71], a[128:131], a[184:187], v[68:71]
    v_mfma_f32_16x16x32_bf16 v[68:71], a[92:95], a[176:179], v[68:71]
    v_mfma_f32_16x16x32_bf16 v[72:75], a[96:99], a[176:179], v[72:75]
    v_mfma_f32_16x16x32_bf16 v[72:75], a[132:135], a[184:187], v[72:75]
    v_mfma_f32_16x16x32_bf16 v[108:111], a[132:135], a[188:191], v[108:111]
    v_mfma_f32_16x16x32_bf16 v[108:111], a[96:99], a[180:183], v[108:111]
    v_mfma_f32_16x16x32_bf16 v[112:115], a[100:103], a[180:183], v[112:115]
    v_mfma_f32_16x16x32_bf16 v[112:115], a[136:139], a[188:191], v[112:115]
    v_mfma_f32_16x16x32_bf16 v[76:79], a[136:139], a[184:187], v[76:79]
    v_mfma_f32_16x16x32_bf16 v[76:79], a[100:103], a[176:179], v[76:79]
    v_mfma_f32_16x16x32_bf16 v[80:83], a[104:107], a[176:179], v[80:83]
    v_mfma_f32_16x16x32_bf16 v[80:83], a[140:143], a[184:187], v[80:83]
    v_mfma_f32_16x16x32_bf16 v[116:119], a[140:143], a[188:191], v[116:119]
    v_mfma_f32_16x16x32_bf16 v[116:119], a[104:107], a[180:183], v[116:119]
    s_waitcnt lgkmcnt(7)
    v_mfma_f32_16x16x32_bf16 v[84:87], a[0:3], a[196:199], v[84:87]
    ds_read_b128 a[32:35], v2 offset:25600
    s_waitcnt lgkmcnt(7)
    v_mfma_f32_16x16x32_bf16 v[84:87], a[4:7], a[204:207], v[84:87]
    s_waitcnt vmcnt(2) lgkmcnt(6)
    v_mfma_f32_16x16x32_bf16 v[84:87], a[8:11], a[212:215], v[84:87]
    ds_read_b128 a[36:39], v37 offset:3072
    s_waitcnt vmcnt(0) lgkmcnt(6)
    v_mfma_f32_16x16x32_bf16 v[84:87], a[12:15], a[220:223], v[84:87]
    ds_read_b128 a[40:43], v1 offset:14336
    v_mfma_f32_16x16x32_bf16 v[48:51], a[12:15], a[216:219], v[48:51]
    v_mfma_f32_16x16x32_bf16 v[48:51], a[8:11], a[208:211], v[48:51]
    ds_read_b128 a[44:47], v1 offset:57344
    v_mfma_f32_16x16x32_bf16 v[48:51], a[4:7], a[200:203], v[48:51]
    v_mfma_f32_16x16x32_bf16 v[48:51], a[0:3], a[192:195], v[48:51]
    s_waitcnt lgkmcnt(7)
    v_mfma_f32_16x16x32_bf16 v[88:91], a[16:19], a[196:199], v[88:91]
    ds_read_b128 a[48:51], v37 offset:1024
    s_waitcnt lgkmcnt(7)
    v_mfma_f32_16x16x32_bf16 v[88:91], a[20:23], a[204:207], v[88:91]
    s_waitcnt lgkmcnt(6)
    v_mfma_f32_16x16x32_bf16 v[88:91], a[24:27], a[212:215], v[88:91]
    ds_read_b128 a[52:55], v1 offset:12288
    s_waitcnt lgkmcnt(6)
    v_mfma_f32_16x16x32_bf16 v[88:91], a[28:31], a[220:223], v[88:91]
    ds_read_b128 a[56:59], v1 offset:55296
    v_mfma_f32_16x16x32_bf16 v[52:55], a[28:31], a[216:219], v[52:55]
    v_mfma_f32_16x16x32_bf16 v[52:55], a[24:27], a[208:211], v[52:55]
    ds_read_b128 a[60:63], v2 offset:32768
    v_mfma_f32_16x16x32_bf16 v[52:55], a[20:23], a[200:203], v[52:55]
    v_cvt_pk_bf16_f32 v84, v84, v85
    v_mfma_f32_16x16x32_bf16 v[52:55], a[16:19], a[192:195], v[52:55]
    v_min_u32 v84, -2, v84
    s_waitcnt lgkmcnt(7)
    v_mfma_f32_16x16x32_bf16 v[92:95], a[32:35], a[196:199], v[92:95]
    ds_read_b128 a[0:3], v1 offset:10240
    v_cvt_pk_bf16_f32 v85, v86, v87
    s_waitcnt lgkmcnt(7)
    v_mfma_f32_16x16x32_bf16 v[92:95], a[36:39], a[204:207], v[92:95]
    v_min_u32 v85, -2, v85
    v_cvt_pk_bf16_f32 v86, v88, v89
    s_waitcnt lgkmcnt(6)
    v_mfma_f32_16x16x32_bf16 v[92:95], a[40:43], a[212:215], v[92:95]
    ds_read_b128 a[4:7], v1 offset:53248
    v_min_u32 v86, -2, v86
    s_waitcnt lgkmcnt(6)
    v_mfma_f32_16x16x32_bf16 v[92:95], a[44:47], a[220:223], v[92:95]
    ds_read_b128 a[8:11], v2 offset:30720
    v_cvt_pk_bf16_f32 v87, v90, v91
    v_mfma_f32_16x16x32_bf16 v[56:59], a[44:47], a[216:219], v[56:59]
    v_cvt_pk_bf16_f32 v48, v48, v49
    v_min_u32 v87, -2, v87
    v_mfma_f32_16x16x32_bf16 v[56:59], a[40:43], a[208:211], v[56:59]
    ds_read_b128 a[12:15], v37 offset:8192
    v_min_u32 v48, -2, v48
    v_mfma_f32_16x16x32_bf16 v[56:59], a[36:39], a[200:203], v[56:59]
    buffer_store_dwordx4 v[84:87], v1, s[76:79], s48 offen offset:0 sc1
    v_mfma_f32_16x16x32_bf16 v[56:59], a[32:35], a[192:195], v[56:59]
    v_cvt_pk_bf16_f32 v49, v50, v51
    v_min_u32 v49, -2, v49
    s_waitcnt lgkmcnt(7)
    v_mfma_f32_16x16x32_bf16 v[96:99], a[48:51], a[196:199], v[96:99]
    ds_read_b128 a[16:19], v1 offset:51200
    v_cvt_pk_bf16_f32 v50, v52, v53
    s_waitcnt lgkmcnt(7)
    v_mfma_f32_16x16x32_bf16 v[96:99], a[52:55], a[204:207], v[96:99]
    v_min_u32 v50, -2, v50
    v_cvt_pk_bf16_f32 v51, v54, v55
    s_waitcnt lgkmcnt(6)
    v_mfma_f32_16x16x32_bf16 v[96:99], a[56:59], a[212:215], v[96:99]
    ds_read_b128 a[20:23], v2 offset:28672
    v_min_u32 v51, -2, v51
    s_waitcnt lgkmcnt(6)
    v_mfma_f32_16x16x32_bf16 v[96:99], a[60:63], a[220:223], v[96:99]
    buffer_store_dwordx4 v[48:51], v1, s[76:79], s46 offen offset:0 sc1
    v_mfma_f32_16x16x32_bf16 v[60:63], a[60:63], a[216:219], v[60:63]
    ds_read_b128 a[24:27], v37 offset:6144
    v_mfma_f32_16x16x32_bf16 v[60:63], a[56:59], a[208:211], v[60:63]
    ds_read_b128 a[28:31], v1 offset:17408
    v_mfma_f32_16x16x32_bf16 v[60:63], a[52:55], a[200:203], v[60:63]
    v_cvt_pk_bf16_f32 v92, v92, v93
    v_mfma_f32_16x16x32_bf16 v[60:63], a[48:51], a[192:195], v[60:63]
    v_min_u32 v92, -2, v92
    s_waitcnt lgkmcnt(7)
    v_mfma_f32_16x16x32_bf16 v[100:103], a[0:3], a[196:199], v[100:103]
    ds_read_b128 a[32:35], v2 offset:26624
    v_cvt_pk_bf16_f32 v93, v94, v95
    s_waitcnt lgkmcnt(7)
    v_mfma_f32_16x16x32_bf16 v[100:103], a[4:7], a[204:207], v[100:103]
    v_min_u32 v93, -2, v93
    v_cvt_pk_bf16_f32 v94, v96, v97
    s_waitcnt lgkmcnt(6)
    v_mfma_f32_16x16x32_bf16 v[100:103], a[8:11], a[212:215], v[100:103]
    ds_read_b128 a[36:39], v37 offset:4096
    v_min_u32 v94, -2, v94
    s_waitcnt lgkmcnt(6)
    v_mfma_f32_16x16x32_bf16 v[100:103], a[12:15], a[220:223], v[100:103]
    ds_read_b128 a[40:43], v1 offset:15360
    v_cvt_pk_bf16_f32 v95, v98, v99
    v_mfma_f32_16x16x32_bf16 v[64:67], a[12:15], a[216:219], v[64:67]
    v_cvt_pk_bf16_f32 v56, v56, v57
    v_min_u32 v95, -2, v95
    v_mfma_f32_16x16x32_bf16 v[64:67], a[8:11], a[208:211], v[64:67]
    ds_read_b128 a[44:47], v1 offset:58368
    v_min_u32 v56, -2, v56
    v_mfma_f32_16x16x32_bf16 v[64:67], a[4:7], a[200:203], v[64:67]
    buffer_store_dwordx4 v[92:95], v1, s[76:79], s48 offen offset:1024 sc1
    v_mfma_f32_16x16x32_bf16 v[64:67], a[0:3], a[192:195], v[64:67]
    v_cvt_pk_bf16_f32 v57, v58, v59
    v_min_u32 v57, -2, v57
    s_waitcnt lgkmcnt(7)
    v_mfma_f32_16x16x32_bf16 v[104:107], a[16:19], a[196:199], v[104:107]
    ds_read_b128 a[48:51], v37 offset:2048
    v_cvt_pk_bf16_f32 v58, v60, v61
    s_waitcnt lgkmcnt(7)
    v_mfma_f32_16x16x32_bf16 v[104:107], a[20:23], a[204:207], v[104:107]
    v_min_u32 v58, -2, v58
    v_cvt_pk_bf16_f32 v59, v62, v63
    s_waitcnt lgkmcnt(6)
    v_mfma_f32_16x16x32_bf16 v[104:107], a[24:27], a[212:215], v[104:107]
    ds_read_b128 a[52:55], v1 offset:13312
    v_min_u32 v59, -2, v59
    s_waitcnt lgkmcnt(6)
    v_mfma_f32_16x16x32_bf16 v[104:107], a[28:31], a[220:223], v[104:107]
    buffer_store_dwordx4 v[56:59], v1, s[76:79], s46 offen offset:1024 sc1
    v_mfma_f32_16x16x32_bf16 v[68:71], a[28:31], a[216:219], v[68:71]
    ds_read_b128 a[56:59], v1 offset:56320
    v_mfma_f32_16x16x32_bf16 v[68:71], a[24:27], a[208:211], v[68:71]
    ds_read_b128 a[60:63], v2 offset:33792
    v_mfma_f32_16x16x32_bf16 v[68:71], a[20:23], a[200:203], v[68:71]
    v_cvt_pk_bf16_f32 v100, v100, v101
    v_mfma_f32_16x16x32_bf16 v[68:71], a[16:19], a[192:195], v[68:71]
    v_min_u32 v100, -2, v100
    s_waitcnt lgkmcnt(7)
    v_mfma_f32_16x16x32_bf16 v[108:111], a[32:35], a[196:199], v[108:111]
    ds_read_b128 a[0:3], v1 offset:11264
    v_cvt_pk_bf16_f32 v101, v102, v103
    s_waitcnt lgkmcnt(7)
    v_mfma_f32_16x16x32_bf16 v[108:111], a[36:39], a[204:207], v[108:111]
    v_min_u32 v101, -2, v101
    v_cvt_pk_bf16_f32 v102, v104, v105
    s_waitcnt lgkmcnt(6)
    v_mfma_f32_16x16x32_bf16 v[108:111], a[40:43], a[212:215], v[108:111]
    ds_read_b128 a[4:7], v1 offset:54272
    v_min_u32 v102, -2, v102
    s_waitcnt lgkmcnt(6)
    v_mfma_f32_16x16x32_bf16 v[108:111], a[44:47], a[220:223], v[108:111]
    ds_read_b128 a[8:11], v2 offset:31744
    v_cvt_pk_bf16_f32 v103, v106, v107
    v_mfma_f32_16x16x32_bf16 v[72:75], a[44:47], a[216:219], v[72:75]
    v_cvt_pk_bf16_f32 v64, v64, v65
    v_min_u32 v103, -2, v103
    v_mfma_f32_16x16x32_bf16 v[72:75], a[40:43], a[208:211], v[72:75]
    ds_read_b128 a[12:15], v37 offset:9216
    v_min_u32 v64, -2, v64
    v_mfma_f32_16x16x32_bf16 v[72:75], a[36:39], a[200:203], v[72:75]
    buffer_store_dwordx4 v[100:103], v1, s[76:79], s48 offen offset:2048 sc1
    v_mfma_f32_16x16x32_bf16 v[72:75], a[32:35], a[192:195], v[72:75]
    v_cvt_pk_bf16_f32 v65, v66, v67
    v_min_u32 v65, -2, v65
    s_waitcnt lgkmcnt(7)
    v_mfma_f32_16x16x32_bf16 v[112:115], a[48:51], a[196:199], v[112:115]
    v_cvt_pk_bf16_f32 v66, v68, v69
    v_min_u32 v66, -2, v66
    s_waitcnt lgkmcnt(6)
    v_mfma_f32_16x16x32_bf16 v[112:115], a[52:55], a[204:207], v[112:115]
    v_cvt_pk_bf16_f32 v67, v70, v71
    v_min_u32 v67, -2, v67
    s_waitcnt lgkmcnt(5)
    v_mfma_f32_16x16x32_bf16 v[112:115], a[56:59], a[212:215], v[112:115]
    buffer_store_dwordx4 v[64:67], v1, s[76:79], s46 offen offset:2048 sc1
    s_waitcnt lgkmcnt(4)
    v_mfma_f32_16x16x32_bf16 v[112:115], a[60:63], a[220:223], v[112:115]
    v_mfma_f32_16x16x32_bf16 v[76:79], a[60:63], a[216:219], v[76:79]
    v_mfma_f32_16x16x32_bf16 v[76:79], a[56:59], a[208:211], v[76:79]
    v_mfma_f32_16x16x32_bf16 v[76:79], a[52:55], a[200:203], v[76:79]
    v_cvt_pk_bf16_f32 v108, v108, v109
    v_mfma_f32_16x16x32_bf16 v[76:79], a[48:51], a[192:195], v[76:79]
    v_min_u32 v108, -2, v108
    s_waitcnt lgkmcnt(3)
    v_mfma_f32_16x16x32_bf16 v[116:119], a[0:3], a[196:199], v[116:119]
    v_cvt_pk_bf16_f32 v109, v110, v111
    v_min_u32 v109, -2, v109
    s_waitcnt lgkmcnt(2)
    v_mfma_f32_16x16x32_bf16 v[116:119], a[4:7], a[204:207], v[116:119]
    v_cvt_pk_bf16_f32 v110, v112, v113
    s_waitcnt lgkmcnt(1)
    v_mfma_f32_16x16x32_bf16 v[116:119], a[8:11], a[212:215], v[116:119]
    v_min_u32 v110, -2, v110
    v_cvt_pk_bf16_f32 v111, v114, v115
    s_waitcnt lgkmcnt(0)
    v_mfma_f32_16x16x32_bf16 v[116:119], a[12:15], a[220:223], v[116:119]
    v_cvt_pk_bf16_f32 v72, v72, v73
    v_min_u32 v111, -2, v111
    v_mfma_f32_16x16x32_bf16 v[80:83], a[12:15], a[216:219], v[80:83]
    v_min_u32 v72, -2, v72
    v_cvt_pk_bf16_f32 v73, v74, v75
    v_mfma_f32_16x16x32_bf16 v[80:83], a[8:11], a[208:211], v[80:83]
    buffer_store_dwordx4 v[108:111], v1, s[76:79], s48 offen offset:3072 sc1
    v_mfma_f32_16x16x32_bf16 v[80:83], a[4:7], a[200:203], v[80:83]
    v_min_u32 v73, -2, v73
    v_cvt_pk_bf16_f32 v74, v76, v77
    v_mfma_f32_16x16x32_bf16 v[80:83], a[0:3], a[192:195], v[80:83]
    v_min_u32 v74, -2, v74
    v_cvt_pk_bf16_f32 v116, v116, v117
    v_cvt_pk_bf16_f32 v75, v78, v79
    v_min_u32 v116, -2, v116
    v_min_u32 v75, -2, v75
    buffer_store_dwordx4 v[72:75], v1, s[76:79], s46 offen offset:3072 sc1
    v_cvt_pk_bf16_f32 v117, v118, v119
    v_min_u32 v117, -2, v117
    v_cvt_pk_bf16_f32 v80, v80, v81
    buffer_store_dwordx2 v[116:117], v3, s[76:79], s49 offen sc1
    v_min_u32 v80, -2, v80
    v_cvt_pk_bf16_f32 v81, v82, v83
    v_min_u32 v81, -2, v81
    buffer_store_dwordx2 v[80:81], v3, s[76:79], s47 offen sc1
fin_k1_23:
done_k1_1:
    s_endpgm
sig_k1_6:
    s_and_b32 s3, s2, 7
    s_lshl_b32 s3, s3, 2
    v_mov_b32 v2, s3
    v_mov_b32 v3, 1
    s_mov_b64 exec, 1
    global_atomic_add v2, v3, s[94:95] sc1
    s_and_b32 s3, s2, 6
    s_lshl_b32 s3, s3, 1
    s_add_u32 s3, s3, 32
    v_mov_b32 v2, s3
    s_and_b32 s3, s2, 1
    s_or_b32 s3, s3, 64
    v_mov_b32 v4, s3
    v_mov_b32 v5, 0
    global_atomic_cmpswap v2, v[4:5], s[94:95] sc1
    s_mov_b64 exec, -1
    s_branch sig_k1_6r
slowB_k1_18:
    s_mov_b32 s53, 131072
spin_k1_20:
    buffer_load_dword v36, v39, s[76:79], s42 offen sc1
    s_waitcnt vmcnt(0)
    v_cmp_eq_u32 vcc, -1, v36
    s_nop 4
    s_cbranch_vccz spun_k1_21
    s_sleep 2
    s_sub_u32 s53, s53, 1
    s_cbranch_scc0 spin_k1_20
spun_k1_21:
    s_branch slowB_k1_18r
fallback_k1_9:
    s_nop 7
    v_and_b32 v10, 15, v0
    v_lshlrev_b32 v10, 8, v10
    v_and_b32 v11, 48, v0
    v_add3_u32 v8, v10, v11, s33
    v_lshrrev_b32 v10, 2, v0
    v_lshlrev_b32 v10, 8, v10
    v_and_b32 v11, 3, v0
    v_lshlrev_b32 v11, 3, v11
    v_add3_u32 v9, v10, v11, s33
    s_mov_b32 s50, 0
    s_waitcnt vmcnt(0)
    v_mov_b32 v96, 0
    v_mov_b32 v97, 0
    v_mov_b32 v98, 0
    v_mov_b32 v99, 0
    v_mov_b32 v100, 0
    v_mov_b32 v101, 0
    v_mov_b32 v102, 0
    v_mov_b32 v103, 0
    v_mov_b32 v104, 0
    v_mov_b32 v105, 0
    v_mov_b32 v106, 0
    v_mov_b32 v107, 0
    v_mov_b32 v108, 0
    v_mov_b32 v109, 0
    v_mov_b32 v110, 0
    v_mov_b32 v111, 0
    v_mov_b32 v112, 0
    v_mov_b32 v113, 0
    v_mov_b32 v114, 0
    v_mov_b32 v115, 0
    v_mov_b32 v116, 0
    v_mov_b32 v117, 0
    v_mov_b32 v118, 0
    v_mov_b32 v119, 0
    v_mov_b32 v120, 0
    v_mov_b32 v121, 0
    v_mov_b32 v122, 0
    v_mov_b32 v123, 0
    v_mov_b32 v124, 0
    v_mov_b32 v125, 0
    v_mov_b32 v126, 0
    v_mov_b32 v127, 0
    v_mov_b32 v128, 0
    v_mov_b32 v129, 0
    v_mov_b32 v130, 0
    v_mov_b32 v131, 0
    v_mov_b32 v132, 0
    v_mov_b32 v133, 0
    v_mov_b32 v134, 0
    v_mov_b32 v135, 0
    v_mov_b32 v136, 0
    v_mov_b32 v137, 0
    v_mov_b32 v138, 0
    v_mov_b32 v139, 0
    v_mov_b32 v140, 0
    v_mov_b32 v141, 0
    v_mov_b32 v142, 0
    v_mov_b32 v143, 0
    v_mov_b32 v144, 0
    v_mov_b32 v145, 0
    v_mov_b32 v146, 0
    v_mov_b32 v147, 0
    v_mov_b32 v148, 0
    v_mov_b32 v149, 0
    v_mov_b32 v150, 0
    v_mov_b32 v151, 0
    v_mov_b32 v152, 0
    v_mov_b32 v153, 0
    v_mov_b32 v154, 0
    v_mov_b32 v155, 0
    v_mov_b32 v156, 0
    v_mov_b32 v157, 0
    v_mov_b32 v158, 0
    v_mov_b32 v159, 0
    v_mov_b32 v160, 0
    v_mov_b32 v161, 0
    v_mov_b32 v162, 0
    v_mov_b32 v163, 0
    v_mov_b32 v164, 0
    v_mov_b32 v165, 0
    v_mov_b32 v166, 0
    v_mov_b32 v167, 0
    v_mov_b32 v168, 0
    v_mov_b32 v169, 0
    v_mov_b32 v170, 0
    v_mov_b32 v171, 0
    v_mov_b32 v172, 0
    v_mov_b32 v173, 0
    v_mov_b32 v174, 0
    v_mov_b32 v175, 0
    v_mov_b32 v176, 0
    v_mov_b32 v177, 0
    v_mov_b32 v178, 0
    v_mov_b32 v179, 0
    v_mov_b32 v180, 0
    v_mov_b32 v181, 0
    v_mov_b32 v182, 0
    v_mov_b32 v183, 0
    v_mov_b32 v184, 0
    v_mov_b32 v185, 0
    v_mov_b32 v186, 0
    v_mov_b32 v187, 0
    v_mov_b32 v188, 0
    v_mov_b32 v189, 0
    v_mov_b32 v190, 0
    v_mov_b32 v191, 0
    v_mov_b32 v192, 0
    v_mov_b32 v193, 0
    v_mov_b32 v194, 0
    v_mov_b32 v195, 0
    v_mov_b32 v196, 0
    v_mov_b32 v197, 0
    v_mov_b32 v198, 0
    v_mov_b32 v199, 0
    v_mov_b32 v200, 0
    v_mov_b32 v201, 0
    v_mov_b32 v202, 0
    v_mov_b32 v203, 0
    v_mov_b32 v204, 0
    v_mov_b32 v205, 0
    v_mov_b32 v206, 0
    v_mov_b32 v207, 0
    v_mov_b32 v208, 0
    v_mov_b32 v209, 0
    v_mov_b32 v210, 0
    v_mov_b32 v211, 0
    v_mov_b32 v212, 0
    v_mov_b32 v213, 0
    v_mov_b32 v214, 0
    v_mov_b32 v215, 0
    v_mov_b32 v216, 0
    v_mov_b32 v217, 0
    v_mov_b32 v218, 0
    v_mov_b32 v219, 0
    v_mov_b32 v220, 0
    v_mov_b32 v221, 0
    v_mov_b32 v222, 0
    v_mov_b32 v223, 0
    v_mov_b32 v26, 0
    v_mov_b32 v20, 0xff800000
    v_mov_b32 v27, 0
    v_mov_b32 v21, 0xff800000
    v_mov_b32 v28, 0
    v_mov_b32 v22, 0xff800000
    v_mov_b32 v29, 0
    v_mov_b32 v23, 0xff800000
slow_fb_1:
    s_add_u32 m0, s33, 0
    s_add_u32 s37, s50, 0
    buffer_load_dwordx4 v1, s[16:19], s37 offen lds
    s_add_u32 m0, s33, 1024
    s_add_u32 s37, s50, 1024
    buffer_load_dwordx4 v1, s[16:19], s37 offen lds
    s_add_u32 m0, s33, 2048
    s_add_u32 s37, s50, 2048
    buffer_load_dwordx4 v1, s[16:19], s37 offen lds
    s_add_u32 m0, s33, 3072
    s_add_u32 s37, s50, 3072
    buffer_load_dwordx4 v1, s[16:19], s37 offen lds
    s_add_u32 m0, s33, 4096
    s_add_u32 s37, s50, 4096
    buffer_load_dwordx4 v1, s[16:19], s37 offen lds
    s_add_u32 m0, s33, 5120
    s_add_u32 s37, s50, 5120
    buffer_load_dwordx4 v1, s[16:19], s37 offen lds
    s_add_u32 m0, s33, 6144
    s_add_u32 s37, s50, 6144
    buffer_load_dwordx4 v1, s[16:19], s37 offen lds
    s_add_u32 m0, s33, 7168
    s_add_u32 s37, s50, 7168
    buffer_load_dwordx4 v1, s[16:19], s37 offen lds
    s_add_u32 m0, s33, 8192
    s_add_u32 s37, s50, 2048
    buffer_load_dwordx4 v1, s[20:23], s37 offen lds
    s_add_u32 m0, s33, 9216
    s_add_u32 s37, s50, 3072
    buffer_load_dwordx4 v1, s[20:23], s37 offen lds
    s_add_u32 m0, s33, 10240
    s_add_u32 s37, s50, 4096
    buffer_load_dwordx4 v1, s[20:23], s37 offen lds
    s_add_u32 m0, s33, 11264
    s_add_u32 s37, s50, 5120
    buffer_load_dwordx4 v1, s[20:23], s37 offen lds
    s_add_u32 m0, s33, 12288
    s_add_u32 s37, s50, 6144
    buffer_load_dwordx4 v1, s[20:23], s37 offen lds
    s_add_u32 m0, s33, 13312
    s_add_u32 s37, s50, 7168
    buffer_load_dwordx4 v1, s[20:23], s37 offen lds
    s_add_u32 m0, s33, 14336
    s_add_u32 s37, s50, 8192
    buffer_load_dwordx4 v1, s[20:23], s37 offen lds
    s_add_u32 m0, s33, 15360
    s_add_u32 s37, s50, 9216
    buffer_load_dwordx4 v1, s[20:23], s37 offen lds
    s_waitcnt vmcnt(0)
    ds_read_b128 a[64:67], v8 offset:0
    ds_read_b128 a[68:71], v8 offset:64
    ds_read_b128 a[72:75], v8 offset:128
    ds_read_b128 a[76:79], v8 offset:192
    ds_read_b128 a[80:83], v8 offset:4096
    ds_read_b128 a[84:87], v8 offset:4160
    ds_read_b128 a[88:91], v8 offset:4224
    ds_read_b128 a[92:95], v8 offset:4288
    s_waitcnt lgkmcnt(0)
    ds_read_b64_tr_b16 a[96:97], v9 offset:8192
    ds_read_b64_tr_b16 a[98:99], v9 offset:12288
    ds_read_b64_tr_b16 a[100:101], v9 offset:8224
    ds_read_b64_tr_b16 a[102:103], v9 offset:12320
    ds_read_b64_tr_b16 a[104:105], v9 offset:8256
    ds_read_b64_tr_b16 a[106:107], v9 offset:12352
    ds_read_b64_tr_b16 a[108:109], v9 offset:8288
    ds_read_b64_tr_b16 a[110:111], v9 offset:12384
    ds_read_b64_tr_b16 a[112:113], v9 offset:8320
    ds_read_b64_tr_b16 a[114:115], v9 offset:12416
    ds_read_b64_tr_b16 a[116:117], v9 offset:8352
    ds_read_b64_tr_b16 a[118:119], v9 offset:12448
    ds_read_b64_tr_b16 a[120:121], v9 offset:8384
    ds_read_b64_tr_b16 a[122:123], v9 offset:12480
    ds_read_b64_tr_b16 a[124:125], v9 offset:8416
    ds_read_b64_tr_b16 a[126:127], v9 offset:12512
    s_waitcnt lgkmcnt(0)
    v_mfma_f32_16x16x32_bf16 v[40:43], a[64:67], a[0:3], 0
    v_mfma_f32_16x16x32_bf16 v[40:43], a[68:71], a[16:19], v[40:43]
    v_mfma_f32_16x16x32_bf16 v[40:43], a[72:75], a[32:35], v[40:43]
    v_mfma_f32_16x16x32_bf16 v[40:43], a[76:79], a[48:51], v[40:43]
    v_mfma_f32_16x16x32_bf16 v[44:47], a[92:95], a[48:51], 0
    v_mfma_f32_16x16x32_bf16 v[44:47], a[88:91], a[32:35], v[44:47]
    v_mfma_f32_16x16x32_bf16 v[44:47], a[84:87], a[16:19], v[44:47]
    v_mfma_f32_16x16x32_bf16 v[44:47], a[80:83], a[0:3], v[44:47]
    v_mfma_f32_16x16x32_bf16 v[52:55], a[80:83], a[4:7], 0
    v_mfma_f32_16x16x32_bf16 v[52:55], a[84:87], a[20:23], v[52:55]
    v_mfma_f32_16x16x32_bf16 v[52:55], a[88:91], a[36:39], v[52:55]
    v_mfma_f32_16x16x32_bf16 v[52:55], a[92:95], a[52:55], v[52:55]
    v_mfma_f32_16x16x32_bf16 v[48:51], a[76:79], a[52:55], 0
    v_mfma_f32_16x16x32_bf16 v[48:51], a[72:75], a[36:39], v[48:51]
    v_mfma_f32_16x16x32_bf16 v[48:51], a[68:71], a[20:23], v[48:51]
    v_mfma_f32_16x16x32_bf16 v[48:51], a[64:67], a[4:7], v[48:51]
    v_mfma_f32_16x16x32_bf16 v[56:59], a[64:67], a[8:11], 0
    v_mfma_f32_16x16x32_bf16 v[56:59], a[68:71], a[24:27], v[56:59]
    v_mfma_f32_16x16x32_bf16 v[56:59], a[72:75], a[40:43], v[56:59]
    v_mfma_f32_16x16x32_bf16 v[56:59], a[76:79], a[56:59], v[56:59]
    v_mfma_f32_16x16x32_bf16 v[60:63], a[92:95], a[56:59], 0
    v_mfma_f32_16x16x32_bf16 v[60:63], a[88:91], a[40:43], v[60:63]
    v_mfma_f32_16x16x32_bf16 v[60:63], a[84:87], a[24:27], v[60:63]
    v_mfma_f32_16x16x32_bf16 v[60:63], a[80:83], a[8:11], v[60:63]
    v_mfma_f32_16x16x32_bf16 v[68:71], a[80:83], a[12:15], 0
    v_mfma_f32_16x16x32_bf16 v[68:71], a[84:87], a[28:31], v[68:71]
    v_mfma_f32_16x16x32_bf16 v[68:71], a[88:91], a[44:47], v[68:71]
    v_mfma_f32_16x16x32_bf16 v[68:71], a[92:95], a[60:63], v[68:71]
    v_mfma_f32_16x16x32_bf16 v[64:67], a[76:79], a[60:63], 0
    v_mfma_f32_16x16x32_bf16 v[64:67], a[72:75], a[44:47], v[64:67]
    v_mfma_f32_16x16x32_bf16 v[64:67], a[68:71], a[28:31], v[64:67]
    v_mfma_f32_16x16x32_bf16 v[64:67], a[64:67], a[12:15], v[64:67]
    v_max3_f32 v72, v40, v41, v42
    v_max3_f32 v73, v43, v44, v45
    v_max3_f32 v72, v72, v46, v47
    v_max3_f32 v72, v72, v73, v20
    v_mov_b32 v73, v72
    s_nop 1
    v_permlane16_swap_b32 v72, v73
    v_max_f32 v72, v72, v73
    v_mov_b32 v73, v72
    s_nop 1
    v_permlane32_swap_b32 v72, v73
    v_max_f32 v72, v72, v73
    v_sub_f32 v30, v20, v72
    v_exp_f32 v30, v30
    v_mov_b32 v20, v72
    v_mul_f32 v26, v26, v30
    v_sub_f32 v40, v40, v72
    v_sub_f32 v41, v41, v72
    v_sub_f32 v42, v42, v72
    v_sub_f32 v43, v43, v72
    v_sub_f32 v44, v44, v72
    v_sub_f32 v45, v45, v72
    v_sub_f32 v46, v46, v72
    v_sub_f32 v47, v47, v72
    v_exp_f32 v40, v40
    v_exp_f32 v41, v41
    v_exp_f32 v42, v42
    v_exp_f32 v43, v43
    v_exp_f32 v44, v44
    v_exp_f32 v45, v45
    v_exp_f32 v46, v46
    v_exp_f32 v47, v47
    v_add_f32 v26, v26, v40
    v_add_f32 v26, v26, v41
    v_add_f32 v26, v26, v42
    v_add_f32 v26, v26, v43
    v_add_f32 v26, v26, v44
    v_add_f32 v26, v26, v45
    v_add_f32 v26, v26, v46
    v_add_f32 v26, v26, v47
    v_cvt_pk_bf16_f32 v224, v40, v41
    v_cvt_pk_bf16_f32 v225, v42, v43
    v_cvt_pk_bf16_f32 v226, v44, v45
    v_cvt_pk_bf16_f32 v227, v46, v47
    v_mul_f32 v96, v96, v30
    v_mul_f32 v97, v97, v30
    v_mul_f32 v98, v98, v30
    v_mul_f32 v99, v99, v30
    v_mul_f32 v112, v112, v30
    v_mul_f32 v113, v113, v30
    v_mul_f32 v114, v114, v30
    v_mul_f32 v115, v115, v30
    v_mul_f32 v128, v128, v30
    v_mul_f32 v129, v129, v30
    v_mul_f32 v130, v130, v30
    v_mul_f32 v131, v131, v30
    v_mul_f32 v144, v144, v30
    v_mul_f32 v145, v145, v30
    v_mul_f32 v146, v146, v30
    v_mul_f32 v147, v147, v30
    v_mul_f32 v160, v160, v30
    v_mul_f32 v161, v161, v30
    v_mul_f32 v162, v162, v30
    v_mul_f32 v163, v163, v30
    v_mul_f32 v176, v176, v30
    v_mul_f32 v177, v177, v30
    v_mul_f32 v178, v178, v30
    v_mul_f32 v179, v179, v30
    v_mul_f32 v192, v192, v30
    v_mul_f32 v193, v193, v30
    v_mul_f32 v194, v194, v30
    v_mul_f32 v195, v195, v30
    v_mul_f32 v208, v208, v30
    v_mul_f32 v209, v209, v30
    v_mul_f32 v210, v210, v30
    v_mul_f32 v211, v211, v30
    v_max3_f32 v76, v48, v49, v50
    v_max3_f32 v77, v51, v52, v53
    v_max3_f32 v76, v76, v54, v55
    v_max3_f32 v76, v76, v77, v21
    v_mov_b32 v77, v76
    s_nop 1
    v_permlane16_swap_b32 v76, v77
    v_max_f32 v76, v76, v77
    v_mov_b32 v77, v76
    s_nop 1
    v_permlane32_swap_b32 v76, v77
    v_max_f32 v76, v76, v77
    v_sub_f32 v31, v21, v76
    v_exp_f32 v31, v31
    v_mov_b32 v21, v76
    v_mul_f32 v27, v27, v31
    v_sub_f32 v48, v48, v76
    v_sub_f32 v49, v49, v76
    v_sub_f32 v50, v50, v76
    v_sub_f32 v51, v51, v76
    v_sub_f32 v52, v52, v76
    v_sub_f32 v53, v53, v76
    v_sub_f32 v54, v54, v76
    v_sub_f32 v55, v55, v76
    v_exp_f32 v48, v48
    v_exp_f32 v49, v49
    v_exp_f32 v50, v50
    v_exp_f32 v51, v51
    v_exp_f32 v52, v52
    v_exp_f32 v53, v53
    v_exp_f32 v54, v54
    v_exp_f32 v55, v55
    v_add_f32 v27, v27, v48
    v_add_f32 v27, v27, v49
    v_add_f32 v27, v27, v50
    v_add_f32 v27, v27, v51
    v_add_f32 v27, v27, v52
    v_add_f32 v27, v27, v53
    v_add_f32 v27, v27, v54
    v_add_f32 v27, v27, v55
    v_cvt_pk_bf16_f32 v228, v48, v49
    v_cvt_pk_bf16_f32 v229, v50, v51
    v_cvt_pk_bf16_f32 v230, v52, v53
    v_cvt_pk_bf16_f32 v231, v54, v55
    v_mul_f32 v100, v100, v31
    v_mul_f32 v101, v101, v31
    v_mul_f32 v102, v102, v31
    v_mul_f32 v103, v103, v31
    v_mul_f32 v116, v116, v31
    v_mul_f32 v117, v117, v31
    v_mul_f32 v118, v118, v31
    v_mul_f32 v119, v119, v31
    v_mul_f32 v132, v132, v31
    v_mul_f32 v133, v133, v31
    v_mul_f32 v134, v134, v31
    v_mul_f32 v135, v135, v31
    v_mul_f32 v148, v148, v31
    v_mul_f32 v149, v149, v31
    v_mul_f32 v150, v150, v31
    v_mul_f32 v151, v151, v31
    v_mul_f32 v164, v164, v31
    v_mul_f32 v165, v165, v31
    v_mul_f32 v166, v166, v31
    v_mul_f32 v167, v167, v31
    v_mul_f32 v180, v180, v31
    v_mul_f32 v181, v181, v31
    v_mul_f32 v182, v182, v31
    v_mul_f32 v183, v183, v31
    v_mul_f32 v196, v196, v31
    v_mul_f32 v197, v197, v31
    v_mul_f32 v198, v198, v31
    v_mul_f32 v199, v199, v31
    v_mul_f32 v212, v212, v31
    v_mul_f32 v213, v213, v31
    v_mul_f32 v214, v214, v31
    v_mul_f32 v215, v215, v31
    v_max3_f32 v80, v56, v57, v58
    v_max3_f32 v81, v59, v60, v61
    v_max3_f32 v80, v80, v62, v63
    v_max3_f32 v80, v80, v81, v22
    v_mov_b32 v81, v80
    s_nop 1
    v_permlane16_swap_b32 v80, v81
    v_max_f32 v80, v80, v81
    v_mov_b32 v81, v80
    s_nop 1
    v_permlane32_swap_b32 v80, v81
    v_max_f32 v80, v80, v81
    v_sub_f32 v32, v22, v80
    v_exp_f32 v32, v32
    v_mov_b32 v22, v80
    v_mul_f32 v28, v28, v32
    v_sub_f32 v56, v56, v80
    v_sub_f32 v57, v57, v80
    v_sub_f32 v58, v58, v80
    v_sub_f32 v59, v59, v80
    v_sub_f32 v60, v60, v80
    v_sub_f32 v61, v61, v80
    v_sub_f32 v62, v62, v80
    v_sub_f32 v63, v63, v80
    v_exp_f32 v56, v56
    v_exp_f32 v57, v57
    v_exp_f32 v58, v58
    v_exp_f32 v59, v59
    v_exp_f32 v60, v60
    v_exp_f32 v61, v61
    v_exp_f32 v62, v62
    v_exp_f32 v63, v63
    v_add_f32 v28, v28, v56
    v_add_f32 v28, v28, v57
    v_add_f32 v28, v28, v58
    v_add_f32 v28, v28, v59
    v_add_f32 v28, v28, v60
    v_add_f32 v28, v28, v61
    v_add_f32 v28, v28, v62
    v_add_f32 v28, v28, v63
    v_cvt_pk_bf16_f32 v232, v56, v57
    v_cvt_pk_bf16_f32 v233, v58, v59
    v_cvt_pk_bf16_f32 v234, v60, v61
    v_cvt_pk_bf16_f32 v235, v62, v63
    v_mul_f32 v104, v104, v32
    v_mul_f32 v105, v105, v32
    v_mul_f32 v106, v106, v32
    v_mul_f32 v107, v107, v32
    v_mul_f32 v120, v120, v32
    v_mul_f32 v121, v121, v32
    v_mul_f32 v122, v122, v32
    v_mul_f32 v123, v123, v32
    v_mul_f32 v136, v136, v32
    v_mul_f32 v137, v137, v32
    v_mul_f32 v138, v138, v32
    v_mul_f32 v139, v139, v32
    v_mul_f32 v152, v152, v32
    v_mul_f32 v153, v153, v32
    v_mul_f32 v154, v154, v32
    v_mul_f32 v155, v155, v32
    v_mul_f32 v168, v168, v32
    v_mul_f32 v169, v169, v32
    v_mul_f32 v170, v170, v32
    v_mul_f32 v171, v171, v32
    v_mul_f32 v184, v184, v32
    v_mul_f32 v185, v185, v32
    v_mul_f32 v186, v186, v32
    v_mul_f32 v187, v187, v32
    v_mul_f32 v200, v200, v32
    v_mul_f32 v201, v201, v32
    v_mul_f32 v202, v202, v32
    v_mul_f32 v203, v203, v32
    v_mul_f32 v216, v216, v32
    v_mul_f32 v217, v217, v32
    v_mul_f32 v218, v218, v32
    v_mul_f32 v219, v219, v32
    v_max3_f32 v84, v64, v65, v66
    v_max3_f32 v85, v67, v68, v69
    v_max3_f32 v84, v84, v70, v71
    v_max3_f32 v84, v84, v85, v23
    v_mov_b32 v85, v84
    s_nop 1
    v_permlane16_swap_b32 v84, v85
    v_max_f32 v84, v84, v85
    v_mov_b32 v85, v84
    s_nop 1
    v_permlane32_swap_b32 v84, v85
    v_max_f32 v84, v84, v85
    v_sub_f32 v33, v23, v84
    v_exp_f32 v33, v33
    v_mov_b32 v23, v84
    v_mul_f32 v29, v29, v33
    v_sub_f32 v64, v64, v84
    v_sub_f32 v65, v65, v84
    v_sub_f32 v66, v66, v84
    v_sub_f32 v67, v67, v84
    v_sub_f32 v68, v68, v84
    v_sub_f32 v69, v69, v84
    v_sub_f32 v70, v70, v84
    v_sub_f32 v71, v71, v84
    v_exp_f32 v64, v64
    v_exp_f32 v65, v65
    v_exp_f32 v66, v66
    v_exp_f32 v67, v67
    v_exp_f32 v68, v68
    v_exp_f32 v69, v69
    v_exp_f32 v70, v70
    v_exp_f32 v71, v71
    v_add_f32 v29, v29, v64
    v_add_f32 v29, v29, v65
    v_add_f32 v29, v29, v66
    v_add_f32 v29, v29, v67
    v_add_f32 v29, v29, v68
    v_add_f32 v29, v29, v69
    v_add_f32 v29, v29, v70
    v_add_f32 v29, v29, v71
    v_cvt_pk_bf16_f32 v236, v64, v65
    v_cvt_pk_bf16_f32 v237, v66, v67
    v_cvt_pk_bf16_f32 v238, v68, v69
    v_cvt_pk_bf16_f32 v239, v70, v71
    v_mul_f32 v108, v108, v33
    v_mul_f32 v109, v109, v33
    v_mul_f32 v110, v110, v33
    v_mul_f32 v111, v111, v33
    v_mul_f32 v124, v124, v33
    v_mul_f32 v125, v125, v33
    v_mul_f32 v126, v126, v33
    v_mul_f32 v127, v127, v33
    v_mul_f32 v140, v140, v33
    v_mul_f32 v141, v141, v33
    v_mul_f32 v142, v142, v33
    v_mul_f32 v143, v143, v33
    v_mul_f32 v156, v156, v33
    v_mul_f32 v157, v157, v33
    v_mul_f32 v158, v158, v33
    v_mul_f32 v159, v159, v33
    v_mul_f32 v172, v172, v33
    v_mul_f32 v173, v173, v33
    v_mul_f32 v174, v174, v33
    v_mul_f32 v175, v175, v33
    v_mul_f32 v188, v188, v33
    v_mul_f32 v189, v189, v33
    v_mul_f32 v190, v190, v33
    v_mul_f32 v191, v191, v33
    v_mul_f32 v204, v204, v33
    v_mul_f32 v205, v205, v33
    v_mul_f32 v206, v206, v33
    v_mul_f32 v207, v207, v33
    v_mul_f32 v220, v220, v33
    v_mul_f32 v221, v221, v33
    v_mul_f32 v222, v222, v33
    v_mul_f32 v223, v223, v33
    v_mfma_f32_16x16x32_bf16 v[96:99], a[96:99], v[224:227], v[96:99]
    v_mfma_f32_16x16x32_bf16 v[112:115], a[100:103], v[224:227], v[112:115]
    v_mfma_f32_16x16x32_bf16 v[128:131], a[104:107], v[224:227], v[128:131]
    v_mfma_f32_16x16x32_bf16 v[144:147], a[108:111], v[224:227], v[144:147]
    v_mfma_f32_16x16x32_bf16 v[160:163], a[112:115], v[224:227], v[160:163]
    v_mfma_f32_16x16x32_bf16 v[176:179], a[116:119], v[224:227], v[176:179]
    v_mfma_f32_16x16x32_bf16 v[192:195], a[120:123], v[224:227], v[192:195]
    v_mfma_f32_16x16x32_bf16 v[208:211], a[124:127], v[224:227], v[208:211]
    v_mfma_f32_16x16x32_bf16 v[100:103], a[96:99], v[228:231], v[100:103]
    v_mfma_f32_16x16x32_bf16 v[116:119], a[100:103], v[228:231], v[116:119]
    v_mfma_f32_16x16x32_bf16 v[132:135], a[104:107], v[228:231], v[132:135]
    v_mfma_f32_16x16x32_bf16 v[148:151], a[108:111], v[228:231], v[148:151]
    v_mfma_f32_16x16x32_bf16 v[164:167], a[112:115], v[228:231], v[164:167]
    v_mfma_f32_16x16x32_bf16 v[180:183], a[116:119], v[228:231], v[180:183]
    v_mfma_f32_16x16x32_bf16 v[196:199], a[120:123], v[228:231], v[196:199]
    v_mfma_f32_16x16x32_bf16 v[212:215], a[124:127], v[228:231], v[212:215]
    v_mfma_f32_16x16x32_bf16 v[104:107], a[96:99], v[232:235], v[104:107]
    v_mfma_f32_16x16x32_bf16 v[120:123], a[100:103], v[232:235], v[120:123]
    v_mfma_f32_16x16x32_bf16 v[136:139], a[104:107], v[232:235], v[136:139]
    v_mfma_f32_16x16x32_bf16 v[152:155], a[108:111], v[232:235], v[152:155]
    v_mfma_f32_16x16x32_bf16 v[168:171], a[112:115], v[232:235], v[168:171]
    v_mfma_f32_16x16x32_bf16 v[184:187], a[116:119], v[232:235], v[184:187]
    v_mfma_f32_16x16x32_bf16 v[200:203], a[120:123], v[232:235], v[200:203]
    v_mfma_f32_16x16x32_bf16 v[216:219], a[124:127], v[232:235], v[216:219]
    v_mfma_f32_16x16x32_bf16 v[108:111], a[96:99], v[236:239], v[108:111]
    v_mfma_f32_16x16x32_bf16 v[124:127], a[100:103], v[236:239], v[124:127]
    v_mfma_f32_16x16x32_bf16 v[140:143], a[104:107], v[236:239], v[140:143]
    v_mfma_f32_16x16x32_bf16 v[156:159], a[108:111], v[236:239], v[156:159]
    v_mfma_f32_16x16x32_bf16 v[172:175], a[112:115], v[236:239], v[172:175]
    v_mfma_f32_16x16x32_bf16 v[188:191], a[116:119], v[236:239], v[188:191]
    v_mfma_f32_16x16x32_bf16 v[204:207], a[120:123], v[236:239], v[204:207]
    v_mfma_f32_16x16x32_bf16 v[220:223], a[124:127], v[236:239], v[220:223]
    s_add_u32 s50, s50, 8192
    s_cmp_lt_u32 s50, 0x80000
    s_cbranch_scc1 slow_fb_1
    v_mov_b32 v72, v26
    s_nop 1
    v_permlane16_swap_b32 v26, v72
    v_add_f32 v26, v26, v72
    v_mov_b32 v72, v26
    s_nop 1
    v_permlane32_swap_b32 v26, v72
    v_add_f32 v26, v26, v72
    v_rcp_f32 v72, v26
    s_lshl_b32 s38, s53, 14
    s_add_u32 s38, s38, s40
    v_mul_f32 v96, v96, v72
    v_mul_f32 v97, v97, v72
    v_mul_f32 v98, v98, v72
    v_mul_f32 v99, v99, v72
    v_cvt_pk_bf16_f32 v40, v96, v97
    v_cvt_pk_bf16_f32 v41, v98, v99
    v_mul_f32 v112, v112, v72
    v_mul_f32 v113, v113, v72
    v_mul_f32 v114, v114, v72
    v_mul_f32 v115, v115, v72
    v_cvt_pk_bf16_f32 v42, v112, v113
    v_cvt_pk_bf16_f32 v43, v114, v115
    buffer_store_dwordx4 v[40:43], v1, s[28:31], s38 offen sc1
    s_add_u32 s38, s38, 4096
    v_mul_f32 v128, v128, v72
    v_mul_f32 v129, v129, v72
    v_mul_f32 v130, v130, v72
    v_mul_f32 v131, v131, v72
    v_cvt_pk_bf16_f32 v44, v128, v129
    v_cvt_pk_bf16_f32 v45, v130, v131
    v_mul_f32 v144, v144, v72
    v_mul_f32 v145, v145, v72
    v_mul_f32 v146, v146, v72
    v_mul_f32 v147, v147, v72
    v_cvt_pk_bf16_f32 v46, v144, v145
    v_cvt_pk_bf16_f32 v47, v146, v147
    buffer_store_dwordx4 v[44:47], v1, s[28:31], s38 offen sc1
    s_add_u32 s38, s38, 4096
    v_mul_f32 v160, v160, v72
    v_mul_f32 v161, v161, v72
    v_mul_f32 v162, v162, v72
    v_mul_f32 v163, v163, v72
    v_cvt_pk_bf16_f32 v40, v160, v161
    v_cvt_pk_bf16_f32 v41, v162, v163
    v_mul_f32 v176, v176, v72
    v_mul_f32 v177, v177, v72
    v_mul_f32 v178, v178, v72
    v_mul_f32 v179, v179, v72
    v_cvt_pk_bf16_f32 v42, v176, v177
    v_cvt_pk_bf16_f32 v43, v178, v179
    buffer_store_dwordx4 v[40:43], v1, s[28:31], s38 offen sc1
    s_add_u32 s38, s38, 4096
    v_mul_f32 v192, v192, v72
    v_mul_f32 v193, v193, v72
    v_mul_f32 v194, v194, v72
    v_mul_f32 v195, v195, v72
    v_cvt_pk_bf16_f32 v44, v192, v193
    v_cvt_pk_bf16_f32 v45, v194, v195
    v_mul_f32 v208, v208, v72
    v_mul_f32 v209, v209, v72
    v_mul_f32 v210, v210, v72
    v_mul_f32 v211, v211, v72
    v_cvt_pk_bf16_f32 v46, v208, v209
    v_cvt_pk_bf16_f32 v47, v210, v211
    buffer_store_dwordx4 v[44:47], v1, s[28:31], s38 offen sc1
    v_mov_b32 v76, v27
    s_nop 1
    v_permlane16_swap_b32 v27, v76
    v_add_f32 v27, v27, v76
    v_mov_b32 v76, v27
    s_nop 1
    v_permlane32_swap_b32 v27, v76
    v_add_f32 v27, v27, v76
    v_rcp_f32 v76, v27
    s_lshl_b32 s37, s53, 14
    s_add_u32 s37, s37, s41
    v_pk_mul_f32 v[100:101], v[100:101], v[76:77] op_sel_hi:[1,0]
    v_pk_mul_f32 v[102:103], v[102:103], v[76:77] op_sel_hi:[1,0]
    v_cvt_pk_bf16_f32 v48, v100, v101
    v_cvt_pk_bf16_f32 v49, v102, v103
    v_pk_mul_f32 v[116:117], v[116:117], v[76:77] op_sel_hi:[1,0]
    v_pk_mul_f32 v[118:119], v[118:119], v[76:77] op_sel_hi:[1,0]
    v_cvt_pk_bf16_f32 v50, v116, v117
    v_cvt_pk_bf16_f32 v51, v118, v119
    buffer_store_dwordx4 v[48:51], v1, s[28:31], s37 offen sc1
    s_add_u32 s37, s37, 4096
    v_pk_mul_f32 v[132:133], v[132:133], v[76:77] op_sel_hi:[1,0]
    v_pk_mul_f32 v[134:135], v[134:135], v[76:77] op_sel_hi:[1,0]
    v_cvt_pk_bf16_f32 v52, v132, v133
    v_cvt_pk_bf16_f32 v53, v134, v135
    v_pk_mul_f32 v[148:149], v[148:149], v[76:77] op_sel_hi:[1,0]
    v_pk_mul_f32 v[150:151], v[150:151], v[76:77] op_sel_hi:[1,0]
    v_cvt_pk_bf16_f32 v54, v148, v149
    v_cvt_pk_bf16_f32 v55, v150, v151
    buffer_store_dwordx4 v[52:55], v1, s[28:31], s37 offen sc1
    s_add_u32 s37, s37, 4096
    v_pk_mul_f32 v[164:165], v[164:165], v[76:77] op_sel_hi:[1,0]
    v_pk_mul_f32 v[166:167], v[166:167], v[76:77] op_sel_hi:[1,0]
    v_cvt_pk_bf16_f32 v48, v164, v165
    v_cvt_pk_bf16_f32 v49, v166, v167
    v_pk_mul_f32 v[180:181], v[180:181], v[76:77] op_sel_hi:[1,0]
    v_pk_mul_f32 v[182:183], v[182:183], v[76:77] op_sel_hi:[1,0]
    v_cvt_pk_bf16_f32 v50, v180, v181
    v_cvt_pk_bf16_f32 v51, v182, v183
    buffer_store_dwordx4 v[48:51], v1, s[28:31], s37 offen sc1
    s_add_u32 s37, s37, 4096
    v_pk_mul_f32 v[196:197], v[196:197], v[76:77] op_sel_hi:[1,0]
    v_pk_mul_f32 v[198:199], v[198:199], v[76:77] op_sel_hi:[1,0]
    v_cvt_pk_bf16_f32 v52, v196, v197
    v_cvt_pk_bf16_f32 v53, v198, v199
    v_pk_mul_f32 v[212:213], v[212:213], v[76:77] op_sel_hi:[1,0]
    v_pk_mul_f32 v[214:215], v[214:215], v[76:77] op_sel_hi:[1,0]
    v_cvt_pk_bf16_f32 v54, v212, v213
    v_cvt_pk_bf16_f32 v55, v214, v215
    buffer_store_dwordx4 v[52:55], v1, s[28:31], s37 offen sc1
    v_mov_b32 v80, v28
    s_nop 1
    v_permlane16_swap_b32 v28, v80
    v_add_f32 v28, v28, v80
    v_mov_b32 v80, v28
    s_nop 1
    v_permlane32_swap_b32 v28, v80
    v_add_f32 v28, v28, v80
    v_rcp_f32 v80, v28
    s_lshl_b32 s38, s53, 14
    s_add_u32 s38, s38, s42
    v_pk_mul_f32 v[104:105], v[104:105], v[80:81] op_sel_hi:[1,0]
    v_pk_mul_f32 v[106:107], v[106:107], v[80:81] op_sel_hi:[1,0]
    v_cvt_pk_bf16_f32 v56, v104, v105
    v_cvt_pk_bf16_f32 v57, v106, v107
    v_pk_mul_f32 v[120:121], v[120:121], v[80:81] op_sel_hi:[1,0]
    v_pk_mul_f32 v[122:123], v[122:123], v[80:81] op_sel_hi:[1,0]
    v_cvt_pk_bf16_f32 v58, v120, v121
    v_cvt_pk_bf16_f32 v59, v122, v123
    buffer_store_dwordx4 v[56:59], v1, s[28:31], s38 offen sc1
    s_add_u32 s38, s38, 4096
    v_pk_mul_f32 v[136:137], v[136:137], v[80:81] op_sel_hi:[1,0]
    v_pk_mul_f32 v[138:139], v[138:139], v[80:81] op_sel_hi:[1,0]
    v_cvt_pk_bf16_f32 v60, v136, v137
    v_cvt_pk_bf16_f32 v61, v138, v139
    v_pk_mul_f32 v[152:153], v[152:153], v[80:81] op_sel_hi:[1,0]
    v_pk_mul_f32 v[154:155], v[154:155], v[80:81] op_sel_hi:[1,0]
    v_cvt_pk_bf16_f32 v62, v152, v153
    v_cvt_pk_bf16_f32 v63, v154, v155
    buffer_store_dwordx4 v[60:63], v1, s[28:31], s38 offen sc1
    s_add_u32 s38, s38, 4096
    v_pk_mul_f32 v[168:169], v[168:169], v[80:81] op_sel_hi:[1,0]
    v_pk_mul_f32 v[170:171], v[170:171], v[80:81] op_sel_hi:[1,0]
    v_cvt_pk_bf16_f32 v56, v168, v169
    v_cvt_pk_bf16_f32 v57, v170, v171
    v_pk_mul_f32 v[184:185], v[184:185], v[80:81] op_sel_hi:[1,0]
    v_pk_mul_f32 v[186:187], v[186:187], v[80:81] op_sel_hi:[1,0]
    v_cvt_pk_bf16_f32 v58, v184, v185
    v_cvt_pk_bf16_f32 v59, v186, v187
    buffer_store_dwordx4 v[56:59], v1, s[28:31], s38 offen sc1
    s_add_u32 s38, s38, 4096
    v_pk_mul_f32 v[200:201], v[200:201], v[80:81] op_sel_hi:[1,0]
    v_pk_mul_f32 v[202:203], v[202:203], v[80:81] op_sel_hi:[1,0]
    v_cvt_pk_bf16_f32 v60, v200, v201
    v_cvt_pk_bf16_f32 v61, v202, v203
    v_pk_mul_f32 v[216:217], v[216:217], v[80:81] op_sel_hi:[1,0]
    v_pk_mul_f32 v[218:219], v[218:219], v[80:81] op_sel_hi:[1,0]
    v_cvt_pk_bf16_f32 v62, v216, v217
    v_cvt_pk_bf16_f32 v63, v218, v219
    buffer_store_dwordx4 v[60:63], v1, s[28:31], s38 offen sc1
    v_mov_b32 v84, v29
    s_nop 1
    v_permlane16_swap_b32 v29, v84
    v_add_f32 v29, v29, v84
    v_mov_b32 v84, v29
    s_nop 1
    v_permlane32_swap_b32 v29, v84
    v_add_f32 v29, v29, v84
    v_rcp_f32 v84, v29
    s_lshl_b32 s37, s53, 14
    s_add_u32 s37, s37, s43
    v_pk_mul_f32 v[108:109], v[108:109], v[84:85] op_sel_hi:[1,0]
    v_pk_mul_f32 v[110:111], v[110:111], v[84:85] op_sel_hi:[1,0]
    v_cvt_pk_bf16_f32 v64, v108, v109
    v_cvt_pk_bf16_f32 v65, v110, v111
    v_pk_mul_f32 v[124:125], v[124:125], v[84:85] op_sel_hi:[1,0]
    v_pk_mul_f32 v[126:127], v[126:127], v[84:85] op_sel_hi:[1,0]
    v_cvt_pk_bf16_f32 v66, v124, v125
    v_cvt_pk_bf16_f32 v67, v126, v127
    buffer_store_dwordx4 v[64:67], v1, s[28:31], s37 offen sc1
    s_add_u32 s37, s37, 4096
    v_pk_mul_f32 v[140:141], v[140:141], v[84:85] op_sel_hi:[1,0]
    v_pk_mul_f32 v[142:143], v[142:143], v[84:85] op_sel_hi:[1,0]
    v_cvt_pk_bf16_f32 v68, v140, v141
    v_cvt_pk_bf16_f32 v69, v142, v143
    v_pk_mul_f32 v[156:157], v[156:157], v[84:85] op_sel_hi:[1,0]
    v_pk_mul_f32 v[158:159], v[158:159], v[84:85] op_sel_hi:[1,0]
    v_cvt_pk_bf16_f32 v70, v156, v157
    v_cvt_pk_bf16_f32 v71, v158, v159
    buffer_store_dwordx4 v[68:71], v1, s[28:31], s37 offen sc1
    s_add_u32 s37, s37, 4096
    v_pk_mul_f32 v[172:173], v[172:173], v[84:85] op_sel_hi:[1,0]
    v_pk_mul_f32 v[174:175], v[174:175], v[84:85] op_sel_hi:[1,0]
    v_cvt_pk_bf16_f32 v64, v172, v173
    v_cvt_pk_bf16_f32 v65, v174, v175
    v_pk_mul_f32 v[188:189], v[188:189], v[84:85] op_sel_hi:[1,0]
    v_pk_mul_f32 v[190:191], v[190:191], v[84:85] op_sel_hi:[1,0]
    v_cvt_pk_bf16_f32 v66, v188, v189
    v_cvt_pk_bf16_f32 v67, v190, v191
    buffer_store_dwordx4 v[64:67], v1, s[28:31], s37 offen sc1
    s_add_u32 s37, s37, 4096
    v_pk_mul_f32 v[204:205], v[204:205], v[84:85] op_sel_hi:[1,0]
    v_pk_mul_f32 v[206:207], v[206:207], v[84:85] op_sel_hi:[1,0]
    v_cvt_pk_bf16_f32 v68, v204, v205
    v_cvt_pk_bf16_f32 v69, v206, v207
    v_pk_mul_f32 v[220:221], v[220:221], v[84:85] op_sel_hi:[1,0]
    v_pk_mul_f32 v[222:223], v[222:223], v[84:85] op_sel_hi:[1,0]
    v_cvt_pk_bf16_f32 v70, v220, v221
    v_cvt_pk_bf16_f32 v71, v222, v223
    buffer_store_dwordx4 v[68:71], v1, s[28:31], s37 offen sc1
    s_mov_b64 s[82:83], -1
    s_branch ok_k1_8
.p2align 8
.fill 5184, 4, 0xbf800000
.section .rodata,"a"
.p2align 6
.amdhsa_kernel recurrent_scan__gqa_block_cached__glu_gated_geglu__prompt_kernel
  .amdhsa_next_free_vgpr 512
  .amdhsa_next_free_sgpr 102
  .amdhsa_accum_offset 256
  .amdhsa_group_segment_fixed_size 0
  .amdhsa_kernarg_size 96
  .amdhsa_user_sgpr_count 2
  .amdhsa_user_sgpr_kernarg_segment_ptr 1
  .amdhsa_system_sgpr_workgroup_id_x 1
.end_amdhsa_kernel
```
